```python
import torch

def _softmax(x, axis=-1):
    return torch.softmax(x, dim=axis)
def _gelu(x):
    return torch.nn.functional.gelu(x, approximate="tanh")
def _silu(x):
    return torch.nn.functional.silu(x)
def _sigmoid(x):
    return torch.sigmoid(x)
def _layernorm(x, axis=-1, eps=1e-5):
    m = x.mean(dim=axis, keepdim=True)
    v = x.var(dim=axis, keepdim=True, unbiased=False)
    return (x - m) / torch.sqrt(v + eps)
def _scatter_add(tgt, idx, src, axis=0):
    return tgt.clone().index_add_(axis, idx, src)
def _segment_sum(src, seg, n):
    out = torch.zeros((n,) + src.shape[1:], dtype=src.dtype)
    return out.index_add_(0, seg, src)
def _pad(x, pw):
    flat = tuple(v for pair in reversed(pw) for v in pair)
    return torch.nn.functional.pad(x, flat)

kernel_name = 'recurrent_scan__sliding_block_cached__mixer_s_mlp__prompt'

def setup_inputs():

    _w = (lambda a: (lambda t: t.to(torch.bfloat16) if t.is_floating_point() else t)(torch.as_tensor(a)))
    def _A_setup():
        B, Sq, D = 1, 2048, 512
        Hq, Hkv, Sk, Dh = 32, 32, 2048, 128
        assert Hq % Hkv == 0, (Hq, Hkv)
        return {
            "x": _w((lambda *s: torch.randn(*s, dtype=torch.bfloat16) * 0.05)(B, Sq, D)),
            "k_cache": _w((lambda *s: torch.randn(*s, dtype=torch.bfloat16) * 0.8)(B, Hkv, Sk, Dh)),
            "v_cache": _w((lambda *s: torch.randn(*s, dtype=torch.bfloat16) * 0.8)(B, Hkv, Sk, Dh)),
            "wq": _w((lambda *s: torch.randn(*s, dtype=torch.bfloat16) * 0.8)(D, Hq * Dh) * (D ** -0.5)),
            "wo": _w((lambda *s: torch.randn(*s, dtype=torch.bfloat16) * 0.8)(Hq * Dh, D) * ((Hq * Dh) ** -0.5)),
        }
    _A_in = _A_setup()

    def _B_setup():
        B, S, D, F = 1, 2048, 512, 1376
        return {
            "x":  _w((lambda *s: torch.randn(*s, dtype=torch.bfloat16) * 0.05)(B, S, D)),
            "w1": _w((lambda *s: torch.randn(*s, dtype=torch.bfloat16) * 3.2)(D, D) * (D ** -0.5)),
            "w2": _w((lambda *s: torch.randn(*s, dtype=torch.bfloat16) * 3.2)(D, D) * (D ** -0.5)),
            "w3": _w((lambda *s: torch.randn(*s, dtype=torch.bfloat16) * 3.2)(D, F) * (D ** -0.5)),
            "w4": _w((lambda *s: torch.randn(*s, dtype=torch.bfloat16) * 3.2)(F, D) * (F ** -0.5)),
        }
    _B_in = _B_setup()

    return {
        "A_x": _A_in["x"],
        "A_k_cache": _A_in["k_cache"],
        "A_v_cache": _A_in["v_cache"],
        "A_wq": _A_in["wq"],
        "A_wo": _A_in["wo"],
        "B_x": _B_in["x"],
        "B_w1": _B_in["w1"],
        "B_w2": _B_in["w2"],
        "B_w3": _B_in["w3"],
        "B_w4": _B_in["w4"],
    }

def reference(A_x, A_k_cache, A_v_cache, A_wq, A_wo, B_x, B_w1, B_w2, B_w3, B_w4):
    def _A_ref(x, k_cache, v_cache, wq, wo):
        B, Sq, D = x.shape
        Hq, Dh = 32, 128
        Hkv, Sk = k_cache.shape[1], k_cache.shape[2]
        W = min(4096, max(256, Sk // 4))
        rep = Hq // Hkv
        q = (lambda x, *d: x.permute(*d))((x @ wq).reshape(B, Sq, Hq, Dh), 0, 2, 1, 3)
        k = (lambda x, n, axis: torch.repeat_interleave(x, n, dim=axis))(k_cache[:, :, Sk - W:, :], rep, axis=1)
        v = (lambda x, n, axis: torch.repeat_interleave(x, n, dim=axis))(v_cache[:, :, Sk - W:, :], rep, axis=1)
        scores = torch.einsum("bhqd,bhkd->bhqk", q, k) * (Dh ** -0.5)
        p = _softmax(scores, axis=-1)
        o = torch.einsum("bhqk,bhkd->bhqd", p, v)
        return (lambda x, *d: x.permute(*d))(o, 0, 2, 1, 3).reshape(B, Sq, Hq * Dh) @ wo

    def _B_ref(x, w1, w2, w3, w4):
        B, S, D = x.shape
        h = _gelu(_layernorm(x, axis=-1) @ w1)
        c = D // 4
        g0 = _pad(h[:, :, 0*c:1*c], ((0, 0), (1, 0), (0, 0)))[:, :S, :]
        g1 = _pad(h[:, :, 1*c:2*c], ((0, 0), (0, 1), (0, 0)))[:, 1:, :]
        g2 = _pad(h[:, :, 2*c:3*c], ((0, 0), (2, 0), (0, 0)))[:, :S, :]
        g3 = _pad(h[:, :, 3*c:   ], ((0, 0), (0, 2), (0, 0)))[:, 2:, :]
        hs = torch.concatenate([g0, g1, g2, g3], axis=-1) @ w2
        x1 = x + hs
        h2 = _gelu(_layernorm(x1, axis=-1) @ w3) @ w4
        return x1 + h2

    x = A_x
    xn = _layernorm(x, axis=-1)
    s = _A_ref(xn, A_k_cache, A_v_cache, A_wq, A_wo)
    g = _silu(_B_ref(xn, B_w1, B_w2, B_w3, B_w4))
    return x + s * g
```

```asm
; @launch grid=(256,1,1) block=(256,1,1) lds=163840
.amdgcn_target "amdgcn-amd-amdhsa--gfx950"
.text
.p2align 12
.globl recurrent_scan__sliding_block_cached__mixer_s_mlp__prompt_kernel
.p2align 8
.type recurrent_scan__sliding_block_cached__mixer_s_mlp__prompt_kernel,@function
recurrent_scan__sliding_block_cached__mixer_s_mlp__prompt_kernel:
    s_cmp_ge_u32 s2, 0x100
    s_cbranch_scc1 L_end
    s_load_dwordx2 s[32:33], s[0:1], 0
    s_load_dwordx2 s[44:45], s[0:1], 24
    s_load_dwordx2 s[52:53], s[0:1], 48
    s_load_dwordx2 s[76:77], s[0:1], 96
    s_load_dwordx2 s[36:37], s[0:1], 8
    s_load_dwordx2 s[40:41], s[0:1], 16
    s_load_dwordx2 s[48:49], s[0:1], 32
    s_load_dwordx2 s[56:57], s[0:1], 56
    s_load_dwordx2 s[60:61], s[0:1], 64
    s_load_dwordx2 s[64:65], s[0:1], 72
    s_load_dwordx2 s[68:69], s[0:1], 80
    s_load_dwordx2 s[72:73], s[0:1], 88
    s_load_dwordx2 s[80:81], s[0:1], 96
    v_lshrrev_b32 v50, 6, v0
    v_lshlrev_b32 v51, 4, v0
    v_readfirstlane_b32 s5, v50
    v_and_b32 v0, 63, v0
    s_getpc_b64 s[84:85]
    s_and_b32 s84, s84, 0xffffff00
    s_mov_b32 s86, 63232
    s_mov_b32 s87, 0x20000
    s_lshr_b32 s24, s2, 3
    s_lshl_b32 s24, s24, 12
    buffer_load_dwordx4 a[252:255], v51, s[84:87], s24 offen
    s_and_b32 s24, s2, 7
    s_lshr_b32 s25, s2, 3
    s_and_b32 s3, s24, 1
    s_lshl_b32 s3, s3, 2
    s_and_b32 s27, s25, 3
    s_lshr_b32 s25, s25, 2
    s_add_u32 s3, s3, s27
    s_lshr_b32 s8, s24, 1
    s_lshl_b32 s4, s8, 3
    s_add_u32 s4, s4, s25
    s_and_b32 s6, s4, 1
    s_lshr_b32 s7, s4, 1
    s_lshr_b32 s9, s25, 1
    s_mov_b32 s10, 0
    s_lshl_b32 s11, s3, 3
    s_lshl_b32 s24, s5, 1
    s_add_u32 s11, s11, s24
    s_add_u32 s11, s11, s6
    s_lshl_b32 s23, s3, 12
    s_mov_b32 s34, 2097152
    s_mov_b32 s35, 0x20000
    s_mov_b32 s46, 4194304
    s_mov_b32 s47, 0x20000
    s_mov_b32 s78, 50331648
    s_mov_b32 s79, 0x20000
    s_lshl_b32 s16, s5, 13
    s_lshl_b32 s17, s5, 12
    s_add_u32 s17, s17, 98304
    v_lshlrev_b32 v25, 4, v0
    v_lshrrev_b32 v50, 4, v0
    v_lshrrev_b32 v51, 3, v0
    v_and_b32 v52, 7, v0
    v_xor_b32 v52, v52, v50
    v_lshlrev_b32 v52, 4, v52
    v_lshl_add_u32 v52, v51, 10, v52
    s_lshl_b32 s24, s3, 18
    s_lshl_b32 s25, s5, 16
    s_add_u32 s24, s24, s25
    s_lshl_b32 s25, s6, 15
    s_add_u32 s27, s24, s25
    s_xor_b32 s25, s25, 0x8000
    s_add_u32 s28, s24, s25
    v_add_u32 v64, s27, v52
    v_add_u32 v68, s28, v52
    v_xor_b32 v65, 64, v64
    v_add_u32 v66, 14336, v64
    v_add_u32 v67, 21504, v65
    v_add_u32 v65, 7168, v65
    v_xor_b32 v69, 64, v68
    v_add_u32 v70, 14336, v68
    v_add_u32 v71, 21504, v69
    v_add_u32 v69, 7168, v69
    v_and_b32 v53, 15, v0
    v_lshlrev_b32 v54, 1, v50
    v_xor_b32 v54, v53, v54
    v_lshlrev_b32 v54, 4, v54
    s_lshl_b32 s24, s5, 17
    s_lshl_b32 s25, s4, 8
    s_add_u32 s24, s24, s25
    v_lshl_add_u32 v72, v50, 13, v54
    v_add_u32 v72, s24, v72
    v_xor_b32 v74, 0x80, v72
    v_add_u32 v73, 31744, v72
    v_add_u32 v75, 95232, v74
    v_add_u32 v74, 63488, v74
    v_mov_b32 v30, 0x80000000
    s_or_b32 s24, s5, s4
    s_cmp_eq_u32 s24, 0
    s_cselect_b32 s24, 18, 0
    s_cselect_b32 s27, 1, 0
    v_lshlrev_b32 v28, 7, v0
    v_cmp_gt_u32 vcc, s24, v0
    v_mov_b32 v62, 0
    s_lshl_b32 s29, s3, 18
    v_cndmask_b32 v28, v30, v28, vcc
    s_lshl_b32 s30, s4, 13
    s_add_u32 s29, s29, s30
    s_lshl_b32 s30, s5, 11
    s_add_u32 s29, s29, s30
    s_waitcnt lgkmcnt(0)
    buffer_store_dword v62, v28, s[76:79], s23 offen sc1
    buffer_load_dwordx4 v[192:195], v25, s[32:35], s29 offen
    buffer_load_dwordx4 v[196:199], v25, s[32:35], s29 offen offset:1024
    s_add_u32 s15, s10, 0
    s_and_b32 s15, s15, 7
    s_lshl_b32 s13, s15, 19
    s_lshl_b32 s12, s15, 7
    s_add_u32 m0, s17, 0
    s_lshl_b32 s14, s15, 16
    buffer_load_dwordx4 v72, s[44:47], s13 offen offset:0 lds
    buffer_load_dwordx4 v73, s[44:47], s13 offen offset:1024 lds
    buffer_load_dwordx4 v74, s[44:47], s13 offen offset:2048 lds
    buffer_load_dwordx4 v75, s[44:47], s13 offen offset:3072 lds
    s_add_u32 m0, s16, 0
    s_nop 0
    buffer_load_dwordx4 v64, s[32:35], s12 offen offset:0 lds
    buffer_load_dwordx4 v65, s[32:35], s12 offen offset:1024 lds
    buffer_load_dwordx4 v66, s[32:35], s12 offen offset:2048 lds
    buffer_load_dwordx4 v67, s[32:35], s12 offen offset:3072 lds
    s_add_u32 m0, s16, 4096
    s_nop 0
    buffer_load_dwordx4 v68, s[32:35], s12 offen offset:0 lds
    buffer_load_dwordx4 v69, s[32:35], s12 offen offset:1024 lds
    buffer_load_dwordx4 v70, s[32:35], s12 offen offset:2048 lds
    buffer_load_dwordx4 v71, s[32:35], s12 offen offset:3072 lds
    s_cmp_eq_u32 s5, 0
    s_cselect_b32 s25, 1, 0
    v_cmp_gt_u32 vcc, s27, v0
    s_lshl_b32 s28, s3, 2
    v_mov_b32 v29, s28
    v_cndmask_b32 v29, v30, v29, vcc
    v_cmp_gt_u32 vcc, s25, v0
    s_nop 1
    v_cndmask_b32 v63, v30, 0, vcc
    s_lshl_b32 s18, s5, 10
    s_add_u32 s18, s18, 147456
    s_lshl_b32 s19, s5, 11
    s_add_u32 s20, s19, 131072
    s_add_u32 s19, s19, 65536
    s_mov_b32 s54, 524288
    s_mov_b32 s55, 0x20000
    s_mov_b32 s38, 131072
    s_mov_b32 s39, 0x20000
    s_mov_b32 s42, 131072
    s_mov_b32 s43, 0x20000
    s_mov_b32 s50, 4194304
    s_mov_b32 s51, 0x20000
    s_mov_b32 s58, 524288
    s_mov_b32 s59, 0x20000
    s_mov_b32 s62, 1409024
    s_mov_b32 s63, 0x20000
    s_mov_b32 s66, 1409024
    s_mov_b32 s67, 0x20000
    s_mov_b32 s70, 2097152
    s_mov_b32 s71, 0x20000
    s_mov_b32 s74, 256
    s_mov_b32 s75, 0x20000
    s_mov_b32 s82, 2097152
    s_mov_b32 s83, 0x20000
    v_lshrrev_b32 v55, 5, v0
    v_lshlrev_b32 v55, 1, v55
    v_and_b32 v56, 3, v0
    v_xor_b32 v55, v55, v56
    v_lshlrev_b32 v55, 4, v55
    v_lshrrev_b32 v51, 2, v0
    v_lshl_add_u32 v76, v51, 10, v55
    s_lshl_b32 s24, s5, 14
    s_lshl_b32 s25, s7, 6
    s_add_u32 s24, s24, s25
    v_add_u32 v76, s24, v76
    s_lshr_b32 s92, s29, 6
    s_add_u32 s92, s92, 65536
    s_lshl_b32 s24, s4, 19
    s_add_u32 s24, s24, 393216
    s_add_u32 s36, s36, s24
    s_addc_u32 s37, s37, 0
    s_add_u32 s40, s40, s24
    s_addc_u32 s41, s41, 0
    s_add_u32 s80, s80, 1048576
    s_addc_u32 s81, s81, 0
    s_lshl_b32 s24, s5, 11
    v_lshl_add_u32 v19, v50, 8, v54
    v_add_u32 v19, s24, v19
    v_xor_b32 v20, 0x80, v19
    s_and_b32 s25, s5, 1
    s_lshl_b32 s25, s25, 3
    v_xor_b32 v51, v53, v50
    v_xor_b32 v51, s25, v51
    v_lshlrev_b32 v51, 4, v51
    v_lshl_add_u32 v17, v50, 8, v51
    v_add_u32 v17, s24, v17
    v_xor_b32 v18, 64, v17
    v_bfe_u32 v51, v0, 2, 2
    v_and_b32 v52, 1, v50
    v_lshlrev_b32 v56, 3, v56
    v_lshl_add_u32 v54, v52, 2, v51
    v_lshl_add_u32 v54, v54, 5, v56
    v_lshl_add_u32 v55, v52, 5, v56
    v_lshl_add_u32 v57, v50, 3, v51
    v_lshl_add_u32 v51, v50, 2, v51
    v_lshl_add_u32 v9, v51, 8, v54
    v_add_u32 v9, 131072, v9
    v_lshl_add_u32 v48, v51, 6, v55
    v_add_u32 v48, 98304, v48
    v_xor_b32 v49, 32, v48
    v_lshl_add_u32 v81, v57, 8, v54
    s_lshl_b32 s24, s5, 6
    v_xor_b32 v81, s24, v81
    v_add_u32 v81, 98304, v81
    v_xor_b32 v10, 32, v9
    v_xor_b32 v82, 32, v81
    v_xor_b32 v11, 64, v9
    v_xor_b32 v83, 64, v81
    v_xor_b32 v12, 96, v9
    v_xor_b32 v84, 96, v81
    v_xor_b32 v13, 128, v9
    v_xor_b32 v85, 128, v81
    v_xor_b32 v14, 160, v9
    v_xor_b32 v86, 160, v81
    v_xor_b32 v15, 192, v9
    v_xor_b32 v87, 192, v81
    v_xor_b32 v16, 224, v9
    v_xor_b32 v88, 224, v81
    v_lshl_add_u32 v89, v57, 6, v55
    v_add_u32 v89, 147456, v89
    v_xor_b32 v90, 32, v89
    s_and_b32 s25, s5, 1
    s_lshl_b32 s25, s25, 5
    s_lshr_b32 s27, s5, 1
    s_lshl_b32 s27, s27, 11
    v_xor_b32 v91, s25, v89
    v_add_u32 v91, s27, v91
    v_lshrrev_b32 v51, 1, v53
    v_xor_b32 v51, v51, v50
    v_lshlrev_b32 v51, 4, v51
    v_lshl_add_u32 v51, v53, 7, v51
    v_add_u32 v77, s16, v51
    v_xor_b32 v78, 64, v77
    v_add_u32 v79, 0x10000, v77
    v_add_u32 v80, 0x10000, v78
    v_lshrrev_b32 v51, 1, v50
    v_xor_b32 v51, v51, v53
    v_lshlrev_b32 v51, 4, v51
    v_lshl_add_u32 v51, v52, 3, v51
    v_lshl_add_u32 v51, v53, 8, v51
    v_xor_b32 v51, s24, v51
    v_add_u32 v1, 65536, v51
    v_xor_b32 v2, 32, v1
    v_xor_b32 v3, 64, v1
    v_xor_b32 v4, 96, v1
    v_xor_b32 v5, 128, v1
    v_xor_b32 v6, 160, v1
    v_xor_b32 v7, 192, v1
    v_xor_b32 v8, 224, v1
    v_mov_b32 v61, 0xbdd2d3e8
    v_mov_b32 v51, 0x3f803f80
    v_mov_b32 v21, 0
    v_accvgpr_write_b32 a112, v51
    v_mov_b32 v22, 0
    v_accvgpr_write_b32 a113, v51
    v_mov_b32 v23, 0
    v_accvgpr_write_b32 a114, v51
    v_mov_b32 v24, 0
    v_accvgpr_write_b32 a115, v51
    v_mov_b32 v62, 1
    v_lshlrev_b32 v92, 2, v53
    s_lshl_b32 s24, s5, 7
    s_add_u32 s24, s24, 159744
    v_add_u32 v92, s24, v92
    v_xor_b32 v93, 128, v92
    v_xor_b32 v94, 256, v92
    v_xor_b32 v95, 384, v92
    s_lshl_b32 s24, s11, 5
    v_add_u32 v51, s24, v53
    v_and_b32 v52, 48, v0
    v_add_u32 v54, -1, v51
    v_and_or_b32 v36, v54, 15, v52
    v_ashrrev_i32 v54, 4, v54
    v_lshlrev_b32 v36, 4, v36
    v_lshl_add_u32 v36, v54, 14, v36
    v_add_u32 v54, 15, v51
    v_and_or_b32 v37, v54, 15, v52
    v_ashrrev_i32 v54, 4, v54
    v_lshlrev_b32 v37, 4, v37
    v_lshl_add_u32 v37, v54, 14, v37
    v_add_u32 v54, 1, v51
    v_and_or_b32 v38, v54, 15, v52
    v_ashrrev_i32 v54, 4, v54
    v_lshlrev_b32 v38, 4, v38
    v_lshl_add_u32 v38, v54, 14, v38
    v_add_u32 v54, 17, v51
    v_and_or_b32 v39, v54, 15, v52
    v_ashrrev_i32 v54, 4, v54
    v_lshlrev_b32 v39, 4, v39
    v_lshl_add_u32 v39, v54, 14, v39
    v_add_u32 v54, -2, v51
    v_and_or_b32 v40, v54, 15, v52
    v_ashrrev_i32 v54, 4, v54
    v_lshlrev_b32 v40, 4, v40
    v_lshl_add_u32 v40, v54, 14, v40
    v_add_u32 v54, 14, v51
    v_and_or_b32 v41, v54, 15, v52
    v_ashrrev_i32 v54, 4, v54
    v_lshlrev_b32 v41, 4, v41
    v_lshl_add_u32 v41, v54, 14, v41
    v_add_u32 v54, 2, v51
    v_and_or_b32 v42, v54, 15, v52
    v_ashrrev_i32 v54, 4, v54
    v_lshlrev_b32 v42, 4, v42
    v_lshl_add_u32 v42, v54, 14, v42
    v_add_u32 v54, 18, v51
    v_and_or_b32 v43, v54, 15, v52
    v_ashrrev_i32 v54, 4, v54
    v_lshlrev_b32 v43, 4, v43
    v_lshl_add_u32 v43, v54, 14, v43
    v_lshlrev_b32 v59, 3, v50
    v_lshl_add_u32 v59, v53, 10, v59
    s_lshl_b32 s29, s7, 6
    s_mul_i32 s30, s5, 131072
    s_add_u32 s30, s30, s29
    v_lshrrev_b32 v44, 2, v0
    v_mul_u32_u24 v44, 1024, v44
    v_bfe_u32 v45, v0, 4, 1
    v_and_b32 v46, 3, v0
    v_lshlrev_b32 v45, 1, v45
    v_xor_b32 v45, v45, v46
    v_lshl_add_u32 v44, v45, 4, v44
    v_add_u32 v44, s30, v44
    v_add_u32 v45, 15360, v44
    v_add_u32 v46, 30720, v44
    v_add_u32 v47, 46080, v44
    s_lshl_b32 s24, s6, 1
    s_add_u32 s24, s24, s3
    s_sub_u32 s24, s24, 1
    s_lshl_b32 s25, s24, 12
    s_cmp_lt_u32 s24, 8
    s_cselect_b32 s25, s25, s23
    v_and_b32 v51, 1, v0
    v_cmp_eq_u32 vcc, 0, v51
    v_mov_b32 v51, s23
    v_mov_b32 v52, s25
    v_cndmask_b32 v58, v52, v51, vcc
    v_cmp_gt_u32 vcc, 16, v0
    v_lshlrev_b32 v51, 7, v0
    s_lshr_b32 s24, s2, 3
    v_cndmask_b32 v27, v30, v51, vcc
    s_lshl_b32 s25, s24, 15
    s_lshl_b32 s27, s8, 20
    s_add_u32 s25, s25, s27
    s_add_u32 s0, s25, s16
    s_mul_i32 s27, s5, 11
    s_mul_i32 s28, s2, 43
    s_add_u32 s28, s28, s27
    s_lshl_b32 s1, s28, 7
    v_cmp_gt_u32 vcc, 8, v0
    v_lshlrev_b32 v55, 2, v0
    v_lshlrev_b32 v57, 4, v53
    v_cndmask_b32 v55, v30, v55, vcc
    v_cndmask_b32 v56, 0, v62, vcc
    s_lshl_b32 s95, s11, 15
    s_add_u32 s31, s95, s29
    s_lshl_b32 s25, s7, 10
    s_add_u32 s95, s95, s25
    s_lshl_b32 s97, s6, 7
    s_add_u32 s97, s97, s23
    s_mul_i32 s28, s7, 3
    s_lshl_b32 s29, s7, 1
    s_add_u32 s29, s29, 11
    s_cmp_lt_u32 s7, 11
    s_cselect_b32 s29, s28, s29
    s_lshl_b32 s91, s29, 6
    s_lshl_b32 s96, s3, 1
    s_add_u32 s96, s96, s6
    s_lshl_b32 s96, s96, 6
    s_add_u32 s96, s96, s5
    s_lshl_b32 s96, s96, 8
    s_add_u32 s96, s96, 131072
    s_lshl_b32 s93, s11, 9
    s_add_u32 s93, s93, 65536
    s_xor_b32 s94, s93, 512
    s_add_u32 m0, s18, 0
    s_nop 0
    buffer_load_dwordx4 v76, s[52:55], s14 offen lds
    s_waitcnt vmcnt(15)
    buffer_store_dword v62, v29, s[72:75], 0 offen sc1
    s_waitcnt vmcnt(15)
    v_lshlrev_b32 v224, 16, v192
    v_and_b32 v225, 0xffff0000, v192
    v_lshlrev_b32 v226, 16, v193
    v_and_b32 v227, 0xffff0000, v193
    v_lshlrev_b32 v228, 16, v194
    v_and_b32 v229, 0xffff0000, v194
    v_lshlrev_b32 v230, 16, v195
    v_and_b32 v231, 0xffff0000, v195
    s_waitcnt vmcnt(14)
    v_lshlrev_b32 v232, 16, v196
    v_and_b32 v233, 0xffff0000, v196
    v_lshlrev_b32 v234, 16, v197
    v_and_b32 v235, 0xffff0000, v197
    v_lshlrev_b32 v236, 16, v198
    v_and_b32 v237, 0xffff0000, v198
    v_lshlrev_b32 v238, 16, v199
    v_and_b32 v239, 0xffff0000, v199
    v_add_f32 v200, v224, v225
    v_add_f32 v201, v232, v233
    v_add_f32 v200, v200, v226
    v_add_f32 v201, v201, v234
    v_add_f32 v200, v200, v227
    v_add_f32 v201, v201, v235
    v_add_f32 v200, v200, v228
    v_add_f32 v201, v201, v236
    v_add_f32 v200, v200, v229
    v_add_f32 v201, v201, v237
    v_add_f32 v200, v200, v230
    v_add_f32 v201, v201, v238
    v_add_f32 v200, v200, v231
    v_add_f32 v201, v201, v239
    s_nop 0
    v_add_f32_dpp v200, v200, v200 quad_perm:[1,0,3,2] row_mask:0xf bank_mask:0xf
    v_add_f32_dpp v201, v201, v201 quad_perm:[1,0,3,2] row_mask:0xf bank_mask:0xf
    s_nop 0
    v_add_f32_dpp v200, v200, v200 quad_perm:[2,3,0,1] row_mask:0xf bank_mask:0xf
    v_add_f32_dpp v201, v201, v201 quad_perm:[2,3,0,1] row_mask:0xf bank_mask:0xf
    s_nop 0
    v_add_f32_dpp v200, v200, v200 row_half_mirror row_mask:0xf bank_mask:0xf
    v_add_f32_dpp v201, v201, v201 row_half_mirror row_mask:0xf bank_mask:0xf
    s_nop 0
    v_add_f32_dpp v200, v200, v200 row_mirror row_mask:0xf bank_mask:0xf
    v_add_f32_dpp v201, v201, v201 row_mirror row_mask:0xf bank_mask:0xf
    v_mov_b32 v202, v200
    v_mov_b32 v203, v201
    s_nop 0
    v_permlane16_swap_b32 v200, v202
    v_permlane16_swap_b32 v201, v203
    v_add_f32 v200, v200, v202
    v_add_f32 v201, v201, v203
    v_mov_b32 v202, v200
    v_mov_b32 v203, v201
    s_nop 0
    v_permlane32_swap_b32 v200, v202
    v_permlane32_swap_b32 v201, v203
    v_add_f32 v200, v200, v202
    v_add_f32 v201, v201, v203
    v_mul_f32 v200, 0x3b000000, v200
    v_mul_f32 v201, 0x3b000000, v201
    v_sub_f32 v224, v224, v200
    v_sub_f32 v232, v232, v201
    v_sub_f32 v225, v225, v200
    v_sub_f32 v233, v233, v201
    v_sub_f32 v226, v226, v200
    v_sub_f32 v234, v234, v201
    v_sub_f32 v227, v227, v200
    v_sub_f32 v235, v235, v201
    v_sub_f32 v228, v228, v200
    v_sub_f32 v236, v236, v201
    v_sub_f32 v229, v229, v200
    v_sub_f32 v237, v237, v201
    v_sub_f32 v230, v230, v200
    v_sub_f32 v238, v238, v201
    v_sub_f32 v231, v231, v200
    v_sub_f32 v239, v239, v201
    v_mul_f32 v204, v224, v224
    v_mul_f32 v205, v232, v232
    v_fmac_f32 v204, v225, v225
    v_fmac_f32 v205, v233, v233
    v_fmac_f32 v204, v226, v226
    v_fmac_f32 v205, v234, v234
    v_fmac_f32 v204, v227, v227
    v_fmac_f32 v205, v235, v235
    v_fmac_f32 v204, v228, v228
    v_fmac_f32 v205, v236, v236
    v_fmac_f32 v204, v229, v229
    v_fmac_f32 v205, v237, v237
    v_fmac_f32 v204, v230, v230
    v_fmac_f32 v205, v238, v238
    v_fmac_f32 v204, v231, v231
    v_fmac_f32 v205, v239, v239
    s_nop 0
    v_add_f32_dpp v204, v204, v204 quad_perm:[1,0,3,2] row_mask:0xf bank_mask:0xf
    v_add_f32_dpp v205, v205, v205 quad_perm:[1,0,3,2] row_mask:0xf bank_mask:0xf
    s_nop 0
    v_add_f32_dpp v204, v204, v204 quad_perm:[2,3,0,1] row_mask:0xf bank_mask:0xf
    v_add_f32_dpp v205, v205, v205 quad_perm:[2,3,0,1] row_mask:0xf bank_mask:0xf
    s_nop 0
    v_add_f32_dpp v204, v204, v204 row_half_mirror row_mask:0xf bank_mask:0xf
    v_add_f32_dpp v205, v205, v205 row_half_mirror row_mask:0xf bank_mask:0xf
    s_nop 0
    v_add_f32_dpp v204, v204, v204 row_mirror row_mask:0xf bank_mask:0xf
    v_add_f32_dpp v205, v205, v205 row_mirror row_mask:0xf bank_mask:0xf
    v_mov_b32 v202, v204
    v_mov_b32 v203, v205
    s_nop 0
    v_permlane16_swap_b32 v204, v202
    v_permlane16_swap_b32 v205, v203
    v_add_f32 v204, v204, v202
    v_add_f32 v205, v205, v203
    v_mov_b32 v202, v204
    v_mov_b32 v203, v205
    s_nop 0
    v_permlane32_swap_b32 v204, v202
    v_permlane32_swap_b32 v205, v203
    v_add_f32 v204, v204, v202
    v_add_f32 v205, v205, v203
    v_cmp_eq_u32 vcc, 0, v0
    v_mov_b32 v227, 0
    v_mov_b32 v229, 0x3727c5ac
    v_cndmask_b32 v224, v201, v200, vcc
    v_cndmask_b32 v228, v205, v204, vcc
    v_mul_f32 v228, 0x3b000000, v228
    v_add_f32 v225, v228, v229
    v_rsq_f32 v225, v225
    v_cmp_gt_u32 vcc, 2, v0
    v_mul_f32 v228, v228, v225
    v_fmac_f32 v229, v228, v225
    v_rsq_f32 v229, v229
    v_cndmask_b32 v230, v30, v25, vcc
    v_mul_f32 v226, v229, v225
    s_add_u32 s15, s10, 1
    s_and_b32 s15, s15, 7
    s_lshl_b32 s13, s15, 19
    s_lshl_b32 s12, s15, 7
    s_lshl_b32 s14, s15, 16
    s_add_u32 m0, s17, 16384
    s_nop 0
    buffer_load_dwordx4 v72, s[44:47], s13 offen offset:0 lds
    buffer_load_dwordx4 v73, s[44:47], s13 offen offset:1024 lds
    buffer_load_dwordx4 v74, s[44:47], s13 offen offset:2048 lds
    buffer_load_dwordx4 v75, s[44:47], s13 offen offset:3072 lds
    s_add_u32 m0, s16, 32768
    s_nop 0
    buffer_load_dwordx4 v64, s[32:35], s12 offen offset:0 lds
    buffer_load_dwordx4 v65, s[32:35], s12 offen offset:1024 lds
    buffer_load_dwordx4 v66, s[32:35], s12 offen offset:2048 lds
    buffer_load_dwordx4 v67, s[32:35], s12 offen offset:3072 lds
    s_add_u32 m0, s16, 36864
    s_nop 0
    buffer_load_dwordx4 v68, s[32:35], s12 offen offset:0 lds
    buffer_load_dwordx4 v69, s[32:35], s12 offen offset:1024 lds
    buffer_load_dwordx4 v70, s[32:35], s12 offen offset:2048 lds
    buffer_load_dwordx4 v71, s[32:35], s12 offen offset:3072 lds
    s_add_u32 m0, s18, 4096
    s_nop 0
    buffer_load_dwordx4 v76, s[52:55], s14 offen lds
    buffer_store_dwordx4 v[224:227], v230, s[76:79], s92 offen sc1
    s_mov_b64 exec, 0
    s_cmp_eq_u32 s5, 0
    s_cbranch_scc1 L_warm0_0
    s_cmp_eq_u32 s5, 1
    s_cbranch_scc1 L_warm0_3
    s_cmp_eq_u32 s5, 2
    s_cbranch_scc1 L_warm0_6
    s_branch L_warm0_9
L_warm_ret0:
    s_mov_b64 exec, -1
    s_waitcnt vmcnt(15)
    s_barrier
    ds_read_b128 a[40:43], v77 offset:0
    ds_read_b128 a[44:47], v77 offset:2048
    ds_read_b128 a[48:51], v77 offset:4096
    ds_read_b128 a[52:55], v77 offset:6144
    ds_read_b64_tr_b16 a[0:1], v81 offset:0
    ds_read_b64_tr_b16 a[2:3], v81 offset:1024
    ds_read_b64_tr_b16 a[4:5], v82 offset:0
    ds_read_b64_tr_b16 a[6:7], v82 offset:1024
    ds_read_b64_tr_b16 a[8:9], v83 offset:0
    ds_read_b64_tr_b16 a[10:11], v83 offset:1024
    ds_read_b64_tr_b16 a[12:13], v84 offset:0
    ds_read_b64_tr_b16 a[14:15], v84 offset:1024
    ds_read_b64_tr_b16 a[16:17], v85 offset:0
    ds_read_b64_tr_b16 a[18:19], v85 offset:1024
    ds_read_b64_tr_b16 a[20:21], v86 offset:0
    ds_read_b64_tr_b16 a[22:23], v86 offset:1024
    ds_read_b64_tr_b16 a[24:25], v87 offset:0
    ds_read_b64_tr_b16 a[26:27], v87 offset:1024
    ds_read_b64_tr_b16 a[28:29], v88 offset:0
    ds_read_b64_tr_b16 a[30:31], v88 offset:1024
    ds_read_b64_tr_b16 a[32:33], v89 offset:0
    ds_read_b64_tr_b16 a[34:35], v89 offset:256
    ds_read_b64_tr_b16 a[36:37], v90 offset:0
    ds_read_b64_tr_b16 a[38:39], v90 offset:256
    s_waitcnt lgkmcnt(15)
    v_mfma_f32_16x16x32_bf16 v[128:131], a[0:3], a[40:43], 0
    s_add_u32 s15, s10, 2
    s_and_b32 s15, s15, 7
    v_mfma_f32_16x16x32_bf16 v[160:163], a[0:3], a[44:47], 0
    s_lshl_b32 s13, s15, 19
    v_mfma_f32_16x16x32_bf16 v[192:195], a[0:3], a[48:51], 0
    s_lshl_b32 s12, s15, 7
    v_mfma_f32_16x16x32_bf16 v[224:227], a[0:3], a[52:55], 0
    s_add_u32 m0, s17, 32768
    v_mfma_f32_16x16x32_bf16 v[96:99], a[112:115], a[0:3], 0
    buffer_load_dwordx4 v72, s[44:47], s13 offen offset:0 lds
L_warm0_0:
    s_cbranch_execz L_warm0_1
    v_mfma_f32_16x16x32_bf16 v[132:135], a[4:7], a[40:43], 0
    ds_read_b64_tr_b16 a[0:1], v81 offset:8192
    ds_read_b64_tr_b16 a[2:3], v81 offset:9216
    v_mfma_f32_16x16x32_bf16 v[164:167], a[4:7], a[44:47], 0
    ds_read_b128 a[56:59], v78 offset:0
    v_mfma_f32_16x16x32_bf16 v[196:199], a[4:7], a[48:51], 0
    ds_read_b128 a[60:63], v78 offset:2048
    v_mfma_f32_16x16x32_bf16 v[228:231], a[4:7], a[52:55], 0
    buffer_load_dwordx4 v73, s[44:47], s13 offen offset:1024 lds
    v_mfma_f32_16x16x32_bf16 v[100:103], a[112:115], a[4:7], 0
    s_waitcnt lgkmcnt(15)
    v_mfma_f32_16x16x32_bf16 v[136:139], a[8:11], a[40:43], 0
    buffer_load_dwordx4 v74, s[44:47], s13 offen offset:2048 lds
    ds_read_b64_tr_b16 a[4:5], v82 offset:8192
    ds_read_b64_tr_b16 a[6:7], v82 offset:9216
    v_mfma_f32_16x16x32_bf16 v[168:171], a[8:11], a[44:47], 0
    ds_read_b128 a[64:67], v78 offset:4096
    v_mfma_f32_16x16x32_bf16 v[200:203], a[8:11], a[48:51], 0
    ds_read_b128 a[68:71], v78 offset:6144
    v_mfma_f32_16x16x32_bf16 v[232:235], a[8:11], a[52:55], 0
    buffer_load_dwordx4 v75, s[44:47], s13 offen offset:3072 lds
    v_mfma_f32_16x16x32_bf16 v[140:143], a[12:15], a[40:43], 0
    ds_read_b64_tr_b16 a[8:9], v83 offset:8192
    ds_read_b64_tr_b16 a[10:11], v83 offset:9216
    v_mfma_f32_16x16x32_bf16 v[172:175], a[12:15], a[44:47], 0
    s_add_u32 m0, s16, 65536
    v_mfma_f32_16x16x32_bf16 v[204:207], a[12:15], a[48:51], 0
    ds_read_b64_tr_b16 a[80:81], v91 offset:0
    ds_read_b64_tr_b16 a[82:83], v91 offset:256
    v_mfma_f32_16x16x32_bf16 v[236:239], a[12:15], a[52:55], 0
    buffer_load_dwordx4 v64, s[32:35], s12 offen offset:0 lds
    s_waitcnt lgkmcnt(15)
    v_mfma_f32_16x16x32_bf16 v[144:147], a[16:19], a[40:43], 0
    ds_read_b64_tr_b16 a[12:13], v84 offset:8192
    ds_read_b64_tr_b16 a[14:15], v84 offset:9216
    v_mfma_f32_16x16x32_bf16 v[176:179], a[16:19], a[44:47], 0
    buffer_load_dwordx4 v65, s[32:35], s12 offen offset:1024 lds
    v_mfma_f32_16x16x32_bf16 v[208:211], a[16:19], a[48:51], 0
    v_mfma_f32_16x16x32_bf16 v[240:243], a[16:19], a[52:55], 0
    v_mfma_f32_16x16x32_bf16 v[148:151], a[20:23], a[40:43], 0
    ds_read_b64_tr_b16 a[16:17], v85 offset:8192
    ds_read_b64_tr_b16 a[18:19], v85 offset:9216
    v_mfma_f32_16x16x32_bf16 v[180:183], a[20:23], a[44:47], 0
    buffer_load_dwordx4 v66, s[32:35], s12 offen offset:2048 lds
    v_mfma_f32_16x16x32_bf16 v[212:215], a[20:23], a[48:51], 0
    v_mfma_f32_16x16x32_bf16 v[244:247], a[20:23], a[52:55], 0
    buffer_load_dwordx4 v67, s[32:35], s12 offen offset:3072 lds
    v_mfma_f32_16x16x32_bf16 v[152:155], a[24:27], a[40:43], 0
    ds_read_b64_tr_b16 a[20:21], v86 offset:8192
    ds_read_b64_tr_b16 a[22:23], v86 offset:9216
    v_mfma_f32_16x16x32_bf16 v[184:187], a[24:27], a[44:47], 0
    s_add_u32 m0, s16, 69632
    v_mfma_f32_16x16x32_bf16 v[216:219], a[24:27], a[48:51], 0
    buffer_load_dwordx4 v68, s[32:35], s12 offen offset:0 lds
    v_mfma_f32_16x16x32_bf16 v[248:251], a[24:27], a[52:55], 0
    v_mfma_f32_16x16x32_bf16 v[156:159], a[28:31], a[40:43], 0
    ds_read_b64_tr_b16 a[24:25], v87 offset:8192
    ds_read_b64_tr_b16 a[26:27], v87 offset:9216
    v_mfma_f32_16x16x32_bf16 v[188:191], a[28:31], a[44:47], 0
    buffer_load_dwordx4 v69, s[32:35], s12 offen offset:1024 lds
    v_mfma_f32_16x16x32_bf16 v[220:223], a[28:31], a[48:51], 0
    v_mfma_f32_16x16x32_bf16 v[252:255], a[28:31], a[52:55], 0
    s_waitcnt lgkmcnt(15)
    v_mfma_f32_16x16x32_bf16 v[112:115], a[32:35], a[40:43], 0
    ds_read_b64_tr_b16 a[28:29], v88 offset:8192
    ds_read_b64_tr_b16 a[30:31], v88 offset:9216
    v_mfma_f32_16x16x32_bf16 v[120:123], a[32:35], a[44:47], 0
    buffer_load_dwordx4 v70, s[32:35], s12 offen offset:2048 lds
    v_mfma_f32_16x16x32_bf16 v[116:119], a[36:39], a[40:43], 0
    ds_read_b64_tr_b16 a[32:33], v89 offset:2048
    ds_read_b64_tr_b16 a[34:35], v89 offset:2304
    v_mfma_f32_16x16x32_bf16 v[124:127], a[36:39], a[44:47], 0
    s_waitcnt lgkmcnt(4)
    ds_read_b64_tr_b16 a[36:37], v90 offset:2048
    ds_read_b64_tr_b16 a[38:39], v90 offset:2304
    v_mfma_f32_16x16x32_bf16 v[128:131], a[0:3], a[56:59], v[128:131]
    buffer_load_dwordx4 v71, s[32:35], s12 offen offset:3072 lds
    v_mfma_f32_16x16x32_bf16 v[160:163], a[0:3], a[60:63], v[160:163]
    s_lshl_b32 s14, s15, 16
    v_mfma_f32_16x16x32_bf16 v[192:195], a[0:3], a[64:67], v[192:195]
    s_add_u32 m0, s18, 8192
    v_mfma_f32_16x16x32_bf16 v[224:227], a[0:3], a[68:71], v[224:227]
    s_waitcnt vmcnt(13) lgkmcnt(0)
    s_barrier
    v_mfma_f32_16x16x32_bf16 v[96:99], a[112:115], a[0:3], v[96:99]
    buffer_load_dwordx4 v76, s[52:55], s14 offen lds
    v_mfma_f32_16x16x32_bf16 v[132:135], a[4:7], a[56:59], v[132:135]
    s_add_u32 s15, s10, 3
    s_and_b32 s15, s15, 7
    ds_read_b64_tr_b16 a[0:1], v81 offset:16384
    ds_read_b64_tr_b16 a[2:3], v81 offset:17408
    v_mfma_f32_16x16x32_bf16 v[164:167], a[4:7], a[60:63], v[164:167]
    s_lshl_b32 s13, s15, 19
    ds_read_b128 a[40:43], v77 offset:32768
    v_mfma_f32_16x16x32_bf16 v[196:199], a[4:7], a[64:67], v[196:199]
    s_lshl_b32 s12, s15, 7
    ds_read_b128 a[44:47], v77 offset:34816
    v_mfma_f32_16x16x32_bf16 v[228:231], a[4:7], a[68:71], v[228:231]
    s_add_u32 m0, s17, 0
    v_mfma_f32_16x16x32_bf16 v[100:103], a[112:115], a[4:7], v[100:103]
    buffer_load_dwordx4 v72, s[44:47], s13 offen offset:0 lds
    v_mfma_f32_16x16x32_bf16 v[136:139], a[8:11], a[56:59], v[136:139]
    ds_read_b64_tr_b16 a[4:5], v82 offset:16384
    ds_read_b64_tr_b16 a[6:7], v82 offset:17408
    v_mfma_f32_16x16x32_bf16 v[168:171], a[8:11], a[60:63], v[168:171]
    ds_read_b128 a[48:51], v77 offset:36864
    v_mfma_f32_16x16x32_bf16 v[200:203], a[8:11], a[64:67], v[200:203]
    ds_read_b128 a[52:55], v77 offset:38912
    v_mfma_f32_16x16x32_bf16 v[232:235], a[8:11], a[68:71], v[232:235]
    v_mfma_f32_16x16x32_bf16 v[140:143], a[12:15], a[56:59], v[140:143]
    ds_read_b64_tr_b16 a[8:9], v83 offset:16384
    ds_read_b64_tr_b16 a[10:11], v83 offset:17408
    v_mfma_f32_16x16x32_bf16 v[172:175], a[12:15], a[60:63], v[172:175]
    buffer_load_dwordx4 v73, s[44:47], s13 offen offset:1024 lds
    v_mfma_f32_16x16x32_bf16 v[204:207], a[12:15], a[64:67], v[204:207]
    v_mfma_f32_16x16x32_bf16 v[236:239], a[12:15], a[68:71], v[236:239]
    v_mfma_f32_16x16x32_bf16 v[144:147], a[16:19], a[56:59], v[144:147]
    ds_read_b64_tr_b16 a[12:13], v84 offset:16384
    ds_read_b64_tr_b16 a[14:15], v84 offset:17408
    v_mfma_f32_16x16x32_bf16 v[176:179], a[16:19], a[60:63], v[176:179]
    v_mfma_f32_16x16x32_bf16 v[208:211], a[16:19], a[64:67], v[208:211]
    buffer_load_dwordx4 v74, s[44:47], s13 offen offset:2048 lds
    v_mfma_f32_16x16x32_bf16 v[240:243], a[16:19], a[68:71], v[240:243]
    v_mfma_f32_16x16x32_bf16 v[148:151], a[20:23], a[56:59], v[148:151]
    ds_read_b64_tr_b16 a[16:17], v85 offset:16384
    ds_read_b64_tr_b16 a[18:19], v85 offset:17408
    v_mfma_f32_16x16x32_bf16 v[180:183], a[20:23], a[60:63], v[180:183]
    v_mfma_f32_16x16x32_bf16 v[212:215], a[20:23], a[64:67], v[212:215]
    v_mfma_f32_16x16x32_bf16 v[244:247], a[20:23], a[68:71], v[244:247]
    v_mfma_f32_16x16x32_bf16 v[152:155], a[24:27], a[56:59], v[152:155]
    ds_read_b64_tr_b16 a[20:21], v86 offset:16384
    ds_read_b64_tr_b16 a[22:23], v86 offset:17408
    v_mfma_f32_16x16x32_bf16 v[184:187], a[24:27], a[60:63], v[184:187]
    buffer_load_dwordx4 v75, s[44:47], s13 offen offset:3072 lds
    v_mfma_f32_16x16x32_bf16 v[216:219], a[24:27], a[64:67], v[216:219]
    v_mfma_f32_16x16x32_bf16 v[248:251], a[24:27], a[68:71], v[248:251]
    v_mfma_f32_16x16x32_bf16 v[156:159], a[28:31], a[56:59], v[156:159]
    ds_read_b64_tr_b16 a[24:25], v87 offset:16384
    ds_read_b64_tr_b16 a[26:27], v87 offset:17408
    v_mfma_f32_16x16x32_bf16 v[188:191], a[28:31], a[60:63], v[188:191]
    s_add_u32 m0, s16, 0
    v_mfma_f32_16x16x32_bf16 v[220:223], a[28:31], a[64:67], v[220:223]
    buffer_load_dwordx4 v64, s[32:35], s12 offen offset:0 lds
    v_mfma_f32_16x16x32_bf16 v[252:255], a[28:31], a[68:71], v[252:255]
    v_mfma_f32_16x16x32_bf16 v[112:115], a[32:35], a[56:59], v[112:115]
    ds_read_b64_tr_b16 a[28:29], v88 offset:16384
    ds_read_b64_tr_b16 a[30:31], v88 offset:17408
    v_mfma_f32_16x16x32_bf16 v[120:123], a[32:35], a[60:63], v[120:123]
    v_mfma_f32_16x16x32_bf16 v[116:119], a[36:39], a[56:59], v[116:119]
    ds_read_b64_tr_b16 a[32:33], v89 offset:4096
    ds_read_b64_tr_b16 a[34:35], v89 offset:4352
    v_mfma_f32_16x16x32_bf16 v[124:127], a[36:39], a[60:63], v[124:127]
    buffer_load_dwordx4 v65, s[32:35], s12 offen offset:1024 lds
    v_mfma_f32_16x16x32_bf16 v[104:107], a[112:115], a[80:83], 0
    s_waitcnt lgkmcnt(4)
    ds_read_b64_tr_b16 a[36:37], v90 offset:4096
    ds_read_b64_tr_b16 a[38:39], v90 offset:4352
    v_mfma_f32_16x16x32_bf16 v[128:131], a[0:3], a[40:43], v[128:131]
    v_mfma_f32_16x16x32_bf16 v[160:163], a[0:3], a[44:47], v[160:163]
    v_mfma_f32_16x16x32_bf16 v[192:195], a[0:3], a[48:51], v[192:195]
    v_mfma_f32_16x16x32_bf16 v[224:227], a[0:3], a[52:55], v[224:227]
    v_mfma_f32_16x16x32_bf16 v[96:99], a[112:115], a[0:3], v[96:99]
    buffer_load_dwordx4 v66, s[32:35], s12 offen offset:2048 lds
    v_mfma_f32_16x16x32_bf16 v[132:135], a[4:7], a[40:43], v[132:135]
    ds_read_b64_tr_b16 a[0:1], v81 offset:24576
    ds_read_b64_tr_b16 a[2:3], v81 offset:25600
    v_mfma_f32_16x16x32_bf16 v[164:167], a[4:7], a[44:47], v[164:167]
    ds_read_b128 a[56:59], v78 offset:32768
    v_mfma_f32_16x16x32_bf16 v[196:199], a[4:7], a[48:51], v[196:199]
    ds_read_b128 a[60:63], v78 offset:34816
    v_mfma_f32_16x16x32_bf16 v[228:231], a[4:7], a[52:55], v[228:231]
    v_mfma_f32_16x16x32_bf16 v[100:103], a[112:115], a[4:7], v[100:103]
    v_mfma_f32_16x16x32_bf16 v[136:139], a[8:11], a[40:43], v[136:139]
    buffer_load_dwordx4 v67, s[32:35], s12 offen offset:3072 lds
    ds_read_b64_tr_b16 a[4:5], v82 offset:24576
    ds_read_b64_tr_b16 a[6:7], v82 offset:25600
    v_mfma_f32_16x16x32_bf16 v[168:171], a[8:11], a[44:47], v[168:171]
    ds_read_b128 a[64:67], v78 offset:36864
    v_mfma_f32_16x16x32_bf16 v[200:203], a[8:11], a[48:51], v[200:203]
    ds_read_b128 a[68:71], v78 offset:38912
    v_mfma_f32_16x16x32_bf16 v[232:235], a[8:11], a[52:55], v[232:235]
    v_mfma_f32_16x16x32_bf16 v[140:143], a[12:15], a[40:43], v[140:143]
    ds_read_b64_tr_b16 a[8:9], v83 offset:24576
    ds_read_b64_tr_b16 a[10:11], v83 offset:25600
    v_mfma_f32_16x16x32_bf16 v[172:175], a[12:15], a[44:47], v[172:175]
    s_add_u32 m0, s16, 4096
    buffer_load_dword v26, v55, s[72:75], 0 offen offset:0 sc1
    v_mfma_f32_16x16x32_bf16 v[204:207], a[12:15], a[48:51], v[204:207]
    ds_read_b64_tr_b16 a[80:81], v91 offset:4096
    ds_read_b64_tr_b16 a[82:83], v91 offset:4352
    v_mfma_f32_16x16x32_bf16 v[236:239], a[12:15], a[52:55], v[236:239]
    buffer_load_dwordx4 v68, s[32:35], s12 offen offset:0 lds
    v_mfma_f32_16x16x32_bf16 v[144:147], a[16:19], a[40:43], v[144:147]
    ds_read_b64_tr_b16 a[12:13], v84 offset:24576
    ds_read_b64_tr_b16 a[14:15], v84 offset:25600
    v_mfma_f32_16x16x32_bf16 v[176:179], a[16:19], a[44:47], v[176:179]
    v_mfma_f32_16x16x32_bf16 v[208:211], a[16:19], a[48:51], v[208:211]
    v_mfma_f32_16x16x32_bf16 v[240:243], a[16:19], a[52:55], v[240:243]
    buffer_load_dwordx4 v69, s[32:35], s12 offen offset:1024 lds
    v_mfma_f32_16x16x32_bf16 v[148:151], a[20:23], a[40:43], v[148:151]
    ds_read_b64_tr_b16 a[16:17], v85 offset:24576
    ds_read_b64_tr_b16 a[18:19], v85 offset:25600
    v_mfma_f32_16x16x32_bf16 v[180:183], a[20:23], a[44:47], v[180:183]
    v_mfma_f32_16x16x32_bf16 v[212:215], a[20:23], a[48:51], v[212:215]
    v_mfma_f32_16x16x32_bf16 v[244:247], a[20:23], a[52:55], v[244:247]
    v_mfma_f32_16x16x32_bf16 v[152:155], a[24:27], a[40:43], v[152:155]
    s_waitcnt lgkmcnt(15)
    ds_read_b64_tr_b16 a[20:21], v86 offset:24576
    ds_read_b64_tr_b16 a[22:23], v86 offset:25600
    v_mfma_f32_16x16x32_bf16 v[184:187], a[24:27], a[44:47], v[184:187]
    buffer_load_dwordx4 v70, s[32:35], s12 offen offset:2048 lds
    v_mfma_f32_16x16x32_bf16 v[216:219], a[24:27], a[48:51], v[216:219]
    v_mfma_f32_16x16x32_bf16 v[248:251], a[24:27], a[52:55], v[248:251]
    v_mfma_f32_16x16x32_bf16 v[156:159], a[28:31], a[40:43], v[156:159]
    ds_read_b64_tr_b16 a[24:25], v87 offset:24576
    ds_read_b64_tr_b16 a[26:27], v87 offset:25600
    v_mfma_f32_16x16x32_bf16 v[188:191], a[28:31], a[44:47], v[188:191]
    v_mfma_f32_16x16x32_bf16 v[220:223], a[28:31], a[48:51], v[220:223]
    v_mfma_f32_16x16x32_bf16 v[252:255], a[28:31], a[52:55], v[252:255]
    buffer_load_dwordx4 v71, s[32:35], s12 offen offset:3072 lds
    v_mfma_f32_16x16x32_bf16 v[112:115], a[32:35], a[40:43], v[112:115]
    ds_read_b64_tr_b16 a[28:29], v88 offset:24576
    ds_read_b64_tr_b16 a[30:31], v88 offset:25600
    v_mfma_f32_16x16x32_bf16 v[120:123], a[32:35], a[44:47], v[120:123]
    v_mfma_f32_16x16x32_bf16 v[116:119], a[36:39], a[40:43], v[116:119]
    ds_read_b64_tr_b16 a[32:33], v89 offset:6144
    ds_read_b64_tr_b16 a[34:35], v89 offset:6400
    v_mfma_f32_16x16x32_bf16 v[124:127], a[36:39], a[44:47], v[124:127]
    s_lshl_b32 s14, s15, 16
    ds_read_b64_tr_b16 a[36:37], v90 offset:6144
    ds_read_b64_tr_b16 a[38:39], v90 offset:6400
    s_waitcnt lgkmcnt(6)
    v_mfma_f32_16x16x32_bf16 v[128:131], a[0:3], a[56:59], v[128:131]
    s_add_u32 m0, s18, 0
    v_mfma_f32_16x16x32_bf16 v[160:163], a[0:3], a[60:63], v[160:163]
    s_waitcnt vmcnt(4)
    v_cmp_gt_u32 vcc, v56, v26
    s_cbranch_vccnz L_spin_1
    L_back_2:
    v_mfma_f32_16x16x32_bf16 v[192:195], a[0:3], a[64:67], v[192:195]
    buffer_load_dwordx4 v76, s[52:55], s14 offen lds
    v_mfma_f32_16x16x32_bf16 v[224:227], a[0:3], a[68:71], v[224:227]
    s_waitcnt lgkmcnt(0)
    s_barrier
    v_mfma_f32_16x16x32_bf16 v[96:99], a[112:115], a[0:3], v[96:99]
    v_mfma_f32_16x16x32_bf16 v[132:135], a[4:7], a[56:59], v[132:135]
    s_add_u32 s15, s10, 4
    s_and_b32 s15, s15, 7
    ds_read_b64_tr_b16 a[0:1], v81 offset:32768
    ds_read_b64_tr_b16 a[2:3], v81 offset:33792
    v_mfma_f32_16x16x32_bf16 v[164:167], a[4:7], a[60:63], v[164:167]
    s_lshl_b32 s13, s15, 19
    ds_read_b128 a[40:43], v79 offset:0
    v_mfma_f32_16x16x32_bf16 v[196:199], a[4:7], a[64:67], v[196:199]
    s_lshl_b32 s12, s15, 7
    ds_read_b128 a[44:47], v79 offset:2048
    v_mfma_f32_16x16x32_bf16 v[228:231], a[4:7], a[68:71], v[228:231]
    s_add_u32 m0, s17, 16384
    buffer_atomic_add v62, v63, s[76:79], s23 offen offset:0 sc1
    v_mfma_f32_16x16x32_bf16 v[100:103], a[112:115], a[4:7], v[100:103]
    buffer_load_dwordx4 v72, s[44:47], s13 offen offset:0 lds
    v_mfma_f32_16x16x32_bf16 v[136:139], a[8:11], a[56:59], v[136:139]
    ds_read_b64_tr_b16 a[4:5], v82 offset:32768
    ds_read_b64_tr_b16 a[6:7], v82 offset:33792
    v_mfma_f32_16x16x32_bf16 v[168:171], a[8:11], a[60:63], v[168:171]
    ds_read_b128 a[48:51], v79 offset:4096
    v_mfma_f32_16x16x32_bf16 v[200:203], a[8:11], a[64:67], v[200:203]
    ds_read_b128 a[52:55], v79 offset:6144
    v_mfma_f32_16x16x32_bf16 v[232:235], a[8:11], a[68:71], v[232:235]
    v_mfma_f32_16x16x32_bf16 v[140:143], a[12:15], a[56:59], v[140:143]
    ds_read_b64_tr_b16 a[8:9], v83 offset:32768
    ds_read_b64_tr_b16 a[10:11], v83 offset:33792
    v_mfma_f32_16x16x32_bf16 v[172:175], a[12:15], a[60:63], v[172:175]
    buffer_load_dwordx4 v73, s[44:47], s13 offen offset:1024 lds
    v_mfma_f32_16x16x32_bf16 v[204:207], a[12:15], a[64:67], v[204:207]
    v_mfma_f32_16x16x32_bf16 v[236:239], a[12:15], a[68:71], v[236:239]
    v_mfma_f32_16x16x32_bf16 v[144:147], a[16:19], a[56:59], v[144:147]
    ds_read_b64_tr_b16 a[12:13], v84 offset:32768
    ds_read_b64_tr_b16 a[14:15], v84 offset:33792
    v_mfma_f32_16x16x32_bf16 v[176:179], a[16:19], a[60:63], v[176:179]
    v_mfma_f32_16x16x32_bf16 v[208:211], a[16:19], a[64:67], v[208:211]
    buffer_load_dwordx4 v74, s[44:47], s13 offen offset:2048 lds
    v_mfma_f32_16x16x32_bf16 v[240:243], a[16:19], a[68:71], v[240:243]
    v_mfma_f32_16x16x32_bf16 v[148:151], a[20:23], a[56:59], v[148:151]
    ds_read_b64_tr_b16 a[16:17], v85 offset:32768
    ds_read_b64_tr_b16 a[18:19], v85 offset:33792
    v_mfma_f32_16x16x32_bf16 v[180:183], a[20:23], a[60:63], v[180:183]
    v_mfma_f32_16x16x32_bf16 v[212:215], a[20:23], a[64:67], v[212:215]
    v_mfma_f32_16x16x32_bf16 v[244:247], a[20:23], a[68:71], v[244:247]
    v_mfma_f32_16x16x32_bf16 v[152:155], a[24:27], a[56:59], v[152:155]
    ds_read_b64_tr_b16 a[20:21], v86 offset:32768
    ds_read_b64_tr_b16 a[22:23], v86 offset:33792
    v_mfma_f32_16x16x32_bf16 v[184:187], a[24:27], a[60:63], v[184:187]
    buffer_load_dwordx4 v75, s[44:47], s13 offen offset:3072 lds
    v_mfma_f32_16x16x32_bf16 v[216:219], a[24:27], a[64:67], v[216:219]
    v_mfma_f32_16x16x32_bf16 v[248:251], a[24:27], a[68:71], v[248:251]
    v_mfma_f32_16x16x32_bf16 v[156:159], a[28:31], a[56:59], v[156:159]
    ds_read_b64_tr_b16 a[24:25], v87 offset:32768
    ds_read_b64_tr_b16 a[26:27], v87 offset:33792
    v_mfma_f32_16x16x32_bf16 v[188:191], a[28:31], a[60:63], v[188:191]
    s_add_u32 m0, s16, 32768
    v_mfma_f32_16x16x32_bf16 v[220:223], a[28:31], a[64:67], v[220:223]
    buffer_load_dwordx4 v64, s[32:35], s12 offen offset:0 lds
    v_mfma_f32_16x16x32_bf16 v[252:255], a[28:31], a[68:71], v[252:255]
    v_mfma_f32_16x16x32_bf16 v[112:115], a[32:35], a[56:59], v[112:115]
    ds_read_b64_tr_b16 a[28:29], v88 offset:32768
    ds_read_b64_tr_b16 a[30:31], v88 offset:33792
    v_mfma_f32_16x16x32_bf16 v[120:123], a[32:35], a[60:63], v[120:123]
    v_mfma_f32_16x16x32_bf16 v[116:119], a[36:39], a[56:59], v[116:119]
    ds_read_b64_tr_b16 a[32:33], v89 offset:8192
    ds_read_b64_tr_b16 a[34:35], v89 offset:8448
    v_mfma_f32_16x16x32_bf16 v[124:127], a[36:39], a[60:63], v[124:127]
    buffer_load_dwordx4 v65, s[32:35], s12 offen offset:1024 lds
    v_mfma_f32_16x16x32_bf16 v[104:107], a[112:115], a[80:83], v[104:107]
    s_waitcnt lgkmcnt(4)
    ds_read_b64_tr_b16 a[36:37], v90 offset:8192
    ds_read_b64_tr_b16 a[38:39], v90 offset:8448
    v_mfma_f32_16x16x32_bf16 v[128:131], a[0:3], a[40:43], v[128:131]
    v_mfma_f32_16x16x32_bf16 v[160:163], a[0:3], a[44:47], v[160:163]
    v_mfma_f32_16x16x32_bf16 v[192:195], a[0:3], a[48:51], v[192:195]
    v_mfma_f32_16x16x32_bf16 v[224:227], a[0:3], a[52:55], v[224:227]
    v_mfma_f32_16x16x32_bf16 v[96:99], a[112:115], a[0:3], v[96:99]
    buffer_load_dwordx4 v66, s[32:35], s12 offen offset:2048 lds
    v_mfma_f32_16x16x32_bf16 v[132:135], a[4:7], a[40:43], v[132:135]
    ds_read_b64_tr_b16 a[0:1], v81 offset:40960
    ds_read_b64_tr_b16 a[2:3], v81 offset:41984
    v_mfma_f32_16x16x32_bf16 v[164:167], a[4:7], a[44:47], v[164:167]
    ds_read_b128 a[56:59], v80 offset:0
    v_mfma_f32_16x16x32_bf16 v[196:199], a[4:7], a[48:51], v[196:199]
    ds_read_b128 a[60:63], v80 offset:2048
    v_mfma_f32_16x16x32_bf16 v[228:231], a[4:7], a[52:55], v[228:231]
    v_mfma_f32_16x16x32_bf16 v[100:103], a[112:115], a[4:7], v[100:103]
    v_mfma_f32_16x16x32_bf16 v[136:139], a[8:11], a[40:43], v[136:139]
    buffer_load_dwordx4 v67, s[32:35], s12 offen offset:3072 lds
    ds_read_b64_tr_b16 a[4:5], v82 offset:40960
    ds_read_b64_tr_b16 a[6:7], v82 offset:41984
    v_mfma_f32_16x16x32_bf16 v[168:171], a[8:11], a[44:47], v[168:171]
    ds_read_b128 a[64:67], v80 offset:4096
    v_mfma_f32_16x16x32_bf16 v[200:203], a[8:11], a[48:51], v[200:203]
    ds_read_b128 a[68:71], v80 offset:6144
    v_mfma_f32_16x16x32_bf16 v[232:235], a[8:11], a[52:55], v[232:235]
    v_mfma_f32_16x16x32_bf16 v[140:143], a[12:15], a[40:43], v[140:143]
    ds_read_b64_tr_b16 a[8:9], v83 offset:40960
    ds_read_b64_tr_b16 a[10:11], v83 offset:41984
    v_mfma_f32_16x16x32_bf16 v[172:175], a[12:15], a[44:47], v[172:175]
    s_add_u32 m0, s16, 36864
    v_mfma_f32_16x16x32_bf16 v[204:207], a[12:15], a[48:51], v[204:207]
    ds_read_b64_tr_b16 a[80:81], v91 offset:8192
    ds_read_b64_tr_b16 a[82:83], v91 offset:8448
    v_mfma_f32_16x16x32_bf16 v[236:239], a[12:15], a[52:55], v[236:239]
    buffer_load_dwordx4 v68, s[32:35], s12 offen offset:0 lds
    v_mfma_f32_16x16x32_bf16 v[144:147], a[16:19], a[40:43], v[144:147]
    ds_read_b64_tr_b16 a[12:13], v84 offset:40960
    ds_read_b64_tr_b16 a[14:15], v84 offset:41984
    v_mfma_f32_16x16x32_bf16 v[176:179], a[16:19], a[44:47], v[176:179]
    v_mfma_f32_16x16x32_bf16 v[208:211], a[16:19], a[48:51], v[208:211]
    v_mfma_f32_16x16x32_bf16 v[240:243], a[16:19], a[52:55], v[240:243]
    buffer_load_dwordx4 v69, s[32:35], s12 offen offset:1024 lds
    v_mfma_f32_16x16x32_bf16 v[148:151], a[20:23], a[40:43], v[148:151]
    ds_read_b64_tr_b16 a[16:17], v85 offset:40960
    ds_read_b64_tr_b16 a[18:19], v85 offset:41984
    v_mfma_f32_16x16x32_bf16 v[180:183], a[20:23], a[44:47], v[180:183]
    v_mfma_f32_16x16x32_bf16 v[212:215], a[20:23], a[48:51], v[212:215]
    v_mfma_f32_16x16x32_bf16 v[244:247], a[20:23], a[52:55], v[244:247]
    v_mfma_f32_16x16x32_bf16 v[152:155], a[24:27], a[40:43], v[152:155]
    s_waitcnt lgkmcnt(15)
    ds_read_b64_tr_b16 a[20:21], v86 offset:40960
    ds_read_b64_tr_b16 a[22:23], v86 offset:41984
    v_mfma_f32_16x16x32_bf16 v[184:187], a[24:27], a[44:47], v[184:187]
    buffer_load_dwordx4 v70, s[32:35], s12 offen offset:2048 lds
    v_mfma_f32_16x16x32_bf16 v[216:219], a[24:27], a[48:51], v[216:219]
    v_mfma_f32_16x16x32_bf16 v[248:251], a[24:27], a[52:55], v[248:251]
    v_mfma_f32_16x16x32_bf16 v[156:159], a[28:31], a[40:43], v[156:159]
    ds_read_b64_tr_b16 a[24:25], v87 offset:40960
    ds_read_b64_tr_b16 a[26:27], v87 offset:41984
    v_mfma_f32_16x16x32_bf16 v[188:191], a[28:31], a[44:47], v[188:191]
    v_mfma_f32_16x16x32_bf16 v[220:223], a[28:31], a[48:51], v[220:223]
    v_mfma_f32_16x16x32_bf16 v[252:255], a[28:31], a[52:55], v[252:255]
    buffer_load_dwordx4 v71, s[32:35], s12 offen offset:3072 lds
    v_mfma_f32_16x16x32_bf16 v[112:115], a[32:35], a[40:43], v[112:115]
    ds_read_b64_tr_b16 a[28:29], v88 offset:40960
    ds_read_b64_tr_b16 a[30:31], v88 offset:41984
    v_mfma_f32_16x16x32_bf16 v[120:123], a[32:35], a[44:47], v[120:123]
    v_mfma_f32_16x16x32_bf16 v[116:119], a[36:39], a[40:43], v[116:119]
    ds_read_b64_tr_b16 a[32:33], v89 offset:10240
    ds_read_b64_tr_b16 a[34:35], v89 offset:10496
    v_mfma_f32_16x16x32_bf16 v[124:127], a[36:39], a[44:47], v[124:127]
    s_lshl_b32 s14, s15, 16
    ds_read_b64_tr_b16 a[36:37], v90 offset:10240
    ds_read_b64_tr_b16 a[38:39], v90 offset:10496
    s_waitcnt lgkmcnt(6)
    v_mfma_f32_16x16x32_bf16 v[128:131], a[0:3], a[56:59], v[128:131]
    s_add_u32 m0, s18, 4096
    v_mfma_f32_16x16x32_bf16 v[160:163], a[0:3], a[60:63], v[160:163]
    buffer_load_dwordx4 v76, s[52:55], s14 offen lds
    v_mfma_f32_16x16x32_bf16 v[192:195], a[0:3], a[64:67], v[192:195]
    v_mfma_f32_16x16x32_bf16 v[224:227], a[0:3], a[68:71], v[224:227]
    s_waitcnt vmcnt(14) lgkmcnt(0)
    s_barrier
    v_mfma_f32_16x16x32_bf16 v[96:99], a[112:115], a[0:3], v[96:99]
    v_mfma_f32_16x16x32_bf16 v[132:135], a[4:7], a[56:59], v[132:135]
    s_add_u32 s15, s10, 5
    s_and_b32 s15, s15, 7
    ds_read_b64_tr_b16 a[0:1], v81 offset:0
    ds_read_b64_tr_b16 a[2:3], v81 offset:1024
    v_mfma_f32_16x16x32_bf16 v[164:167], a[4:7], a[60:63], v[164:167]
    s_lshl_b32 s13, s15, 19
    ds_read_b128 a[40:43], v77 offset:0
    v_mfma_f32_16x16x32_bf16 v[196:199], a[4:7], a[64:67], v[196:199]
    s_lshl_b32 s12, s15, 7
    ds_read_b128 a[44:47], v77 offset:2048
    v_mfma_f32_16x16x32_bf16 v[228:231], a[4:7], a[68:71], v[228:231]
    s_add_u32 m0, s17, 32768
    v_mfma_f32_16x16x32_bf16 v[100:103], a[112:115], a[4:7], v[100:103]
    buffer_load_dwordx4 v72, s[44:47], s13 offen offset:0 lds
    v_mfma_f32_16x16x32_bf16 v[136:139], a[8:11], a[56:59], v[136:139]
    ds_read_b64_tr_b16 a[4:5], v82 offset:0
    ds_read_b64_tr_b16 a[6:7], v82 offset:1024
    v_mfma_f32_16x16x32_bf16 v[168:171], a[8:11], a[60:63], v[168:171]
    ds_read_b128 a[48:51], v77 offset:4096
    v_mfma_f32_16x16x32_bf16 v[200:203], a[8:11], a[64:67], v[200:203]
    ds_read_b128 a[52:55], v77 offset:6144
    v_mfma_f32_16x16x32_bf16 v[232:235], a[8:11], a[68:71], v[232:235]
    v_mfma_f32_16x16x32_bf16 v[140:143], a[12:15], a[56:59], v[140:143]
    ds_read_b64_tr_b16 a[8:9], v83 offset:0
    ds_read_b64_tr_b16 a[10:11], v83 offset:1024
    v_mfma_f32_16x16x32_bf16 v[172:175], a[12:15], a[60:63], v[172:175]
    buffer_load_dwordx4 v73, s[44:47], s13 offen offset:1024 lds
    v_mfma_f32_16x16x32_bf16 v[204:207], a[12:15], a[64:67], v[204:207]
    v_mfma_f32_16x16x32_bf16 v[236:239], a[12:15], a[68:71], v[236:239]
    v_mfma_f32_16x16x32_bf16 v[144:147], a[16:19], a[56:59], v[144:147]
    ds_read_b64_tr_b16 a[12:13], v84 offset:0
    ds_read_b64_tr_b16 a[14:15], v84 offset:1024
    v_mfma_f32_16x16x32_bf16 v[176:179], a[16:19], a[60:63], v[176:179]
    v_mfma_f32_16x16x32_bf16 v[208:211], a[16:19], a[64:67], v[208:211]
    buffer_load_dwordx4 v74, s[44:47], s13 offen offset:2048 lds
    v_mfma_f32_16x16x32_bf16 v[240:243], a[16:19], a[68:71], v[240:243]
    v_mfma_f32_16x16x32_bf16 v[148:151], a[20:23], a[56:59], v[148:151]
    ds_read_b64_tr_b16 a[16:17], v85 offset:0
    ds_read_b64_tr_b16 a[18:19], v85 offset:1024
    v_mfma_f32_16x16x32_bf16 v[180:183], a[20:23], a[60:63], v[180:183]
    v_mfma_f32_16x16x32_bf16 v[212:215], a[20:23], a[64:67], v[212:215]
    v_mfma_f32_16x16x32_bf16 v[244:247], a[20:23], a[68:71], v[244:247]
    v_mfma_f32_16x16x32_bf16 v[152:155], a[24:27], a[56:59], v[152:155]
    ds_read_b64_tr_b16 a[20:21], v86 offset:0
    ds_read_b64_tr_b16 a[22:23], v86 offset:1024
    v_mfma_f32_16x16x32_bf16 v[184:187], a[24:27], a[60:63], v[184:187]
    buffer_load_dwordx4 v75, s[44:47], s13 offen offset:3072 lds
    v_mfma_f32_16x16x32_bf16 v[216:219], a[24:27], a[64:67], v[216:219]
    v_mfma_f32_16x16x32_bf16 v[248:251], a[24:27], a[68:71], v[248:251]
    v_mfma_f32_16x16x32_bf16 v[156:159], a[28:31], a[56:59], v[156:159]
    ds_read_b64_tr_b16 a[24:25], v87 offset:0
    ds_read_b64_tr_b16 a[26:27], v87 offset:1024
    v_mfma_f32_16x16x32_bf16 v[188:191], a[28:31], a[60:63], v[188:191]
    s_add_u32 m0, s16, 65536
    v_mfma_f32_16x16x32_bf16 v[220:223], a[28:31], a[64:67], v[220:223]
    buffer_load_dwordx4 v64, s[32:35], s12 offen offset:0 lds
    v_mfma_f32_16x16x32_bf16 v[252:255], a[28:31], a[68:71], v[252:255]
    v_mfma_f32_16x16x32_bf16 v[112:115], a[32:35], a[56:59], v[112:115]
    ds_read_b64_tr_b16 a[28:29], v88 offset:0
    ds_read_b64_tr_b16 a[30:31], v88 offset:1024
    v_mfma_f32_16x16x32_bf16 v[120:123], a[32:35], a[60:63], v[120:123]
    v_mfma_f32_16x16x32_bf16 v[116:119], a[36:39], a[56:59], v[116:119]
    ds_read_b64_tr_b16 a[32:33], v89 offset:0
    ds_read_b64_tr_b16 a[34:35], v89 offset:256
    v_mfma_f32_16x16x32_bf16 v[124:127], a[36:39], a[60:63], v[124:127]
    buffer_load_dwordx4 v65, s[32:35], s12 offen offset:1024 lds
    v_mfma_f32_16x16x32_bf16 v[104:107], a[112:115], a[80:83], v[104:107]
    s_waitcnt lgkmcnt(4)
    ds_read_b64_tr_b16 a[36:37], v90 offset:0
    ds_read_b64_tr_b16 a[38:39], v90 offset:256
    v_mfma_f32_16x16x32_bf16 v[128:131], a[0:3], a[40:43], v[128:131]
    v_mfma_f32_16x16x32_bf16 v[160:163], a[0:3], a[44:47], v[160:163]
    v_mfma_f32_16x16x32_bf16 v[192:195], a[0:3], a[48:51], v[192:195]
    v_mfma_f32_16x16x32_bf16 v[224:227], a[0:3], a[52:55], v[224:227]
    v_mfma_f32_16x16x32_bf16 v[96:99], a[112:115], a[0:3], v[96:99]
    buffer_load_dwordx4 v66, s[32:35], s12 offen offset:2048 lds
    v_mfma_f32_16x16x32_bf16 v[132:135], a[4:7], a[40:43], v[132:135]
    ds_read_b64_tr_b16 a[0:1], v81 offset:8192
    ds_read_b64_tr_b16 a[2:3], v81 offset:9216
    v_mfma_f32_16x16x32_bf16 v[164:167], a[4:7], a[44:47], v[164:167]
    ds_read_b128 a[56:59], v78 offset:0
    v_mfma_f32_16x16x32_bf16 v[196:199], a[4:7], a[48:51], v[196:199]
    ds_read_b128 a[60:63], v78 offset:2048
    v_mfma_f32_16x16x32_bf16 v[228:231], a[4:7], a[52:55], v[228:231]
    v_mfma_f32_16x16x32_bf16 v[100:103], a[112:115], a[4:7], v[100:103]
    v_mfma_f32_16x16x32_bf16 v[136:139], a[8:11], a[40:43], v[136:139]
    buffer_load_dwordx4 v67, s[32:35], s12 offen offset:3072 lds
    ds_read_b64_tr_b16 a[4:5], v82 offset:8192
    ds_read_b64_tr_b16 a[6:7], v82 offset:9216
    v_mfma_f32_16x16x32_bf16 v[168:171], a[8:11], a[44:47], v[168:171]
    ds_read_b128 a[64:67], v78 offset:4096
    v_mfma_f32_16x16x32_bf16 v[200:203], a[8:11], a[48:51], v[200:203]
    ds_read_b128 a[68:71], v78 offset:6144
    v_mfma_f32_16x16x32_bf16 v[232:235], a[8:11], a[52:55], v[232:235]
    v_mfma_f32_16x16x32_bf16 v[140:143], a[12:15], a[40:43], v[140:143]
    ds_read_b64_tr_b16 a[8:9], v83 offset:8192
    ds_read_b64_tr_b16 a[10:11], v83 offset:9216
    v_mfma_f32_16x16x32_bf16 v[172:175], a[12:15], a[44:47], v[172:175]
    s_add_u32 m0, s16, 69632
    v_mfma_f32_16x16x32_bf16 v[204:207], a[12:15], a[48:51], v[204:207]
    ds_read_b64_tr_b16 a[80:81], v91 offset:0
    ds_read_b64_tr_b16 a[82:83], v91 offset:256
    v_mfma_f32_16x16x32_bf16 v[236:239], a[12:15], a[52:55], v[236:239]
    buffer_load_dwordx4 v68, s[32:35], s12 offen offset:0 lds
    v_mfma_f32_16x16x32_bf16 v[144:147], a[16:19], a[40:43], v[144:147]
    ds_read_b64_tr_b16 a[12:13], v84 offset:8192
    ds_read_b64_tr_b16 a[14:15], v84 offset:9216
    v_mfma_f32_16x16x32_bf16 v[176:179], a[16:19], a[44:47], v[176:179]
    v_mfma_f32_16x16x32_bf16 v[208:211], a[16:19], a[48:51], v[208:211]
    v_mfma_f32_16x16x32_bf16 v[240:243], a[16:19], a[52:55], v[240:243]
    buffer_load_dwordx4 v69, s[32:35], s12 offen offset:1024 lds
    v_mfma_f32_16x16x32_bf16 v[148:151], a[20:23], a[40:43], v[148:151]
    ds_read_b64_tr_b16 a[16:17], v85 offset:8192
    ds_read_b64_tr_b16 a[18:19], v85 offset:9216
    v_mfma_f32_16x16x32_bf16 v[180:183], a[20:23], a[44:47], v[180:183]
    v_mfma_f32_16x16x32_bf16 v[212:215], a[20:23], a[48:51], v[212:215]
    v_mfma_f32_16x16x32_bf16 v[244:247], a[20:23], a[52:55], v[244:247]
    v_mfma_f32_16x16x32_bf16 v[152:155], a[24:27], a[40:43], v[152:155]
    s_waitcnt lgkmcnt(15)
    ds_read_b64_tr_b16 a[20:21], v86 offset:8192
    ds_read_b64_tr_b16 a[22:23], v86 offset:9216
    v_mfma_f32_16x16x32_bf16 v[184:187], a[24:27], a[44:47], v[184:187]
    buffer_load_dwordx4 v70, s[32:35], s12 offen offset:2048 lds
    v_mfma_f32_16x16x32_bf16 v[216:219], a[24:27], a[48:51], v[216:219]
    v_mfma_f32_16x16x32_bf16 v[248:251], a[24:27], a[52:55], v[248:251]
    v_mfma_f32_16x16x32_bf16 v[156:159], a[28:31], a[40:43], v[156:159]
    ds_read_b64_tr_b16 a[24:25], v87 offset:8192
    ds_read_b64_tr_b16 a[26:27], v87 offset:9216
    v_mfma_f32_16x16x32_bf16 v[188:191], a[28:31], a[44:47], v[188:191]
    v_mfma_f32_16x16x32_bf16 v[220:223], a[28:31], a[48:51], v[220:223]
    v_mfma_f32_16x16x32_bf16 v[252:255], a[28:31], a[52:55], v[252:255]
    buffer_load_dwordx4 v71, s[32:35], s12 offen offset:3072 lds
L_warm0_1:
    s_cbranch_execz L_warm0_2
    v_mfma_f32_16x16x32_bf16 v[112:115], a[32:35], a[40:43], v[112:115]
    ds_read_b64_tr_b16 a[28:29], v88 offset:8192
    ds_read_b64_tr_b16 a[30:31], v88 offset:9216
    v_mfma_f32_16x16x32_bf16 v[120:123], a[32:35], a[44:47], v[120:123]
    v_mfma_f32_16x16x32_bf16 v[116:119], a[36:39], a[40:43], v[116:119]
    ds_read_b64_tr_b16 a[32:33], v89 offset:2048
    ds_read_b64_tr_b16 a[34:35], v89 offset:2304
    v_mfma_f32_16x16x32_bf16 v[124:127], a[36:39], a[44:47], v[124:127]
    s_lshl_b32 s14, s15, 16
    ds_read_b64_tr_b16 a[36:37], v90 offset:2048
    ds_read_b64_tr_b16 a[38:39], v90 offset:2304
    s_waitcnt lgkmcnt(6)
    v_mfma_f32_16x16x32_bf16 v[128:131], a[0:3], a[56:59], v[128:131]
    s_add_u32 m0, s18, 8192
    v_mfma_f32_16x16x32_bf16 v[160:163], a[0:3], a[60:63], v[160:163]
    buffer_load_dwordx4 v76, s[52:55], s14 offen lds
    v_mfma_f32_16x16x32_bf16 v[192:195], a[0:3], a[64:67], v[192:195]
    v_mfma_f32_16x16x32_bf16 v[224:227], a[0:3], a[68:71], v[224:227]
    s_waitcnt vmcnt(13) lgkmcnt(0)
    s_barrier
    v_mfma_f32_16x16x32_bf16 v[96:99], a[112:115], a[0:3], v[96:99]
    v_mfma_f32_16x16x32_bf16 v[132:135], a[4:7], a[56:59], v[132:135]
    s_add_u32 s15, s10, 6
    s_and_b32 s15, s15, 7
    ds_read_b64_tr_b16 a[0:1], v81 offset:16384
    ds_read_b64_tr_b16 a[2:3], v81 offset:17408
    v_mfma_f32_16x16x32_bf16 v[164:167], a[4:7], a[60:63], v[164:167]
    s_lshl_b32 s13, s15, 19
    ds_read_b128 a[40:43], v77 offset:32768
    v_mfma_f32_16x16x32_bf16 v[196:199], a[4:7], a[64:67], v[196:199]
    s_lshl_b32 s12, s15, 7
    ds_read_b128 a[44:47], v77 offset:34816
    v_mfma_f32_16x16x32_bf16 v[228:231], a[4:7], a[68:71], v[228:231]
    s_add_u32 m0, s17, 0
    v_mfma_f32_16x16x32_bf16 v[100:103], a[112:115], a[4:7], v[100:103]
    buffer_load_dwordx4 v72, s[44:47], s13 offen offset:0 lds
    v_mfma_f32_16x16x32_bf16 v[136:139], a[8:11], a[56:59], v[136:139]
    ds_read_b64_tr_b16 a[4:5], v82 offset:16384
    ds_read_b64_tr_b16 a[6:7], v82 offset:17408
    v_mfma_f32_16x16x32_bf16 v[168:171], a[8:11], a[60:63], v[168:171]
    ds_read_b128 a[48:51], v77 offset:36864
    v_mfma_f32_16x16x32_bf16 v[200:203], a[8:11], a[64:67], v[200:203]
    ds_read_b128 a[52:55], v77 offset:38912
    v_mfma_f32_16x16x32_bf16 v[232:235], a[8:11], a[68:71], v[232:235]
    v_mfma_f32_16x16x32_bf16 v[140:143], a[12:15], a[56:59], v[140:143]
    ds_read_b64_tr_b16 a[8:9], v83 offset:16384
    ds_read_b64_tr_b16 a[10:11], v83 offset:17408
    v_mfma_f32_16x16x32_bf16 v[172:175], a[12:15], a[60:63], v[172:175]
    buffer_load_dwordx4 v73, s[44:47], s13 offen offset:1024 lds
    v_mfma_f32_16x16x32_bf16 v[204:207], a[12:15], a[64:67], v[204:207]
    v_mfma_f32_16x16x32_bf16 v[236:239], a[12:15], a[68:71], v[236:239]
    v_mfma_f32_16x16x32_bf16 v[144:147], a[16:19], a[56:59], v[144:147]
    ds_read_b64_tr_b16 a[12:13], v84 offset:16384
    ds_read_b64_tr_b16 a[14:15], v84 offset:17408
    v_mfma_f32_16x16x32_bf16 v[176:179], a[16:19], a[60:63], v[176:179]
    v_mfma_f32_16x16x32_bf16 v[208:211], a[16:19], a[64:67], v[208:211]
    buffer_load_dwordx4 v74, s[44:47], s13 offen offset:2048 lds
    v_mfma_f32_16x16x32_bf16 v[240:243], a[16:19], a[68:71], v[240:243]
    v_mfma_f32_16x16x32_bf16 v[148:151], a[20:23], a[56:59], v[148:151]
    ds_read_b64_tr_b16 a[16:17], v85 offset:16384
    ds_read_b64_tr_b16 a[18:19], v85 offset:17408
    v_mfma_f32_16x16x32_bf16 v[180:183], a[20:23], a[60:63], v[180:183]
    v_mfma_f32_16x16x32_bf16 v[212:215], a[20:23], a[64:67], v[212:215]
    v_mfma_f32_16x16x32_bf16 v[244:247], a[20:23], a[68:71], v[244:247]
    v_mfma_f32_16x16x32_bf16 v[152:155], a[24:27], a[56:59], v[152:155]
    ds_read_b64_tr_b16 a[20:21], v86 offset:16384
    ds_read_b64_tr_b16 a[22:23], v86 offset:17408
    v_mfma_f32_16x16x32_bf16 v[184:187], a[24:27], a[60:63], v[184:187]
    buffer_load_dwordx4 v75, s[44:47], s13 offen offset:3072 lds
    v_mfma_f32_16x16x32_bf16 v[216:219], a[24:27], a[64:67], v[216:219]
    v_mfma_f32_16x16x32_bf16 v[248:251], a[24:27], a[68:71], v[248:251]
    v_mfma_f32_16x16x32_bf16 v[156:159], a[28:31], a[56:59], v[156:159]
    ds_read_b64_tr_b16 a[24:25], v87 offset:16384
    ds_read_b64_tr_b16 a[26:27], v87 offset:17408
    v_mfma_f32_16x16x32_bf16 v[188:191], a[28:31], a[60:63], v[188:191]
    s_add_u32 m0, s16, 0
    v_mfma_f32_16x16x32_bf16 v[220:223], a[28:31], a[64:67], v[220:223]
    buffer_load_dwordx4 v64, s[32:35], s12 offen offset:0 lds
    v_mfma_f32_16x16x32_bf16 v[252:255], a[28:31], a[68:71], v[252:255]
    v_mfma_f32_16x16x32_bf16 v[112:115], a[32:35], a[56:59], v[112:115]
    ds_read_b64_tr_b16 a[28:29], v88 offset:16384
    ds_read_b64_tr_b16 a[30:31], v88 offset:17408
    v_mfma_f32_16x16x32_bf16 v[120:123], a[32:35], a[60:63], v[120:123]
    v_mfma_f32_16x16x32_bf16 v[116:119], a[36:39], a[56:59], v[116:119]
    ds_read_b64_tr_b16 a[32:33], v89 offset:4096
    ds_read_b64_tr_b16 a[34:35], v89 offset:4352
    v_mfma_f32_16x16x32_bf16 v[124:127], a[36:39], a[60:63], v[124:127]
    buffer_load_dwordx4 v65, s[32:35], s12 offen offset:1024 lds
    v_mfma_f32_16x16x32_bf16 v[104:107], a[112:115], a[80:83], v[104:107]
    s_waitcnt lgkmcnt(4)
    ds_read_b64_tr_b16 a[36:37], v90 offset:4096
    ds_read_b64_tr_b16 a[38:39], v90 offset:4352
    v_mfma_f32_16x16x32_bf16 v[128:131], a[0:3], a[40:43], v[128:131]
    v_mfma_f32_16x16x32_bf16 v[160:163], a[0:3], a[44:47], v[160:163]
    v_mfma_f32_16x16x32_bf16 v[192:195], a[0:3], a[48:51], v[192:195]
    v_mfma_f32_16x16x32_bf16 v[224:227], a[0:3], a[52:55], v[224:227]
    v_mfma_f32_16x16x32_bf16 v[96:99], a[112:115], a[0:3], v[96:99]
    buffer_load_dwordx4 v66, s[32:35], s12 offen offset:2048 lds
    v_mfma_f32_16x16x32_bf16 v[132:135], a[4:7], a[40:43], v[132:135]
    ds_read_b64_tr_b16 a[0:1], v81 offset:24576
    ds_read_b64_tr_b16 a[2:3], v81 offset:25600
    v_mfma_f32_16x16x32_bf16 v[164:167], a[4:7], a[44:47], v[164:167]
    ds_read_b128 a[56:59], v78 offset:32768
    v_mfma_f32_16x16x32_bf16 v[196:199], a[4:7], a[48:51], v[196:199]
    ds_read_b128 a[60:63], v78 offset:34816
    v_mfma_f32_16x16x32_bf16 v[228:231], a[4:7], a[52:55], v[228:231]
    v_mfma_f32_16x16x32_bf16 v[100:103], a[112:115], a[4:7], v[100:103]
    v_mfma_f32_16x16x32_bf16 v[136:139], a[8:11], a[40:43], v[136:139]
    buffer_load_dwordx4 v67, s[32:35], s12 offen offset:3072 lds
    ds_read_b64_tr_b16 a[4:5], v82 offset:24576
    ds_read_b64_tr_b16 a[6:7], v82 offset:25600
    v_mfma_f32_16x16x32_bf16 v[168:171], a[8:11], a[44:47], v[168:171]
    ds_read_b128 a[64:67], v78 offset:36864
    v_mfma_f32_16x16x32_bf16 v[200:203], a[8:11], a[48:51], v[200:203]
    ds_read_b128 a[68:71], v78 offset:38912
    v_mfma_f32_16x16x32_bf16 v[232:235], a[8:11], a[52:55], v[232:235]
    v_mfma_f32_16x16x32_bf16 v[140:143], a[12:15], a[40:43], v[140:143]
    ds_read_b64_tr_b16 a[8:9], v83 offset:24576
    ds_read_b64_tr_b16 a[10:11], v83 offset:25600
    v_mfma_f32_16x16x32_bf16 v[172:175], a[12:15], a[44:47], v[172:175]
    s_add_u32 m0, s16, 4096
    v_mfma_f32_16x16x32_bf16 v[204:207], a[12:15], a[48:51], v[204:207]
    ds_read_b64_tr_b16 a[80:81], v91 offset:4096
    ds_read_b64_tr_b16 a[82:83], v91 offset:4352
    v_mfma_f32_16x16x32_bf16 v[236:239], a[12:15], a[52:55], v[236:239]
    buffer_load_dwordx4 v68, s[32:35], s12 offen offset:0 lds
    v_mfma_f32_16x16x32_bf16 v[144:147], a[16:19], a[40:43], v[144:147]
    ds_read_b64_tr_b16 a[12:13], v84 offset:24576
    ds_read_b64_tr_b16 a[14:15], v84 offset:25600
    v_mfma_f32_16x16x32_bf16 v[176:179], a[16:19], a[44:47], v[176:179]
    v_mfma_f32_16x16x32_bf16 v[208:211], a[16:19], a[48:51], v[208:211]
    v_mfma_f32_16x16x32_bf16 v[240:243], a[16:19], a[52:55], v[240:243]
    buffer_load_dwordx4 v69, s[32:35], s12 offen offset:1024 lds
    v_mfma_f32_16x16x32_bf16 v[148:151], a[20:23], a[40:43], v[148:151]
    ds_read_b64_tr_b16 a[16:17], v85 offset:24576
    ds_read_b64_tr_b16 a[18:19], v85 offset:25600
    v_mfma_f32_16x16x32_bf16 v[180:183], a[20:23], a[44:47], v[180:183]
    v_mfma_f32_16x16x32_bf16 v[212:215], a[20:23], a[48:51], v[212:215]
    v_mfma_f32_16x16x32_bf16 v[244:247], a[20:23], a[52:55], v[244:247]
    v_mfma_f32_16x16x32_bf16 v[152:155], a[24:27], a[40:43], v[152:155]
    s_waitcnt lgkmcnt(15)
    ds_read_b64_tr_b16 a[20:21], v86 offset:24576
    ds_read_b64_tr_b16 a[22:23], v86 offset:25600
    v_mfma_f32_16x16x32_bf16 v[184:187], a[24:27], a[44:47], v[184:187]
    buffer_load_dwordx4 v70, s[32:35], s12 offen offset:2048 lds
    v_mfma_f32_16x16x32_bf16 v[216:219], a[24:27], a[48:51], v[216:219]
    v_mfma_f32_16x16x32_bf16 v[248:251], a[24:27], a[52:55], v[248:251]
    v_mfma_f32_16x16x32_bf16 v[156:159], a[28:31], a[40:43], v[156:159]
    ds_read_b64_tr_b16 a[24:25], v87 offset:24576
    ds_read_b64_tr_b16 a[26:27], v87 offset:25600
    v_mfma_f32_16x16x32_bf16 v[188:191], a[28:31], a[44:47], v[188:191]
    v_mfma_f32_16x16x32_bf16 v[220:223], a[28:31], a[48:51], v[220:223]
    v_mfma_f32_16x16x32_bf16 v[252:255], a[28:31], a[52:55], v[252:255]
    buffer_load_dwordx4 v71, s[32:35], s12 offen offset:3072 lds
    v_mfma_f32_16x16x32_bf16 v[112:115], a[32:35], a[40:43], v[112:115]
    ds_read_b64_tr_b16 a[28:29], v88 offset:24576
    ds_read_b64_tr_b16 a[30:31], v88 offset:25600
    v_mfma_f32_16x16x32_bf16 v[120:123], a[32:35], a[44:47], v[120:123]
    v_mfma_f32_16x16x32_bf16 v[116:119], a[36:39], a[40:43], v[116:119]
    ds_read_b64_tr_b16 a[32:33], v89 offset:6144
    ds_read_b64_tr_b16 a[34:35], v89 offset:6400
    v_mfma_f32_16x16x32_bf16 v[124:127], a[36:39], a[44:47], v[124:127]
    s_lshl_b32 s14, s15, 16
    ds_read_b64_tr_b16 a[36:37], v90 offset:6144
    ds_read_b64_tr_b16 a[38:39], v90 offset:6400
    s_waitcnt lgkmcnt(6)
    v_mfma_f32_16x16x32_bf16 v[128:131], a[0:3], a[56:59], v[128:131]
    s_add_u32 m0, s18, 0
    v_mfma_f32_16x16x32_bf16 v[160:163], a[0:3], a[60:63], v[160:163]
    buffer_load_dwordx4 v76, s[52:55], s14 offen lds
    v_mfma_f32_16x16x32_bf16 v[192:195], a[0:3], a[64:67], v[192:195]
    buffer_load_dword v26, off, s[76:79], s23 offset:0 sc1
    v_mfma_f32_16x16x32_bf16 v[224:227], a[0:3], a[68:71], v[224:227]
    s_waitcnt vmcnt(14) lgkmcnt(0)
    s_barrier
    v_mfma_f32_16x16x32_bf16 v[96:99], a[112:115], a[0:3], v[96:99]
    v_mfma_f32_16x16x32_bf16 v[132:135], a[4:7], a[56:59], v[132:135]
    s_add_u32 s15, s10, 7
    s_and_b32 s15, s15, 7
    ds_read_b64_tr_b16 a[0:1], v81 offset:32768
    ds_read_b64_tr_b16 a[2:3], v81 offset:33792
    v_mfma_f32_16x16x32_bf16 v[164:167], a[4:7], a[60:63], v[164:167]
    s_lshl_b32 s13, s15, 19
    ds_read_b128 a[40:43], v79 offset:0
    v_mfma_f32_16x16x32_bf16 v[196:199], a[4:7], a[64:67], v[196:199]
    s_lshl_b32 s12, s15, 7
    ds_read_b128 a[44:47], v79 offset:2048
    v_mfma_f32_16x16x32_bf16 v[228:231], a[4:7], a[68:71], v[228:231]
    s_add_u32 m0, s17, 16384
    v_mfma_f32_16x16x32_bf16 v[100:103], a[112:115], a[4:7], v[100:103]
    buffer_load_dwordx4 v72, s[44:47], s13 offen offset:0 lds
    v_mfma_f32_16x16x32_bf16 v[136:139], a[8:11], a[56:59], v[136:139]
    ds_read_b64_tr_b16 a[4:5], v82 offset:32768
    ds_read_b64_tr_b16 a[6:7], v82 offset:33792
    v_mfma_f32_16x16x32_bf16 v[168:171], a[8:11], a[60:63], v[168:171]
    ds_read_b128 a[48:51], v79 offset:4096
    v_mfma_f32_16x16x32_bf16 v[200:203], a[8:11], a[64:67], v[200:203]
    ds_read_b128 a[52:55], v79 offset:6144
    v_mfma_f32_16x16x32_bf16 v[232:235], a[8:11], a[68:71], v[232:235]
    v_mfma_f32_16x16x32_bf16 v[140:143], a[12:15], a[56:59], v[140:143]
    ds_read_b64_tr_b16 a[8:9], v83 offset:32768
    ds_read_b64_tr_b16 a[10:11], v83 offset:33792
    v_mfma_f32_16x16x32_bf16 v[172:175], a[12:15], a[60:63], v[172:175]
    buffer_load_dwordx4 v73, s[44:47], s13 offen offset:1024 lds
    v_mfma_f32_16x16x32_bf16 v[204:207], a[12:15], a[64:67], v[204:207]
    v_mfma_f32_16x16x32_bf16 v[236:239], a[12:15], a[68:71], v[236:239]
    v_mfma_f32_16x16x32_bf16 v[144:147], a[16:19], a[56:59], v[144:147]
    ds_read_b64_tr_b16 a[12:13], v84 offset:32768
    ds_read_b64_tr_b16 a[14:15], v84 offset:33792
    v_mfma_f32_16x16x32_bf16 v[176:179], a[16:19], a[60:63], v[176:179]
    v_mfma_f32_16x16x32_bf16 v[208:211], a[16:19], a[64:67], v[208:211]
    buffer_load_dwordx4 v74, s[44:47], s13 offen offset:2048 lds
    v_mfma_f32_16x16x32_bf16 v[240:243], a[16:19], a[68:71], v[240:243]
    v_mfma_f32_16x16x32_bf16 v[148:151], a[20:23], a[56:59], v[148:151]
    ds_read_b64_tr_b16 a[16:17], v85 offset:32768
    ds_read_b64_tr_b16 a[18:19], v85 offset:33792
    v_mfma_f32_16x16x32_bf16 v[180:183], a[20:23], a[60:63], v[180:183]
    v_mfma_f32_16x16x32_bf16 v[212:215], a[20:23], a[64:67], v[212:215]
    v_mfma_f32_16x16x32_bf16 v[244:247], a[20:23], a[68:71], v[244:247]
    v_mfma_f32_16x16x32_bf16 v[152:155], a[24:27], a[56:59], v[152:155]
    ds_read_b64_tr_b16 a[20:21], v86 offset:32768
    ds_read_b64_tr_b16 a[22:23], v86 offset:33792
    v_mfma_f32_16x16x32_bf16 v[184:187], a[24:27], a[60:63], v[184:187]
    buffer_load_dwordx4 v75, s[44:47], s13 offen offset:3072 lds
    v_mfma_f32_16x16x32_bf16 v[216:219], a[24:27], a[64:67], v[216:219]
    v_mfma_f32_16x16x32_bf16 v[248:251], a[24:27], a[68:71], v[248:251]
    v_mfma_f32_16x16x32_bf16 v[156:159], a[28:31], a[56:59], v[156:159]
    ds_read_b64_tr_b16 a[24:25], v87 offset:32768
    ds_read_b64_tr_b16 a[26:27], v87 offset:33792
    v_mfma_f32_16x16x32_bf16 v[188:191], a[28:31], a[60:63], v[188:191]
    s_add_u32 m0, s16, 32768
    v_mfma_f32_16x16x32_bf16 v[220:223], a[28:31], a[64:67], v[220:223]
    buffer_load_dwordx4 v64, s[32:35], s12 offen offset:0 lds
    v_mfma_f32_16x16x32_bf16 v[252:255], a[28:31], a[68:71], v[252:255]
    v_mfma_f32_16x16x32_bf16 v[112:115], a[32:35], a[56:59], v[112:115]
    ds_read_b64_tr_b16 a[28:29], v88 offset:32768
    ds_read_b64_tr_b16 a[30:31], v88 offset:33792
    v_mfma_f32_16x16x32_bf16 v[120:123], a[32:35], a[60:63], v[120:123]
    v_mfma_f32_16x16x32_bf16 v[116:119], a[36:39], a[56:59], v[116:119]
    ds_read_b64_tr_b16 a[32:33], v89 offset:8192
    ds_read_b64_tr_b16 a[34:35], v89 offset:8448
    v_mfma_f32_16x16x32_bf16 v[124:127], a[36:39], a[60:63], v[124:127]
    buffer_load_dwordx4 v65, s[32:35], s12 offen offset:1024 lds
    v_mfma_f32_16x16x32_bf16 v[104:107], a[112:115], a[80:83], v[104:107]
    s_waitcnt lgkmcnt(4)
    ds_read_b64_tr_b16 a[36:37], v90 offset:8192
    ds_read_b64_tr_b16 a[38:39], v90 offset:8448
    v_mfma_f32_16x16x32_bf16 v[128:131], a[0:3], a[40:43], v[128:131]
    v_mfma_f32_16x16x32_bf16 v[160:163], a[0:3], a[44:47], v[160:163]
    v_mfma_f32_16x16x32_bf16 v[192:195], a[0:3], a[48:51], v[192:195]
    v_mfma_f32_16x16x32_bf16 v[224:227], a[0:3], a[52:55], v[224:227]
    v_mfma_f32_16x16x32_bf16 v[96:99], a[112:115], a[0:3], v[96:99]
    buffer_load_dwordx4 v66, s[32:35], s12 offen offset:2048 lds
    v_mfma_f32_16x16x32_bf16 v[132:135], a[4:7], a[40:43], v[132:135]
    ds_read_b64_tr_b16 a[0:1], v81 offset:40960
    ds_read_b64_tr_b16 a[2:3], v81 offset:41984
    v_mfma_f32_16x16x32_bf16 v[164:167], a[4:7], a[44:47], v[164:167]
    ds_read_b128 a[56:59], v80 offset:0
    v_mfma_f32_16x16x32_bf16 v[196:199], a[4:7], a[48:51], v[196:199]
    ds_read_b128 a[60:63], v80 offset:2048
    v_mfma_f32_16x16x32_bf16 v[228:231], a[4:7], a[52:55], v[228:231]
    v_mfma_f32_16x16x32_bf16 v[100:103], a[112:115], a[4:7], v[100:103]
    v_mfma_f32_16x16x32_bf16 v[136:139], a[8:11], a[40:43], v[136:139]
    buffer_load_dwordx4 v67, s[32:35], s12 offen offset:3072 lds
    ds_read_b64_tr_b16 a[4:5], v82 offset:40960
    ds_read_b64_tr_b16 a[6:7], v82 offset:41984
    v_mfma_f32_16x16x32_bf16 v[168:171], a[8:11], a[44:47], v[168:171]
    ds_read_b128 a[64:67], v80 offset:4096
    v_mfma_f32_16x16x32_bf16 v[200:203], a[8:11], a[48:51], v[200:203]
    ds_read_b128 a[68:71], v80 offset:6144
    v_mfma_f32_16x16x32_bf16 v[232:235], a[8:11], a[52:55], v[232:235]
    v_mfma_f32_16x16x32_bf16 v[140:143], a[12:15], a[40:43], v[140:143]
    ds_read_b64_tr_b16 a[8:9], v83 offset:40960
    ds_read_b64_tr_b16 a[10:11], v83 offset:41984
    v_mfma_f32_16x16x32_bf16 v[172:175], a[12:15], a[44:47], v[172:175]
    s_add_u32 m0, s16, 36864
    v_mfma_f32_16x16x32_bf16 v[204:207], a[12:15], a[48:51], v[204:207]
    ds_read_b64_tr_b16 a[80:81], v91 offset:8192
    ds_read_b64_tr_b16 a[82:83], v91 offset:8448
    v_mfma_f32_16x16x32_bf16 v[236:239], a[12:15], a[52:55], v[236:239]
    buffer_load_dwordx4 v68, s[32:35], s12 offen offset:0 lds
    v_mfma_f32_16x16x32_bf16 v[144:147], a[16:19], a[40:43], v[144:147]
    ds_read_b64_tr_b16 a[12:13], v84 offset:40960
    ds_read_b64_tr_b16 a[14:15], v84 offset:41984
    v_mfma_f32_16x16x32_bf16 v[176:179], a[16:19], a[44:47], v[176:179]
    v_mfma_f32_16x16x32_bf16 v[208:211], a[16:19], a[48:51], v[208:211]
    v_mfma_f32_16x16x32_bf16 v[240:243], a[16:19], a[52:55], v[240:243]
    buffer_load_dwordx4 v69, s[32:35], s12 offen offset:1024 lds
    v_mfma_f32_16x16x32_bf16 v[148:151], a[20:23], a[40:43], v[148:151]
    ds_read_b64_tr_b16 a[16:17], v85 offset:40960
    ds_read_b64_tr_b16 a[18:19], v85 offset:41984
    v_mfma_f32_16x16x32_bf16 v[180:183], a[20:23], a[44:47], v[180:183]
    v_mfma_f32_16x16x32_bf16 v[212:215], a[20:23], a[48:51], v[212:215]
    v_mfma_f32_16x16x32_bf16 v[244:247], a[20:23], a[52:55], v[244:247]
    v_mfma_f32_16x16x32_bf16 v[152:155], a[24:27], a[40:43], v[152:155]
    s_waitcnt lgkmcnt(15)
    ds_read_b64_tr_b16 a[20:21], v86 offset:40960
    ds_read_b64_tr_b16 a[22:23], v86 offset:41984
    v_mfma_f32_16x16x32_bf16 v[184:187], a[24:27], a[44:47], v[184:187]
    buffer_load_dwordx4 v70, s[32:35], s12 offen offset:2048 lds
    v_mfma_f32_16x16x32_bf16 v[216:219], a[24:27], a[48:51], v[216:219]
    v_mfma_f32_16x16x32_bf16 v[248:251], a[24:27], a[52:55], v[248:251]
    v_mfma_f32_16x16x32_bf16 v[156:159], a[28:31], a[40:43], v[156:159]
    ds_read_b64_tr_b16 a[24:25], v87 offset:40960
    ds_read_b64_tr_b16 a[26:27], v87 offset:41984
    s_waitcnt vmcnt(11)
    v_cmp_gt_u32 vcc, 32, v26
    s_cbranch_vccnz L_spin_3
    L_back_4:
    v_mfma_f32_16x16x32_bf16 v[188:191], a[28:31], a[44:47], v[188:191]
    v_mfma_f32_16x16x32_bf16 v[220:223], a[28:31], a[48:51], v[220:223]
    v_mfma_f32_16x16x32_bf16 v[252:255], a[28:31], a[52:55], v[252:255]
    buffer_load_dwordx4 v71, s[32:35], s12 offen offset:3072 lds
    v_mfma_f32_16x16x32_bf16 v[112:115], a[32:35], a[40:43], v[112:115]
    ds_read_b64_tr_b16 a[28:29], v88 offset:40960
    ds_read_b64_tr_b16 a[30:31], v88 offset:41984
    v_mfma_f32_16x16x32_bf16 v[120:123], a[32:35], a[44:47], v[120:123]
    v_mfma_f32_16x16x32_bf16 v[116:119], a[36:39], a[40:43], v[116:119]
    ds_read_b64_tr_b16 a[32:33], v89 offset:10240
    ds_read_b64_tr_b16 a[34:35], v89 offset:10496
    v_mfma_f32_16x16x32_bf16 v[124:127], a[36:39], a[44:47], v[124:127]
    s_lshl_b32 s14, s15, 16
    ds_read_b64_tr_b16 a[36:37], v90 offset:10240
    ds_read_b64_tr_b16 a[38:39], v90 offset:10496
    s_waitcnt lgkmcnt(6)
    v_mfma_f32_16x16x32_bf16 v[128:131], a[0:3], a[56:59], v[128:131]
    s_add_u32 m0, s18, 4096
    buffer_load_dwordx4 v[28:31], v57, s[76:79], s93 offen sc1
    v_mfma_f32_16x16x32_bf16 v[160:163], a[0:3], a[60:63], v[160:163]
    buffer_load_dwordx4 v76, s[52:55], s14 offen lds
    v_mfma_f32_16x16x32_bf16 v[192:195], a[0:3], a[64:67], v[192:195]
    buffer_load_dwordx4 v[32:35], v57, s[76:79], s93 offen offset:256 sc1
    buffer_load_dwordx2 v[108:109], v57, s[76:79], s94 offen sc1
    v_mfma_f32_16x16x32_bf16 v[224:227], a[0:3], a[68:71], v[224:227]
    s_waitcnt lgkmcnt(0)
    s_barrier
    v_mfma_f32_16x16x32_bf16 v[96:99], a[112:115], a[0:3], v[96:99]
    v_mfma_f32_16x16x32_bf16 v[132:135], a[4:7], a[56:59], v[132:135]
    ds_read_b64_tr_b16 a[0:1], v81 offset:0
    ds_read_b64_tr_b16 a[2:3], v81 offset:1024
    v_mfma_f32_16x16x32_bf16 v[164:167], a[4:7], a[60:63], v[164:167]
    ds_read_b128 a[40:43], v77 offset:0
    v_mfma_f32_16x16x32_bf16 v[196:199], a[4:7], a[64:67], v[196:199]
    ds_read_b128 a[44:47], v77 offset:2048
    v_mfma_f32_16x16x32_bf16 v[228:231], a[4:7], a[68:71], v[228:231]
    buffer_load_dwordx2 v[110:111], v57, s[76:79], s94 offen offset:256 sc1
    v_mfma_f32_16x16x32_bf16 v[100:103], a[112:115], a[4:7], v[100:103]
    v_mfma_f32_16x16x32_bf16 v[136:139], a[8:11], a[56:59], v[136:139]
    s_and_b32 s21, s3, 4
    ds_read_b64_tr_b16 a[4:5], v82 offset:0
    ds_read_b64_tr_b16 a[6:7], v82 offset:1024
    v_mfma_f32_16x16x32_bf16 v[168:171], a[8:11], a[60:63], v[168:171]
    s_lshl_b32 s21, s21, 14
    ds_read_b128 a[48:51], v77 offset:4096
    v_mfma_f32_16x16x32_bf16 v[200:203], a[8:11], a[64:67], v[200:203]
    s_add_u32 m0, s19, 0
    ds_read_b128 a[52:55], v77 offset:6144
    v_mfma_f32_16x16x32_bf16 v[232:235], a[8:11], a[68:71], v[232:235]
    buffer_load_dwordx4 v17, s[36:39], s21 offen offset:0 lds
    v_mfma_f32_16x16x32_bf16 v[140:143], a[12:15], a[56:59], v[140:143]
    ds_read_b64_tr_b16 a[8:9], v83 offset:0
    ds_read_b64_tr_b16 a[10:11], v83 offset:1024
    v_mfma_f32_16x16x32_bf16 v[172:175], a[12:15], a[60:63], v[172:175]
    v_mfma_f32_16x16x32_bf16 v[204:207], a[12:15], a[64:67], v[204:207]
    v_mfma_f32_16x16x32_bf16 v[236:239], a[12:15], a[68:71], v[236:239]
    v_mfma_f32_16x16x32_bf16 v[144:147], a[16:19], a[56:59], v[144:147]
    ds_read_b64_tr_b16 a[12:13], v84 offset:0
    ds_read_b64_tr_b16 a[14:15], v84 offset:1024
    v_mfma_f32_16x16x32_bf16 v[176:179], a[16:19], a[60:63], v[176:179]
    v_mfma_f32_16x16x32_bf16 v[208:211], a[16:19], a[64:67], v[208:211]
    v_mfma_f32_16x16x32_bf16 v[240:243], a[16:19], a[68:71], v[240:243]
    v_mfma_f32_16x16x32_bf16 v[148:151], a[20:23], a[56:59], v[148:151]
    ds_read_b64_tr_b16 a[16:17], v85 offset:0
    ds_read_b64_tr_b16 a[18:19], v85 offset:1024
    v_mfma_f32_16x16x32_bf16 v[180:183], a[20:23], a[60:63], v[180:183]
    buffer_load_dwordx4 v18, s[36:39], s21 offen offset:1024 lds
    v_mfma_f32_16x16x32_bf16 v[212:215], a[20:23], a[64:67], v[212:215]
    v_mfma_f32_16x16x32_bf16 v[244:247], a[20:23], a[68:71], v[244:247]
    v_mfma_f32_16x16x32_bf16 v[152:155], a[24:27], a[56:59], v[152:155]
    ds_read_b64_tr_b16 a[20:21], v86 offset:0
    ds_read_b64_tr_b16 a[22:23], v86 offset:1024
    v_mfma_f32_16x16x32_bf16 v[184:187], a[24:27], a[60:63], v[184:187]
    v_mfma_f32_16x16x32_bf16 v[216:219], a[24:27], a[64:67], v[216:219]
    v_mfma_f32_16x16x32_bf16 v[248:251], a[24:27], a[68:71], v[248:251]
    v_mfma_f32_16x16x32_bf16 v[156:159], a[28:31], a[56:59], v[156:159]
    s_and_b32 s22, s3, 4
    ds_read_b64_tr_b16 a[24:25], v87 offset:0
    ds_read_b64_tr_b16 a[26:27], v87 offset:1024
    v_mfma_f32_16x16x32_bf16 v[188:191], a[28:31], a[60:63], v[188:191]
    s_lshl_b32 s22, s22, 14
    v_mfma_f32_16x16x32_bf16 v[220:223], a[28:31], a[64:67], v[220:223]
    s_add_u32 m0, s20, 0
    v_mfma_f32_16x16x32_bf16 v[252:255], a[28:31], a[68:71], v[252:255]
    buffer_load_dwordx4 v19, s[40:43], s22 offen offset:0 lds
    v_mfma_f32_16x16x32_bf16 v[112:115], a[32:35], a[56:59], v[112:115]
    ds_read_b64_tr_b16 a[28:29], v88 offset:0
    ds_read_b64_tr_b16 a[30:31], v88 offset:1024
    v_mfma_f32_16x16x32_bf16 v[120:123], a[32:35], a[60:63], v[120:123]
    v_mfma_f32_16x16x32_bf16 v[116:119], a[36:39], a[56:59], v[116:119]
    ds_read_b64_tr_b16 a[32:33], v89 offset:0
    ds_read_b64_tr_b16 a[34:35], v89 offset:256
    v_mfma_f32_16x16x32_bf16 v[124:127], a[36:39], a[60:63], v[124:127]
    v_mfma_f32_16x16x32_bf16 v[104:107], a[112:115], a[80:83], v[104:107]
    s_waitcnt lgkmcnt(4)
    ds_read_b64_tr_b16 a[36:37], v90 offset:0
    ds_read_b64_tr_b16 a[38:39], v90 offset:256
    v_mfma_f32_16x16x32_bf16 v[128:131], a[0:3], a[40:43], v[128:131]
    v_mfma_f32_16x16x32_bf16 v[160:163], a[0:3], a[44:47], v[160:163]
    v_mfma_f32_16x16x32_bf16 v[192:195], a[0:3], a[48:51], v[192:195]
    v_mfma_f32_16x16x32_bf16 v[224:227], a[0:3], a[52:55], v[224:227]
    v_mfma_f32_16x16x32_bf16 v[96:99], a[112:115], a[0:3], v[96:99]
    buffer_load_dwordx4 v20, s[40:43], s22 offen offset:1024 lds
    v_mfma_f32_16x16x32_bf16 v[132:135], a[4:7], a[40:43], v[132:135]
    ds_read_b64_tr_b16 a[0:1], v81 offset:8192
    ds_read_b64_tr_b16 a[2:3], v81 offset:9216
    v_mfma_f32_16x16x32_bf16 v[164:167], a[4:7], a[44:47], v[164:167]
    ds_read_b128 a[56:59], v78 offset:0
    v_mfma_f32_16x16x32_bf16 v[196:199], a[4:7], a[48:51], v[196:199]
    ds_read_b128 a[60:63], v78 offset:2048
    v_mfma_f32_16x16x32_bf16 v[228:231], a[4:7], a[52:55], v[228:231]
    v_mfma_f32_16x16x32_bf16 v[100:103], a[112:115], a[4:7], v[100:103]
    v_mfma_f32_16x16x32_bf16 v[136:139], a[8:11], a[40:43], v[136:139]
    ds_read_b64_tr_b16 a[4:5], v82 offset:8192
    ds_read_b64_tr_b16 a[6:7], v82 offset:9216
    v_mfma_f32_16x16x32_bf16 v[168:171], a[8:11], a[44:47], v[168:171]
    s_add_u32 s21, s21, 0x2000
    ds_read_b128 a[64:67], v78 offset:4096
    v_mfma_f32_16x16x32_bf16 v[200:203], a[8:11], a[48:51], v[200:203]
    s_and_b32 s21, s21, 0x1ffff
    ds_read_b128 a[68:71], v78 offset:6144
    v_mfma_f32_16x16x32_bf16 v[232:235], a[8:11], a[52:55], v[232:235]
    s_add_u32 m0, s19, 8192
    v_mfma_f32_16x16x32_bf16 v[140:143], a[12:15], a[40:43], v[140:143]
    ds_read_b64_tr_b16 a[8:9], v83 offset:8192
    ds_read_b64_tr_b16 a[10:11], v83 offset:9216
    v_mfma_f32_16x16x32_bf16 v[172:175], a[12:15], a[44:47], v[172:175]
    buffer_load_dwordx4 v17, s[36:39], s21 offen offset:0 lds
    v_mfma_f32_16x16x32_bf16 v[204:207], a[12:15], a[48:51], v[204:207]
    ds_read_b64_tr_b16 a[80:81], v91 offset:0
    ds_read_b64_tr_b16 a[82:83], v91 offset:256
    v_mfma_f32_16x16x32_bf16 v[236:239], a[12:15], a[52:55], v[236:239]
    v_mfma_f32_16x16x32_bf16 v[144:147], a[16:19], a[40:43], v[144:147]
    ds_read_b64_tr_b16 a[12:13], v84 offset:8192
    ds_read_b64_tr_b16 a[14:15], v84 offset:9216
    v_mfma_f32_16x16x32_bf16 v[176:179], a[16:19], a[44:47], v[176:179]
    v_mfma_f32_16x16x32_bf16 v[208:211], a[16:19], a[48:51], v[208:211]
    v_mfma_f32_16x16x32_bf16 v[240:243], a[16:19], a[52:55], v[240:243]
    v_mfma_f32_16x16x32_bf16 v[148:151], a[20:23], a[40:43], v[148:151]
    ds_read_b64_tr_b16 a[16:17], v85 offset:8192
    ds_read_b64_tr_b16 a[18:19], v85 offset:9216
    v_mfma_f32_16x16x32_bf16 v[180:183], a[20:23], a[44:47], v[180:183]
    v_mfma_f32_16x16x32_bf16 v[212:215], a[20:23], a[48:51], v[212:215]
    buffer_load_dwordx4 v18, s[36:39], s21 offen offset:1024 lds
    v_mfma_f32_16x16x32_bf16 v[244:247], a[20:23], a[52:55], v[244:247]
    v_mfma_f32_16x16x32_bf16 v[152:155], a[24:27], a[40:43], v[152:155]
    s_waitcnt lgkmcnt(15)
    ds_read_b64_tr_b16 a[20:21], v86 offset:8192
    ds_read_b64_tr_b16 a[22:23], v86 offset:9216
    v_mfma_f32_16x16x32_bf16 v[184:187], a[24:27], a[44:47], v[184:187]
    v_mfma_f32_16x16x32_bf16 v[216:219], a[24:27], a[48:51], v[216:219]
    v_cmp_gt_u32 vcc, 16, v0
    s_waitcnt vmcnt(10)
    v_sub_f32 v50, 0, v28
    v_mfma_f32_16x16x32_bf16 v[248:251], a[24:27], a[52:55], v[248:251]
    v_cndmask_b32 v50, 0, v50, vcc
    v_cvt_pk_bf16_f32 v51, v50, v50
    v_mfma_f32_16x16x32_bf16 v[156:159], a[28:31], a[40:43], v[156:159]
    ds_read_b64_tr_b16 a[24:25], v87 offset:8192
    ds_read_b64_tr_b16 a[26:27], v87 offset:9216
    v_mfma_f32_16x16x32_bf16 v[188:191], a[28:31], a[44:47], v[188:191]
    v_and_b32 v51, 0xffff0000, v51
    v_sub_f32 v51, v50, v51
    v_mfma_f32_16x16x32_bf16 v[220:223], a[28:31], a[48:51], v[220:223]
    v_cvt_pk_bf16_f32 v50, v50, v51
    v_accvgpr_write_b32 a116, v50
    v_mfma_f32_16x16x32_bf16 v[252:255], a[28:31], a[52:55], v[252:255]
    v_accvgpr_write_b32 a117, v50
    v_mul_f32 v31, 0x3e0293ee, v29
    v_mfma_f32_16x16x32_bf16 v[112:115], a[32:35], a[40:43], v[112:115]
    ds_read_b64_tr_b16 a[28:29], v88 offset:8192
    ds_read_b64_tr_b16 a[30:31], v88 offset:9216
    v_mfma_f32_16x16x32_bf16 v[120:123], a[32:35], a[44:47], v[120:123]
    s_waitcnt vmcnt(8)
    v_sub_f32 v50, 0, v32
    v_cndmask_b32 v50, 0, v50, vcc
    v_mfma_f32_16x16x32_bf16 v[116:119], a[36:39], a[40:43], v[116:119]
    ds_read_b64_tr_b16 a[32:33], v89 offset:2048
    ds_read_b64_tr_b16 a[34:35], v89 offset:2304
    v_mfma_f32_16x16x32_bf16 v[124:127], a[36:39], a[44:47], v[124:127]
    s_waitcnt lgkmcnt(4)
    ds_read_b64_tr_b16 a[36:37], v90 offset:2048
    ds_read_b64_tr_b16 a[38:39], v90 offset:2304
    v_mfma_f32_16x16x32_bf16 v[128:131], a[0:3], a[56:59], v[128:131]
    v_cvt_pk_bf16_f32 v51, v50, v50
    v_and_b32 v51, 0xffff0000, v51
    v_mfma_f32_16x16x32_bf16 v[160:163], a[0:3], a[60:63], v[160:163]
    v_sub_f32 v51, v50, v51
    v_cvt_pk_bf16_f32 v50, v50, v51
    v_mfma_f32_16x16x32_bf16 v[192:195], a[0:3], a[64:67], v[192:195]
    v_accvgpr_write_b32 a118, v50
    v_accvgpr_write_b32 a119, v50
    v_mfma_f32_16x16x32_bf16 v[224:227], a[0:3], a[68:71], v[224:227]
    s_waitcnt lgkmcnt(0)
    s_barrier
    v_mfma_f32_16x16x32_bf16 v[96:99], a[112:115], a[0:3], v[96:99]
    v_mul_f32 v35, 0x3e0293ee, v33
    s_waitcnt vmcnt(7)
    v_sub_f32 v50, 0, v108
    v_mfma_f32_16x16x32_bf16 v[132:135], a[4:7], a[56:59], v[132:135]
    ds_read_b64_tr_b16 a[0:1], v81 offset:16384
    ds_read_b64_tr_b16 a[2:3], v81 offset:17408
    v_mfma_f32_16x16x32_bf16 v[164:167], a[4:7], a[60:63], v[164:167]
    ds_read_b128 a[40:43], v77 offset:32768
    v_cndmask_b32 v50, 0, v50, vcc
    v_mfma_f32_16x16x32_bf16 v[196:199], a[4:7], a[64:67], v[196:199]
    ds_read_b128 a[44:47], v77 offset:34816
    v_cvt_pk_bf16_f32 v51, v50, v50
    v_mfma_f32_16x16x32_bf16 v[228:231], a[4:7], a[68:71], v[228:231]
    v_and_b32 v51, 0xffff0000, v51
    v_sub_f32 v51, v50, v51
    v_mfma_f32_16x16x32_bf16 v[100:103], a[112:115], a[4:7], v[100:103]
    v_cvt_pk_bf16_f32 v50, v50, v51
    v_accvgpr_write_b32 a120, v50
    v_mfma_f32_16x16x32_bf16 v[136:139], a[8:11], a[56:59], v[136:139]
    ds_read_b64_tr_b16 a[4:5], v82 offset:16384
    ds_read_b64_tr_b16 a[6:7], v82 offset:17408
    v_mfma_f32_16x16x32_bf16 v[168:171], a[8:11], a[60:63], v[168:171]
    ds_read_b128 a[48:51], v77 offset:36864
    v_accvgpr_write_b32 a121, v50
    v_mfma_f32_16x16x32_bf16 v[200:203], a[8:11], a[64:67], v[200:203]
    ds_read_b128 a[52:55], v77 offset:38912
    v_mul_f32 v109, 0x3e0293ee, v109
    v_mfma_f32_16x16x32_bf16 v[232:235], a[8:11], a[68:71], v[232:235]
    s_waitcnt vmcnt(6)
    v_sub_f32 v50, 0, v110
    v_cndmask_b32 v50, 0, v50, vcc
    v_mfma_f32_16x16x32_bf16 v[140:143], a[12:15], a[56:59], v[140:143]
    ds_read_b64_tr_b16 a[8:9], v83 offset:16384
    ds_read_b64_tr_b16 a[10:11], v83 offset:17408
    v_mfma_f32_16x16x32_bf16 v[172:175], a[12:15], a[60:63], v[172:175]
L_warm0_2:
    s_cbranch_execz L_warm_ret0
    v_cvt_pk_bf16_f32 v51, v50, v50
    v_and_b32 v51, 0xffff0000, v51
    v_mfma_f32_16x16x32_bf16 v[204:207], a[12:15], a[64:67], v[204:207]
    v_sub_f32 v51, v50, v51
    v_cvt_pk_bf16_f32 v50, v50, v51
    v_mfma_f32_16x16x32_bf16 v[236:239], a[12:15], a[68:71], v[236:239]
    v_accvgpr_write_b32 a122, v50
    v_accvgpr_write_b32 a123, v50
    v_mfma_f32_16x16x32_bf16 v[144:147], a[16:19], a[56:59], v[144:147]
    ds_read_b64_tr_b16 a[12:13], v84 offset:16384
    ds_read_b64_tr_b16 a[14:15], v84 offset:17408
    v_mfma_f32_16x16x32_bf16 v[176:179], a[16:19], a[60:63], v[176:179]
    v_mul_f32 v111, 0x3e0293ee, v111
    v_and_b32 v54, 15, v0
    v_mfma_f32_16x16x32_bf16 v[208:211], a[16:19], a[64:67], v[208:211]
    ds_read_b64_tr_b16 a[84:85], v91 offset:4096
    ds_read_b64_tr_b16 a[86:87], v91 offset:4352
    v_mfma_f32_16x16x32_bf16 v[240:243], a[16:19], a[68:71], v[240:243]
    v_lshlrev_b32 v54, 2, v54
    v_add_u32 v54, 160256, v54
    v_mfma_f32_16x16x32_bf16 v[148:151], a[20:23], a[56:59], v[148:151]
    s_add_u32 s22, s22, 0x2000
    ds_read_b64_tr_b16 a[16:17], v85 offset:16384
    ds_read_b64_tr_b16 a[18:19], v85 offset:17408
    v_mfma_f32_16x16x32_bf16 v[180:183], a[20:23], a[60:63], v[180:183]
    s_and_b32 s22, s22, 0x1ffff
    s_lshl_b32 s24, s5, 6
    v_add_u32 v55, s24, v54
    v_mfma_f32_16x16x32_bf16 v[212:215], a[20:23], a[64:67], v[212:215]
    s_add_u32 m0, s20, 8192
    ds_read_b64_tr_b16 a[72:73], v81 offset:24576
    ds_read_b64_tr_b16 a[74:75], v81 offset:25600
    v_mfma_f32_16x16x32_bf16 v[244:247], a[20:23], a[68:71], v[244:247]
    buffer_load_dwordx4 v19, s[40:43], s22 offen offset:0 lds
    v_mfma_f32_16x16x32_bf16 v[152:155], a[24:27], a[56:59], v[152:155]
    ds_read_b64_tr_b16 a[20:21], v86 offset:16384
    ds_read_b64_tr_b16 a[22:23], v86 offset:17408
    v_mfma_f32_16x16x32_bf16 v[184:187], a[24:27], a[60:63], v[184:187]
    v_mfma_f32_16x16x32_bf16 v[216:219], a[24:27], a[64:67], v[216:219]
    ds_read_b64_tr_b16 a[76:77], v82 offset:24576
    ds_read_b64_tr_b16 a[78:79], v82 offset:25600
    v_mfma_f32_16x16x32_bf16 v[248:251], a[24:27], a[68:71], v[248:251]
    v_mfma_f32_16x16x32_bf16 v[156:159], a[28:31], a[56:59], v[156:159]
    ds_read_b64_tr_b16 a[24:25], v87 offset:16384
    ds_read_b64_tr_b16 a[26:27], v87 offset:17408
    v_mfma_f32_16x16x32_bf16 v[188:191], a[28:31], a[60:63], v[188:191]
    v_mfma_f32_16x16x32_bf16 v[220:223], a[28:31], a[64:67], v[220:223]
    v_mfma_f32_16x16x32_bf16 v[252:255], a[28:31], a[68:71], v[252:255]
    buffer_load_dwordx4 v20, s[40:43], s22 offen offset:1024 lds
    v_mfma_f32_16x16x32_bf16 v[112:115], a[32:35], a[56:59], v[112:115]
    ds_read_b64_tr_b16 a[28:29], v88 offset:16384
    ds_read_b64_tr_b16 a[30:31], v88 offset:17408
    v_mfma_f32_16x16x32_bf16 v[120:123], a[32:35], a[60:63], v[120:123]
    v_mfma_f32_16x16x32_bf16 v[116:119], a[36:39], a[56:59], v[116:119]
    ds_read_b64_tr_b16 a[32:33], v89 offset:4096
    ds_read_b64_tr_b16 a[34:35], v89 offset:4352
    v_mfma_f32_16x16x32_bf16 v[124:127], a[36:39], a[60:63], v[124:127]
    v_mfma_f32_16x16x32_bf16 v[104:107], a[112:115], a[80:83], v[104:107]
    s_waitcnt lgkmcnt(4)
    ds_read_b64_tr_b16 a[36:37], v90 offset:4096
    ds_read_b64_tr_b16 a[38:39], v90 offset:4352
    v_mfma_f32_16x16x32_bf16 v[128:131], a[0:3], a[40:43], v[128:131]
    v_mfma_f32_16x16x32_bf16 v[160:163], a[0:3], a[44:47], v[160:163]
    v_mfma_f32_16x16x32_bf16 v[192:195], a[0:3], a[48:51], v[192:195]
    v_mfma_f32_16x16x32_bf16 v[224:227], a[0:3], a[52:55], v[224:227]
    s_add_u32 s21, s21, 0x2000
    v_mfma_f32_16x16x32_bf16 v[96:99], a[112:115], a[0:3], v[96:99]
    s_and_b32 s21, s21, 0x1ffff
    v_mfma_f32_16x16x32_bf16 v[132:135], a[4:7], a[40:43], v[132:135]
    s_add_u32 m0, s19, 16384
    ds_read_b64_tr_b16 a[0:1], v81 offset:24576
    ds_read_b64_tr_b16 a[2:3], v81 offset:25600
    v_mfma_f32_16x16x32_bf16 v[164:167], a[4:7], a[44:47], v[164:167]
    ds_read_b128 a[56:59], v78 offset:32768
    v_mfma_f32_16x16x32_bf16 v[196:199], a[4:7], a[48:51], v[196:199]
    ds_read_b128 a[60:63], v78 offset:34816
    v_mfma_f32_16x16x32_bf16 v[228:231], a[4:7], a[52:55], v[228:231]
    buffer_load_dwordx4 v17, s[36:39], s21 offen offset:0 lds
    v_mfma_f32_16x16x32_bf16 v[100:103], a[112:115], a[4:7], v[100:103]
    v_mfma_f32_16x16x32_bf16 v[136:139], a[8:11], a[40:43], v[136:139]
    ds_read_b64_tr_b16 a[4:5], v82 offset:24576
    ds_read_b64_tr_b16 a[6:7], v82 offset:25600
    v_mfma_f32_16x16x32_bf16 v[168:171], a[8:11], a[44:47], v[168:171]
    ds_read_b128 a[64:67], v78 offset:36864
    v_mfma_f32_16x16x32_bf16 v[200:203], a[8:11], a[48:51], v[200:203]
    ds_read_b128 a[68:71], v78 offset:38912
    v_mfma_f32_16x16x32_bf16 v[232:235], a[8:11], a[52:55], v[232:235]
    v_mfma_f32_16x16x32_bf16 v[140:143], a[12:15], a[40:43], v[140:143]
    ds_read_b64_tr_b16 a[8:9], v83 offset:24576
    ds_read_b64_tr_b16 a[10:11], v83 offset:25600
    v_mfma_f32_16x16x32_bf16 v[172:175], a[12:15], a[44:47], v[172:175]
    buffer_load_dwordx4 v18, s[36:39], s21 offen offset:1024 lds
    v_mfma_f32_16x16x32_bf16 v[204:207], a[12:15], a[48:51], v[204:207]
    v_mfma_f32_16x16x32_bf16 v[236:239], a[12:15], a[52:55], v[236:239]
    v_mfma_f32_16x16x32_bf16 v[144:147], a[16:19], a[40:43], v[144:147]
    ds_read_b64_tr_b16 a[12:13], v84 offset:24576
    ds_read_b64_tr_b16 a[14:15], v84 offset:25600
    v_mfma_f32_16x16x32_bf16 v[176:179], a[16:19], a[44:47], v[176:179]
    v_mfma_f32_16x16x32_bf16 v[208:211], a[16:19], a[48:51], v[208:211]
    v_mfma_f32_16x16x32_bf16 v[240:243], a[16:19], a[52:55], v[240:243]
    v_mfma_f32_16x16x32_bf16 v[148:151], a[20:23], a[40:43], v[148:151]
    ds_read_b64_tr_b16 a[16:17], v85 offset:24576
    ds_read_b64_tr_b16 a[18:19], v85 offset:25600
    v_mfma_f32_16x16x32_bf16 v[180:183], a[20:23], a[44:47], v[180:183]
    v_mfma_f32_16x16x32_bf16 v[212:215], a[20:23], a[48:51], v[212:215]
    v_mfma_f32_16x16x32_bf16 v[244:247], a[20:23], a[52:55], v[244:247]
    v_mfma_f32_16x16x32_bf16 v[152:155], a[24:27], a[40:43], v[152:155]
    s_waitcnt lgkmcnt(14)
    ds_read_b64_tr_b16 a[20:21], v86 offset:24576
    ds_read_b64_tr_b16 a[22:23], v86 offset:25600
    v_mfma_f32_16x16x32_bf16 v[184:187], a[24:27], a[44:47], v[184:187]
    v_mfma_f32_16x16x32_bf16 v[216:219], a[24:27], a[48:51], v[216:219]
    v_mfma_f32_16x16x32_bf16 v[248:251], a[24:27], a[52:55], v[248:251]
    v_mfma_f32_16x16x32_bf16 v[156:159], a[28:31], a[40:43], v[156:159]
    ds_read_b64_tr_b16 a[24:25], v87 offset:24576
    ds_read_b64_tr_b16 a[26:27], v87 offset:25600
    v_mfma_f32_16x16x32_bf16 v[188:191], a[28:31], a[44:47], v[188:191]
    v_mfma_f32_16x16x32_bf16 v[220:223], a[28:31], a[48:51], v[220:223]
    v_mfma_f32_16x16x32_bf16 v[252:255], a[28:31], a[52:55], v[252:255]
    v_mfma_f32_16x16x32_bf16 v[112:115], a[32:35], a[40:43], v[112:115]
    ds_read_b64_tr_b16 a[28:29], v88 offset:24576
    ds_read_b64_tr_b16 a[30:31], v88 offset:25600
    v_mfma_f32_16x16x32_bf16 v[120:123], a[32:35], a[44:47], v[120:123]
    v_mfma_f32_16x16x32_bf16 v[116:119], a[36:39], a[40:43], v[116:119]
    ds_read_b64_tr_b16 a[32:33], v89 offset:6144
    ds_read_b64_tr_b16 a[34:35], v89 offset:6400
    v_mfma_f32_16x16x32_bf16 v[124:127], a[36:39], a[44:47], v[124:127]
    v_mfma_f32_16x16x32_bf16 v[104:107], a[112:115], a[84:87], v[104:107]
    ds_read_b64_tr_b16 a[36:37], v90 offset:6144
    ds_read_b64_tr_b16 a[38:39], v90 offset:6400
    v_mfma_f32_16x16x32_bf16 v[96:99], a[112:115], a[72:75], v[96:99]
    v_mfma_f32_16x16x32_bf16 v[100:103], a[112:115], a[76:79], v[100:103]
    s_waitcnt lgkmcnt(6)
    v_mfma_f32_16x16x32_bf16 v[128:131], a[0:3], a[56:59], v[128:131]
    ds_write_b32 v55, v104
    v_mfma_f32_16x16x32_bf16 v[160:163], a[0:3], a[60:63], v[160:163]
    ds_write_b32 v92, v96
    v_mfma_f32_16x16x32_bf16 v[192:195], a[0:3], a[64:67], v[192:195]
    ds_write_b32 v92, v100 offset:64
    v_mfma_f32_16x16x32_bf16 v[224:227], a[0:3], a[68:71], v[224:227]
    s_waitcnt lgkmcnt(0)
    s_barrier
    v_mfma_f32_16x16x32_bf16 v[132:135], a[4:7], a[56:59], v[132:135]
    ds_read_b32 v65, v92 offset:0
    ds_read_b32 v67, v92 offset:64
    v_mfma_f32_16x16x32_bf16 v[164:167], a[4:7], a[60:63], v[164:167]
    ds_read_b32 v69, v93 offset:0
    ds_read_b32 v71, v93 offset:64
    v_mfma_f32_16x16x32_bf16 v[196:199], a[4:7], a[64:67], v[196:199]
    ds_read_b32 v73, v94 offset:0
    ds_read_b32 v75, v94 offset:64
    v_mfma_f32_16x16x32_bf16 v[228:231], a[4:7], a[68:71], v[228:231]
    ds_read_b32 v77, v95 offset:0
    ds_read_b32 v79, v95 offset:64
    v_mfma_f32_16x16x32_bf16 v[136:139], a[8:11], a[56:59], v[136:139]
    ds_read_b32 v96, v54 offset:0
    ds_read_b32 v97, v54 offset:64
    v_mfma_f32_16x16x32_bf16 v[168:171], a[8:11], a[60:63], v[168:171]
    ds_read_b32 v98, v54 offset:128
    ds_read_b32 v99, v54 offset:192
    v_mfma_f32_16x16x32_bf16 v[200:203], a[8:11], a[64:67], v[200:203]
    v_mfma_f32_16x16x32_bf16 v[232:235], a[8:11], a[68:71], v[232:235]
    v_mfma_f32_16x16x32_bf16 v[140:143], a[12:15], a[56:59], v[140:143]
    s_add_u32 s21, s21, 0x2000
    s_waitcnt lgkmcnt(0)
    v_cvt_pk_bf16_f32 v64, v65, v65
    v_mfma_f32_16x16x32_bf16 v[172:175], a[12:15], a[60:63], v[172:175]
    s_and_b32 s21, s21, 0x1ffff
    v_and_b32 v50, 0xffff0000, v64
    v_sub_f32 v50, v65, v50
    v_mfma_f32_16x16x32_bf16 v[204:207], a[12:15], a[64:67], v[204:207]
    s_add_u32 m0, s19, 24576
    v_cvt_pk_bf16_f32 v65, v50, v50
    v_cvt_pk_bf16_f32 v66, v67, v67
    v_mfma_f32_16x16x32_bf16 v[236:239], a[12:15], a[68:71], v[236:239]
    buffer_load_dwordx4 v17, s[36:39], s21 offen offset:0 lds
    v_mfma_f32_16x16x32_bf16 v[144:147], a[16:19], a[56:59], v[144:147]
    v_and_b32 v50, 0xffff0000, v66
    v_sub_f32 v50, v67, v50
    v_mfma_f32_16x16x32_bf16 v[176:179], a[16:19], a[60:63], v[176:179]
    v_cvt_pk_bf16_f32 v67, v50, v50
    v_cvt_pk_bf16_f32 v68, v69, v69
    v_mfma_f32_16x16x32_bf16 v[208:211], a[16:19], a[64:67], v[208:211]
    v_and_b32 v50, 0xffff0000, v68
    v_sub_f32 v50, v69, v50
    v_mfma_f32_16x16x32_bf16 v[240:243], a[16:19], a[68:71], v[240:243]
    v_cvt_pk_bf16_f32 v69, v50, v50
    v_cvt_pk_bf16_f32 v70, v71, v71
    v_mfma_f32_16x16x32_bf16 v[148:151], a[20:23], a[56:59], v[148:151]
    v_and_b32 v50, 0xffff0000, v70
    v_sub_f32 v50, v71, v50
    v_mfma_f32_16x16x32_bf16 v[180:183], a[20:23], a[60:63], v[180:183]
    buffer_load_dwordx4 v18, s[36:39], s21 offen offset:1024 lds
    v_mfma_f32_16x16x32_bf16 v[212:215], a[20:23], a[64:67], v[212:215]
    v_cvt_pk_bf16_f32 v71, v50, v50
    v_cvt_pk_bf16_f32 v72, v73, v73
    v_mfma_f32_16x16x32_bf16 v[244:247], a[20:23], a[68:71], v[244:247]
    v_and_b32 v50, 0xffff0000, v72
    v_sub_f32 v50, v73, v50
    v_mfma_f32_16x16x32_bf16 v[152:155], a[24:27], a[56:59], v[152:155]
    s_add_u32 s22, s22, 0x2000
    v_cvt_pk_bf16_f32 v73, v50, v50
    v_mfma_f32_16x16x32_bf16 v[184:187], a[24:27], a[60:63], v[184:187]
    s_and_b32 s22, s22, 0x1ffff
    v_cvt_pk_bf16_f32 v74, v75, v75
    v_and_b32 v50, 0xffff0000, v74
    v_mfma_f32_16x16x32_bf16 v[216:219], a[24:27], a[64:67], v[216:219]
    s_add_u32 m0, s20, 16384
    v_sub_f32 v50, v75, v50
    v_cvt_pk_bf16_f32 v75, v50, v50
    v_mfma_f32_16x16x32_bf16 v[248:251], a[24:27], a[68:71], v[248:251]
    buffer_load_dwordx4 v19, s[40:43], s22 offen offset:0 lds
    v_mfma_f32_16x16x32_bf16 v[156:159], a[28:31], a[56:59], v[156:159]
    v_cvt_pk_bf16_f32 v76, v77, v77
    v_and_b32 v50, 0xffff0000, v76
    v_mfma_f32_16x16x32_bf16 v[188:191], a[28:31], a[60:63], v[188:191]
    v_sub_f32 v50, v77, v50
    v_cvt_pk_bf16_f32 v77, v50, v50
    v_mfma_f32_16x16x32_bf16 v[220:223], a[28:31], a[64:67], v[220:223]
    v_cvt_pk_bf16_f32 v78, v79, v79
    v_and_b32 v50, 0xffff0000, v78
    v_mfma_f32_16x16x32_bf16 v[252:255], a[28:31], a[68:71], v[252:255]
    v_sub_f32 v50, v79, v50
    v_cvt_pk_bf16_f32 v79, v50, v50
    v_mfma_f32_16x16x32_bf16 v[112:115], a[32:35], a[56:59], v[112:115]
    v_add_f32 v96, v96, v98
    v_cvt_pk_bf16_f32 v80, v96, v96
    v_mfma_f32_16x16x32_bf16 v[120:123], a[32:35], a[60:63], v[120:123]
    buffer_load_dwordx4 v20, s[40:43], s22 offen offset:1024 lds
    v_mfma_f32_16x16x32_bf16 v[116:119], a[36:39], a[56:59], v[116:119]
    v_and_b32 v50, 0xffff0000, v80
    v_sub_f32 v50, v96, v50
    v_mfma_f32_16x16x32_bf16 v[124:127], a[36:39], a[60:63], v[124:127]
    v_cvt_pk_bf16_f32 v81, v50, v50
    v_add_f32 v97, v97, v99
    v_mfma_f32_16x16x16_bf16 v[128:131], v[64:65], a[116:117], v[128:131]
    s_waitcnt vmcnt(12)
    s_barrier
    v_cvt_pk_bf16_f32 v82, v97, v97
    v_mfma_f32_16x16x16_bf16 v[132:135], v[66:67], a[116:117], v[132:135]
    s_add_u32 s24, s95, 0x4000
    v_and_b32 v50, 0xffff0000, v82
    v_sub_f32 v50, v97, v50
    v_cvt_pk_bf16_f32 v83, v50, v50
    v_mfma_f32_16x16x16_bf16 v[136:139], v[68:69], a[116:117], v[136:139]
    ds_read_b64 a[128:129], v1 offset:0
    ds_read_b64 a[130:131], v2 offset:0
    v_mul_f32 v128, v128, v31
    v_mfma_f32_16x16x16_bf16 v[140:143], v[70:71], a[116:117], v[140:143]
    v_mul_f32 v129, v129, v31
    v_mul_f32 v130, v130, v31
    v_mul_f32 v131, v131, v31
    v_mfma_f32_16x16x16_bf16 v[144:147], v[72:73], a[116:117], v[144:147]
    v_mul_f32 v132, v132, v31
    v_mul_f32 v133, v133, v31
    v_mul_f32 v134, v134, v31
    v_mfma_f32_16x16x16_bf16 v[148:151], v[74:75], a[116:117], v[148:151]
    ds_read_b64 a[132:133], v1 offset:4096
    ds_read_b64 a[134:135], v2 offset:4096
    v_mul_f32 v135, v135, v31
    v_mfma_f32_16x16x16_bf16 v[152:155], v[76:77], a[116:117], v[152:155]
    v_cvt_pk_bf16_f32 v128, v128, v129
    v_cvt_pk_bf16_f32 v129, v130, v131
    v_cvt_pk_bf16_f32 v130, v132, v133
    v_mfma_f32_16x16x16_bf16 v[156:159], v[78:79], a[116:117], v[156:159]
    v_cvt_pk_bf16_f32 v131, v134, v135
    v_mul_f32 v136, v136, v31
    v_mul_f32 v137, v137, v31
    v_mfma_f32_16x16x16_bf16 v[160:163], v[64:65], a[118:119], v[160:163]
    ds_read_b64 a[136:137], v3 offset:0
    ds_read_b64 a[138:139], v4 offset:0
    v_mul_f32 v138, v138, v31
    v_mfma_f32_16x16x16_bf16 v[164:167], v[66:67], a[118:119], v[164:167]
    v_mul_f32 v139, v139, v31
    v_mul_f32 v140, v140, v31
    v_mul_f32 v141, v141, v31
    v_mfma_f32_16x16x16_bf16 v[168:171], v[68:69], a[118:119], v[168:171]
    v_mul_f32 v142, v142, v31
    v_mul_f32 v143, v143, v31
    v_cvt_pk_bf16_f32 v132, v136, v137
    v_mfma_f32_16x16x16_bf16 v[172:175], v[70:71], a[118:119], v[172:175]
    ds_read_b64 a[140:141], v3 offset:4096
    ds_read_b64 a[142:143], v4 offset:4096
    v_cvt_pk_bf16_f32 v133, v138, v139
    v_mfma_f32_16x16x16_bf16 v[176:179], v[72:73], a[118:119], v[176:179]
    v_cvt_pk_bf16_f32 v134, v140, v141
    v_cvt_pk_bf16_f32 v135, v142, v143
    v_mul_f32 v144, v144, v31
    v_mfma_f32_16x16x16_bf16 v[180:183], v[74:75], a[118:119], v[180:183]
    v_mul_f32 v145, v145, v31
    v_mul_f32 v146, v146, v31
    v_mul_f32 v147, v147, v31
    v_mfma_f32_16x16x16_bf16 v[184:187], v[76:77], a[118:119], v[184:187]
    ds_read_b64 a[144:145], v5 offset:0
    ds_read_b64 a[146:147], v6 offset:0
    v_mul_f32 v148, v148, v31
    v_mfma_f32_16x16x16_bf16 v[188:191], v[78:79], a[118:119], v[188:191]
    v_mul_f32 v149, v149, v31
    v_mul_f32 v150, v150, v31
    v_mul_f32 v151, v151, v31
    v_mfma_f32_16x16x16_bf16 v[112:115], v[80:81], a[116:117], v[112:115]
    v_cvt_pk_bf16_f32 v136, v144, v145
    v_cvt_pk_bf16_f32 v137, v146, v147
    v_cvt_pk_bf16_f32 v138, v148, v149
    v_mfma_f32_16x16x16_bf16 v[116:119], v[82:83], a[116:117], v[116:119]
    ds_read_b64 a[148:149], v5 offset:4096
    ds_read_b64 a[150:151], v6 offset:4096
    v_cvt_pk_bf16_f32 v139, v150, v151
    v_mfma_f32_16x16x16_bf16 v[120:123], v[80:81], a[118:119], v[120:123]
    v_mul_f32 v152, v152, v31
    v_mul_f32 v153, v153, v31
    v_mul_f32 v154, v154, v31
    v_mfma_f32_16x16x16_bf16 v[124:127], v[82:83], a[118:119], v[124:127]
    v_mul_f32 v155, v155, v31
    v_mul_f32 v156, v156, v31
    v_mul_f32 v157, v157, v31
    v_mfma_f32_16x16x16_bf16 v[192:195], v[64:65], a[120:121], v[192:195]
    ds_read_b64 a[152:153], v7 offset:0
    ds_read_b64 a[154:155], v8 offset:0
    v_mul_f32 v158, v158, v31
    v_mfma_f32_16x16x16_bf16 v[196:199], v[66:67], a[120:121], v[196:199]
    v_mul_f32 v159, v159, v31
    v_cvt_pk_bf16_f32 v140, v152, v153
    v_cvt_pk_bf16_f32 v141, v154, v155
    v_mfma_f32_16x16x16_bf16 v[200:203], v[68:69], a[120:121], v[200:203]
    v_cvt_pk_bf16_f32 v142, v156, v157
    v_cvt_pk_bf16_f32 v143, v158, v159
    v_mul_f32 v160, v160, v35
    v_mfma_f32_16x16x16_bf16 v[204:207], v[70:71], a[120:121], v[204:207]
    ds_read_b64 a[156:157], v7 offset:4096
    ds_read_b64 a[158:159], v8 offset:4096
    v_mul_f32 v161, v161, v35
    v_mfma_f32_16x16x16_bf16 v[208:211], v[72:73], a[120:121], v[208:211]
    v_mul_f32 v162, v162, v35
    v_mul_f32 v163, v163, v35
    v_mul_f32 v164, v164, v35
    v_mfma_f32_16x16x16_bf16 v[212:215], v[74:75], a[120:121], v[212:215]
    v_mul_f32 v165, v165, v35
    v_mul_f32 v166, v166, v35
    v_mul_f32 v167, v167, v35
    v_mfma_f32_16x16x16_bf16 v[216:219], v[76:77], a[120:121], v[216:219]
    v_cvt_pk_bf16_f32 v144, v160, v161
    v_cvt_pk_bf16_f32 v145, v162, v163
    v_cvt_pk_bf16_f32 v146, v164, v165
    v_mfma_f32_16x16x16_bf16 v[220:223], v[78:79], a[120:121], v[220:223]
    v_cvt_pk_bf16_f32 v147, v166, v167
    v_mul_f32 v168, v168, v35
    v_mul_f32 v169, v169, v35
    v_mfma_f32_16x16x16_bf16 v[224:227], v[64:65], a[122:123], v[224:227]
    v_mul_f32 v170, v170, v35
    v_mul_f32 v171, v171, v35
    v_mul_f32 v172, v172, v35
    v_mfma_f32_16x16x16_bf16 v[228:231], v[66:67], a[122:123], v[228:231]
    v_mul_f32 v173, v173, v35
    v_mul_f32 v174, v174, v35
    v_mul_f32 v175, v175, v35
    v_mfma_f32_16x16x16_bf16 v[232:235], v[68:69], a[122:123], v[232:235]
    v_cvt_pk_bf16_f32 v148, v168, v169
    v_cvt_pk_bf16_f32 v149, v170, v171
    v_cvt_pk_bf16_f32 v150, v172, v173
    v_mfma_f32_16x16x16_bf16 v[236:239], v[70:71], a[122:123], v[236:239]
    v_cvt_pk_bf16_f32 v151, v174, v175
    v_mul_f32 v176, v176, v35
    v_mul_f32 v177, v177, v35
    v_mfma_f32_16x16x16_bf16 v[240:243], v[72:73], a[122:123], v[240:243]
    v_mul_f32 v178, v178, v35
    v_mul_f32 v179, v179, v35
    v_mul_f32 v180, v180, v35
    v_mfma_f32_16x16x16_bf16 v[244:247], v[74:75], a[122:123], v[244:247]
    v_mul_f32 v181, v181, v35
    v_mul_f32 v182, v182, v35
    v_mul_f32 v183, v183, v35
    v_mfma_f32_16x16x16_bf16 v[248:251], v[76:77], a[122:123], v[248:251]
    s_waitcnt lgkmcnt(0)
    v_cvt_pk_bf16_f32 v152, v176, v177
    v_cvt_pk_bf16_f32 v153, v178, v179
    v_cvt_pk_bf16_f32 v154, v180, v181
    v_mfma_f32_16x16x16_bf16 v[252:255], v[78:79], a[122:123], v[252:255]
    v_cvt_pk_bf16_f32 v155, v182, v183
    v_mul_f32 v184, v184, v35
    v_mul_f32 v185, v185, v35
    v_mfma_f32_16x16x32_bf16 v[64:67], a[128:131], v[128:131], 0
    v_mul_f32 v186, v186, v35
    v_mul_f32 v187, v187, v35
    v_mfma_f32_16x16x32_bf16 v[64:67], a[136:139], v[132:135], v[64:67]
    v_mul_f32 v188, v188, v35
    v_mul_f32 v189, v189, v35
    v_mfma_f32_16x16x32_bf16 v[64:67], a[144:147], v[136:139], v[64:67]
    v_mul_f32 v190, v190, v35
    v_mul_f32 v191, v191, v35
    v_mfma_f32_16x16x32_bf16 v[64:67], a[152:155], v[140:143], v[64:67]
    v_cvt_pk_bf16_f32 v156, v184, v185
    v_cvt_pk_bf16_f32 v157, v186, v187
    v_mfma_f32_16x16x32_bf16 v[72:75], a[128:131], v[144:147], 0
    v_cvt_pk_bf16_f32 v158, v188, v189
    v_cvt_pk_bf16_f32 v159, v190, v191
    v_mfma_f32_16x16x32_bf16 v[72:75], a[136:139], v[148:151], v[72:75]
    v_mul_f32 v112, v112, v30
    v_mul_f32 v113, v113, v30
    v_mfma_f32_16x16x32_bf16 v[72:75], a[144:147], v[152:155], v[72:75]
    v_mul_f32 v96, v112, v112
    v_mul_f32 v97, v113, v113
    v_mfma_f32_16x16x32_bf16 v[72:75], a[152:155], v[156:159], v[72:75]
    v_fmaak_f32 v96, v96, v61, 0xc0135761
    v_fmaak_f32 v97, v97, v61, 0xc0135761
    v_mfma_f32_16x16x32_bf16 v[68:71], a[132:135], v[128:131], 0
    v_mul_f32 v96, v96, v112
    v_mul_f32 v97, v97, v113
    v_mfma_f32_16x16x32_bf16 v[68:71], a[140:143], v[132:135], v[68:71]
    v_exp_f32 v96, v96
    v_mfma_f32_16x16x32_bf16 v[68:71], a[148:151], v[136:139], v[68:71]
    v_exp_f32 v97, v97
    v_mfma_f32_16x16x32_bf16 v[68:71], a[156:159], v[140:143], v[68:71]
    v_add_f32 v96, 1.0, v96
    v_add_f32 v97, 1.0, v97
    v_mfma_f32_16x16x32_bf16 v[76:79], a[132:135], v[144:147], 0
    v_rcp_f32 v96, v96
    v_mfma_f32_16x16x32_bf16 v[76:79], a[140:143], v[148:151], v[76:79]
    v_rcp_f32 v97, v97
    v_mul_f32 v112, v112, v96
    v_mul_f32 v113, v113, v97
    v_cvt_pk_bf16_f32 v112, v112, v113
    v_mul_f32 v114, v114, v30
    v_mul_f32 v115, v115, v30
    v_mul_f32 v98, v114, v114
    v_mul_f32 v99, v115, v115
    v_fmaak_f32 v98, v98, v61, 0xc0135761
    v_fmaak_f32 v99, v99, v61, 0xc0135761
    v_mul_f32 v98, v98, v114
    v_mul_f32 v99, v99, v115
    v_exp_f32 v98, v98
    v_exp_f32 v99, v99
    v_add_f32 v98, 1.0, v98
    v_add_f32 v99, 1.0, v99
    v_rcp_f32 v98, v98
    v_rcp_f32 v99, v99
    v_mul_f32 v114, v114, v98
    v_mul_f32 v115, v115, v99
    v_cvt_pk_bf16_f32 v113, v114, v115
    v_mul_f32 v116, v116, v30
    v_mul_f32 v117, v117, v30
    v_mul_f32 v96, v116, v116
    v_mul_f32 v97, v117, v117
    v_fmaak_f32 v96, v96, v61, 0xc0135761
    v_fmaak_f32 v97, v97, v61, 0xc0135761
    v_mul_f32 v96, v96, v116
    v_mul_f32 v97, v97, v117
    v_exp_f32 v96, v96
    v_exp_f32 v97, v97
    v_add_f32 v96, 1.0, v96
    v_add_f32 v97, 1.0, v97
    v_rcp_f32 v96, v96
    v_rcp_f32 v97, v97
    v_mul_f32 v116, v116, v96
    v_mul_f32 v117, v117, v97
    v_cvt_pk_bf16_f32 v114, v116, v117
    v_mul_f32 v118, v118, v30
    v_mul_f32 v119, v119, v30
    v_mul_f32 v98, v118, v118
    v_mul_f32 v99, v119, v119
    v_fmaak_f32 v98, v98, v61, 0xc0135761
    v_fmaak_f32 v99, v99, v61, 0xc0135761
    v_mul_f32 v98, v98, v118
    v_mul_f32 v99, v99, v119
    v_exp_f32 v98, v98
    v_exp_f32 v99, v99
    v_add_f32 v98, 1.0, v98
    v_add_f32 v99, 1.0, v99
    v_rcp_f32 v98, v98
    v_rcp_f32 v99, v99
    v_mul_f32 v118, v118, v98
    v_mul_f32 v119, v119, v99
    v_cvt_pk_bf16_f32 v115, v118, v119
    v_mul_f32 v120, v120, v34
    v_mul_f32 v121, v121, v34
    v_mul_f32 v96, v120, v120
    v_mul_f32 v97, v121, v121
    v_fmaak_f32 v96, v96, v61, 0xc0135761
    v_fmaak_f32 v97, v97, v61, 0xc0135761
    v_mul_f32 v96, v96, v120
    v_mul_f32 v97, v97, v121
    v_exp_f32 v96, v96
    v_exp_f32 v97, v97
    v_add_f32 v96, 1.0, v96
    v_add_f32 v97, 1.0, v97
    v_rcp_f32 v96, v96
    v_rcp_f32 v97, v97
    v_mul_f32 v120, v120, v96
    v_mul_f32 v121, v121, v97
    v_cvt_pk_bf16_f32 v116, v120, v121
    v_mul_f32 v122, v122, v34
    v_mul_f32 v123, v123, v34
    v_mul_f32 v98, v122, v122
    v_mul_f32 v99, v123, v123
    v_fmaak_f32 v98, v98, v61, 0xc0135761
    v_fmaak_f32 v99, v99, v61, 0xc0135761
    v_mul_f32 v98, v98, v122
    v_mul_f32 v99, v99, v123
    v_exp_f32 v98, v98
    v_exp_f32 v99, v99
    v_add_f32 v98, 1.0, v98
    v_add_f32 v99, 1.0, v99
    v_rcp_f32 v98, v98
    v_rcp_f32 v99, v99
    v_mul_f32 v122, v122, v98
    v_mul_f32 v123, v123, v99
    v_cvt_pk_bf16_f32 v117, v122, v123
    v_mul_f32 v124, v124, v34
    v_mul_f32 v125, v125, v34
    v_mul_f32 v96, v124, v124
    v_mul_f32 v97, v125, v125
    v_fmaak_f32 v96, v96, v61, 0xc0135761
    v_fmaak_f32 v97, v97, v61, 0xc0135761
    v_mul_f32 v96, v96, v124
    v_mul_f32 v97, v97, v125
    v_exp_f32 v96, v96
    v_exp_f32 v97, v97
    v_add_f32 v96, 1.0, v96
    v_add_f32 v97, 1.0, v97
    v_rcp_f32 v96, v96
    v_rcp_f32 v97, v97
    v_mul_f32 v124, v124, v96
    v_mul_f32 v125, v125, v97
    v_cvt_pk_bf16_f32 v118, v124, v125
    v_mul_f32 v126, v126, v34
    v_mul_f32 v127, v127, v34
    v_mul_f32 v98, v126, v126
    v_mul_f32 v99, v127, v127
    v_fmaak_f32 v98, v98, v61, 0xc0135761
    v_fmaak_f32 v99, v99, v61, 0xc0135761
    v_mul_f32 v98, v98, v126
    v_mul_f32 v99, v99, v127
    v_exp_f32 v98, v98
    v_exp_f32 v99, v99
    v_add_f32 v98, 1.0, v98
    v_add_f32 v99, 1.0, v99
    v_rcp_f32 v98, v98
    v_rcp_f32 v99, v99
    v_mul_f32 v126, v126, v98
    v_mul_f32 v127, v127, v99
    v_cvt_pk_bf16_f32 v119, v126, v127
    v_mfma_f32_16x16x32_bf16 v[76:79], a[148:151], v[152:155], v[76:79]
    s_add_u32 s21, s21, 0x2000
    buffer_store_dwordx4 v[112:115], v25, s[80:83], s95 offen sc1
    buffer_store_dwordx4 v[116:119], v25, s[80:83], s24 offen sc1
    v_mul_f32 v192, v192, v109
    v_mul_f32 v193, v193, v109
    v_mfma_f32_16x16x32_bf16 v[76:79], a[156:159], v[156:159], v[76:79]
    s_waitcnt vmcnt(10)
    s_barrier
    s_and_b32 s21, s21, 0x1ffff
    v_mul_f32 v194, v194, v109
    v_mul_f32 v195, v195, v109
    v_mul_f32 v196, v196, v109
    v_mul_f32 v197, v197, v109
    v_mul_f32 v198, v198, v109
    v_mul_f32 v199, v199, v109
    v_cvt_pk_bf16_f32 v160, v192, v193
    v_cvt_pk_bf16_f32 v161, v194, v195
    v_cvt_pk_bf16_f32 v162, v196, v197
    v_cvt_pk_bf16_f32 v163, v198, v199
    v_mul_f32 v200, v200, v109
    v_mul_f32 v201, v201, v109
    v_mul_f32 v202, v202, v109
    v_mul_f32 v203, v203, v109
    v_mul_f32 v204, v204, v109
    v_mul_f32 v205, v205, v109
    v_mul_f32 v206, v206, v109
    v_mul_f32 v207, v207, v109
    v_cvt_pk_bf16_f32 v164, v200, v201
    v_cvt_pk_bf16_f32 v165, v202, v203
    v_cvt_pk_bf16_f32 v166, v204, v205
    v_cvt_pk_bf16_f32 v167, v206, v207
    v_mul_f32 v208, v208, v109
    v_mul_f32 v209, v209, v109
    v_mul_f32 v210, v210, v109
    v_mul_f32 v211, v211, v109
    v_mul_f32 v212, v212, v109
    v_mul_f32 v213, v213, v109
    v_mul_f32 v214, v214, v109
    v_mul_f32 v215, v215, v109
    v_cvt_pk_bf16_f32 v168, v208, v209
    v_cvt_pk_bf16_f32 v169, v210, v211
    v_cvt_pk_bf16_f32 v170, v212, v213
    v_cvt_pk_bf16_f32 v171, v214, v215
    v_mul_f32 v216, v216, v109
    v_mul_f32 v217, v217, v109
    v_mul_f32 v218, v218, v109
    v_mul_f32 v219, v219, v109
    v_mul_f32 v220, v220, v109
    v_mul_f32 v221, v221, v109
    v_mul_f32 v222, v222, v109
    v_mul_f32 v223, v223, v109
    v_cvt_pk_bf16_f32 v172, v216, v217
    v_cvt_pk_bf16_f32 v173, v218, v219
    v_cvt_pk_bf16_f32 v174, v220, v221
    v_cvt_pk_bf16_f32 v175, v222, v223
    v_mfma_f32_16x16x32_bf16 v[208:211], a[128:131], v[160:163], 0
    s_add_u32 m0, s19, 0
    v_mul_f32 v224, v224, v111
    v_mul_f32 v225, v225, v111
    v_mfma_f32_16x16x32_bf16 v[208:211], a[136:139], v[164:167], v[208:211]
    buffer_load_dwordx4 v17, s[36:39], s21 offen offset:0 lds
    v_mfma_f32_16x16x32_bf16 v[208:211], a[144:147], v[168:171], v[208:211]
    v_mul_f32 v226, v226, v111
    v_mul_f32 v227, v227, v111
    v_mfma_f32_16x16x32_bf16 v[208:211], a[152:155], v[172:175], v[208:211]
    v_mul_f32 v228, v228, v111
    v_mul_f32 v229, v229, v111
    v_mul_f32 v230, v230, v111
    v_mul_f32 v231, v231, v111
    v_cvt_pk_bf16_f32 v176, v224, v225
    v_cvt_pk_bf16_f32 v177, v226, v227
    v_cvt_pk_bf16_f32 v178, v228, v229
    v_cvt_pk_bf16_f32 v179, v230, v231
    s_nop 1
    v_mfma_f32_16x16x32_bf16 v[216:219], a[128:131], v[176:179], 0
    ds_read_b64 a[128:129], v1 offset:8192
    ds_read_b64 a[130:131], v2 offset:8192
    v_mul_f32 v232, v232, v111
    v_mul_f32 v233, v233, v111
    v_mul_f32 v234, v234, v111
    v_mul_f32 v235, v235, v111
    v_mul_f32 v236, v236, v111
    v_mul_f32 v237, v237, v111
    v_mul_f32 v238, v238, v111
    v_mul_f32 v239, v239, v111
    v_cvt_pk_bf16_f32 v180, v232, v233
    v_cvt_pk_bf16_f32 v181, v234, v235
    v_cvt_pk_bf16_f32 v182, v236, v237
    v_cvt_pk_bf16_f32 v183, v238, v239
    s_nop 1
    v_mfma_f32_16x16x32_bf16 v[216:219], a[136:139], v[180:183], v[216:219]
    v_mul_f32 v240, v240, v111
    v_mul_f32 v241, v241, v111
    v_mul_f32 v242, v242, v111
    v_mul_f32 v243, v243, v111
    v_mul_f32 v244, v244, v111
    v_mul_f32 v245, v245, v111
    v_mul_f32 v246, v246, v111
    v_mul_f32 v247, v247, v111
    v_cvt_pk_bf16_f32 v184, v240, v241
    v_cvt_pk_bf16_f32 v185, v242, v243
L_warm0_3:
    s_cbranch_execz L_warm0_4
    v_cvt_pk_bf16_f32 v186, v244, v245
    v_cvt_pk_bf16_f32 v187, v246, v247
    s_nop 1
    v_mfma_f32_16x16x32_bf16 v[216:219], a[144:147], v[184:187], v[216:219]
    ds_read_b64 a[136:137], v3 offset:8192
    ds_read_b64 a[138:139], v4 offset:8192
    v_mul_f32 v248, v248, v111
    v_mul_f32 v249, v249, v111
    v_mul_f32 v250, v250, v111
    v_mul_f32 v251, v251, v111
    v_mul_f32 v252, v252, v111
    v_mul_f32 v253, v253, v111
    v_mul_f32 v254, v254, v111
    v_mul_f32 v255, v255, v111
    v_cvt_pk_bf16_f32 v188, v248, v249
    v_cvt_pk_bf16_f32 v189, v250, v251
    v_cvt_pk_bf16_f32 v190, v252, v253
    v_cvt_pk_bf16_f32 v191, v254, v255
    s_nop 1
    v_mfma_f32_16x16x32_bf16 v[216:219], a[152:155], v[188:191], v[216:219]
    buffer_load_dwordx4 v18, s[36:39], s21 offen offset:1024 lds
    v_mfma_f32_16x16x32_bf16 v[212:215], a[132:135], v[160:163], 0
    ds_read_b64 a[144:145], v5 offset:8192
    ds_read_b64 a[146:147], v6 offset:8192
    v_mfma_f32_16x16x32_bf16 v[212:215], a[140:143], v[164:167], v[212:215]
    v_exp_f32 v64, v64
    v_mfma_f32_16x16x32_bf16 v[212:215], a[148:151], v[168:171], v[212:215]
    ds_read_b64 a[152:153], v7 offset:8192
    ds_read_b64 a[154:155], v8 offset:8192
    v_mfma_f32_16x16x32_bf16 v[212:215], a[156:159], v[172:175], v[212:215]
    v_exp_f32 v65, v65
    v_mfma_f32_16x16x32_bf16 v[220:223], a[132:135], v[176:179], 0
    s_mov_b32 s90, 0
    ds_read_b64 a[132:133], v1 offset:12288
    ds_read_b64 a[134:135], v2 offset:12288
    v_mfma_f32_16x16x32_bf16 v[220:223], a[140:143], v[180:183], v[220:223]
    s_add_u32 m0, s16, 98304
    ds_read_b64_tr_b16 a[160:161], v9 offset:0
    ds_read_b64_tr_b16 a[162:163], v9 offset:4096
    v_mfma_f32_16x16x32_bf16 v[220:223], a[148:151], v[184:187], v[220:223]
    buffer_load_dwordx4 v44, s[56:59], s90 offen offset:0 lds
    ds_read_b64 a[140:141], v3 offset:12288
    ds_read_b64 a[142:143], v4 offset:12288
    v_mov_b32 v50, 0x3f803f80
    v_mov_b32 v51, 0x3f803f80
    v_mov_b32 v52, 0x3f803f80
    v_mov_b32 v53, 0x3f803f80
    v_mfma_f32_16x16x32_bf16 v[220:223], a[156:159], v[188:191], v[220:223]
    s_waitcnt lgkmcnt(6)
    ds_read_b64_tr_b16 a[164:165], v10 offset:0
    ds_read_b64_tr_b16 a[166:167], v10 offset:4096
    v_mfma_f32_16x16x32_bf16 v[192:195], a[128:131], v[128:131], 0
    ds_read_b64 a[148:149], v5 offset:12288
    ds_read_b64 a[150:151], v6 offset:12288
    v_mfma_f32_16x16x32_bf16 v[192:195], a[136:139], v[132:135], v[192:195]
    ds_read_b64_tr_b16 a[168:169], v11 offset:0
    ds_read_b64_tr_b16 a[170:171], v11 offset:4096
    v_mfma_f32_16x16x32_bf16 v[192:195], a[144:147], v[136:139], v[192:195]
    ds_read_b64 a[156:157], v7 offset:12288
    ds_read_b64 a[158:159], v8 offset:12288
    v_mfma_f32_16x16x32_bf16 v[192:195], a[152:155], v[140:143], v[192:195]
    ds_read_b64_tr_b16 a[172:173], v12 offset:0
    ds_read_b64_tr_b16 a[174:175], v12 offset:4096
    v_mfma_f32_16x16x32_bf16 v[200:203], a[128:131], v[144:147], 0
    buffer_load_dwordx4 v45, s[56:59], s90 offen offset:1024 lds
    v_mfma_f32_16x16x32_bf16 v[200:203], a[136:139], v[148:151], v[200:203]
    ds_read_b64_tr_b16 a[176:177], v13 offset:0
    ds_read_b64_tr_b16 a[178:179], v13 offset:4096
    v_mfma_f32_16x16x32_bf16 v[200:203], a[144:147], v[152:155], v[200:203]
    v_exp_f32 v66, v66
    v_mfma_f32_16x16x32_bf16 v[200:203], a[152:155], v[156:159], v[200:203]
    s_waitcnt lgkmcnt(4)
    ds_read_b64_tr_b16 a[180:181], v14 offset:0
    ds_read_b64_tr_b16 a[182:183], v14 offset:4096
    v_mfma_f32_16x16x32_bf16 v[196:199], a[132:135], v[128:131], 0
    v_exp_f32 v67, v67
    v_mfma_f32_16x16x32_bf16 v[196:199], a[140:143], v[132:135], v[196:199]
    ds_read_b64_tr_b16 a[184:185], v15 offset:0
    ds_read_b64_tr_b16 a[186:187], v15 offset:4096
    v_mfma_f32_16x16x32_bf16 v[196:199], a[148:151], v[136:139], v[196:199]
    buffer_load_dwordx4 v46, s[56:59], s90 offen offset:2048 lds
    v_mfma_f32_16x16x32_bf16 v[196:199], a[156:159], v[140:143], v[196:199]
    ds_read_b64_tr_b16 a[188:189], v16 offset:0
    ds_read_b64_tr_b16 a[190:191], v16 offset:4096
    v_mfma_f32_16x16x32_bf16 v[204:207], a[132:135], v[144:147], 0
    v_exp_f32 v72, v72
    v_mfma_f32_16x16x32_bf16 v[204:207], a[140:143], v[148:151], v[204:207]
    v_cvt_pk_bf16_f32 v224, v64, v65
    v_cvt_pk_bf16_f32 v225, v66, v67
    v_mfma_f32_16x16x32_bf16 v[204:207], a[148:151], v[152:155], v[204:207]
    v_exp_f32 v73, v73
    v_exp_f32 v74, v74
    v_exp_f32 v75, v75
    v_exp_f32 v68, v68
    v_cvt_pk_bf16_f32 v228, v72, v73
    v_cvt_pk_bf16_f32 v229, v74, v75
    v_exp_f32 v69, v69
    v_exp_f32 v70, v70
    v_exp_f32 v71, v71
    v_exp_f32 v76, v76
    v_cvt_pk_bf16_f32 v226, v68, v69
    v_cvt_pk_bf16_f32 v227, v70, v71
    v_exp_f32 v77, v77
    v_exp_f32 v78, v78
    v_exp_f32 v79, v79
    v_cvt_pk_bf16_f32 v230, v76, v77
    v_cvt_pk_bf16_f32 v231, v78, v79
    v_mfma_f32_16x16x32_bf16 v[204:207], a[156:159], v[156:159], v[204:207]
    s_waitcnt lgkmcnt(0)
    v_exp_f32 v208, v208
    v_mfma_f32_16x16x32_bf16 a[0:3], a[160:163], v[224:227], 0
    v_exp_f32 v209, v209
    v_mfma_f32_16x16x32_bf16 a[32:35], a[160:163], v[228:231], 0
    v_exp_f32 v210, v210
    v_mfma_f32_16x16x32_bf16 a[4:7], a[164:167], v[224:227], 0
    v_exp_f32 v211, v211
    v_mfma_f32_16x16x32_bf16 a[36:39], a[164:167], v[228:231], 0
    v_exp_f32 v216, v216
    v_mfma_f32_16x16x32_bf16 a[8:11], a[168:171], v[224:227], 0
    v_cvt_pk_bf16_f32 v232, v208, v209
    v_cvt_pk_bf16_f32 v233, v210, v211
    v_mfma_f32_16x16x32_bf16 a[40:43], a[168:171], v[228:231], 0
    v_exp_f32 v217, v217
    v_mfma_f32_16x16x32_bf16 a[12:15], a[172:175], v[224:227], 0
    v_exp_f32 v218, v218
    v_mfma_f32_16x16x32_bf16 a[44:47], a[172:175], v[228:231], 0
    v_exp_f32 v219, v219
    v_mfma_f32_16x16x32_bf16 a[16:19], a[176:179], v[224:227], 0
    v_exp_f32 v212, v212
    v_mfma_f32_16x16x32_bf16 a[48:51], a[176:179], v[228:231], 0
    v_cvt_pk_bf16_f32 v236, v216, v217
    v_cvt_pk_bf16_f32 v237, v218, v219
    v_mfma_f32_16x16x32_bf16 a[20:23], a[180:183], v[224:227], 0
    v_exp_f32 v213, v213
    v_mfma_f32_16x16x32_bf16 a[52:55], a[180:183], v[228:231], 0
    v_exp_f32 v214, v214
    v_mfma_f32_16x16x32_bf16 a[24:27], a[184:187], v[224:227], 0
    v_exp_f32 v215, v215
    v_mfma_f32_16x16x32_bf16 a[56:59], a[184:187], v[228:231], 0
    v_exp_f32 v220, v220
    v_mfma_f32_16x16x32_bf16 a[28:31], a[188:191], v[224:227], 0
    v_cvt_pk_bf16_f32 v234, v212, v213
    v_cvt_pk_bf16_f32 v235, v214, v215
    v_mfma_f32_16x16x32_bf16 a[60:63], a[188:191], v[228:231], 0
    v_exp_f32 v221, v221
    v_mfma_f32_16x16x32_bf16 v[96:99], v[50:53], v[224:227], 0
    s_add_u32 s21, s21, 0x2000
    v_exp_f32 v222, v222
    v_exp_f32 v223, v223
    v_cvt_pk_bf16_f32 v238, v220, v221
    v_cvt_pk_bf16_f32 v239, v222, v223
    v_mfma_f32_16x16x32_bf16 v[100:103], v[50:53], v[228:231], 0
    s_waitcnt vmcnt(11)
    s_barrier
    s_and_b32 s21, s21, 0x1ffff
    v_mfma_f32_16x16x32_bf16 v[208:211], a[128:131], v[160:163], 0
    s_add_u32 m0, s19, 8192
    v_exp_f32 v192, v192
    v_mfma_f32_16x16x32_bf16 v[208:211], a[136:139], v[164:167], v[208:211]
    buffer_load_dwordx4 v17, s[36:39], s21 offen offset:0 lds
    v_mfma_f32_16x16x32_bf16 v[208:211], a[144:147], v[168:171], v[208:211]
    v_exp_f32 v193, v193
    v_mfma_f32_16x16x32_bf16 v[208:211], a[152:155], v[172:175], v[208:211]
    v_exp_f32 v194, v194
    v_mfma_f32_16x16x32_bf16 v[216:219], a[128:131], v[176:179], 0
    ds_read_b64 a[128:129], v1 offset:16384
    ds_read_b64 a[130:131], v2 offset:16384
    v_mfma_f32_16x16x32_bf16 v[216:219], a[136:139], v[180:183], v[216:219]
    v_exp_f32 v195, v195
    v_mfma_f32_16x16x32_bf16 v[216:219], a[144:147], v[184:187], v[216:219]
    ds_read_b64 a[136:137], v3 offset:16384
    ds_read_b64 a[138:139], v4 offset:16384
    v_mfma_f32_16x16x32_bf16 v[216:219], a[152:155], v[188:191], v[216:219]
    buffer_load_dwordx4 v18, s[36:39], s21 offen offset:1024 lds
    v_mfma_f32_16x16x32_bf16 v[212:215], a[132:135], v[160:163], 0
    ds_read_b64 a[144:145], v5 offset:16384
    ds_read_b64 a[146:147], v6 offset:16384
    v_mfma_f32_16x16x32_bf16 v[212:215], a[140:143], v[164:167], v[212:215]
    v_exp_f32 v200, v200
    v_mfma_f32_16x16x32_bf16 v[212:215], a[148:151], v[168:171], v[212:215]
    s_add_u32 s22, s22, 0x2000
    ds_read_b64 a[152:153], v7 offset:16384
    ds_read_b64 a[154:155], v8 offset:16384
    v_mfma_f32_16x16x32_bf16 v[212:215], a[156:159], v[172:175], v[212:215]
    s_and_b32 s22, s22, 0x1ffff
    v_cvt_pk_bf16_f32 v240, v192, v193
    v_cvt_pk_bf16_f32 v241, v194, v195
    v_mfma_f32_16x16x32_bf16 v[220:223], a[132:135], v[176:179], 0
    s_add_u32 m0, s20, 0
    ds_read_b64 a[132:133], v1 offset:20480
    ds_read_b64 a[134:135], v2 offset:20480
    v_mfma_f32_16x16x32_bf16 v[220:223], a[140:143], v[180:183], v[220:223]
    buffer_load_dwordx4 v19, s[40:43], s22 offen offset:0 lds
    v_mfma_f32_16x16x32_bf16 v[220:223], a[148:151], v[184:187], v[220:223]
    ds_read_b64 a[140:141], v3 offset:20480
    ds_read_b64 a[142:143], v4 offset:20480
    v_mfma_f32_16x16x32_bf16 v[220:223], a[156:159], v[188:191], v[220:223]
    v_exp_f32 v201, v201
    v_mfma_f32_16x16x32_bf16 a[64:67], a[160:163], v[232:235], 0
    ds_read_b64 a[148:149], v5 offset:20480
    ds_read_b64 a[150:151], v6 offset:20480
    v_mfma_f32_16x16x32_bf16 a[96:99], a[160:163], v[236:239], 0
    v_exp_f32 v202, v202
    v_mfma_f32_16x16x32_bf16 a[68:71], a[164:167], v[232:235], 0
    ds_read_b64 a[156:157], v7 offset:20480
    ds_read_b64 a[158:159], v8 offset:20480
    v_mfma_f32_16x16x32_bf16 a[100:103], a[164:167], v[236:239], 0
    ds_read_b64_tr_b16 a[160:161], v9 offset:8192
    ds_read_b64_tr_b16 a[162:163], v9 offset:12288
    v_mfma_f32_16x16x32_bf16 a[72:75], a[168:171], v[232:235], 0
    buffer_load_dwordx4 v20, s[40:43], s22 offen offset:1024 lds
    v_mfma_f32_16x16x32_bf16 a[104:107], a[168:171], v[236:239], 0
    ds_read_b64_tr_b16 a[164:165], v10 offset:8192
    ds_read_b64_tr_b16 a[166:167], v10 offset:12288
    v_mfma_f32_16x16x32_bf16 a[76:79], a[172:175], v[232:235], 0
    v_exp_f32 v203, v203
    v_mfma_f32_16x16x32_bf16 a[108:111], a[172:175], v[236:239], 0
    ds_read_b64_tr_b16 a[168:169], v11 offset:8192
    ds_read_b64_tr_b16 a[170:171], v11 offset:12288
    v_mfma_f32_16x16x32_bf16 a[80:83], a[176:179], v[232:235], 0
    v_exp_f32 v196, v196
    v_mfma_f32_16x16x32_bf16 a[112:115], a[176:179], v[236:239], 0
    s_add_u32 m0, s16, 98304
    ds_read_b64_tr_b16 a[172:173], v12 offset:8192
    ds_read_b64_tr_b16 a[174:175], v12 offset:12288
    v_mfma_f32_16x16x32_bf16 a[84:87], a[180:183], v[232:235], 0
    buffer_load_dwordx4 v47, s[56:59], s90 offen offset:3072 lds
    v_mfma_f32_16x16x32_bf16 a[116:119], a[180:183], v[236:239], 0
    ds_read_b64_tr_b16 a[176:177], v13 offset:8192
    ds_read_b64_tr_b16 a[178:179], v13 offset:12288
    v_mfma_f32_16x16x32_bf16 a[88:91], a[184:187], v[232:235], 0
    v_cvt_pk_bf16_f32 v244, v200, v201
    v_cvt_pk_bf16_f32 v245, v202, v203
    v_mfma_f32_16x16x32_bf16 a[120:123], a[184:187], v[236:239], 0
    ds_read_b64_tr_b16 a[180:181], v14 offset:8192
    ds_read_b64_tr_b16 a[182:183], v14 offset:12288
    v_mfma_f32_16x16x32_bf16 a[92:95], a[188:191], v[232:235], 0
    v_exp_f32 v197, v197
    v_mfma_f32_16x16x32_bf16 a[124:127], a[188:191], v[236:239], 0
    ds_read_b64_tr_b16 a[184:185], v15 offset:8192
    ds_read_b64_tr_b16 a[186:187], v15 offset:12288
    v_mfma_f32_16x16x32_bf16 v[104:107], v[50:53], v[232:235], 0
    s_mov_b32 s90, 65536
    v_exp_f32 v198, v198
    v_exp_f32 v199, v199
    v_exp_f32 v204, v204
    v_cvt_pk_bf16_f32 v242, v196, v197
    v_cvt_pk_bf16_f32 v243, v198, v199
    v_exp_f32 v205, v205
    v_exp_f32 v206, v206
    v_exp_f32 v207, v207
    v_cvt_pk_bf16_f32 v246, v204, v205
    v_cvt_pk_bf16_f32 v247, v206, v207
    v_mfma_f32_16x16x32_bf16 v[108:111], v[50:53], v[236:239], 0
    s_add_u32 m0, s16, 102400
    s_waitcnt lgkmcnt(14)
    ds_read_b64_tr_b16 a[188:189], v16 offset:8192
    ds_read_b64_tr_b16 a[190:191], v16 offset:12288
    v_mfma_f32_16x16x32_bf16 v[192:195], a[128:131], v[128:131], 0
    buffer_load_dwordx4 v44, s[56:59], s90 offen offset:0 lds
    v_mfma_f32_16x16x32_bf16 v[192:195], a[136:139], v[132:135], v[192:195]
    v_exp_f32 v208, v208
    v_mfma_f32_16x16x32_bf16 v[192:195], a[144:147], v[136:139], v[192:195]
    v_exp_f32 v209, v209
    v_mfma_f32_16x16x32_bf16 v[192:195], a[152:155], v[140:143], v[192:195]
    v_exp_f32 v210, v210
    v_mfma_f32_16x16x32_bf16 v[200:203], a[128:131], v[144:147], 0
    v_exp_f32 v211, v211
    v_mfma_f32_16x16x32_bf16 v[200:203], a[136:139], v[148:151], v[200:203]
    v_exp_f32 v216, v216
    v_mfma_f32_16x16x32_bf16 v[200:203], a[144:147], v[152:155], v[200:203]
    buffer_load_dwordx4 v45, s[56:59], s90 offen offset:1024 lds
    v_mfma_f32_16x16x32_bf16 v[200:203], a[152:155], v[156:159], v[200:203]
    v_cvt_pk_bf16_f32 v248, v208, v209
    v_cvt_pk_bf16_f32 v249, v210, v211
    v_mfma_f32_16x16x32_bf16 v[196:199], a[132:135], v[128:131], 0
    v_exp_f32 v217, v217
    v_mfma_f32_16x16x32_bf16 v[196:199], a[140:143], v[132:135], v[196:199]
    v_exp_f32 v218, v218
    v_mfma_f32_16x16x32_bf16 v[196:199], a[148:151], v[136:139], v[196:199]
    v_exp_f32 v219, v219
    v_mfma_f32_16x16x32_bf16 v[196:199], a[156:159], v[140:143], v[196:199]
    v_exp_f32 v212, v212
    v_mfma_f32_16x16x32_bf16 v[204:207], a[132:135], v[144:147], 0
    buffer_load_dwordx4 v46, s[56:59], s90 offen offset:2048 lds
    v_mfma_f32_16x16x32_bf16 v[204:207], a[140:143], v[148:151], v[204:207]
    v_cvt_pk_bf16_f32 v252, v216, v217
    v_cvt_pk_bf16_f32 v253, v218, v219
    v_mfma_f32_16x16x32_bf16 v[204:207], a[148:151], v[152:155], v[204:207]
    v_exp_f32 v213, v213
    v_mfma_f32_16x16x32_bf16 v[204:207], a[156:159], v[156:159], v[204:207]
    s_waitcnt lgkmcnt(0)
    v_exp_f32 v214, v214
    v_mfma_f32_16x16x32_bf16 a[0:3], a[160:163], v[240:243], a[0:3]
    v_exp_f32 v215, v215
    v_mfma_f32_16x16x32_bf16 a[32:35], a[160:163], v[244:247], a[32:35]
    v_exp_f32 v220, v220
    v_mfma_f32_16x16x32_bf16 a[4:7], a[164:167], v[240:243], a[4:7]
    v_cvt_pk_bf16_f32 v250, v212, v213
    v_cvt_pk_bf16_f32 v251, v214, v215
    v_mfma_f32_16x16x32_bf16 a[36:39], a[164:167], v[244:247], a[36:39]
    v_exp_f32 v221, v221
    v_mfma_f32_16x16x32_bf16 a[8:11], a[168:171], v[240:243], a[8:11]
    v_exp_f32 v222, v222
    v_mfma_f32_16x16x32_bf16 a[40:43], a[168:171], v[244:247], a[40:43]
    v_exp_f32 v223, v223
    v_mfma_f32_16x16x32_bf16 a[12:15], a[172:175], v[240:243], a[12:15]
    v_cvt_pk_bf16_f32 v254, v220, v221
    v_cvt_pk_bf16_f32 v255, v222, v223
    v_mfma_f32_16x16x32_bf16 a[44:47], a[172:175], v[244:247], a[44:47]
    v_exp_f32 v192, v192
    v_mfma_f32_16x16x32_bf16 a[16:19], a[176:179], v[240:243], a[16:19]
    v_exp_f32 v193, v193
    v_mfma_f32_16x16x32_bf16 a[48:51], a[176:179], v[244:247], a[48:51]
    v_exp_f32 v194, v194
    v_mfma_f32_16x16x32_bf16 a[20:23], a[180:183], v[240:243], a[20:23]
    v_exp_f32 v195, v195
    v_mfma_f32_16x16x32_bf16 a[52:55], a[180:183], v[244:247], a[52:55]
    v_exp_f32 v200, v200
    v_mfma_f32_16x16x32_bf16 a[24:27], a[184:187], v[240:243], a[24:27]
    v_cvt_pk_bf16_f32 v224, v192, v193
    v_cvt_pk_bf16_f32 v225, v194, v195
    v_mfma_f32_16x16x32_bf16 a[56:59], a[184:187], v[244:247], a[56:59]
    v_exp_f32 v201, v201
    v_mfma_f32_16x16x32_bf16 a[28:31], a[188:191], v[240:243], a[28:31]
    v_exp_f32 v202, v202
    v_mfma_f32_16x16x32_bf16 a[60:63], a[188:191], v[244:247], a[60:63]
    v_exp_f32 v203, v203
    v_mfma_f32_16x16x32_bf16 v[96:99], v[50:53], v[240:243], v[96:99]
    s_add_u32 s21, s21, 0x2000
    v_exp_f32 v196, v196
    v_mfma_f32_16x16x32_bf16 v[100:103], v[50:53], v[244:247], v[100:103]
    s_waitcnt vmcnt(13)
    s_barrier
    s_and_b32 s21, s21, 0x1ffff
    v_mfma_f32_16x16x32_bf16 v[208:211], a[128:131], v[160:163], 0
    s_add_u32 m0, s19, 16384
    buffer_atomic_add v62, v63, s[76:79], s23 offen offset:128 sc1
    v_mfma_f32_16x16x32_bf16 v[208:211], a[136:139], v[164:167], v[208:211]
    buffer_load_dwordx4 v17, s[36:39], s21 offen offset:0 lds
    v_mfma_f32_16x16x32_bf16 v[208:211], a[144:147], v[168:171], v[208:211]
    v_cvt_pk_bf16_f32 v228, v200, v201
    v_cvt_pk_bf16_f32 v229, v202, v203
    v_mfma_f32_16x16x32_bf16 v[208:211], a[152:155], v[172:175], v[208:211]
    v_exp_f32 v197, v197
    v_mfma_f32_16x16x32_bf16 v[216:219], a[128:131], v[176:179], 0
    ds_read_b64 a[128:129], v1 offset:24576
    ds_read_b64 a[130:131], v2 offset:24576
    v_mfma_f32_16x16x32_bf16 v[216:219], a[136:139], v[180:183], v[216:219]
    v_exp_f32 v198, v198
    v_mfma_f32_16x16x32_bf16 v[216:219], a[144:147], v[184:187], v[216:219]
    ds_read_b64 a[136:137], v3 offset:24576
    ds_read_b64 a[138:139], v4 offset:24576
    v_mfma_f32_16x16x32_bf16 v[216:219], a[152:155], v[188:191], v[216:219]
    buffer_load_dwordx4 v18, s[36:39], s21 offen offset:1024 lds
    v_mfma_f32_16x16x32_bf16 v[212:215], a[132:135], v[160:163], 0
    ds_read_b64 a[144:145], v5 offset:24576
    ds_read_b64 a[146:147], v6 offset:24576
    v_mfma_f32_16x16x32_bf16 v[212:215], a[140:143], v[164:167], v[212:215]
    v_exp_f32 v199, v199
    v_mfma_f32_16x16x32_bf16 v[212:215], a[148:151], v[168:171], v[212:215]
    s_add_u32 s22, s22, 0x2000
    ds_read_b64 a[152:153], v7 offset:24576
    ds_read_b64 a[154:155], v8 offset:24576
    v_mfma_f32_16x16x32_bf16 v[212:215], a[156:159], v[172:175], v[212:215]
    s_and_b32 s22, s22, 0x1ffff
    v_exp_f32 v204, v204
    v_mfma_f32_16x16x32_bf16 v[220:223], a[132:135], v[176:179], 0
    s_add_u32 m0, s20, 8192
    ds_read_b64 a[132:133], v1 offset:28672
    ds_read_b64 a[134:135], v2 offset:28672
    v_mfma_f32_16x16x32_bf16 v[220:223], a[140:143], v[180:183], v[220:223]
    buffer_load_dwordx4 v19, s[40:43], s22 offen offset:0 lds
    v_mfma_f32_16x16x32_bf16 v[220:223], a[148:151], v[184:187], v[220:223]
    ds_read_b64 a[140:141], v3 offset:28672
    ds_read_b64 a[142:143], v4 offset:28672
    v_mfma_f32_16x16x32_bf16 v[220:223], a[156:159], v[188:191], v[220:223]
    v_cvt_pk_bf16_f32 v226, v196, v197
    v_cvt_pk_bf16_f32 v227, v198, v199
    v_mfma_f32_16x16x32_bf16 a[64:67], a[160:163], v[248:251], a[64:67]
    ds_read_b64 a[148:149], v5 offset:28672
    ds_read_b64 a[150:151], v6 offset:28672
    v_mfma_f32_16x16x32_bf16 a[96:99], a[160:163], v[252:255], a[96:99]
    v_exp_f32 v205, v205
    v_mfma_f32_16x16x32_bf16 a[68:71], a[164:167], v[248:251], a[68:71]
    ds_read_b64 a[156:157], v7 offset:28672
    ds_read_b64 a[158:159], v8 offset:28672
    v_mfma_f32_16x16x32_bf16 a[100:103], a[164:167], v[252:255], a[100:103]
    ds_read_b64_tr_b16 a[160:161], v9 offset:16384
    ds_read_b64_tr_b16 a[162:163], v9 offset:20480
    v_mfma_f32_16x16x32_bf16 a[72:75], a[168:171], v[248:251], a[72:75]
    buffer_load_dwordx4 v20, s[40:43], s22 offen offset:1024 lds
    v_mfma_f32_16x16x32_bf16 a[104:107], a[168:171], v[252:255], a[104:107]
    ds_read_b64_tr_b16 a[164:165], v10 offset:16384
    ds_read_b64_tr_b16 a[166:167], v10 offset:20480
    v_mfma_f32_16x16x32_bf16 a[76:79], a[172:175], v[248:251], a[76:79]
    v_exp_f32 v206, v206
    v_mfma_f32_16x16x32_bf16 a[108:111], a[172:175], v[252:255], a[108:111]
    ds_read_b64_tr_b16 a[168:169], v11 offset:16384
    ds_read_b64_tr_b16 a[170:171], v11 offset:20480
    v_mfma_f32_16x16x32_bf16 a[80:83], a[176:179], v[248:251], a[80:83]
    buffer_load_dword v21, v27, s[60:63], s1 offen
    v_mfma_f32_16x16x32_bf16 a[112:115], a[176:179], v[252:255], a[112:115]
    s_add_u32 m0, s16, 102400
    ds_read_b64_tr_b16 a[172:173], v12 offset:16384
    ds_read_b64_tr_b16 a[174:175], v12 offset:20480
    v_mfma_f32_16x16x32_bf16 a[84:87], a[180:183], v[248:251], a[84:87]
    buffer_load_dwordx4 v47, s[56:59], s90 offen offset:3072 lds
    v_mfma_f32_16x16x32_bf16 a[116:119], a[180:183], v[252:255], a[116:119]
    ds_read_b64_tr_b16 a[176:177], v13 offset:16384
    ds_read_b64_tr_b16 a[178:179], v13 offset:20480
    v_mfma_f32_16x16x32_bf16 a[88:91], a[184:187], v[248:251], a[88:91]
    v_exp_f32 v207, v207
    v_mfma_f32_16x16x32_bf16 a[120:123], a[184:187], v[252:255], a[120:123]
    ds_read_b64_tr_b16 a[180:181], v14 offset:16384
    ds_read_b64_tr_b16 a[182:183], v14 offset:20480
    v_mfma_f32_16x16x32_bf16 a[92:95], a[188:191], v[248:251], a[92:95]
    v_cvt_pk_bf16_f32 v230, v204, v205
    v_cvt_pk_bf16_f32 v231, v206, v207
    v_mfma_f32_16x16x32_bf16 a[124:127], a[188:191], v[252:255], a[124:127]
    ds_read_b64_tr_b16 a[184:185], v15 offset:16384
    ds_read_b64_tr_b16 a[186:187], v15 offset:20480
    v_mfma_f32_16x16x32_bf16 v[104:107], v[50:53], v[248:251], v[104:107]
    v_exp_f32 v208, v208
    v_mfma_f32_16x16x32_bf16 v[108:111], v[50:53], v[252:255], v[108:111]
    s_waitcnt lgkmcnt(14)
    ds_read_b64_tr_b16 a[188:189], v16 offset:16384
    ds_read_b64_tr_b16 a[190:191], v16 offset:20480
    v_mfma_f32_16x16x32_bf16 v[192:195], a[128:131], v[128:131], 0
    v_exp_f32 v209, v209
    v_mfma_f32_16x16x32_bf16 v[192:195], a[136:139], v[132:135], v[192:195]
    v_exp_f32 v210, v210
    v_mfma_f32_16x16x32_bf16 v[192:195], a[144:147], v[136:139], v[192:195]
    v_exp_f32 v211, v211
    v_mfma_f32_16x16x32_bf16 v[192:195], a[152:155], v[140:143], v[192:195]
    v_exp_f32 v216, v216
    v_mfma_f32_16x16x32_bf16 v[200:203], a[128:131], v[144:147], 0
    v_cvt_pk_bf16_f32 v232, v208, v209
    v_cvt_pk_bf16_f32 v233, v210, v211
    v_mfma_f32_16x16x32_bf16 v[200:203], a[136:139], v[148:151], v[200:203]
    v_exp_f32 v217, v217
    v_mfma_f32_16x16x32_bf16 v[200:203], a[144:147], v[152:155], v[200:203]
    v_exp_f32 v218, v218
    v_mfma_f32_16x16x32_bf16 v[200:203], a[152:155], v[156:159], v[200:203]
    v_exp_f32 v219, v219
    v_mfma_f32_16x16x32_bf16 v[196:199], a[132:135], v[128:131], 0
    v_exp_f32 v212, v212
    v_mfma_f32_16x16x32_bf16 v[196:199], a[140:143], v[132:135], v[196:199]
    v_cvt_pk_bf16_f32 v236, v216, v217
    v_cvt_pk_bf16_f32 v237, v218, v219
    v_mfma_f32_16x16x32_bf16 v[196:199], a[148:151], v[136:139], v[196:199]
    v_exp_f32 v213, v213
    v_mfma_f32_16x16x32_bf16 v[196:199], a[156:159], v[140:143], v[196:199]
    v_exp_f32 v214, v214
    v_mfma_f32_16x16x32_bf16 v[204:207], a[132:135], v[144:147], 0
    v_exp_f32 v215, v215
    v_mfma_f32_16x16x32_bf16 v[204:207], a[140:143], v[148:151], v[204:207]
    v_exp_f32 v220, v220
    v_mfma_f32_16x16x32_bf16 v[204:207], a[148:151], v[152:155], v[204:207]
    v_cvt_pk_bf16_f32 v234, v212, v213
    v_cvt_pk_bf16_f32 v235, v214, v215
    v_mfma_f32_16x16x32_bf16 v[204:207], a[156:159], v[156:159], v[204:207]
    s_waitcnt lgkmcnt(0)
    v_exp_f32 v221, v221
    v_mfma_f32_16x16x32_bf16 a[0:3], a[160:163], v[224:227], a[0:3]
    s_add_u32 s25, s31, 0x4000
    v_exp_f32 v222, v222
    v_mfma_f32_16x16x32_bf16 a[32:35], a[160:163], v[228:231], a[32:35]
    buffer_load_dwordx2 v[112:113], v59, s[32:35], s31 offen offset:0
    v_mfma_f32_16x16x32_bf16 a[4:7], a[164:167], v[224:227], a[4:7]
    v_exp_f32 v223, v223
    v_mfma_f32_16x16x32_bf16 a[36:39], a[164:167], v[228:231], a[36:39]
    v_cvt_pk_bf16_f32 v238, v220, v221
    v_cvt_pk_bf16_f32 v239, v222, v223
    v_mfma_f32_16x16x32_bf16 a[8:11], a[168:171], v[224:227], a[8:11]
    v_exp_f32 v192, v192
    v_mfma_f32_16x16x32_bf16 a[40:43], a[168:171], v[228:231], a[40:43]
    buffer_load_dwordx2 v[114:115], v59, s[32:35], s31 offen offset:32
    v_mfma_f32_16x16x32_bf16 a[12:15], a[172:175], v[224:227], a[12:15]
    v_exp_f32 v193, v193
    v_mfma_f32_16x16x32_bf16 a[44:47], a[172:175], v[228:231], a[44:47]
    v_exp_f32 v194, v194
    v_mfma_f32_16x16x32_bf16 a[16:19], a[176:179], v[224:227], a[16:19]
    v_exp_f32 v195, v195
    v_mfma_f32_16x16x32_bf16 a[48:51], a[176:179], v[228:231], a[48:51]
    buffer_load_dwordx2 v[116:117], v59, s[32:35], s25 offen offset:0
    v_mfma_f32_16x16x32_bf16 a[20:23], a[180:183], v[224:227], a[20:23]
    v_exp_f32 v200, v200
    v_mfma_f32_16x16x32_bf16 a[52:55], a[180:183], v[228:231], a[52:55]
    v_cvt_pk_bf16_f32 v240, v192, v193
    v_cvt_pk_bf16_f32 v241, v194, v195
    v_mfma_f32_16x16x32_bf16 a[24:27], a[184:187], v[224:227], a[24:27]
    v_exp_f32 v201, v201
    v_mfma_f32_16x16x32_bf16 a[56:59], a[184:187], v[228:231], a[56:59]
    buffer_load_dwordx2 v[118:119], v59, s[32:35], s25 offen offset:32
    v_mfma_f32_16x16x32_bf16 a[28:31], a[188:191], v[224:227], a[28:31]
    v_exp_f32 v202, v202
    v_mfma_f32_16x16x32_bf16 a[60:63], a[188:191], v[228:231], a[60:63]
    v_exp_f32 v203, v203
    v_mfma_f32_16x16x32_bf16 v[96:99], v[50:53], v[224:227], v[96:99]
    s_add_u32 s21, s21, 0x2000
    v_exp_f32 v196, v196
    v_mfma_f32_16x16x32_bf16 v[100:103], v[50:53], v[228:231], v[100:103]
    s_waitcnt vmcnt(15)
    s_barrier
    s_and_b32 s21, s21, 0x1ffff
    v_mfma_f32_16x16x32_bf16 v[208:211], a[128:131], v[160:163], 0
    s_add_u32 m0, s19, 24576
    v_cvt_pk_bf16_f32 v244, v200, v201
    v_cvt_pk_bf16_f32 v245, v202, v203
    v_mfma_f32_16x16x32_bf16 v[208:211], a[136:139], v[164:167], v[208:211]
    buffer_load_dwordx4 v17, s[36:39], s21 offen offset:0 lds
    v_mfma_f32_16x16x32_bf16 v[208:211], a[144:147], v[168:171], v[208:211]
    v_exp_f32 v197, v197
    v_mfma_f32_16x16x32_bf16 v[208:211], a[152:155], v[172:175], v[208:211]
    v_exp_f32 v198, v198
    v_mfma_f32_16x16x32_bf16 v[216:219], a[128:131], v[176:179], 0
    ds_read_b64 a[128:129], v1 offset:0
    ds_read_b64 a[130:131], v2 offset:0
    v_mfma_f32_16x16x32_bf16 v[216:219], a[136:139], v[180:183], v[216:219]
    v_exp_f32 v199, v199
    v_mfma_f32_16x16x32_bf16 v[216:219], a[144:147], v[184:187], v[216:219]
    ds_read_b64 a[136:137], v3 offset:0
    ds_read_b64 a[138:139], v4 offset:0
    v_mfma_f32_16x16x32_bf16 v[216:219], a[152:155], v[188:191], v[216:219]
    buffer_load_dwordx4 v18, s[36:39], s21 offen offset:1024 lds
    v_mfma_f32_16x16x32_bf16 v[212:215], a[132:135], v[160:163], 0
    ds_read_b64 a[144:145], v5 offset:0
    ds_read_b64 a[146:147], v6 offset:0
    v_mfma_f32_16x16x32_bf16 v[212:215], a[140:143], v[164:167], v[212:215]
    v_exp_f32 v204, v204
    v_mfma_f32_16x16x32_bf16 v[212:215], a[148:151], v[168:171], v[212:215]
    s_add_u32 s22, s22, 0x2000
    ds_read_b64 a[152:153], v7 offset:0
    ds_read_b64 a[154:155], v8 offset:0
    v_mfma_f32_16x16x32_bf16 v[212:215], a[156:159], v[172:175], v[212:215]
    s_and_b32 s22, s22, 0x1ffff
    v_cvt_pk_bf16_f32 v242, v196, v197
    v_cvt_pk_bf16_f32 v243, v198, v199
    v_mfma_f32_16x16x32_bf16 v[220:223], a[132:135], v[176:179], 0
    s_add_u32 m0, s20, 16384
    ds_read_b64 a[132:133], v1 offset:4096
    ds_read_b64 a[134:135], v2 offset:4096
    v_mfma_f32_16x16x32_bf16 v[220:223], a[140:143], v[180:183], v[220:223]
    buffer_load_dwordx4 v19, s[40:43], s22 offen offset:0 lds
    v_mfma_f32_16x16x32_bf16 v[220:223], a[148:151], v[184:187], v[220:223]
    ds_read_b64 a[140:141], v3 offset:4096
    ds_read_b64 a[142:143], v4 offset:4096
    v_mfma_f32_16x16x32_bf16 v[220:223], a[156:159], v[188:191], v[220:223]
    v_exp_f32 v205, v205
    v_mfma_f32_16x16x32_bf16 a[64:67], a[160:163], v[232:235], a[64:67]
    ds_read_b64 a[148:149], v5 offset:4096
    ds_read_b64 a[150:151], v6 offset:4096
    v_mfma_f32_16x16x32_bf16 a[96:99], a[160:163], v[236:239], a[96:99]
    v_exp_f32 v206, v206
    v_mfma_f32_16x16x32_bf16 a[68:71], a[164:167], v[232:235], a[68:71]
    ds_read_b64 a[156:157], v7 offset:4096
    ds_read_b64 a[158:159], v8 offset:4096
    v_mfma_f32_16x16x32_bf16 a[100:103], a[164:167], v[236:239], a[100:103]
    ds_read_b64_tr_b16 a[160:161], v9 offset:0
    ds_read_b64_tr_b16 a[162:163], v9 offset:4096
    v_mfma_f32_16x16x32_bf16 a[72:75], a[168:171], v[232:235], a[72:75]
    buffer_load_dwordx4 v20, s[40:43], s22 offen offset:1024 lds
    v_mfma_f32_16x16x32_bf16 a[104:107], a[168:171], v[236:239], a[104:107]
    ds_read_b64_tr_b16 a[164:165], v10 offset:0
    ds_read_b64_tr_b16 a[166:167], v10 offset:4096
    v_mfma_f32_16x16x32_bf16 a[76:79], a[172:175], v[232:235], a[76:79]
    v_exp_f32 v207, v207
    v_mfma_f32_16x16x32_bf16 a[108:111], a[172:175], v[236:239], a[108:111]
    ds_read_b64_tr_b16 a[168:169], v11 offset:0
    ds_read_b64_tr_b16 a[170:171], v11 offset:4096
    v_mfma_f32_16x16x32_bf16 a[80:83], a[176:179], v[232:235], a[80:83]
    v_cvt_pk_bf16_f32 v246, v204, v205
    v_cvt_pk_bf16_f32 v247, v206, v207
    v_mfma_f32_16x16x32_bf16 a[112:115], a[176:179], v[236:239], a[112:115]
    ds_read_b64_tr_b16 a[172:173], v12 offset:0
    ds_read_b64_tr_b16 a[174:175], v12 offset:4096
    v_mfma_f32_16x16x32_bf16 a[84:87], a[180:183], v[232:235], a[84:87]
    v_exp_f32 v208, v208
    v_mfma_f32_16x16x32_bf16 a[116:119], a[180:183], v[236:239], a[116:119]
L_warm0_4:
    s_cbranch_execz L_warm0_5
    ds_read_b64_tr_b16 a[176:177], v13 offset:0
    ds_read_b64_tr_b16 a[178:179], v13 offset:4096
    v_mfma_f32_16x16x32_bf16 a[88:91], a[184:187], v[232:235], a[88:91]
    v_exp_f32 v209, v209
    v_mfma_f32_16x16x32_bf16 a[120:123], a[184:187], v[236:239], a[120:123]
    ds_read_b64_tr_b16 a[180:181], v14 offset:0
    ds_read_b64_tr_b16 a[182:183], v14 offset:4096
    v_mfma_f32_16x16x32_bf16 a[92:95], a[188:191], v[232:235], a[92:95]
    v_exp_f32 v210, v210
    v_mfma_f32_16x16x32_bf16 a[124:127], a[188:191], v[236:239], a[124:127]
    ds_read_b64_tr_b16 a[184:185], v15 offset:0
    ds_read_b64_tr_b16 a[186:187], v15 offset:4096
    v_mfma_f32_16x16x32_bf16 v[104:107], v[50:53], v[232:235], v[104:107]
    v_exp_f32 v211, v211
    v_mfma_f32_16x16x32_bf16 v[108:111], v[50:53], v[236:239], v[108:111]
    s_waitcnt lgkmcnt(14)
    ds_read_b64_tr_b16 a[188:189], v16 offset:0
    ds_read_b64_tr_b16 a[190:191], v16 offset:4096
    v_mfma_f32_16x16x32_bf16 v[192:195], a[128:131], v[128:131], 0
    v_exp_f32 v216, v216
    v_mfma_f32_16x16x32_bf16 v[192:195], a[136:139], v[132:135], v[192:195]
    v_cvt_pk_bf16_f32 v248, v208, v209
    v_cvt_pk_bf16_f32 v249, v210, v211
    v_mfma_f32_16x16x32_bf16 v[192:195], a[144:147], v[136:139], v[192:195]
    v_exp_f32 v217, v217
    v_mfma_f32_16x16x32_bf16 v[192:195], a[152:155], v[140:143], v[192:195]
    v_exp_f32 v218, v218
    v_mfma_f32_16x16x32_bf16 v[200:203], a[128:131], v[144:147], 0
    v_exp_f32 v219, v219
    v_mfma_f32_16x16x32_bf16 v[200:203], a[136:139], v[148:151], v[200:203]
    v_exp_f32 v212, v212
    v_mfma_f32_16x16x32_bf16 v[200:203], a[144:147], v[152:155], v[200:203]
    v_cvt_pk_bf16_f32 v252, v216, v217
    v_cvt_pk_bf16_f32 v253, v218, v219
    v_mfma_f32_16x16x32_bf16 v[200:203], a[152:155], v[156:159], v[200:203]
    v_exp_f32 v213, v213
    v_mfma_f32_16x16x32_bf16 v[196:199], a[132:135], v[128:131], 0
    v_exp_f32 v214, v214
    v_mfma_f32_16x16x32_bf16 v[196:199], a[140:143], v[132:135], v[196:199]
    v_exp_f32 v215, v215
    v_mfma_f32_16x16x32_bf16 v[196:199], a[148:151], v[136:139], v[196:199]
    v_exp_f32 v220, v220
    v_mfma_f32_16x16x32_bf16 v[196:199], a[156:159], v[140:143], v[196:199]
    v_cvt_pk_bf16_f32 v250, v212, v213
    v_cvt_pk_bf16_f32 v251, v214, v215
    v_mfma_f32_16x16x32_bf16 v[204:207], a[132:135], v[144:147], 0
    v_exp_f32 v221, v221
    v_mfma_f32_16x16x32_bf16 v[204:207], a[140:143], v[148:151], v[204:207]
    v_exp_f32 v222, v222
    v_mfma_f32_16x16x32_bf16 v[204:207], a[148:151], v[152:155], v[204:207]
    v_exp_f32 v223, v223
    v_mfma_f32_16x16x32_bf16 v[204:207], a[156:159], v[156:159], v[204:207]
    s_waitcnt lgkmcnt(0)
    v_cvt_pk_bf16_f32 v254, v220, v221
    v_cvt_pk_bf16_f32 v255, v222, v223
    v_mfma_f32_16x16x32_bf16 a[0:3], a[160:163], v[240:243], a[0:3]
    v_exp_f32 v192, v192
    v_mfma_f32_16x16x32_bf16 a[32:35], a[160:163], v[244:247], a[32:35]
    v_exp_f32 v193, v193
    v_mfma_f32_16x16x32_bf16 a[4:7], a[164:167], v[240:243], a[4:7]
    v_exp_f32 v194, v194
    v_mfma_f32_16x16x32_bf16 a[36:39], a[164:167], v[244:247], a[36:39]
    v_exp_f32 v195, v195
    v_mfma_f32_16x16x32_bf16 a[8:11], a[168:171], v[240:243], a[8:11]
    v_exp_f32 v200, v200
    v_mfma_f32_16x16x32_bf16 a[40:43], a[168:171], v[244:247], a[40:43]
    v_cvt_pk_bf16_f32 v224, v192, v193
    v_cvt_pk_bf16_f32 v225, v194, v195
    v_mfma_f32_16x16x32_bf16 a[12:15], a[172:175], v[240:243], a[12:15]
    buffer_load_dword v26, v58, s[76:79], 0 offen offset:128 sc1
    v_mfma_f32_16x16x32_bf16 a[44:47], a[172:175], v[244:247], a[44:47]
    v_exp_f32 v201, v201
    v_mfma_f32_16x16x32_bf16 a[16:19], a[176:179], v[240:243], a[16:19]
    v_exp_f32 v202, v202
    v_mfma_f32_16x16x32_bf16 a[48:51], a[176:179], v[244:247], a[48:51]
    v_exp_f32 v203, v203
    v_mfma_f32_16x16x32_bf16 a[20:23], a[180:183], v[240:243], a[20:23]
    v_exp_f32 v196, v196
    v_mfma_f32_16x16x32_bf16 a[52:55], a[180:183], v[244:247], a[52:55]
    v_cvt_pk_bf16_f32 v228, v200, v201
    v_cvt_pk_bf16_f32 v229, v202, v203
    v_mfma_f32_16x16x32_bf16 a[24:27], a[184:187], v[240:243], a[24:27]
    v_exp_f32 v197, v197
    v_mfma_f32_16x16x32_bf16 a[56:59], a[184:187], v[244:247], a[56:59]
    v_exp_f32 v198, v198
    v_mfma_f32_16x16x32_bf16 a[28:31], a[188:191], v[240:243], a[28:31]
    v_exp_f32 v199, v199
    v_mfma_f32_16x16x32_bf16 a[60:63], a[188:191], v[244:247], a[60:63]
    v_exp_f32 v204, v204
    v_mfma_f32_16x16x32_bf16 v[96:99], v[50:53], v[240:243], v[96:99]
    s_add_u32 s21, s21, 0x2000
    v_cvt_pk_bf16_f32 v226, v196, v197
    v_cvt_pk_bf16_f32 v227, v198, v199
    v_mfma_f32_16x16x32_bf16 v[100:103], v[50:53], v[244:247], v[100:103]
    s_waitcnt vmcnt(11)
    s_barrier
    s_and_b32 s21, s21, 0x1ffff
    v_mfma_f32_16x16x32_bf16 v[208:211], a[128:131], v[160:163], 0
    s_add_u32 m0, s19, 0
    v_exp_f32 v205, v205
    v_mfma_f32_16x16x32_bf16 v[208:211], a[136:139], v[164:167], v[208:211]
    buffer_load_dwordx4 v17, s[36:39], s21 offen offset:0 lds
    v_mfma_f32_16x16x32_bf16 v[208:211], a[144:147], v[168:171], v[208:211]
    v_exp_f32 v206, v206
    v_mfma_f32_16x16x32_bf16 v[208:211], a[152:155], v[172:175], v[208:211]
    v_exp_f32 v207, v207
    v_mfma_f32_16x16x32_bf16 v[216:219], a[128:131], v[176:179], 0
    ds_read_b64 a[128:129], v1 offset:8192
    ds_read_b64 a[130:131], v2 offset:8192
    v_mfma_f32_16x16x32_bf16 v[216:219], a[136:139], v[180:183], v[216:219]
    v_cvt_pk_bf16_f32 v230, v204, v205
    v_cvt_pk_bf16_f32 v231, v206, v207
    v_mfma_f32_16x16x32_bf16 v[216:219], a[144:147], v[184:187], v[216:219]
    ds_read_b64 a[136:137], v3 offset:8192
    ds_read_b64 a[138:139], v4 offset:8192
    v_mfma_f32_16x16x32_bf16 v[216:219], a[152:155], v[188:191], v[216:219]
    buffer_load_dwordx4 v18, s[36:39], s21 offen offset:1024 lds
    v_mfma_f32_16x16x32_bf16 v[212:215], a[132:135], v[160:163], 0
    ds_read_b64 a[144:145], v5 offset:8192
    ds_read_b64 a[146:147], v6 offset:8192
    v_mfma_f32_16x16x32_bf16 v[212:215], a[140:143], v[164:167], v[212:215]
    v_exp_f32 v208, v208
    v_mfma_f32_16x16x32_bf16 v[212:215], a[148:151], v[168:171], v[212:215]
    s_add_u32 s22, s22, 0x2000
    ds_read_b64 a[152:153], v7 offset:8192
    ds_read_b64 a[154:155], v8 offset:8192
    v_mfma_f32_16x16x32_bf16 v[212:215], a[156:159], v[172:175], v[212:215]
    s_and_b32 s22, s22, 0x1ffff
    v_exp_f32 v209, v209
    v_mfma_f32_16x16x32_bf16 v[220:223], a[132:135], v[176:179], 0
    s_add_u32 m0, s20, 0
    ds_read_b64 a[132:133], v1 offset:12288
    ds_read_b64 a[134:135], v2 offset:12288
    v_mfma_f32_16x16x32_bf16 v[220:223], a[140:143], v[180:183], v[220:223]
    buffer_load_dwordx4 v19, s[40:43], s22 offen offset:0 lds
    v_mfma_f32_16x16x32_bf16 v[220:223], a[148:151], v[184:187], v[220:223]
    ds_read_b64 a[140:141], v3 offset:12288
    ds_read_b64 a[142:143], v4 offset:12288
    v_mfma_f32_16x16x32_bf16 v[220:223], a[156:159], v[188:191], v[220:223]
    v_exp_f32 v210, v210
    v_mfma_f32_16x16x32_bf16 a[64:67], a[160:163], v[248:251], a[64:67]
    ds_read_b64 a[148:149], v5 offset:12288
    ds_read_b64 a[150:151], v6 offset:12288
    v_mfma_f32_16x16x32_bf16 a[96:99], a[160:163], v[252:255], a[96:99]
    v_exp_f32 v211, v211
    v_mfma_f32_16x16x32_bf16 a[68:71], a[164:167], v[248:251], a[68:71]
    ds_read_b64 a[156:157], v7 offset:12288
    ds_read_b64 a[158:159], v8 offset:12288
    v_mfma_f32_16x16x32_bf16 a[100:103], a[164:167], v[252:255], a[100:103]
    ds_read_b64_tr_b16 a[160:161], v9 offset:8192
    ds_read_b64_tr_b16 a[162:163], v9 offset:12288
    v_mfma_f32_16x16x32_bf16 a[72:75], a[168:171], v[248:251], a[72:75]
    buffer_load_dwordx4 v20, s[40:43], s22 offen offset:1024 lds
    v_mfma_f32_16x16x32_bf16 a[104:107], a[168:171], v[252:255], a[104:107]
    ds_read_b64_tr_b16 a[164:165], v10 offset:8192
    ds_read_b64_tr_b16 a[166:167], v10 offset:12288
    v_mfma_f32_16x16x32_bf16 a[76:79], a[172:175], v[248:251], a[76:79]
    v_exp_f32 v216, v216
    v_mfma_f32_16x16x32_bf16 a[108:111], a[172:175], v[252:255], a[108:111]
    ds_read_b64_tr_b16 a[168:169], v11 offset:8192
    ds_read_b64_tr_b16 a[170:171], v11 offset:12288
    v_mfma_f32_16x16x32_bf16 a[80:83], a[176:179], v[248:251], a[80:83]
    v_cvt_pk_bf16_f32 v232, v208, v209
    v_cvt_pk_bf16_f32 v233, v210, v211
    v_mfma_f32_16x16x32_bf16 a[112:115], a[176:179], v[252:255], a[112:115]
    ds_read_b64_tr_b16 a[172:173], v12 offset:8192
    ds_read_b64_tr_b16 a[174:175], v12 offset:12288
    v_mfma_f32_16x16x32_bf16 a[84:87], a[180:183], v[248:251], a[84:87]
    v_exp_f32 v217, v217
    v_mfma_f32_16x16x32_bf16 a[116:119], a[180:183], v[252:255], a[116:119]
    ds_read_b64_tr_b16 a[176:177], v13 offset:8192
    ds_read_b64_tr_b16 a[178:179], v13 offset:12288
    v_mfma_f32_16x16x32_bf16 a[88:91], a[184:187], v[248:251], a[88:91]
    v_exp_f32 v218, v218
    v_mfma_f32_16x16x32_bf16 a[120:123], a[184:187], v[252:255], a[120:123]
    ds_read_b64_tr_b16 a[180:181], v14 offset:8192
    ds_read_b64_tr_b16 a[182:183], v14 offset:12288
    v_mfma_f32_16x16x32_bf16 a[92:95], a[188:191], v[248:251], a[92:95]
    v_exp_f32 v219, v219
    v_mfma_f32_16x16x32_bf16 a[124:127], a[188:191], v[252:255], a[124:127]
    ds_read_b64_tr_b16 a[184:185], v15 offset:8192
    ds_read_b64_tr_b16 a[186:187], v15 offset:12288
    v_mfma_f32_16x16x32_bf16 v[104:107], v[50:53], v[248:251], v[104:107]
    v_exp_f32 v212, v212
    v_mfma_f32_16x16x32_bf16 v[108:111], v[50:53], v[252:255], v[108:111]
    s_waitcnt lgkmcnt(14)
    ds_read_b64_tr_b16 a[188:189], v16 offset:8192
    ds_read_b64_tr_b16 a[190:191], v16 offset:12288
    v_mfma_f32_16x16x32_bf16 v[192:195], a[128:131], v[128:131], 0
    v_cvt_pk_bf16_f32 v236, v216, v217
    v_cvt_pk_bf16_f32 v237, v218, v219
    v_mfma_f32_16x16x32_bf16 v[192:195], a[136:139], v[132:135], v[192:195]
    v_exp_f32 v213, v213
    v_mfma_f32_16x16x32_bf16 v[192:195], a[144:147], v[136:139], v[192:195]
    v_exp_f32 v214, v214
    v_mfma_f32_16x16x32_bf16 v[192:195], a[152:155], v[140:143], v[192:195]
    v_exp_f32 v215, v215
    v_mfma_f32_16x16x32_bf16 v[200:203], a[128:131], v[144:147], 0
    v_exp_f32 v220, v220
    v_mfma_f32_16x16x32_bf16 v[200:203], a[136:139], v[148:151], v[200:203]
    v_cvt_pk_bf16_f32 v234, v212, v213
    v_cvt_pk_bf16_f32 v235, v214, v215
    v_mfma_f32_16x16x32_bf16 v[200:203], a[144:147], v[152:155], v[200:203]
    s_waitcnt vmcnt(4)
    v_cmp_gt_u32 vcc, 32, v26
    s_cbranch_vccnz L_spin_5
    L_back_6:
    v_mfma_f32_16x16x32_bf16 v[200:203], a[152:155], v[156:159], v[200:203]
    v_exp_f32 v221, v221
    v_mfma_f32_16x16x32_bf16 v[196:199], a[132:135], v[128:131], 0
    v_exp_f32 v222, v222
    v_mfma_f32_16x16x32_bf16 v[196:199], a[140:143], v[132:135], v[196:199]
    s_movk_i32 s27, 0
    v_exp_f32 v223, v223
    v_mfma_f32_16x16x32_bf16 v[196:199], a[148:151], v[136:139], v[196:199]
    buffer_load_dwordx4 a[192:195], v36, s[80:83], s27 offen offset:0 sc1
    v_mfma_f32_16x16x32_bf16 v[196:199], a[156:159], v[140:143], v[196:199]
    v_cvt_pk_bf16_f32 v238, v220, v221
    v_cvt_pk_bf16_f32 v239, v222, v223
    v_mfma_f32_16x16x32_bf16 v[204:207], a[132:135], v[144:147], 0
    v_exp_f32 v192, v192
    v_mfma_f32_16x16x32_bf16 v[204:207], a[140:143], v[148:151], v[204:207]
    v_exp_f32 v193, v193
    v_mfma_f32_16x16x32_bf16 v[204:207], a[148:151], v[152:155], v[204:207]
    buffer_load_dwordx4 a[196:199], v37, s[80:83], s27 offen offset:0 sc1
    v_mfma_f32_16x16x32_bf16 v[204:207], a[156:159], v[156:159], v[204:207]
    s_waitcnt lgkmcnt(0)
    v_exp_f32 v194, v194
    v_mfma_f32_16x16x32_bf16 a[0:3], a[160:163], v[224:227], a[0:3]
    v_exp_f32 v195, v195
    v_mfma_f32_16x16x32_bf16 a[32:35], a[160:163], v[228:231], a[32:35]
    v_exp_f32 v200, v200
    v_mfma_f32_16x16x32_bf16 a[4:7], a[164:167], v[224:227], a[4:7]
    buffer_load_dwordx4 a[200:203], v36, s[80:83], s27 offen offset:1024 sc1
    v_mfma_f32_16x16x32_bf16 a[36:39], a[164:167], v[228:231], a[36:39]
    v_cvt_pk_bf16_f32 v240, v192, v193
    v_cvt_pk_bf16_f32 v241, v194, v195
    v_mfma_f32_16x16x32_bf16 a[8:11], a[168:171], v[224:227], a[8:11]
    v_exp_f32 v201, v201
    v_mfma_f32_16x16x32_bf16 a[40:43], a[168:171], v[228:231], a[40:43]
    v_exp_f32 v202, v202
    v_mfma_f32_16x16x32_bf16 a[12:15], a[172:175], v[224:227], a[12:15]
    buffer_load_dwordx4 a[204:207], v37, s[80:83], s27 offen offset:1024 sc1
    v_mfma_f32_16x16x32_bf16 a[44:47], a[172:175], v[228:231], a[44:47]
    v_exp_f32 v203, v203
    v_mfma_f32_16x16x32_bf16 a[16:19], a[176:179], v[224:227], a[16:19]
    v_exp_f32 v196, v196
    v_mfma_f32_16x16x32_bf16 a[48:51], a[176:179], v[228:231], a[48:51]
    v_cvt_pk_bf16_f32 v244, v200, v201
    v_cvt_pk_bf16_f32 v245, v202, v203
    v_mfma_f32_16x16x32_bf16 a[20:23], a[180:183], v[224:227], a[20:23]
    buffer_load_dwordx4 a[208:211], v36, s[80:83], s27 offen offset:2048 sc1
    v_mfma_f32_16x16x32_bf16 a[52:55], a[180:183], v[228:231], a[52:55]
    v_exp_f32 v197, v197
    v_mfma_f32_16x16x32_bf16 a[24:27], a[184:187], v[224:227], a[24:27]
    v_exp_f32 v198, v198
    v_mfma_f32_16x16x32_bf16 a[56:59], a[184:187], v[228:231], a[56:59]
    v_exp_f32 v199, v199
    v_mfma_f32_16x16x32_bf16 a[28:31], a[188:191], v[224:227], a[28:31]
    v_exp_f32 v204, v204
    v_mfma_f32_16x16x32_bf16 a[60:63], a[188:191], v[228:231], a[60:63]
    v_cvt_pk_bf16_f32 v242, v196, v197
    v_cvt_pk_bf16_f32 v243, v198, v199
    v_mfma_f32_16x16x32_bf16 v[96:99], v[50:53], v[224:227], v[96:99]
    s_add_u32 s21, s21, 0x2000
    v_exp_f32 v205, v205
    v_mfma_f32_16x16x32_bf16 v[100:103], v[50:53], v[228:231], v[100:103]
    s_barrier
    s_and_b32 s21, s21, 0x1ffff
    v_mfma_f32_16x16x32_bf16 v[208:211], a[128:131], v[160:163], 0
    s_add_u32 m0, s19, 8192
    v_exp_f32 v206, v206
    v_mfma_f32_16x16x32_bf16 v[208:211], a[136:139], v[164:167], v[208:211]
    buffer_load_dwordx4 v17, s[36:39], s21 offen offset:0 lds
    v_mfma_f32_16x16x32_bf16 v[208:211], a[144:147], v[168:171], v[208:211]
    v_exp_f32 v207, v207
    v_mfma_f32_16x16x32_bf16 v[208:211], a[152:155], v[172:175], v[208:211]
    v_cvt_pk_bf16_f32 v246, v204, v205
    v_cvt_pk_bf16_f32 v247, v206, v207
    v_mfma_f32_16x16x32_bf16 v[216:219], a[128:131], v[176:179], 0
    ds_read_b64 a[128:129], v1 offset:16384
    ds_read_b64 a[130:131], v2 offset:16384
    v_mfma_f32_16x16x32_bf16 v[216:219], a[136:139], v[180:183], v[216:219]
    v_exp_f32 v208, v208
    v_mfma_f32_16x16x32_bf16 v[216:219], a[144:147], v[184:187], v[216:219]
    ds_read_b64 a[136:137], v3 offset:16384
    ds_read_b64 a[138:139], v4 offset:16384
    v_mfma_f32_16x16x32_bf16 v[216:219], a[152:155], v[188:191], v[216:219]
    buffer_load_dwordx4 v18, s[36:39], s21 offen offset:1024 lds
    v_mfma_f32_16x16x32_bf16 v[212:215], a[132:135], v[160:163], 0
    ds_read_b64 a[144:145], v5 offset:16384
    ds_read_b64 a[146:147], v6 offset:16384
    v_mfma_f32_16x16x32_bf16 v[212:215], a[140:143], v[164:167], v[212:215]
    v_exp_f32 v209, v209
    v_mfma_f32_16x16x32_bf16 v[212:215], a[148:151], v[168:171], v[212:215]
    s_add_u32 s22, s22, 0x2000
    ds_read_b64 a[152:153], v7 offset:16384
    ds_read_b64 a[154:155], v8 offset:16384
    v_mfma_f32_16x16x32_bf16 v[212:215], a[156:159], v[172:175], v[212:215]
    s_and_b32 s22, s22, 0x1ffff
    v_exp_f32 v210, v210
    v_mfma_f32_16x16x32_bf16 v[220:223], a[132:135], v[176:179], 0
    s_add_u32 m0, s20, 8192
    ds_read_b64 a[132:133], v1 offset:20480
    ds_read_b64 a[134:135], v2 offset:20480
    v_mfma_f32_16x16x32_bf16 v[220:223], a[140:143], v[180:183], v[220:223]
    buffer_load_dwordx4 v19, s[40:43], s22 offen offset:0 lds
    v_mfma_f32_16x16x32_bf16 v[220:223], a[148:151], v[184:187], v[220:223]
    ds_read_b64 a[140:141], v3 offset:20480
    ds_read_b64 a[142:143], v4 offset:20480
    v_mfma_f32_16x16x32_bf16 v[220:223], a[156:159], v[188:191], v[220:223]
    v_exp_f32 v211, v211
    v_mfma_f32_16x16x32_bf16 a[64:67], a[160:163], v[232:235], a[64:67]
    ds_read_b64 a[148:149], v5 offset:20480
    ds_read_b64 a[150:151], v6 offset:20480
    v_mfma_f32_16x16x32_bf16 a[96:99], a[160:163], v[236:239], a[96:99]
    v_exp_f32 v216, v216
    v_mfma_f32_16x16x32_bf16 a[68:71], a[164:167], v[232:235], a[68:71]
    ds_read_b64 a[156:157], v7 offset:20480
    ds_read_b64 a[158:159], v8 offset:20480
    v_mfma_f32_16x16x32_bf16 a[100:103], a[164:167], v[236:239], a[100:103]
    ds_read_b64_tr_b16 a[160:161], v9 offset:16384
    ds_read_b64_tr_b16 a[162:163], v9 offset:20480
    v_mfma_f32_16x16x32_bf16 a[72:75], a[168:171], v[232:235], a[72:75]
    buffer_load_dwordx4 a[212:215], v37, s[80:83], s27 offen offset:2048 sc1
    v_mfma_f32_16x16x32_bf16 a[104:107], a[168:171], v[236:239], a[104:107]
    ds_read_b64_tr_b16 a[164:165], v10 offset:16384
    ds_read_b64_tr_b16 a[166:167], v10 offset:20480
    v_mfma_f32_16x16x32_bf16 a[76:79], a[172:175], v[232:235], a[76:79]
    buffer_load_dwordx4 v20, s[40:43], s22 offen offset:1024 lds
    v_mfma_f32_16x16x32_bf16 a[108:111], a[172:175], v[236:239], a[108:111]
    ds_read_b64_tr_b16 a[168:169], v11 offset:16384
    ds_read_b64_tr_b16 a[170:171], v11 offset:20480
    v_mfma_f32_16x16x32_bf16 a[80:83], a[176:179], v[232:235], a[80:83]
    buffer_load_dwordx4 a[216:219], v36, s[80:83], s27 offen offset:3072 sc1
    v_mfma_f32_16x16x32_bf16 a[112:115], a[176:179], v[236:239], a[112:115]
    ds_read_b64_tr_b16 a[172:173], v12 offset:16384
    ds_read_b64_tr_b16 a[174:175], v12 offset:20480
    v_mfma_f32_16x16x32_bf16 a[84:87], a[180:183], v[232:235], a[84:87]
    v_cvt_pk_bf16_f32 v248, v208, v209
    v_cvt_pk_bf16_f32 v249, v210, v211
    v_mfma_f32_16x16x32_bf16 a[116:119], a[180:183], v[236:239], a[116:119]
    ds_read_b64_tr_b16 a[176:177], v13 offset:16384
    ds_read_b64_tr_b16 a[178:179], v13 offset:20480
    v_mfma_f32_16x16x32_bf16 a[88:91], a[184:187], v[232:235], a[88:91]
    buffer_load_dwordx4 a[220:223], v37, s[80:83], s27 offen offset:3072 sc1
    v_mfma_f32_16x16x32_bf16 a[120:123], a[184:187], v[236:239], a[120:123]
    ds_read_b64_tr_b16 a[180:181], v14 offset:16384
    ds_read_b64_tr_b16 a[182:183], v14 offset:20480
    v_mfma_f32_16x16x32_bf16 a[92:95], a[188:191], v[232:235], a[92:95]
    v_exp_f32 v217, v217
    v_mfma_f32_16x16x32_bf16 a[124:127], a[188:191], v[236:239], a[124:127]
    ds_read_b64_tr_b16 a[184:185], v15 offset:16384
    ds_read_b64_tr_b16 a[186:187], v15 offset:20480
    v_mfma_f32_16x16x32_bf16 v[104:107], v[50:53], v[232:235], v[104:107]
    v_exp_f32 v218, v218
    v_mfma_f32_16x16x32_bf16 v[108:111], v[50:53], v[236:239], v[108:111]
    s_waitcnt lgkmcnt(14)
    ds_read_b64_tr_b16 a[188:189], v16 offset:16384
    ds_read_b64_tr_b16 a[190:191], v16 offset:20480
    s_movk_i32 s27, 4096
    v_mfma_f32_16x16x32_bf16 v[192:195], a[128:131], v[128:131], 0
    s_lshr_b32 s24, s2, 3
    buffer_load_dwordx4 a[224:227], v38, s[80:83], s27 offen offset:0 sc1
    v_mfma_f32_16x16x32_bf16 v[192:195], a[136:139], v[132:135], v[192:195]
    s_mul_i32 s24, s24, 43
    v_exp_f32 v219, v219
    v_mfma_f32_16x16x32_bf16 v[192:195], a[144:147], v[136:139], v[192:195]
    s_mul_i32 s25, s5, 11
    v_exp_f32 v212, v212
    v_mfma_f32_16x16x32_bf16 v[192:195], a[152:155], v[140:143], v[192:195]
    s_add_u32 s24, s24, s25
    v_cvt_pk_bf16_f32 v252, v216, v217
    v_cvt_pk_bf16_f32 v253, v218, v219
    v_mfma_f32_16x16x32_bf16 v[200:203], a[128:131], v[144:147], 0
    s_lshl_b32 s24, s24, 10
    v_exp_f32 v213, v213
    v_mfma_f32_16x16x32_bf16 v[200:203], a[136:139], v[148:151], v[200:203]
    s_and_b32 s25, s8, 1
    v_exp_f32 v214, v214
    v_mfma_f32_16x16x32_bf16 v[200:203], a[144:147], v[152:155], v[200:203]
    s_lshl_b32 s25, s25, 7
    buffer_load_dwordx4 a[228:231], v39, s[80:83], s27 offen offset:0 sc1
    v_mfma_f32_16x16x32_bf16 v[200:203], a[152:155], v[156:159], v[200:203]
    s_add_u32 s1, s24, s25
    v_exp_f32 v215, v215
    v_mfma_f32_16x16x32_bf16 v[196:199], a[132:135], v[128:131], 0
    s_mul_i32 s30, s5, 352256
    v_exp_f32 v220, v220
    v_mfma_f32_16x16x32_bf16 v[196:199], a[140:143], v[132:135], v[196:199]
    s_add_u32 s30, s30, s91
    v_cvt_pk_bf16_f32 v250, v212, v213
    v_cvt_pk_bf16_f32 v251, v214, v215
    v_mfma_f32_16x16x32_bf16 v[196:199], a[148:151], v[136:139], v[196:199]
    v_exp_f32 v221, v221
    v_mfma_f32_16x16x32_bf16 v[196:199], a[156:159], v[140:143], v[196:199]
    v_exp_f32 v222, v222
    v_mfma_f32_16x16x32_bf16 v[204:207], a[132:135], v[144:147], 0
    buffer_load_dwordx4 a[232:235], v38, s[80:83], s27 offen offset:1024 sc1
    v_mfma_f32_16x16x32_bf16 v[204:207], a[140:143], v[148:151], v[204:207]
    v_exp_f32 v223, v223
    v_mfma_f32_16x16x32_bf16 v[204:207], a[148:151], v[152:155], v[204:207]
    v_cvt_pk_bf16_f32 v254, v220, v221
    v_cvt_pk_bf16_f32 v255, v222, v223
    v_mfma_f32_16x16x32_bf16 v[204:207], a[156:159], v[156:159], v[204:207]
    s_waitcnt lgkmcnt(0)
    v_exp_f32 v192, v192
    v_mfma_f32_16x16x32_bf16 a[0:3], a[160:163], v[240:243], a[0:3]
    v_exp_f32 v193, v193
    v_mfma_f32_16x16x32_bf16 a[32:35], a[160:163], v[244:247], a[32:35]
    ds_read_b64_tr_b16 v[64:65], v48 offset:0
    ds_read_b64_tr_b16 v[66:67], v48 offset:1024
    v_mfma_f32_16x16x32_bf16 a[4:7], a[164:167], v[240:243], a[4:7]
    buffer_load_dwordx4 a[236:239], v39, s[80:83], s27 offen offset:1024 sc1
    v_mfma_f32_16x16x32_bf16 a[36:39], a[164:167], v[244:247], a[36:39]
    ds_read_b64_tr_b16 v[68:69], v49 offset:0
    ds_read_b64_tr_b16 v[70:71], v49 offset:1024
    v_mfma_f32_16x16x32_bf16 a[8:11], a[168:171], v[240:243], a[8:11]
    v_exp_f32 v194, v194
    v_mfma_f32_16x16x32_bf16 a[40:43], a[168:171], v[244:247], a[40:43]
    ds_read_b64_tr_b16 v[72:73], v48 offset:2048
    ds_read_b64_tr_b16 v[74:75], v48 offset:3072
    v_mfma_f32_16x16x32_bf16 a[12:15], a[172:175], v[240:243], a[12:15]
    v_exp_f32 v195, v195
    v_mfma_f32_16x16x32_bf16 a[44:47], a[172:175], v[244:247], a[44:47]
    ds_read_b64_tr_b16 v[76:77], v49 offset:2048
    ds_read_b64_tr_b16 v[78:79], v49 offset:3072
    v_mfma_f32_16x16x32_bf16 a[16:19], a[176:179], v[240:243], a[16:19]
    buffer_load_dwordx4 a[240:243], v38, s[80:83], s27 offen offset:2048 sc1
    v_mfma_f32_16x16x32_bf16 a[48:51], a[176:179], v[244:247], a[48:51]
    ds_read_b64_tr_b16 v[80:81], v48 offset:4096
    ds_read_b64_tr_b16 v[82:83], v48 offset:5120
    v_mfma_f32_16x16x32_bf16 a[20:23], a[180:183], v[240:243], a[20:23]
    v_exp_f32 v200, v200
    v_mfma_f32_16x16x32_bf16 a[52:55], a[180:183], v[244:247], a[52:55]
    ds_read_b64_tr_b16 v[84:85], v49 offset:4096
    ds_read_b64_tr_b16 v[86:87], v49 offset:5120
    v_mfma_f32_16x16x32_bf16 a[24:27], a[184:187], v[240:243], a[24:27]
    v_cvt_pk_bf16_f32 v224, v192, v193
    v_cvt_pk_bf16_f32 v225, v194, v195
    v_mfma_f32_16x16x32_bf16 a[56:59], a[184:187], v[244:247], a[56:59]
    ds_read_b64_tr_b16 v[88:89], v48 offset:6144
    ds_read_b64_tr_b16 v[90:91], v48 offset:7168
    v_mfma_f32_16x16x32_bf16 a[28:31], a[188:191], v[240:243], a[28:31]
    ds_read_b64_tr_b16 v[92:93], v49 offset:6144
    ds_read_b64_tr_b16 v[94:95], v49 offset:7168
    v_mfma_f32_16x16x32_bf16 a[60:63], a[188:191], v[244:247], a[60:63]
    v_exp_f32 v201, v201
    v_mfma_f32_16x16x32_bf16 v[96:99], v[50:53], v[240:243], v[96:99]
    s_add_u32 s21, s21, 0x2000
    v_exp_f32 v202, v202
    v_mfma_f32_16x16x32_bf16 v[100:103], v[50:53], v[244:247], v[100:103]
    s_waitcnt vmcnt(17)
    s_barrier
    s_and_b32 s21, s21, 0x1ffff
    v_mfma_f32_16x16x32_bf16 v[208:211], a[128:131], v[160:163], 0
    s_add_u32 m0, s19, 16384
    v_exp_f32 v203, v203
    v_mfma_f32_16x16x32_bf16 v[208:211], a[136:139], v[164:167], v[208:211]
    buffer_load_dwordx4 v17, s[36:39], s21 offen offset:0 lds
    v_mfma_f32_16x16x32_bf16 v[208:211], a[144:147], v[168:171], v[208:211]
    v_exp_f32 v196, v196
    v_mfma_f32_16x16x32_bf16 v[208:211], a[152:155], v[172:175], v[208:211]
    v_cvt_pk_bf16_f32 v228, v200, v201
    v_cvt_pk_bf16_f32 v229, v202, v203
    v_mfma_f32_16x16x32_bf16 v[216:219], a[128:131], v[176:179], 0
    ds_read_b64 a[128:129], v1 offset:24576
    ds_read_b64 a[130:131], v2 offset:24576
    v_mfma_f32_16x16x32_bf16 v[216:219], a[136:139], v[180:183], v[216:219]
    v_exp_f32 v197, v197
    v_mfma_f32_16x16x32_bf16 v[216:219], a[144:147], v[184:187], v[216:219]
    ds_read_b64 a[136:137], v3 offset:24576
    ds_read_b64 a[138:139], v4 offset:24576
    v_mfma_f32_16x16x32_bf16 v[216:219], a[152:155], v[188:191], v[216:219]
    buffer_load_dwordx4 v18, s[36:39], s21 offen offset:1024 lds
    v_mfma_f32_16x16x32_bf16 v[212:215], a[132:135], v[160:163], 0
    ds_read_b64 a[144:145], v5 offset:24576
    ds_read_b64 a[146:147], v6 offset:24576
    v_mfma_f32_16x16x32_bf16 v[212:215], a[140:143], v[164:167], v[212:215]
    v_exp_f32 v198, v198
    v_mfma_f32_16x16x32_bf16 v[212:215], a[148:151], v[168:171], v[212:215]
    s_add_u32 s22, s22, 0x2000
    ds_read_b64 a[152:153], v7 offset:24576
    ds_read_b64 a[154:155], v8 offset:24576
    v_mfma_f32_16x16x32_bf16 v[212:215], a[156:159], v[172:175], v[212:215]
    s_and_b32 s22, s22, 0x1ffff
    v_exp_f32 v199, v199
    v_mfma_f32_16x16x32_bf16 v[220:223], a[132:135], v[176:179], 0
    s_add_u32 m0, s20, 16384
    ds_read_b64 a[132:133], v1 offset:28672
    ds_read_b64 a[134:135], v2 offset:28672
    v_mfma_f32_16x16x32_bf16 v[220:223], a[140:143], v[180:183], v[220:223]
    buffer_load_dwordx4 v19, s[40:43], s22 offen offset:0 lds
    v_mfma_f32_16x16x32_bf16 v[220:223], a[148:151], v[184:187], v[220:223]
    ds_read_b64 a[140:141], v3 offset:28672
    ds_read_b64 a[142:143], v4 offset:28672
    v_mfma_f32_16x16x32_bf16 v[220:223], a[156:159], v[188:191], v[220:223]
    v_exp_f32 v204, v204
    v_mfma_f32_16x16x32_bf16 a[64:67], a[160:163], v[248:251], a[64:67]
    ds_read_b64 a[148:149], v5 offset:28672
    ds_read_b64 a[150:151], v6 offset:28672
    v_mfma_f32_16x16x32_bf16 a[96:99], a[160:163], v[252:255], a[96:99]
    v_cvt_pk_bf16_f32 v226, v196, v197
    v_cvt_pk_bf16_f32 v227, v198, v199
    v_mfma_f32_16x16x32_bf16 a[68:71], a[164:167], v[248:251], a[68:71]
    ds_read_b64 a[156:157], v7 offset:28672
    ds_read_b64 a[158:159], v8 offset:28672
    v_mfma_f32_16x16x32_bf16 a[100:103], a[164:167], v[252:255], a[100:103]
    ds_read_b64_tr_b16 a[160:161], v9 offset:0
    ds_read_b64_tr_b16 a[162:163], v9 offset:4096
    v_mfma_f32_16x16x32_bf16 a[72:75], a[168:171], v[248:251], a[72:75]
    buffer_load_dwordx4 v20, s[40:43], s22 offen offset:1024 lds
    v_mfma_f32_16x16x32_bf16 a[104:107], a[168:171], v[252:255], a[104:107]
    ds_read_b64_tr_b16 a[164:165], v10 offset:0
    ds_read_b64_tr_b16 a[166:167], v10 offset:4096
    v_mfma_f32_16x16x32_bf16 a[76:79], a[172:175], v[248:251], a[76:79]
    v_exp_f32 v205, v205
    v_mfma_f32_16x16x32_bf16 a[108:111], a[172:175], v[252:255], a[108:111]
    ds_read_b64_tr_b16 a[168:169], v11 offset:0
    ds_read_b64_tr_b16 a[170:171], v11 offset:4096
    v_mfma_f32_16x16x32_bf16 a[80:83], a[176:179], v[248:251], a[80:83]
    buffer_load_dwordx4 a[244:247], v39, s[80:83], s27 offen offset:2048 sc1
    v_mfma_f32_16x16x32_bf16 a[112:115], a[176:179], v[252:255], a[112:115]
    ds_read_b64_tr_b16 a[172:173], v12 offset:0
    ds_read_b64_tr_b16 a[174:175], v12 offset:4096
    v_mfma_f32_16x16x32_bf16 a[84:87], a[180:183], v[248:251], a[84:87]
    s_waitcnt lgkmcnt(15)
    v_exp_f32 v206, v206
    v_mfma_f32_16x16x32_bf16 a[116:119], a[180:183], v[252:255], a[116:119]
    ds_read_b64_tr_b16 a[176:177], v13 offset:0
    ds_read_b64_tr_b16 a[178:179], v13 offset:4096
    v_mfma_f32_16x16x32_bf16 a[88:91], a[184:187], v[248:251], a[88:91]
    v_exp_f32 v207, v207
    v_mfma_f32_16x16x32_bf16 a[120:123], a[184:187], v[252:255], a[120:123]
    ds_read_b64_tr_b16 a[180:181], v14 offset:0
    ds_read_b64_tr_b16 a[182:183], v14 offset:4096
    v_mfma_f32_16x16x32_bf16 a[92:95], a[188:191], v[248:251], a[92:95]
    s_waitcnt vmcnt(10)
    buffer_load_dwordx4 a[248:251], v38, s[80:83], s27 offen offset:3072 sc1
    v_mul_f32 v56, v28, v29
    v_mul_f32 v57, v32, v33
    v_and_b32 v127, 0xffff0000, v119
    v_lshlrev_b32 v126, 16, v119
    v_fma_f32 v127, v127, v33, -v57
    v_fma_f32 v126, v126, v33, -v57
    v_and_b32 v125, 0xffff0000, v118
    v_lshlrev_b32 v124, 16, v118
    v_fma_f32 v125, v125, v33, -v57
    v_fma_f32 v124, v124, v33, -v57
    v_and_b32 v123, 0xffff0000, v117
    v_lshlrev_b32 v122, 16, v117
    v_fma_f32 v123, v123, v33, -v57
    v_fma_f32 v122, v122, v33, -v57
    v_and_b32 v121, 0xffff0000, v116
    v_lshlrev_b32 v120, 16, v116
    v_fma_f32 v121, v121, v33, -v57
    v_fma_f32 v120, v120, v33, -v57
    v_and_b32 v119, 0xffff0000, v115
    v_lshlrev_b32 v118, 16, v115
    v_fma_f32 v119, v119, v29, -v56
    v_fma_f32 v118, v118, v29, -v56
    v_and_b32 v117, 0xffff0000, v114
    v_lshlrev_b32 v116, 16, v114
    v_fma_f32 v117, v117, v29, -v56
    v_fma_f32 v116, v116, v29, -v56
    v_and_b32 v115, 0xffff0000, v113
    v_lshlrev_b32 v114, 16, v113
    v_fma_f32 v115, v115, v29, -v56
    v_fma_f32 v114, v114, v29, -v56
    v_and_b32 v113, 0xffff0000, v112
    v_lshlrev_b32 v112, 16, v112
    v_fma_f32 v113, v113, v29, -v56
    v_fma_f32 v112, v112, v29, -v56
    v_mfma_f32_16x16x32_bf16 a[124:127], a[188:191], v[252:255], a[124:127]
    ds_read_b64_tr_b16 a[184:185], v15 offset:0
    ds_read_b64_tr_b16 a[186:187], v15 offset:4096
    v_mfma_f32_16x16x32_bf16 v[104:107], v[50:53], v[248:251], v[104:107]
    v_cvt_pk_bf16_f32 v230, v204, v205
    v_cvt_pk_bf16_f32 v231, v206, v207
    v_mfma_f32_16x16x32_bf16 v[108:111], v[50:53], v[252:255], v[108:111]
L_warm0_5:
    s_cbranch_execz L_warm_ret0
    ds_read_b64_tr_b16 a[188:189], v16 offset:0
    ds_read_b64_tr_b16 a[190:191], v16 offset:4096
    v_mfma_f32_16x16x32_bf16 v[112:115], v[64:67], a[192:195], v[112:115]
    v_exp_f32 v208, v208
    v_mfma_f32_16x16x32_bf16 v[112:115], v[72:75], a[200:203], v[112:115]
    v_exp_f32 v209, v209
    v_mfma_f32_16x16x32_bf16 v[112:115], v[80:83], a[208:211], v[112:115]
    buffer_load_dwordx4 a[252:255], v39, s[80:83], s27 offen offset:3072 sc1
    v_mfma_f32_16x16x32_bf16 v[112:115], v[88:91], a[216:219], v[112:115]
    v_exp_f32 v210, v210
    v_mfma_f32_16x16x32_bf16 v[120:123], v[64:67], a[196:199], v[120:123]
    v_exp_f32 v211, v211
    v_mfma_f32_16x16x32_bf16 v[120:123], v[72:75], a[204:207], v[120:123]
    v_exp_f32 v216, v216
    v_mfma_f32_16x16x32_bf16 v[120:123], v[80:83], a[212:215], v[120:123]
    v_cvt_pk_bf16_f32 v232, v208, v209
    v_cvt_pk_bf16_f32 v233, v210, v211
    v_mfma_f32_16x16x32_bf16 v[120:123], v[88:91], a[220:223], v[120:123]
    v_exp_f32 v217, v217
    v_mfma_f32_16x16x32_bf16 v[116:119], v[68:71], a[192:195], v[116:119]
    v_exp_f32 v218, v218
    v_mfma_f32_16x16x32_bf16 v[116:119], v[76:79], a[200:203], v[116:119]
    v_exp_f32 v219, v219
    v_mfma_f32_16x16x32_bf16 v[116:119], v[84:87], a[208:211], v[116:119]
    v_exp_f32 v212, v212
    v_mfma_f32_16x16x32_bf16 v[116:119], v[92:95], a[216:219], v[116:119]
    v_cvt_pk_bf16_f32 v236, v216, v217
    v_cvt_pk_bf16_f32 v237, v218, v219
    v_mfma_f32_16x16x32_bf16 v[124:127], v[68:71], a[196:199], v[124:127]
    v_exp_f32 v213, v213
    v_mfma_f32_16x16x32_bf16 v[124:127], v[76:79], a[204:207], v[124:127]
    v_exp_f32 v214, v214
    v_mfma_f32_16x16x32_bf16 v[124:127], v[84:87], a[212:215], v[124:127]
    v_exp_f32 v215, v215
    v_mfma_f32_16x16x32_bf16 v[124:127], v[92:95], a[220:223], v[124:127]
    s_waitcnt lgkmcnt(15)
    s_movk_i32 s27, 8192
    v_cmp_gt_u32 vcc, 11, v0
    v_mfma_f32_16x16x32_bf16 v[192:195], a[128:131], v[128:131], 0
    s_add_u32 s95, s95, 3145728
    buffer_load_dwordx4 a[192:195], v40, s[80:83], s27 offen offset:0 sc1
    v_mfma_f32_16x16x32_bf16 v[192:195], a[136:139], v[132:135], v[192:195]
    s_add_u32 s93, s95, 0x4000
    v_exp_f32 v220, v220
    v_mfma_f32_16x16x32_bf16 v[192:195], a[144:147], v[136:139], v[192:195]
    s_lshl_b32 s94, s7, 10
    v_cvt_pk_bf16_f32 v234, v212, v213
    v_cvt_pk_bf16_f32 v235, v214, v215
    v_mfma_f32_16x16x32_bf16 v[192:195], a[152:155], v[140:143], v[192:195]
    s_add_u32 s94, s94, s96
    v_exp_f32 v221, v221
    v_mfma_f32_16x16x32_bf16 v[200:203], a[128:131], v[144:147], 0
    v_exp_f32 v222, v222
    v_mfma_f32_16x16x32_bf16 v[200:203], a[136:139], v[148:151], v[200:203]
    v_exp_f32 v223, v223
    v_mfma_f32_16x16x32_bf16 v[200:203], a[144:147], v[152:155], v[200:203]
    buffer_load_dwordx4 a[196:199], v41, s[80:83], s27 offen offset:0 sc1
    v_mfma_f32_16x16x32_bf16 v[200:203], a[152:155], v[156:159], v[200:203]
    v_cvt_pk_bf16_f32 v238, v220, v221
    v_cvt_pk_bf16_f32 v239, v222, v223
    v_mfma_f32_16x16x32_bf16 v[196:199], a[132:135], v[128:131], 0
    v_exp_f32 v192, v192
    v_mfma_f32_16x16x32_bf16 v[196:199], a[140:143], v[132:135], v[196:199]
    v_exp_f32 v193, v193
    v_mfma_f32_16x16x32_bf16 v[196:199], a[148:151], v[136:139], v[196:199]
    v_exp_f32 v194, v194
    v_mfma_f32_16x16x32_bf16 v[196:199], a[156:159], v[140:143], v[196:199]
    v_exp_f32 v195, v195
    v_mfma_f32_16x16x32_bf16 v[204:207], a[132:135], v[144:147], 0
    buffer_load_dwordx4 a[200:203], v40, s[80:83], s27 offen offset:1024 sc1
    v_mfma_f32_16x16x32_bf16 v[204:207], a[140:143], v[148:151], v[204:207]
    v_exp_f32 v200, v200
    v_mfma_f32_16x16x32_bf16 v[204:207], a[148:151], v[152:155], v[204:207]
    v_cvt_pk_bf16_f32 v240, v192, v193
    v_cvt_pk_bf16_f32 v241, v194, v195
    v_mfma_f32_16x16x32_bf16 v[204:207], a[156:159], v[156:159], v[204:207]
    s_waitcnt lgkmcnt(0)
    v_exp_f32 v201, v201
    v_mfma_f32_16x16x32_bf16 a[0:3], a[160:163], v[224:227], a[0:3]
    v_lshlrev_b32 v59, 10, v0
    v_mov_b32 v54, 0x80000000
    v_cndmask_b32 v59, v54, v59, vcc
    v_exp_f32 v202, v202
    v_mfma_f32_16x16x32_bf16 a[32:35], a[160:163], v[228:231], a[32:35]
    ds_read_b64_tr_b16 v[64:65], v48 offset:8192
    ds_read_b64_tr_b16 v[66:67], v48 offset:9216
    v_mfma_f32_16x16x32_bf16 a[4:7], a[164:167], v[224:227], a[4:7]
    buffer_load_dwordx4 a[204:207], v41, s[80:83], s27 offen offset:1024 sc1
    v_mfma_f32_16x16x32_bf16 a[36:39], a[164:167], v[228:231], a[36:39]
    ds_read_b64_tr_b16 v[68:69], v49 offset:8192
    ds_read_b64_tr_b16 v[70:71], v49 offset:9216
    v_mfma_f32_16x16x32_bf16 a[8:11], a[168:171], v[224:227], a[8:11]
    v_exp_f32 v203, v203
    v_mfma_f32_16x16x32_bf16 a[40:43], a[168:171], v[228:231], a[40:43]
    ds_read_b64_tr_b16 v[72:73], v48 offset:10240
    ds_read_b64_tr_b16 v[74:75], v48 offset:11264
    v_mfma_f32_16x16x32_bf16 a[12:15], a[172:175], v[224:227], a[12:15]
    v_exp_f32 v196, v196
    v_mfma_f32_16x16x32_bf16 a[44:47], a[172:175], v[228:231], a[44:47]
    ds_read_b64_tr_b16 v[76:77], v49 offset:10240
    ds_read_b64_tr_b16 v[78:79], v49 offset:11264
    v_mfma_f32_16x16x32_bf16 a[16:19], a[176:179], v[224:227], a[16:19]
    buffer_load_dwordx4 a[208:211], v40, s[80:83], s27 offen offset:2048 sc1
    v_mfma_f32_16x16x32_bf16 a[48:51], a[176:179], v[228:231], a[48:51]
    ds_read_b64_tr_b16 v[80:81], v48 offset:12288
    ds_read_b64_tr_b16 v[82:83], v48 offset:13312
    v_mfma_f32_16x16x32_bf16 a[20:23], a[180:183], v[224:227], a[20:23]
    v_cvt_pk_bf16_f32 v244, v200, v201
    v_cvt_pk_bf16_f32 v245, v202, v203
    v_mfma_f32_16x16x32_bf16 a[52:55], a[180:183], v[228:231], a[52:55]
    ds_read_b64_tr_b16 v[84:85], v49 offset:12288
    ds_read_b64_tr_b16 v[86:87], v49 offset:13312
    v_mfma_f32_16x16x32_bf16 a[24:27], a[184:187], v[224:227], a[24:27]
    v_exp_f32 v197, v197
    v_mfma_f32_16x16x32_bf16 a[56:59], a[184:187], v[228:231], a[56:59]
    ds_read_b64_tr_b16 v[88:89], v48 offset:14336
    ds_read_b64_tr_b16 v[90:91], v48 offset:15360
    v_mfma_f32_16x16x32_bf16 a[28:31], a[188:191], v[224:227], a[28:31]
    ds_read_b64_tr_b16 v[92:93], v49 offset:14336
    ds_read_b64_tr_b16 v[94:95], v49 offset:15360
    v_mfma_f32_16x16x32_bf16 a[60:63], a[188:191], v[228:231], a[60:63]
    v_exp_f32 v198, v198
    v_mfma_f32_16x16x32_bf16 v[96:99], v[50:53], v[224:227], v[96:99]
    s_add_u32 s21, s21, 0x2000
    v_exp_f32 v199, v199
    v_mfma_f32_16x16x32_bf16 v[100:103], v[50:53], v[228:231], v[100:103]
    s_barrier
    s_and_b32 s21, s21, 0x1ffff
    v_mfma_f32_16x16x32_bf16 v[208:211], a[128:131], v[160:163], 0
    s_add_u32 m0, s19, 24576
    v_exp_f32 v204, v204
    v_mfma_f32_16x16x32_bf16 v[208:211], a[136:139], v[164:167], v[208:211]
    buffer_load_dwordx4 v17, s[36:39], s21 offen offset:0 lds
    v_mfma_f32_16x16x32_bf16 v[208:211], a[144:147], v[168:171], v[208:211]
    v_cvt_pk_bf16_f32 v242, v196, v197
    v_cvt_pk_bf16_f32 v243, v198, v199
    v_mfma_f32_16x16x32_bf16 v[208:211], a[152:155], v[172:175], v[208:211]
    v_exp_f32 v205, v205
    v_mfma_f32_16x16x32_bf16 v[216:219], a[128:131], v[176:179], 0
    ds_read_b64 a[128:129], v1 offset:0
    ds_read_b64 a[130:131], v2 offset:0
    v_mfma_f32_16x16x32_bf16 v[216:219], a[136:139], v[180:183], v[216:219]
    v_exp_f32 v206, v206
    v_mfma_f32_16x16x32_bf16 v[216:219], a[144:147], v[184:187], v[216:219]
    ds_read_b64 a[136:137], v3 offset:0
    ds_read_b64 a[138:139], v4 offset:0
    v_mfma_f32_16x16x32_bf16 v[216:219], a[152:155], v[188:191], v[216:219]
    buffer_load_dwordx4 v18, s[36:39], s21 offen offset:1024 lds
    v_mfma_f32_16x16x32_bf16 v[212:215], a[132:135], v[160:163], 0
    ds_read_b64 a[144:145], v5 offset:0
    ds_read_b64 a[146:147], v6 offset:0
    v_mfma_f32_16x16x32_bf16 v[212:215], a[140:143], v[164:167], v[212:215]
    v_exp_f32 v207, v207
    v_mfma_f32_16x16x32_bf16 v[212:215], a[148:151], v[168:171], v[212:215]
    s_add_u32 s22, s22, 0x2000
    ds_read_b64 a[152:153], v7 offset:0
    ds_read_b64 a[154:155], v8 offset:0
    v_mfma_f32_16x16x32_bf16 v[212:215], a[156:159], v[172:175], v[212:215]
    s_and_b32 s22, s22, 0x1ffff
    v_cvt_pk_bf16_f32 v246, v204, v205
    v_cvt_pk_bf16_f32 v247, v206, v207
    v_mfma_f32_16x16x32_bf16 v[220:223], a[132:135], v[176:179], 0
    s_add_u32 m0, s20, 0
    ds_read_b64 a[132:133], v1 offset:4096
    ds_read_b64 a[134:135], v2 offset:4096
    v_mfma_f32_16x16x32_bf16 v[220:223], a[140:143], v[180:183], v[220:223]
    buffer_load_dwordx4 v19, s[40:43], s22 offen offset:0 lds
    v_mfma_f32_16x16x32_bf16 v[220:223], a[148:151], v[184:187], v[220:223]
    ds_read_b64 a[140:141], v3 offset:4096
    ds_read_b64 a[142:143], v4 offset:4096
    v_mfma_f32_16x16x32_bf16 v[220:223], a[156:159], v[188:191], v[220:223]
    v_exp_f32 v208, v208
    v_mfma_f32_16x16x32_bf16 a[64:67], a[160:163], v[232:235], a[64:67]
    ds_read_b64 a[148:149], v5 offset:4096
    ds_read_b64 a[150:151], v6 offset:4096
    v_mfma_f32_16x16x32_bf16 a[96:99], a[160:163], v[236:239], a[96:99]
    v_exp_f32 v209, v209
    v_mfma_f32_16x16x32_bf16 a[68:71], a[164:167], v[232:235], a[68:71]
    ds_read_b64 a[156:157], v7 offset:4096
    ds_read_b64 a[158:159], v8 offset:4096
    v_mfma_f32_16x16x32_bf16 a[100:103], a[164:167], v[236:239], a[100:103]
    ds_read_b64_tr_b16 a[160:161], v9 offset:8192
    ds_read_b64_tr_b16 a[162:163], v9 offset:12288
    v_mfma_f32_16x16x32_bf16 a[72:75], a[168:171], v[232:235], a[72:75]
    buffer_load_dwordx4 v20, s[40:43], s22 offen offset:1024 lds
    v_mfma_f32_16x16x32_bf16 a[104:107], a[168:171], v[236:239], a[104:107]
    ds_read_b64_tr_b16 a[164:165], v10 offset:8192
    ds_read_b64_tr_b16 a[166:167], v10 offset:12288
    v_mfma_f32_16x16x32_bf16 a[76:79], a[172:175], v[232:235], a[76:79]
    v_exp_f32 v210, v210
    v_mfma_f32_16x16x32_bf16 a[108:111], a[172:175], v[236:239], a[108:111]
    ds_read_b64_tr_b16 a[168:169], v11 offset:8192
    ds_read_b64_tr_b16 a[170:171], v11 offset:12288
    v_mfma_f32_16x16x32_bf16 a[80:83], a[176:179], v[232:235], a[80:83]
    buffer_load_dwordx4 a[212:215], v41, s[80:83], s27 offen offset:2048 sc1
    v_mfma_f32_16x16x32_bf16 a[112:115], a[176:179], v[236:239], a[112:115]
    ds_read_b64_tr_b16 a[172:173], v12 offset:8192
    ds_read_b64_tr_b16 a[174:175], v12 offset:12288
    v_mfma_f32_16x16x32_bf16 a[84:87], a[180:183], v[232:235], a[84:87]
    s_waitcnt lgkmcnt(15)
    v_exp_f32 v211, v211
    v_mfma_f32_16x16x32_bf16 a[116:119], a[180:183], v[236:239], a[116:119]
    ds_read_b64_tr_b16 a[176:177], v13 offset:8192
    ds_read_b64_tr_b16 a[178:179], v13 offset:12288
    v_mfma_f32_16x16x32_bf16 a[88:91], a[184:187], v[232:235], a[88:91]
    v_exp_f32 v216, v216
    v_mfma_f32_16x16x32_bf16 a[120:123], a[184:187], v[236:239], a[120:123]
    ds_read_b64_tr_b16 a[180:181], v14 offset:8192
    ds_read_b64_tr_b16 a[182:183], v14 offset:12288
    v_mfma_f32_16x16x32_bf16 a[92:95], a[188:191], v[232:235], a[92:95]
    s_waitcnt vmcnt(10)
    buffer_load_dwordx4 a[216:219], v40, s[80:83], s27 offen offset:3072 sc1
    v_mfma_f32_16x16x32_bf16 a[124:127], a[188:191], v[236:239], a[124:127]
    ds_read_b64_tr_b16 a[184:185], v15 offset:8192
    ds_read_b64_tr_b16 a[186:187], v15 offset:12288
    v_mfma_f32_16x16x32_bf16 v[104:107], v[50:53], v[232:235], v[104:107]
    v_cvt_pk_bf16_f32 v248, v208, v209
    v_cvt_pk_bf16_f32 v249, v210, v211
    v_mfma_f32_16x16x32_bf16 v[108:111], v[50:53], v[236:239], v[108:111]
    ds_read_b64_tr_b16 a[188:189], v16 offset:8192
    ds_read_b64_tr_b16 a[190:191], v16 offset:12288
    v_mfma_f32_16x16x32_bf16 v[112:115], v[64:67], a[224:227], v[112:115]
    v_exp_f32 v217, v217
    v_mfma_f32_16x16x32_bf16 v[112:115], v[72:75], a[232:235], v[112:115]
    v_exp_f32 v218, v218
    v_mfma_f32_16x16x32_bf16 v[112:115], v[80:83], a[240:243], v[112:115]
    buffer_load_dwordx4 a[220:223], v41, s[80:83], s27 offen offset:3072 sc1
    v_mfma_f32_16x16x32_bf16 v[112:115], v[88:91], a[248:251], v[112:115]
    v_exp_f32 v219, v219
    v_mfma_f32_16x16x32_bf16 v[120:123], v[64:67], a[228:231], v[120:123]
    v_exp_f32 v212, v212
    v_mfma_f32_16x16x32_bf16 v[120:123], v[72:75], a[236:239], v[120:123]
    v_cvt_pk_bf16_f32 v252, v216, v217
    v_cvt_pk_bf16_f32 v253, v218, v219
    v_mfma_f32_16x16x32_bf16 v[120:123], v[80:83], a[244:247], v[120:123]
    v_exp_f32 v213, v213
    v_mfma_f32_16x16x32_bf16 v[120:123], v[88:91], a[252:255], v[120:123]
    v_exp_f32 v214, v214
    v_mfma_f32_16x16x32_bf16 v[116:119], v[68:71], a[224:227], v[116:119]
    v_exp_f32 v215, v215
    v_mfma_f32_16x16x32_bf16 v[116:119], v[76:79], a[232:235], v[116:119]
    v_exp_f32 v220, v220
    v_mfma_f32_16x16x32_bf16 v[116:119], v[84:87], a[240:243], v[116:119]
    v_cvt_pk_bf16_f32 v250, v212, v213
    v_cvt_pk_bf16_f32 v251, v214, v215
    v_mfma_f32_16x16x32_bf16 v[116:119], v[92:95], a[248:251], v[116:119]
    v_exp_f32 v221, v221
    v_mfma_f32_16x16x32_bf16 v[124:127], v[68:71], a[228:231], v[124:127]
    v_exp_f32 v222, v222
    v_mfma_f32_16x16x32_bf16 v[124:127], v[76:79], a[236:239], v[124:127]
    v_exp_f32 v223, v223
    v_mfma_f32_16x16x32_bf16 v[124:127], v[84:87], a[244:247], v[124:127]
    v_cvt_pk_bf16_f32 v254, v220, v221
    v_cvt_pk_bf16_f32 v255, v222, v223
    v_mfma_f32_16x16x32_bf16 v[124:127], v[92:95], a[252:255], v[124:127]
    s_waitcnt lgkmcnt(15)
    s_movk_i32 s27, 12288
    v_cmp_gt_u32 vcc, 32, v0
    v_mfma_f32_16x16x32_bf16 v[192:195], a[128:131], v[128:131], 0
    buffer_load_dwordx4 a[224:227], v42, s[80:83], s27 offen offset:0 sc1
    v_mfma_f32_16x16x32_bf16 v[192:195], a[136:139], v[132:135], v[192:195]
    v_lshlrev_b32 v55, 3, v0
    v_mov_b32 v56, 0x80000000
    v_mfma_f32_16x16x32_bf16 v[192:195], a[144:147], v[136:139], v[192:195]
    v_cndmask_b32 v55, v56, v55, vcc
    v_lshrrev_b32 v44, 2, v0
    v_mfma_f32_16x16x32_bf16 v[192:195], a[152:155], v[140:143], v[192:195]
    v_mul_u32_u24 v44, 2752, v44
    v_bfe_u32 v45, v0, 4, 1
    v_mfma_f32_16x16x32_bf16 v[200:203], a[128:131], v[144:147], 0
    v_and_b32 v46, 3, v0
    v_lshlrev_b32 v45, 1, v45
    v_mfma_f32_16x16x32_bf16 v[200:203], a[136:139], v[148:151], v[200:203]
    v_exp_f32 v192, v192
    v_mfma_f32_16x16x32_bf16 v[200:203], a[144:147], v[152:155], v[200:203]
    buffer_load_dwordx4 a[228:231], v43, s[80:83], s27 offen offset:0 sc1
    v_mfma_f32_16x16x32_bf16 v[200:203], a[152:155], v[156:159], v[200:203]
    v_exp_f32 v193, v193
    v_mfma_f32_16x16x32_bf16 v[196:199], a[132:135], v[128:131], 0
    v_exp_f32 v194, v194
    v_mfma_f32_16x16x32_bf16 v[196:199], a[140:143], v[132:135], v[196:199]
    v_exp_f32 v195, v195
    v_mfma_f32_16x16x32_bf16 v[196:199], a[148:151], v[136:139], v[196:199]
    v_exp_f32 v200, v200
    v_mfma_f32_16x16x32_bf16 v[196:199], a[156:159], v[140:143], v[196:199]
    v_cvt_pk_bf16_f32 v224, v192, v193
    v_cvt_pk_bf16_f32 v225, v194, v195
    v_mfma_f32_16x16x32_bf16 v[204:207], a[132:135], v[144:147], 0
    buffer_load_dwordx4 a[232:235], v42, s[80:83], s27 offen offset:1024 sc1
    v_mfma_f32_16x16x32_bf16 v[204:207], a[140:143], v[148:151], v[204:207]
    v_exp_f32 v201, v201
    v_mfma_f32_16x16x32_bf16 v[204:207], a[148:151], v[152:155], v[204:207]
    v_exp_f32 v202, v202
    v_mfma_f32_16x16x32_bf16 v[204:207], a[156:159], v[156:159], v[204:207]
    s_waitcnt lgkmcnt(0)
    v_exp_f32 v203, v203
    v_mfma_f32_16x16x32_bf16 a[0:3], a[160:163], v[240:243], a[0:3]
    v_exp_f32 v196, v196
    v_mfma_f32_16x16x32_bf16 a[32:35], a[160:163], v[244:247], a[32:35]
    ds_read_b64_tr_b16 v[64:65], v48 offset:16384
    ds_read_b64_tr_b16 v[66:67], v48 offset:17408
    v_mfma_f32_16x16x32_bf16 a[4:7], a[164:167], v[240:243], a[4:7]
    buffer_load_dword v40, v59, s[64:67], s1 offen offset:0
    v_mfma_f32_16x16x32_bf16 a[36:39], a[164:167], v[244:247], a[36:39]
    ds_read_b64_tr_b16 v[68:69], v49 offset:16384
    ds_read_b64_tr_b16 v[70:71], v49 offset:17408
    v_mfma_f32_16x16x32_bf16 a[8:11], a[168:171], v[240:243], a[8:11]
    buffer_load_dwordx4 a[236:239], v43, s[80:83], s27 offen offset:1024 sc1
    v_mfma_f32_16x16x32_bf16 a[40:43], a[168:171], v[244:247], a[40:43]
    ds_read_b64_tr_b16 v[72:73], v48 offset:18432
    ds_read_b64_tr_b16 v[74:75], v48 offset:19456
    v_mfma_f32_16x16x32_bf16 a[12:15], a[172:175], v[240:243], a[12:15]
    v_cvt_pk_bf16_f32 v228, v200, v201
    v_cvt_pk_bf16_f32 v229, v202, v203
    v_mfma_f32_16x16x32_bf16 a[44:47], a[172:175], v[244:247], a[44:47]
    ds_read_b64_tr_b16 v[76:77], v49 offset:18432
    ds_read_b64_tr_b16 v[78:79], v49 offset:19456
    v_mfma_f32_16x16x32_bf16 a[16:19], a[176:179], v[240:243], a[16:19]
    buffer_load_dword v41, v59, s[64:67], s1 offen offset:256
    v_mfma_f32_16x16x32_bf16 a[48:51], a[176:179], v[244:247], a[48:51]
    ds_read_b64_tr_b16 v[80:81], v48 offset:20480
    ds_read_b64_tr_b16 v[82:83], v48 offset:21504
    v_mfma_f32_16x16x32_bf16 a[20:23], a[180:183], v[240:243], a[20:23]
    buffer_load_dwordx4 a[240:243], v42, s[80:83], s27 offen offset:2048 sc1
    v_mfma_f32_16x16x32_bf16 a[52:55], a[180:183], v[244:247], a[52:55]
    ds_read_b64_tr_b16 v[84:85], v49 offset:20480
    ds_read_b64_tr_b16 v[86:87], v49 offset:21504
    v_mfma_f32_16x16x32_bf16 a[24:27], a[184:187], v[240:243], a[24:27]
    v_exp_f32 v197, v197
    v_mfma_f32_16x16x32_bf16 a[56:59], a[184:187], v[244:247], a[56:59]
    ds_read_b64_tr_b16 v[88:89], v48 offset:22528
    ds_read_b64_tr_b16 v[90:91], v48 offset:23552
    v_mfma_f32_16x16x32_bf16 a[28:31], a[188:191], v[240:243], a[28:31]
    ds_read_b64_tr_b16 v[92:93], v49 offset:22528
    ds_read_b64_tr_b16 v[94:95], v49 offset:23552
    v_mfma_f32_16x16x32_bf16 a[60:63], a[188:191], v[244:247], a[60:63]
    v_exp_f32 v198, v198
    v_mfma_f32_16x16x32_bf16 v[96:99], v[50:53], v[240:243], v[96:99]
    s_add_u32 s21, s21, 0x2000
    v_exp_f32 v199, v199
    v_mfma_f32_16x16x32_bf16 v[100:103], v[50:53], v[244:247], v[100:103]
    s_barrier
    s_and_b32 s21, s21, 0x1ffff
    v_mfma_f32_16x16x32_bf16 v[208:211], a[128:131], v[160:163], 0
    s_add_u32 m0, s19, 0
    v_exp_f32 v204, v204
    v_mfma_f32_16x16x32_bf16 v[208:211], a[136:139], v[164:167], v[208:211]
    buffer_load_dwordx4 v17, s[36:39], s21 offen offset:0 lds
    v_mfma_f32_16x16x32_bf16 v[208:211], a[144:147], v[168:171], v[208:211]
    v_cvt_pk_bf16_f32 v226, v196, v197
    v_cvt_pk_bf16_f32 v227, v198, v199
    v_mfma_f32_16x16x32_bf16 v[208:211], a[152:155], v[172:175], v[208:211]
    v_exp_f32 v205, v205
    v_mfma_f32_16x16x32_bf16 v[216:219], a[128:131], v[176:179], 0
    ds_read_b64 a[128:129], v1 offset:8192
    ds_read_b64 a[130:131], v2 offset:8192
    v_mfma_f32_16x16x32_bf16 v[216:219], a[136:139], v[180:183], v[216:219]
    v_exp_f32 v206, v206
    v_mfma_f32_16x16x32_bf16 v[216:219], a[144:147], v[184:187], v[216:219]
    ds_read_b64 a[136:137], v3 offset:8192
    ds_read_b64 a[138:139], v4 offset:8192
    v_mfma_f32_16x16x32_bf16 v[216:219], a[152:155], v[188:191], v[216:219]
    buffer_load_dwordx4 v18, s[36:39], s21 offen offset:1024 lds
    v_mfma_f32_16x16x32_bf16 v[212:215], a[132:135], v[160:163], 0
    ds_read_b64 a[144:145], v5 offset:8192
    ds_read_b64 a[146:147], v6 offset:8192
    v_mfma_f32_16x16x32_bf16 v[212:215], a[140:143], v[164:167], v[212:215]
    v_exp_f32 v207, v207
    v_mfma_f32_16x16x32_bf16 v[212:215], a[148:151], v[168:171], v[212:215]
    s_add_u32 s22, s22, 0x2000
    ds_read_b64 a[152:153], v7 offset:8192
    ds_read_b64 a[154:155], v8 offset:8192
    v_mfma_f32_16x16x32_bf16 v[212:215], a[156:159], v[172:175], v[212:215]
    s_and_b32 s22, s22, 0x1ffff
    v_cvt_pk_bf16_f32 v230, v204, v205
    v_cvt_pk_bf16_f32 v231, v206, v207
    v_mfma_f32_16x16x32_bf16 v[220:223], a[132:135], v[176:179], 0
    s_add_u32 m0, s20, 8192
    ds_read_b64 a[132:133], v1 offset:12288
    ds_read_b64 a[134:135], v2 offset:12288
    v_xor_b32 v45, v45, v46
    v_lshl_add_u32 v44, v45, 4, v44
    v_add_u32 v44, s30, v44
    v_add_u32 v45, 43008, v44
    v_add_u32 v46, 86016, v44
    v_add_u32 v47, 129024, v44
    v_mfma_f32_16x16x32_bf16 v[220:223], a[140:143], v[180:183], v[220:223]
    buffer_load_dwordx4 v19, s[40:43], s22 offen offset:0 lds
    v_mfma_f32_16x16x32_bf16 v[220:223], a[148:151], v[184:187], v[220:223]
    ds_read_b64 a[140:141], v3 offset:12288
    ds_read_b64 a[142:143], v4 offset:12288
    v_mfma_f32_16x16x32_bf16 v[220:223], a[156:159], v[188:191], v[220:223]
    v_exp_f32 v208, v208
    v_mfma_f32_16x16x32_bf16 a[64:67], a[160:163], v[248:251], a[64:67]
    ds_read_b64 a[148:149], v5 offset:12288
    ds_read_b64 a[150:151], v6 offset:12288
    v_mfma_f32_16x16x32_bf16 a[96:99], a[160:163], v[252:255], a[96:99]
    v_exp_f32 v209, v209
    v_mfma_f32_16x16x32_bf16 a[68:71], a[164:167], v[248:251], a[68:71]
    ds_read_b64 a[156:157], v7 offset:12288
    ds_read_b64 a[158:159], v8 offset:12288
    v_mfma_f32_16x16x32_bf16 a[100:103], a[164:167], v[252:255], a[100:103]
    ds_read_b64_tr_b16 a[160:161], v9 offset:16384
    ds_read_b64_tr_b16 a[162:163], v9 offset:20480
    v_mfma_f32_16x16x32_bf16 a[72:75], a[168:171], v[248:251], a[72:75]
    buffer_load_dwordx4 v20, s[40:43], s22 offen offset:1024 lds
    v_mfma_f32_16x16x32_bf16 a[104:107], a[168:171], v[252:255], a[104:107]
    ds_read_b64_tr_b16 a[164:165], v10 offset:16384
    ds_read_b64_tr_b16 a[166:167], v10 offset:20480
    v_mfma_f32_16x16x32_bf16 a[76:79], a[172:175], v[248:251], a[76:79]
    v_exp_f32 v210, v210
    v_mfma_f32_16x16x32_bf16 a[108:111], a[172:175], v[252:255], a[108:111]
    ds_read_b64_tr_b16 a[168:169], v11 offset:16384
    ds_read_b64_tr_b16 a[170:171], v11 offset:20480
    v_mfma_f32_16x16x32_bf16 a[80:83], a[176:179], v[248:251], a[80:83]
    s_mov_b32 s90, 0
    buffer_load_dwordx4 a[244:247], v43, s[80:83], s27 offen offset:2048 sc1
    v_mfma_f32_16x16x32_bf16 a[112:115], a[176:179], v[252:255], a[112:115]
    s_add_u32 m0, s16, 0
    ds_read_b64_tr_b16 a[172:173], v12 offset:16384
    ds_read_b64_tr_b16 a[174:175], v12 offset:20480
    v_mfma_f32_16x16x32_bf16 a[84:87], a[180:183], v[248:251], a[84:87]
    s_waitcnt lgkmcnt(15)
    buffer_load_dwordx4 v44, s[60:63], s90 offen offset:0 lds
    v_mfma_f32_16x16x32_bf16 a[116:119], a[180:183], v[252:255], a[116:119]
    ds_read_b64_tr_b16 a[176:177], v13 offset:16384
    ds_read_b64_tr_b16 a[178:179], v13 offset:20480
    v_mfma_f32_16x16x32_bf16 a[88:91], a[184:187], v[248:251], a[88:91]
    v_exp_f32 v211, v211
    v_mfma_f32_16x16x32_bf16 a[120:123], a[184:187], v[252:255], a[120:123]
    ds_read_b64_tr_b16 a[180:181], v14 offset:16384
    ds_read_b64_tr_b16 a[182:183], v14 offset:20480
    v_mfma_f32_16x16x32_bf16 a[92:95], a[188:191], v[248:251], a[92:95]
    s_waitcnt vmcnt(13)
    buffer_load_dwordx4 a[248:251], v42, s[80:83], s27 offen offset:3072 sc1
    v_mfma_f32_16x16x32_bf16 a[124:127], a[188:191], v[252:255], a[124:127]
    ds_read_b64_tr_b16 a[184:185], v15 offset:16384
    ds_read_b64_tr_b16 a[186:187], v15 offset:20480
    v_mfma_f32_16x16x32_bf16 v[104:107], v[50:53], v[248:251], v[104:107]
    v_exp_f32 v216, v216
    v_mfma_f32_16x16x32_bf16 v[108:111], v[50:53], v[252:255], v[108:111]
    ds_read_b64_tr_b16 a[188:189], v16 offset:16384
    ds_read_b64_tr_b16 a[190:191], v16 offset:20480
    v_mfma_f32_16x16x32_bf16 v[112:115], v[64:67], a[192:195], v[112:115]
    v_cvt_pk_bf16_f32 v232, v208, v209
    v_cvt_pk_bf16_f32 v233, v210, v211
    v_mfma_f32_16x16x32_bf16 v[112:115], v[72:75], a[200:203], v[112:115]
    v_exp_f32 v217, v217
    v_mfma_f32_16x16x32_bf16 v[112:115], v[80:83], a[208:211], v[112:115]
    buffer_load_dwordx4 a[252:255], v43, s[80:83], s27 offen offset:3072 sc1
    v_mfma_f32_16x16x32_bf16 v[112:115], v[88:91], a[216:219], v[112:115]
    v_exp_f32 v218, v218
    v_mfma_f32_16x16x32_bf16 v[120:123], v[64:67], a[196:199], v[120:123]
    v_exp_f32 v219, v219
    v_mfma_f32_16x16x32_bf16 v[120:123], v[72:75], a[204:207], v[120:123]
    v_exp_f32 v212, v212
    v_mfma_f32_16x16x32_bf16 v[120:123], v[80:83], a[212:215], v[120:123]
    v_cvt_pk_bf16_f32 v236, v216, v217
    v_cvt_pk_bf16_f32 v237, v218, v219
    v_mfma_f32_16x16x32_bf16 v[120:123], v[88:91], a[220:223], v[120:123]
    v_exp_f32 v213, v213
    v_mfma_f32_16x16x32_bf16 v[116:119], v[68:71], a[192:195], v[116:119]
    v_exp_f32 v214, v214
    v_mfma_f32_16x16x32_bf16 v[116:119], v[76:79], a[200:203], v[116:119]
    v_exp_f32 v215, v215
    v_mfma_f32_16x16x32_bf16 v[116:119], v[84:87], a[208:211], v[116:119]
    v_exp_f32 v220, v220
    v_mfma_f32_16x16x32_bf16 v[116:119], v[92:95], a[216:219], v[116:119]
    v_cvt_pk_bf16_f32 v234, v212, v213
    v_cvt_pk_bf16_f32 v235, v214, v215
    v_mfma_f32_16x16x32_bf16 v[124:127], v[68:71], a[196:199], v[124:127]
    v_exp_f32 v221, v221
    v_mfma_f32_16x16x32_bf16 v[124:127], v[76:79], a[204:207], v[124:127]
    v_exp_f32 v222, v222
    v_mfma_f32_16x16x32_bf16 v[124:127], v[84:87], a[212:215], v[124:127]
    v_exp_f32 v223, v223
    v_mfma_f32_16x16x32_bf16 v[124:127], v[92:95], a[220:223], v[124:127]
    s_add_u32 m0, s16, 0
    s_waitcnt lgkmcnt(15)
    v_cvt_pk_bf16_f32 v238, v220, v221
    v_mfma_f32_16x16x32_bf16 v[192:195], a[128:131], v[128:131], 0
    buffer_load_dwordx4 v45, s[60:63], s90 offen offset:1024 lds
    v_mfma_f32_16x16x32_bf16 v[192:195], a[136:139], v[132:135], v[192:195]
    v_cvt_pk_bf16_f32 v239, v222, v223
    v_mfma_f32_16x16x32_bf16 v[192:195], a[144:147], v[136:139], v[192:195]
    v_mfma_f32_16x16x32_bf16 v[192:195], a[152:155], v[140:143], v[192:195]
    v_mfma_f32_16x16x32_bf16 v[200:203], a[128:131], v[144:147], 0
    v_mfma_f32_16x16x32_bf16 v[200:203], a[136:139], v[148:151], v[200:203]
    v_exp_f32 v192, v192
    v_mfma_f32_16x16x32_bf16 v[200:203], a[144:147], v[152:155], v[200:203]
    buffer_load_dwordx4 v46, s[60:63], s90 offen offset:2048 lds
    v_mfma_f32_16x16x32_bf16 v[200:203], a[152:155], v[156:159], v[200:203]
    v_exp_f32 v193, v193
    v_mfma_f32_16x16x32_bf16 v[196:199], a[132:135], v[128:131], 0
    v_exp_f32 v194, v194
    v_mfma_f32_16x16x32_bf16 v[196:199], a[140:143], v[132:135], v[196:199]
    v_exp_f32 v195, v195
    v_mfma_f32_16x16x32_bf16 v[196:199], a[148:151], v[136:139], v[196:199]
    v_exp_f32 v200, v200
    v_mfma_f32_16x16x32_bf16 v[196:199], a[156:159], v[140:143], v[196:199]
    v_cvt_pk_bf16_f32 v240, v192, v193
    v_cvt_pk_bf16_f32 v241, v194, v195
    v_mfma_f32_16x16x32_bf16 v[204:207], a[132:135], v[144:147], 0
    buffer_load_dwordx4 v47, s[60:63], s90 offen offset:3072 lds
    v_mfma_f32_16x16x32_bf16 v[204:207], a[140:143], v[148:151], v[204:207]
    v_exp_f32 v201, v201
    v_mfma_f32_16x16x32_bf16 v[204:207], a[148:151], v[152:155], v[204:207]
    v_exp_f32 v202, v202
    v_mfma_f32_16x16x32_bf16 v[204:207], a[156:159], v[156:159], v[204:207]
    s_waitcnt lgkmcnt(0)
    v_exp_f32 v203, v203
    v_mfma_f32_16x16x32_bf16 a[0:3], a[160:163], v[224:227], a[0:3]
    v_exp_f32 v196, v196
    v_mfma_f32_16x16x32_bf16 a[32:35], a[160:163], v[228:231], a[32:35]
    ds_read_b64_tr_b16 v[64:65], v48 offset:24576
    ds_read_b64_tr_b16 v[66:67], v48 offset:25600
    v_mfma_f32_16x16x32_bf16 a[4:7], a[164:167], v[224:227], a[4:7]
    buffer_load_dword v42, v59, s[64:67], s1 offen offset:512
    v_mfma_f32_16x16x32_bf16 a[36:39], a[164:167], v[228:231], a[36:39]
    ds_read_b64_tr_b16 v[68:69], v49 offset:24576
    ds_read_b64_tr_b16 v[70:71], v49 offset:25600
    v_mfma_f32_16x16x32_bf16 a[8:11], a[168:171], v[224:227], a[8:11]
    v_cvt_pk_bf16_f32 v244, v200, v201
    v_cvt_pk_bf16_f32 v245, v202, v203
    v_mfma_f32_16x16x32_bf16 a[40:43], a[168:171], v[228:231], a[40:43]
    ds_read_b64_tr_b16 v[72:73], v48 offset:26624
    ds_read_b64_tr_b16 v[74:75], v48 offset:27648
    v_mfma_f32_16x16x32_bf16 a[12:15], a[172:175], v[224:227], a[12:15]
    v_exp_f32 v197, v197
    v_mfma_f32_16x16x32_bf16 a[44:47], a[172:175], v[228:231], a[44:47]
    ds_read_b64_tr_b16 v[76:77], v49 offset:26624
    ds_read_b64_tr_b16 v[78:79], v49 offset:27648
    v_mfma_f32_16x16x32_bf16 a[16:19], a[176:179], v[224:227], a[16:19]
    buffer_load_dword v43, v59, s[64:67], s1 offen offset:768
    v_mfma_f32_16x16x32_bf16 a[48:51], a[176:179], v[228:231], a[48:51]
    ds_read_b64_tr_b16 v[80:81], v48 offset:28672
    ds_read_b64_tr_b16 v[82:83], v48 offset:29696
    v_mfma_f32_16x16x32_bf16 a[20:23], a[180:183], v[224:227], a[20:23]
    v_exp_f32 v198, v198
    v_mfma_f32_16x16x32_bf16 a[52:55], a[180:183], v[228:231], a[52:55]
    ds_read_b64_tr_b16 v[84:85], v49 offset:28672
    ds_read_b64_tr_b16 v[86:87], v49 offset:29696
    v_mfma_f32_16x16x32_bf16 a[24:27], a[184:187], v[224:227], a[24:27]
    v_exp_f32 v199, v199
    v_mfma_f32_16x16x32_bf16 a[56:59], a[184:187], v[228:231], a[56:59]
    ds_read_b64_tr_b16 v[88:89], v48 offset:30720
    ds_read_b64_tr_b16 v[90:91], v48 offset:31744
    v_mfma_f32_16x16x32_bf16 a[28:31], a[188:191], v[224:227], a[28:31]
    ds_read_b64_tr_b16 v[92:93], v49 offset:30720
    ds_read_b64_tr_b16 v[94:95], v49 offset:31744
    v_mfma_f32_16x16x32_bf16 a[60:63], a[188:191], v[228:231], a[60:63]
    v_exp_f32 v204, v204
    v_mfma_f32_16x16x32_bf16 v[96:99], v[50:53], v[224:227], v[96:99]
    s_add_u32 s21, s21, 0x2000
    v_cvt_pk_bf16_f32 v242, v196, v197
    v_cvt_pk_bf16_f32 v243, v198, v199
    v_mfma_f32_16x16x32_bf16 v[100:103], v[50:53], v[228:231], v[100:103]
    s_barrier
    s_and_b32 s21, s21, 0x1ffff
    v_mfma_f32_16x16x32_bf16 v[208:211], a[128:131], v[160:163], 0
    s_add_u32 m0, s19, 8192
    v_exp_f32 v205, v205
    v_mfma_f32_16x16x32_bf16 v[208:211], a[136:139], v[164:167], v[208:211]
    buffer_load_dwordx4 v17, s[36:39], s21 offen offset:0 lds
    v_mfma_f32_16x16x32_bf16 v[208:211], a[144:147], v[168:171], v[208:211]
    v_exp_f32 v206, v206
    v_mfma_f32_16x16x32_bf16 v[208:211], a[152:155], v[172:175], v[208:211]
    v_exp_f32 v207, v207
    v_mfma_f32_16x16x32_bf16 v[216:219], a[128:131], v[176:179], 0
    ds_read_b64 a[128:129], v1 offset:16384
    ds_read_b64 a[130:131], v2 offset:16384
    v_mfma_f32_16x16x32_bf16 v[216:219], a[136:139], v[180:183], v[216:219]
    v_cvt_pk_bf16_f32 v246, v204, v205
    v_cvt_pk_bf16_f32 v247, v206, v207
    v_mfma_f32_16x16x32_bf16 v[216:219], a[144:147], v[184:187], v[216:219]
    ds_read_b64 a[136:137], v3 offset:16384
L_warm0_6:
    s_cbranch_execz L_warm0_7
    ds_read_b64 a[138:139], v4 offset:16384
    v_mfma_f32_16x16x32_bf16 v[216:219], a[152:155], v[188:191], v[216:219]
    buffer_load_dwordx4 v18, s[36:39], s21 offen offset:1024 lds
    v_mfma_f32_16x16x32_bf16 v[212:215], a[132:135], v[160:163], 0
    ds_read_b64 a[144:145], v5 offset:16384
    ds_read_b64 a[146:147], v6 offset:16384
    v_mfma_f32_16x16x32_bf16 v[212:215], a[140:143], v[164:167], v[212:215]
    v_exp_f32 v208, v208
    v_mfma_f32_16x16x32_bf16 v[212:215], a[148:151], v[168:171], v[212:215]
    s_add_u32 s22, s22, 0x2000
    ds_read_b64 a[152:153], v7 offset:16384
    ds_read_b64 a[154:155], v8 offset:16384
    v_mfma_f32_16x16x32_bf16 v[212:215], a[156:159], v[172:175], v[212:215]
    s_and_b32 s22, s22, 0x1ffff
    v_exp_f32 v209, v209
    v_mfma_f32_16x16x32_bf16 v[220:223], a[132:135], v[176:179], 0
    s_add_u32 m0, s20, 16384
    ds_read_b64 a[132:133], v1 offset:20480
    ds_read_b64 a[134:135], v2 offset:20480
    v_mfma_f32_16x16x32_bf16 v[220:223], a[140:143], v[180:183], v[220:223]
    buffer_load_dwordx4 v19, s[40:43], s22 offen offset:0 lds
    v_mfma_f32_16x16x32_bf16 v[220:223], a[148:151], v[184:187], v[220:223]
    ds_read_b64 a[140:141], v3 offset:20480
    ds_read_b64 a[142:143], v4 offset:20480
    v_mfma_f32_16x16x32_bf16 v[220:223], a[156:159], v[188:191], v[220:223]
    v_exp_f32 v210, v210
    v_mfma_f32_16x16x32_bf16 a[64:67], a[160:163], v[232:235], a[64:67]
    ds_read_b64 a[148:149], v5 offset:20480
    ds_read_b64 a[150:151], v6 offset:20480
    v_mfma_f32_16x16x32_bf16 a[96:99], a[160:163], v[236:239], a[96:99]
    v_exp_f32 v211, v211
    v_mfma_f32_16x16x32_bf16 a[68:71], a[164:167], v[232:235], a[68:71]
    ds_read_b64 a[156:157], v7 offset:20480
    ds_read_b64 a[158:159], v8 offset:20480
    v_mfma_f32_16x16x32_bf16 a[100:103], a[164:167], v[236:239], a[100:103]
    ds_read_b64_tr_b16 a[160:161], v9 offset:0
    ds_read_b64_tr_b16 a[162:163], v9 offset:4096
    v_mfma_f32_16x16x32_bf16 a[72:75], a[168:171], v[232:235], a[72:75]
    buffer_load_dwordx4 v20, s[40:43], s22 offen offset:1024 lds
    v_mfma_f32_16x16x32_bf16 a[104:107], a[168:171], v[236:239], a[104:107]
    ds_read_b64_tr_b16 a[164:165], v10 offset:0
    ds_read_b64_tr_b16 a[166:167], v10 offset:4096
    v_mfma_f32_16x16x32_bf16 a[76:79], a[172:175], v[232:235], a[76:79]
    v_exp_f32 v216, v216
    v_mfma_f32_16x16x32_bf16 a[108:111], a[172:175], v[236:239], a[108:111]
    ds_read_b64_tr_b16 a[168:169], v11 offset:0
    ds_read_b64_tr_b16 a[170:171], v11 offset:4096
    v_mfma_f32_16x16x32_bf16 a[80:83], a[176:179], v[232:235], a[80:83]
    s_mov_b32 s90, 176128
    v_cvt_pk_bf16_f32 v248, v208, v209
    v_cvt_pk_bf16_f32 v249, v210, v211
    v_mfma_f32_16x16x32_bf16 a[112:115], a[176:179], v[236:239], a[112:115]
    s_add_u32 m0, s16, 4096
    ds_read_b64_tr_b16 a[172:173], v12 offset:0
    ds_read_b64_tr_b16 a[174:175], v12 offset:4096
    v_mfma_f32_16x16x32_bf16 a[84:87], a[180:183], v[232:235], a[84:87]
    s_waitcnt lgkmcnt(15)
    buffer_load_dwordx4 v44, s[60:63], s90 offen offset:0 lds
    v_mfma_f32_16x16x32_bf16 a[116:119], a[180:183], v[236:239], a[116:119]
    ds_read_b64_tr_b16 a[176:177], v13 offset:0
    ds_read_b64_tr_b16 a[178:179], v13 offset:4096
    v_mfma_f32_16x16x32_bf16 a[88:91], a[184:187], v[232:235], a[88:91]
    v_exp_f32 v217, v217
    v_mfma_f32_16x16x32_bf16 a[120:123], a[184:187], v[236:239], a[120:123]
    ds_read_b64_tr_b16 a[180:181], v14 offset:0
    ds_read_b64_tr_b16 a[182:183], v14 offset:4096
    v_mfma_f32_16x16x32_bf16 a[92:95], a[188:191], v[232:235], a[92:95]
    s_waitcnt vmcnt(10)
    v_exp_f32 v218, v218
    v_mfma_f32_16x16x32_bf16 a[124:127], a[188:191], v[236:239], a[124:127]
    ds_read_b64_tr_b16 a[184:185], v15 offset:0
    ds_read_b64_tr_b16 a[186:187], v15 offset:4096
    v_mfma_f32_16x16x32_bf16 v[104:107], v[50:53], v[232:235], v[104:107]
    v_exp_f32 v219, v219
    v_mfma_f32_16x16x32_bf16 v[108:111], v[50:53], v[236:239], v[108:111]
    ds_read_b64_tr_b16 a[188:189], v16 offset:0
    ds_read_b64_tr_b16 a[190:191], v16 offset:4096
    v_mfma_f32_16x16x32_bf16 v[112:115], v[64:67], a[224:227], v[112:115]
    v_exp_f32 v212, v212
    v_mfma_f32_16x16x32_bf16 v[112:115], v[72:75], a[232:235], v[112:115]
    v_cvt_pk_bf16_f32 v252, v216, v217
    v_cvt_pk_bf16_f32 v253, v218, v219
    v_mfma_f32_16x16x32_bf16 v[112:115], v[80:83], a[240:243], v[112:115]
    v_exp_f32 v213, v213
    v_mfma_f32_16x16x32_bf16 v[112:115], v[88:91], a[248:251], v[112:115]
    v_exp_f32 v214, v214
    v_mfma_f32_16x16x32_bf16 v[120:123], v[64:67], a[228:231], v[120:123]
    v_exp_f32 v215, v215
    v_mfma_f32_16x16x32_bf16 v[120:123], v[72:75], a[236:239], v[120:123]
    v_exp_f32 v220, v220
    v_mfma_f32_16x16x32_bf16 v[120:123], v[80:83], a[244:247], v[120:123]
    v_cvt_pk_bf16_f32 v250, v212, v213
    v_cvt_pk_bf16_f32 v251, v214, v215
    v_mfma_f32_16x16x32_bf16 v[120:123], v[88:91], a[252:255], v[120:123]
    v_exp_f32 v221, v221
    v_mfma_f32_16x16x32_bf16 v[116:119], v[68:71], a[224:227], v[116:119]
    v_exp_f32 v222, v222
    v_mfma_f32_16x16x32_bf16 v[116:119], v[76:79], a[232:235], v[116:119]
    v_exp_f32 v223, v223
    v_mfma_f32_16x16x32_bf16 v[116:119], v[84:87], a[240:243], v[116:119]
    v_cvt_pk_bf16_f32 v254, v220, v221
    v_cvt_pk_bf16_f32 v255, v222, v223
    v_mfma_f32_16x16x32_bf16 v[116:119], v[92:95], a[248:251], v[116:119]
    v_mfma_f32_16x16x32_bf16 v[124:127], v[68:71], a[228:231], v[124:127]
    v_mfma_f32_16x16x32_bf16 v[124:127], v[76:79], a[236:239], v[124:127]
    v_mfma_f32_16x16x32_bf16 v[124:127], v[84:87], a[244:247], v[124:127]
    v_add_f32 v28, v112, v113
    v_mul_f32 v29, v112, v112
    v_mfma_f32_16x16x32_bf16 v[124:127], v[92:95], a[252:255], v[124:127]
    s_add_u32 m0, s16, 4096
    s_waitcnt lgkmcnt(15)
    v_fmac_f32 v29, v113, v113
    v_mfma_f32_16x16x32_bf16 v[192:195], a[128:131], v[128:131], 0
    buffer_load_dwordx4 v45, s[60:63], s90 offen offset:1024 lds
    v_mfma_f32_16x16x32_bf16 v[192:195], a[136:139], v[132:135], v[192:195]
    v_add_f32 v28, v28, v114
    v_fmac_f32 v29, v114, v114
    v_mfma_f32_16x16x32_bf16 v[192:195], a[144:147], v[136:139], v[192:195]
    v_add_f32 v28, v28, v115
    v_fmac_f32 v29, v115, v115
    v_mfma_f32_16x16x32_bf16 v[192:195], a[152:155], v[140:143], v[192:195]
    v_add_f32 v28, v28, v116
    v_fmac_f32 v29, v116, v116
    v_mfma_f32_16x16x32_bf16 v[200:203], a[128:131], v[144:147], 0
    v_add_f32 v28, v28, v117
    v_fmac_f32 v29, v117, v117
    v_mfma_f32_16x16x32_bf16 v[200:203], a[136:139], v[148:151], v[200:203]
    v_exp_f32 v192, v192
    v_mfma_f32_16x16x32_bf16 v[200:203], a[144:147], v[152:155], v[200:203]
    buffer_load_dwordx4 v46, s[60:63], s90 offen offset:2048 lds
    v_mfma_f32_16x16x32_bf16 v[200:203], a[152:155], v[156:159], v[200:203]
    v_exp_f32 v193, v193
    v_mfma_f32_16x16x32_bf16 v[196:199], a[132:135], v[128:131], 0
    v_exp_f32 v194, v194
    v_mfma_f32_16x16x32_bf16 v[196:199], a[140:143], v[132:135], v[196:199]
    v_exp_f32 v195, v195
    v_mfma_f32_16x16x32_bf16 v[196:199], a[148:151], v[136:139], v[196:199]
    v_exp_f32 v200, v200
    v_mfma_f32_16x16x32_bf16 v[196:199], a[156:159], v[140:143], v[196:199]
    v_cvt_pk_bf16_f32 v224, v192, v193
    v_cvt_pk_bf16_f32 v225, v194, v195
    v_mfma_f32_16x16x32_bf16 v[204:207], a[132:135], v[144:147], 0
    buffer_load_dwordx4 v47, s[60:63], s90 offen offset:3072 lds
    v_mfma_f32_16x16x32_bf16 v[204:207], a[140:143], v[148:151], v[204:207]
    v_exp_f32 v201, v201
    v_mfma_f32_16x16x32_bf16 v[204:207], a[148:151], v[152:155], v[204:207]
    v_exp_f32 v202, v202
    v_mfma_f32_16x16x32_bf16 v[204:207], a[156:159], v[156:159], v[204:207]
    s_waitcnt lgkmcnt(0)
    v_exp_f32 v203, v203
    v_mfma_f32_16x16x32_bf16 a[0:3], a[160:163], v[240:243], a[0:3]
    v_exp_f32 v196, v196
    v_mfma_f32_16x16x32_bf16 a[32:35], a[160:163], v[244:247], a[32:35]
    v_cvt_pk_bf16_f32 v228, v200, v201
    v_cvt_pk_bf16_f32 v229, v202, v203
    v_mfma_f32_16x16x32_bf16 a[4:7], a[164:167], v[240:243], a[4:7]
    buffer_load_dword v36, v27, s[48:51], s0 offen offset:0
    v_mfma_f32_16x16x32_bf16 a[36:39], a[164:167], v[244:247], a[36:39]
    v_exp_f32 v197, v197
    v_mfma_f32_16x16x32_bf16 a[8:11], a[168:171], v[240:243], a[8:11]
    v_exp_f32 v198, v198
    v_mfma_f32_16x16x32_bf16 a[40:43], a[168:171], v[244:247], a[40:43]
    v_exp_f32 v199, v199
    v_mfma_f32_16x16x32_bf16 a[12:15], a[172:175], v[240:243], a[12:15]
    v_exp_f32 v204, v204
    v_mfma_f32_16x16x32_bf16 a[44:47], a[172:175], v[244:247], a[44:47]
    v_cvt_pk_bf16_f32 v226, v196, v197
    v_cvt_pk_bf16_f32 v227, v198, v199
    v_mfma_f32_16x16x32_bf16 a[16:19], a[176:179], v[240:243], a[16:19]
    v_exp_f32 v205, v205
    v_mfma_f32_16x16x32_bf16 a[48:51], a[176:179], v[244:247], a[48:51]
    v_exp_f32 v206, v206
    v_mfma_f32_16x16x32_bf16 a[20:23], a[180:183], v[240:243], a[20:23]
    v_exp_f32 v207, v207
    v_mfma_f32_16x16x32_bf16 a[52:55], a[180:183], v[244:247], a[52:55]
    v_cvt_pk_bf16_f32 v230, v204, v205
    v_cvt_pk_bf16_f32 v231, v206, v207
    v_mfma_f32_16x16x32_bf16 a[24:27], a[184:187], v[240:243], a[24:27]
    v_add_f32 v28, v28, v118
    v_fmac_f32 v29, v118, v118
    v_mfma_f32_16x16x32_bf16 a[56:59], a[184:187], v[244:247], a[56:59]
    v_add_f32 v28, v28, v119
    v_fmac_f32 v29, v119, v119
    v_mfma_f32_16x16x32_bf16 a[28:31], a[188:191], v[240:243], a[28:31]
    v_add_f32 v30, v120, v121
    v_mul_f32 v31, v120, v120
    v_mfma_f32_16x16x32_bf16 a[60:63], a[188:191], v[244:247], a[60:63]
    v_fmac_f32 v31, v121, v121
    v_add_f32 v30, v30, v122
    v_mfma_f32_16x16x32_bf16 v[96:99], v[50:53], v[240:243], v[96:99]
    s_add_u32 s21, s21, 0x2000
    v_fmac_f32 v31, v122, v122
    v_add_f32 v30, v30, v123
    v_fmac_f32 v31, v123, v123
    v_add_f32 v30, v30, v124
    v_fmac_f32 v31, v124, v124
    v_add_f32 v30, v30, v125
    v_fmac_f32 v31, v125, v125
    v_add_f32 v30, v30, v126
    v_fmac_f32 v31, v126, v126
    v_add_f32 v30, v30, v127
    v_fmac_f32 v31, v127, v127
    v_cvt_pk_bf16_f32 v112, v112, v113
    v_cvt_pk_bf16_f32 v113, v114, v115
    v_cvt_pk_bf16_f32 v114, v116, v117
    v_cvt_pk_bf16_f32 v115, v118, v119
    v_cvt_pk_bf16_f32 v116, v120, v121
    v_cvt_pk_bf16_f32 v117, v122, v123
    v_cvt_pk_bf16_f32 v118, v124, v125
    v_cvt_pk_bf16_f32 v119, v126, v127
    v_cmp_gt_u32 vcc, 16, v0
    v_mov_b32 v32, v28
    v_mov_b32 v33, v29
    v_mov_b32 v34, v30
    v_mov_b32 v35, v31
    v_permlane16_swap_b32 v28, v32
    v_permlane16_swap_b32 v29, v33
    v_permlane16_swap_b32 v30, v34
    v_permlane16_swap_b32 v31, v35
    v_add_f32 v28, v28, v32
    v_add_f32 v29, v29, v33
    v_add_f32 v30, v30, v34
    v_add_f32 v31, v31, v35
    v_mov_b32 v32, v28
    v_mov_b32 v33, v29
    v_mov_b32 v34, v30
    v_mov_b32 v35, v31
    v_permlane32_swap_b32 v28, v32
    v_permlane32_swap_b32 v29, v33
    v_permlane32_swap_b32 v30, v34
    v_permlane32_swap_b32 v31, v35
    v_add_f32 v28, v28, v32
    v_add_f32 v29, v29, v33
    v_add_f32 v30, v30, v34
    v_add_f32 v31, v31, v35
    v_cndmask_b32 v28, v30, v28, vcc
    v_cndmask_b32 v29, v31, v29, vcc
    v_mfma_f32_16x16x32_bf16 v[100:103], v[50:53], v[244:247], v[100:103]
    buffer_store_dwordx4 v[112:115], v25, s[76:79], s95 offen sc1
    buffer_store_dwordx4 v[116:119], v25, s[76:79], s93 offen sc1
    buffer_store_dwordx2 v[28:29], v55, s[76:79], s94 offen sc1
    s_barrier
    s_and_b32 s21, s21, 0x1ffff
    v_mfma_f32_16x16x32_bf16 v[208:211], a[128:131], v[160:163], 0
    s_add_u32 m0, s19, 16384
    v_mfma_f32_16x16x32_bf16 v[208:211], a[136:139], v[164:167], v[208:211]
    buffer_load_dwordx4 v17, s[36:39], s21 offen offset:0 lds
    v_mfma_f32_16x16x32_bf16 v[208:211], a[144:147], v[168:171], v[208:211]
    v_mfma_f32_16x16x32_bf16 v[208:211], a[152:155], v[172:175], v[208:211]
    v_mfma_f32_16x16x32_bf16 v[216:219], a[128:131], v[176:179], 0
    ds_read_b64 a[128:129], v1 offset:24576
    ds_read_b64 a[130:131], v2 offset:24576
    v_mfma_f32_16x16x32_bf16 v[216:219], a[136:139], v[180:183], v[216:219]
    v_exp_f32 v208, v208
    v_mfma_f32_16x16x32_bf16 v[216:219], a[144:147], v[184:187], v[216:219]
    ds_read_b64 a[136:137], v3 offset:24576
    ds_read_b64 a[138:139], v4 offset:24576
    v_mfma_f32_16x16x32_bf16 v[216:219], a[152:155], v[188:191], v[216:219]
    buffer_load_dwordx4 v18, s[36:39], s21 offen offset:1024 lds
    v_mfma_f32_16x16x32_bf16 v[212:215], a[132:135], v[160:163], 0
    ds_read_b64 a[144:145], v5 offset:24576
    ds_read_b64 a[146:147], v6 offset:24576
    v_mfma_f32_16x16x32_bf16 v[212:215], a[140:143], v[164:167], v[212:215]
    v_exp_f32 v209, v209
    v_mfma_f32_16x16x32_bf16 v[212:215], a[148:151], v[168:171], v[212:215]
    s_add_u32 s22, s22, 0x2000
    ds_read_b64 a[152:153], v7 offset:24576
    ds_read_b64 a[154:155], v8 offset:24576
    v_mfma_f32_16x16x32_bf16 v[212:215], a[156:159], v[172:175], v[212:215]
    s_and_b32 s22, s22, 0x1ffff
    v_exp_f32 v210, v210
    v_mfma_f32_16x16x32_bf16 v[220:223], a[132:135], v[176:179], 0
    s_add_u32 m0, s20, 0
    ds_read_b64 a[132:133], v1 offset:28672
    ds_read_b64 a[134:135], v2 offset:28672
    v_mfma_f32_16x16x32_bf16 v[220:223], a[140:143], v[180:183], v[220:223]
    buffer_load_dwordx4 v19, s[40:43], s22 offen offset:0 lds
    v_mfma_f32_16x16x32_bf16 v[220:223], a[148:151], v[184:187], v[220:223]
    ds_read_b64 a[140:141], v3 offset:28672
    ds_read_b64 a[142:143], v4 offset:28672
    v_mfma_f32_16x16x32_bf16 v[220:223], a[156:159], v[188:191], v[220:223]
    v_exp_f32 v211, v211
    v_mfma_f32_16x16x32_bf16 a[64:67], a[160:163], v[248:251], a[64:67]
    ds_read_b64 a[148:149], v5 offset:28672
    ds_read_b64 a[150:151], v6 offset:28672
    v_mfma_f32_16x16x32_bf16 a[96:99], a[160:163], v[252:255], a[96:99]
    v_exp_f32 v216, v216
    v_mfma_f32_16x16x32_bf16 a[68:71], a[164:167], v[248:251], a[68:71]
    ds_read_b64 a[156:157], v7 offset:28672
    ds_read_b64 a[158:159], v8 offset:28672
    v_mfma_f32_16x16x32_bf16 a[100:103], a[164:167], v[252:255], a[100:103]
    ds_read_b64_tr_b16 a[160:161], v9 offset:8192
    ds_read_b64_tr_b16 a[162:163], v9 offset:12288
    v_mfma_f32_16x16x32_bf16 a[72:75], a[168:171], v[248:251], a[72:75]
    buffer_load_dwordx4 v20, s[40:43], s22 offen offset:1024 lds
    v_mfma_f32_16x16x32_bf16 a[104:107], a[168:171], v[252:255], a[104:107]
    ds_read_b64_tr_b16 a[164:165], v10 offset:8192
    ds_read_b64_tr_b16 a[166:167], v10 offset:12288
    v_mfma_f32_16x16x32_bf16 a[76:79], a[172:175], v[248:251], a[76:79]
    v_cvt_pk_bf16_f32 v232, v208, v209
    v_cvt_pk_bf16_f32 v233, v210, v211
    v_mfma_f32_16x16x32_bf16 a[108:111], a[172:175], v[252:255], a[108:111]
    ds_read_b64_tr_b16 a[168:169], v11 offset:8192
    ds_read_b64_tr_b16 a[170:171], v11 offset:12288
    v_mfma_f32_16x16x32_bf16 a[80:83], a[176:179], v[248:251], a[80:83]
    s_mov_b32 s90, 64
    v_exp_f32 v217, v217
    v_mfma_f32_16x16x32_bf16 a[112:115], a[176:179], v[252:255], a[112:115]
    s_add_u32 m0, s16, 32768
    ds_read_b64_tr_b16 a[172:173], v12 offset:8192
    ds_read_b64_tr_b16 a[174:175], v12 offset:12288
    v_mfma_f32_16x16x32_bf16 a[84:87], a[180:183], v[248:251], a[84:87]
    buffer_load_dwordx4 v44, s[60:63], s90 offen offset:0 lds
    v_mfma_f32_16x16x32_bf16 a[116:119], a[180:183], v[252:255], a[116:119]
    ds_read_b64_tr_b16 a[176:177], v13 offset:8192
    ds_read_b64_tr_b16 a[178:179], v13 offset:12288
    v_mfma_f32_16x16x32_bf16 a[88:91], a[184:187], v[248:251], a[88:91]
    v_exp_f32 v218, v218
    v_mfma_f32_16x16x32_bf16 a[120:123], a[184:187], v[252:255], a[120:123]
    ds_read_b64_tr_b16 a[180:181], v14 offset:8192
    ds_read_b64_tr_b16 a[182:183], v14 offset:12288
    v_mfma_f32_16x16x32_bf16 a[92:95], a[188:191], v[248:251], a[92:95]
    v_exp_f32 v219, v219
    v_mfma_f32_16x16x32_bf16 a[124:127], a[188:191], v[252:255], a[124:127]
    ds_read_b64_tr_b16 a[184:185], v15 offset:8192
    ds_read_b64_tr_b16 a[186:187], v15 offset:12288
    v_mfma_f32_16x16x32_bf16 v[104:107], v[50:53], v[248:251], v[104:107]
    v_exp_f32 v212, v212
    v_mfma_f32_16x16x32_bf16 v[108:111], v[50:53], v[252:255], v[108:111]
    s_add_u32 m0, s16, 32768
    s_waitcnt lgkmcnt(14)
    ds_read_b64_tr_b16 a[188:189], v16 offset:8192
    ds_read_b64_tr_b16 a[190:191], v16 offset:12288
    v_mfma_f32_16x16x32_bf16 v[192:195], a[128:131], v[128:131], 0
    buffer_load_dwordx4 v45, s[60:63], s90 offen offset:1024 lds
    v_mfma_f32_16x16x32_bf16 v[192:195], a[136:139], v[132:135], v[192:195]
    v_cvt_pk_bf16_f32 v236, v216, v217
    v_cvt_pk_bf16_f32 v237, v218, v219
    v_mfma_f32_16x16x32_bf16 v[192:195], a[144:147], v[136:139], v[192:195]
    v_exp_f32 v213, v213
    v_mfma_f32_16x16x32_bf16 v[192:195], a[152:155], v[140:143], v[192:195]
    v_exp_f32 v214, v214
    v_mfma_f32_16x16x32_bf16 v[200:203], a[128:131], v[144:147], 0
    v_exp_f32 v215, v215
    v_mfma_f32_16x16x32_bf16 v[200:203], a[136:139], v[148:151], v[200:203]
    v_exp_f32 v220, v220
    v_mfma_f32_16x16x32_bf16 v[200:203], a[144:147], v[152:155], v[200:203]
    buffer_load_dwordx4 v46, s[60:63], s90 offen offset:2048 lds
    v_mfma_f32_16x16x32_bf16 v[200:203], a[152:155], v[156:159], v[200:203]
    v_cvt_pk_bf16_f32 v234, v212, v213
    v_cvt_pk_bf16_f32 v235, v214, v215
    v_mfma_f32_16x16x32_bf16 v[196:199], a[132:135], v[128:131], 0
    v_exp_f32 v221, v221
    v_mfma_f32_16x16x32_bf16 v[196:199], a[140:143], v[132:135], v[196:199]
    v_exp_f32 v222, v222
    v_mfma_f32_16x16x32_bf16 v[196:199], a[148:151], v[136:139], v[196:199]
    v_exp_f32 v223, v223
    v_mfma_f32_16x16x32_bf16 v[196:199], a[156:159], v[140:143], v[196:199]
    v_cvt_pk_bf16_f32 v238, v220, v221
    v_cvt_pk_bf16_f32 v239, v222, v223
    v_mfma_f32_16x16x32_bf16 v[204:207], a[132:135], v[144:147], 0
    buffer_load_dwordx4 v47, s[60:63], s90 offen offset:3072 lds
    v_mfma_f32_16x16x32_bf16 v[204:207], a[140:143], v[148:151], v[204:207]
    v_exp_f32 v192, v192
    v_mfma_f32_16x16x32_bf16 v[204:207], a[148:151], v[152:155], v[204:207]
    v_exp_f32 v193, v193
    v_mfma_f32_16x16x32_bf16 v[204:207], a[156:159], v[156:159], v[204:207]
    s_waitcnt lgkmcnt(0)
    v_exp_f32 v194, v194
    v_mfma_f32_16x16x32_bf16 a[0:3], a[160:163], v[224:227], a[0:3]
    v_exp_f32 v195, v195
    v_mfma_f32_16x16x32_bf16 a[32:35], a[160:163], v[228:231], a[32:35]
    v_exp_f32 v200, v200
    v_mfma_f32_16x16x32_bf16 a[4:7], a[164:167], v[224:227], a[4:7]
    buffer_load_dword v37, v27, s[48:51], s0 offen offset:2048
    v_mfma_f32_16x16x32_bf16 a[36:39], a[164:167], v[228:231], a[36:39]
    s_add_u32 s0, s0, 0x1000
    v_cvt_pk_bf16_f32 v240, v192, v193
    v_cvt_pk_bf16_f32 v241, v194, v195
    v_mfma_f32_16x16x32_bf16 a[8:11], a[168:171], v[224:227], a[8:11]
    v_exp_f32 v201, v201
    v_mfma_f32_16x16x32_bf16 a[40:43], a[168:171], v[228:231], a[40:43]
    v_exp_f32 v202, v202
    v_mfma_f32_16x16x32_bf16 a[12:15], a[172:175], v[224:227], a[12:15]
    v_exp_f32 v203, v203
    v_mfma_f32_16x16x32_bf16 a[44:47], a[172:175], v[228:231], a[44:47]
    v_exp_f32 v196, v196
    v_mfma_f32_16x16x32_bf16 a[16:19], a[176:179], v[224:227], a[16:19]
    v_cvt_pk_bf16_f32 v244, v200, v201
    v_cvt_pk_bf16_f32 v245, v202, v203
    v_mfma_f32_16x16x32_bf16 a[48:51], a[176:179], v[228:231], a[48:51]
    v_exp_f32 v197, v197
    v_mfma_f32_16x16x32_bf16 a[20:23], a[180:183], v[224:227], a[20:23]
    v_exp_f32 v198, v198
    v_mfma_f32_16x16x32_bf16 a[52:55], a[180:183], v[228:231], a[52:55]
    v_exp_f32 v199, v199
    v_mfma_f32_16x16x32_bf16 a[24:27], a[184:187], v[224:227], a[24:27]
    v_exp_f32 v204, v204
    v_mfma_f32_16x16x32_bf16 a[56:59], a[184:187], v[228:231], a[56:59]
    v_cvt_pk_bf16_f32 v242, v196, v197
    v_cvt_pk_bf16_f32 v243, v198, v199
    v_mfma_f32_16x16x32_bf16 a[28:31], a[188:191], v[224:227], a[28:31]
    v_exp_f32 v205, v205
    v_mfma_f32_16x16x32_bf16 a[60:63], a[188:191], v[228:231], a[60:63]
    v_exp_f32 v206, v206
    v_mfma_f32_16x16x32_bf16 v[96:99], v[50:53], v[224:227], v[96:99]
    s_add_u32 s21, s21, 0x2000
    v_exp_f32 v207, v207
    v_mfma_f32_16x16x32_bf16 v[100:103], v[50:53], v[228:231], v[100:103]
    s_waitcnt vmcnt(9)
    s_barrier
    s_and_b32 s21, s21, 0x1ffff
    v_mfma_f32_16x16x32_bf16 v[208:211], a[128:131], v[160:163], 0
    s_add_u32 m0, s19, 24576
    buffer_atomic_add v62, v63, s[76:79], s97 offen offset:256 sc1
    v_mfma_f32_16x16x32_bf16 v[208:211], a[136:139], v[164:167], v[208:211]
    buffer_load_dwordx4 v17, s[36:39], s21 offen offset:0 lds
    v_mfma_f32_16x16x32_bf16 v[208:211], a[144:147], v[168:171], v[208:211]
    v_cvt_pk_bf16_f32 v246, v204, v205
    v_cvt_pk_bf16_f32 v247, v206, v207
    v_mfma_f32_16x16x32_bf16 v[208:211], a[152:155], v[172:175], v[208:211]
    v_mfma_f32_16x16x32_bf16 v[216:219], a[128:131], v[176:179], 0
    ds_read_b64 a[128:129], v1 offset:0
    ds_read_b64 a[130:131], v2 offset:0
    v_mfma_f32_16x16x32_bf16 v[216:219], a[136:139], v[180:183], v[216:219]
    v_exp_f32 v208, v208
    v_mfma_f32_16x16x32_bf16 v[216:219], a[144:147], v[184:187], v[216:219]
    ds_read_b64 a[136:137], v3 offset:0
    ds_read_b64 a[138:139], v4 offset:0
    v_mfma_f32_16x16x32_bf16 v[216:219], a[152:155], v[188:191], v[216:219]
    buffer_load_dwordx4 v18, s[36:39], s21 offen offset:1024 lds
    v_mfma_f32_16x16x32_bf16 v[212:215], a[132:135], v[160:163], 0
    ds_read_b64 a[144:145], v5 offset:0
    ds_read_b64 a[146:147], v6 offset:0
    v_mfma_f32_16x16x32_bf16 v[212:215], a[140:143], v[164:167], v[212:215]
    v_exp_f32 v209, v209
    v_mfma_f32_16x16x32_bf16 v[212:215], a[148:151], v[168:171], v[212:215]
    s_add_u32 s22, s22, 0x2000
    ds_read_b64 a[152:153], v7 offset:0
    ds_read_b64 a[154:155], v8 offset:0
    v_mfma_f32_16x16x32_bf16 v[212:215], a[156:159], v[172:175], v[212:215]
    s_and_b32 s22, s22, 0x1ffff
    v_exp_f32 v210, v210
    v_mfma_f32_16x16x32_bf16 v[220:223], a[132:135], v[176:179], 0
    s_add_u32 m0, s20, 8192
    ds_read_b64 a[132:133], v1 offset:4096
    ds_read_b64 a[134:135], v2 offset:4096
    v_mfma_f32_16x16x32_bf16 v[220:223], a[140:143], v[180:183], v[220:223]
    buffer_load_dwordx4 v19, s[40:43], s22 offen offset:0 lds
    v_mfma_f32_16x16x32_bf16 v[220:223], a[148:151], v[184:187], v[220:223]
    ds_read_b64 a[140:141], v3 offset:4096
    ds_read_b64 a[142:143], v4 offset:4096
    v_mfma_f32_16x16x32_bf16 v[220:223], a[156:159], v[188:191], v[220:223]
    v_exp_f32 v211, v211
    v_mfma_f32_16x16x32_bf16 a[64:67], a[160:163], v[232:235], a[64:67]
    ds_read_b64 a[148:149], v5 offset:4096
    ds_read_b64 a[150:151], v6 offset:4096
    v_mfma_f32_16x16x32_bf16 a[96:99], a[160:163], v[236:239], a[96:99]
    v_exp_f32 v216, v216
    v_mfma_f32_16x16x32_bf16 a[68:71], a[164:167], v[232:235], a[68:71]
    ds_read_b64 a[156:157], v7 offset:4096
    ds_read_b64 a[158:159], v8 offset:4096
    v_mfma_f32_16x16x32_bf16 a[100:103], a[164:167], v[236:239], a[100:103]
    ds_read_b64_tr_b16 a[160:161], v9 offset:16384
    ds_read_b64_tr_b16 a[162:163], v9 offset:20480
    v_mfma_f32_16x16x32_bf16 a[72:75], a[168:171], v[232:235], a[72:75]
    buffer_load_dwordx4 v20, s[40:43], s22 offen offset:1024 lds
    v_mfma_f32_16x16x32_bf16 a[104:107], a[168:171], v[236:239], a[104:107]
    ds_read_b64_tr_b16 a[164:165], v10 offset:16384
    ds_read_b64_tr_b16 a[166:167], v10 offset:20480
    v_mfma_f32_16x16x32_bf16 a[76:79], a[172:175], v[232:235], a[76:79]
    v_cvt_pk_bf16_f32 v248, v208, v209
    v_cvt_pk_bf16_f32 v249, v210, v211
    v_mfma_f32_16x16x32_bf16 a[108:111], a[172:175], v[236:239], a[108:111]
    ds_read_b64_tr_b16 a[168:169], v11 offset:16384
    ds_read_b64_tr_b16 a[170:171], v11 offset:20480
    v_mfma_f32_16x16x32_bf16 a[80:83], a[176:179], v[232:235], a[80:83]
    s_mov_b32 s90, 176192
    v_exp_f32 v217, v217
    v_mfma_f32_16x16x32_bf16 a[112:115], a[176:179], v[236:239], a[112:115]
    s_add_u32 m0, s16, 36864
    ds_read_b64_tr_b16 a[172:173], v12 offset:16384
    ds_read_b64_tr_b16 a[174:175], v12 offset:20480
    v_mfma_f32_16x16x32_bf16 a[84:87], a[180:183], v[232:235], a[84:87]
    buffer_load_dwordx4 v44, s[60:63], s90 offen offset:0 lds
    v_mfma_f32_16x16x32_bf16 a[116:119], a[180:183], v[236:239], a[116:119]
    ds_read_b64_tr_b16 a[176:177], v13 offset:16384
    ds_read_b64_tr_b16 a[178:179], v13 offset:20480
    v_mfma_f32_16x16x32_bf16 a[88:91], a[184:187], v[232:235], a[88:91]
    v_exp_f32 v218, v218
    v_mfma_f32_16x16x32_bf16 a[120:123], a[184:187], v[236:239], a[120:123]
    ds_read_b64_tr_b16 a[180:181], v14 offset:16384
    ds_read_b64_tr_b16 a[182:183], v14 offset:20480
    v_mfma_f32_16x16x32_bf16 a[92:95], a[188:191], v[232:235], a[92:95]
    v_exp_f32 v219, v219
    v_mfma_f32_16x16x32_bf16 a[124:127], a[188:191], v[236:239], a[124:127]
    ds_read_b64_tr_b16 a[184:185], v15 offset:16384
    ds_read_b64_tr_b16 a[186:187], v15 offset:20480
    v_mfma_f32_16x16x32_bf16 v[104:107], v[50:53], v[232:235], v[104:107]
    v_exp_f32 v212, v212
    v_mfma_f32_16x16x32_bf16 v[108:111], v[50:53], v[236:239], v[108:111]
    s_add_u32 m0, s16, 36864
    s_waitcnt lgkmcnt(14)
    ds_read_b64_tr_b16 a[188:189], v16 offset:16384
    ds_read_b64_tr_b16 a[190:191], v16 offset:20480
    v_mfma_f32_16x16x32_bf16 v[192:195], a[128:131], v[128:131], 0
    s_lshl_b32 s95, s11, 18
    buffer_load_dwordx4 v45, s[60:63], s90 offen offset:1024 lds
    v_mfma_f32_16x16x32_bf16 v[192:195], a[136:139], v[132:135], v[192:195]
    s_lshl_b32 s25, s4, 12
    v_cvt_pk_bf16_f32 v252, v216, v217
    v_cvt_pk_bf16_f32 v253, v218, v219
    v_mfma_f32_16x16x32_bf16 v[192:195], a[144:147], v[136:139], v[192:195]
    s_add_u32 s95, s95, s25
    v_exp_f32 v213, v213
    v_mfma_f32_16x16x32_bf16 v[192:195], a[152:155], v[140:143], v[192:195]
    s_add_u32 s95, s95, 16777216
    v_exp_f32 v214, v214
    v_mfma_f32_16x16x32_bf16 v[200:203], a[128:131], v[144:147], 0
    s_add_u32 s27, s95, 0x20000
    v_exp_f32 v215, v215
    v_mfma_f32_16x16x32_bf16 v[200:203], a[136:139], v[148:151], v[200:203]
    v_exp_f32 v220, v220
    v_mfma_f32_16x16x32_bf16 v[200:203], a[144:147], v[152:155], v[200:203]
    buffer_load_dwordx4 v46, s[60:63], s90 offen offset:2048 lds
    v_mfma_f32_16x16x32_bf16 v[200:203], a[152:155], v[156:159], v[200:203]
    v_cvt_pk_bf16_f32 v250, v212, v213
    v_cvt_pk_bf16_f32 v251, v214, v215
    v_mfma_f32_16x16x32_bf16 v[196:199], a[132:135], v[128:131], 0
    v_exp_f32 v221, v221
    v_mfma_f32_16x16x32_bf16 v[196:199], a[140:143], v[132:135], v[196:199]
    v_exp_f32 v222, v222
    v_mfma_f32_16x16x32_bf16 v[196:199], a[148:151], v[136:139], v[196:199]
    v_exp_f32 v223, v223
    v_mfma_f32_16x16x32_bf16 v[196:199], a[156:159], v[140:143], v[196:199]
    v_cvt_pk_bf16_f32 v254, v220, v221
    v_cvt_pk_bf16_f32 v255, v222, v223
    v_mfma_f32_16x16x32_bf16 v[204:207], a[132:135], v[144:147], 0
    buffer_load_dwordx4 v47, s[60:63], s90 offen offset:3072 lds
    v_mfma_f32_16x16x32_bf16 v[204:207], a[140:143], v[148:151], v[204:207]
    v_exp_f32 v192, v192
    v_mfma_f32_16x16x32_bf16 v[204:207], a[148:151], v[152:155], v[204:207]
    v_exp_f32 v193, v193
    v_mfma_f32_16x16x32_bf16 v[204:207], a[156:159], v[156:159], v[204:207]
    s_waitcnt lgkmcnt(0)
    v_exp_f32 v194, v194
    v_mfma_f32_16x16x32_bf16 a[0:3], a[160:163], v[240:243], a[0:3]
    v_exp_f32 v195, v195
    v_mfma_f32_16x16x32_bf16 a[32:35], a[160:163], v[244:247], a[32:35]
    v_exp_f32 v200, v200
    v_mfma_f32_16x16x32_bf16 a[4:7], a[164:167], v[240:243], a[4:7]
    buffer_load_dword v38, v27, s[48:51], s0 offen offset:0
    v_mfma_f32_16x16x32_bf16 a[36:39], a[164:167], v[244:247], a[36:39]
    v_cvt_pk_bf16_f32 v224, v192, v193
    v_cvt_pk_bf16_f32 v225, v194, v195
    v_mfma_f32_16x16x32_bf16 a[8:11], a[168:171], v[240:243], a[8:11]
    v_exp_f32 v201, v201
    v_mfma_f32_16x16x32_bf16 a[40:43], a[168:171], v[244:247], a[40:43]
    v_exp_f32 v202, v202
    v_mfma_f32_16x16x32_bf16 a[12:15], a[172:175], v[240:243], a[12:15]
    v_exp_f32 v203, v203
    v_mfma_f32_16x16x32_bf16 a[44:47], a[172:175], v[244:247], a[44:47]
    v_exp_f32 v196, v196
    v_mfma_f32_16x16x32_bf16 a[16:19], a[176:179], v[240:243], a[16:19]
    v_cvt_pk_bf16_f32 v228, v200, v201
    v_cvt_pk_bf16_f32 v229, v202, v203
    v_mfma_f32_16x16x32_bf16 a[48:51], a[176:179], v[244:247], a[48:51]
    v_exp_f32 v197, v197
    v_mfma_f32_16x16x32_bf16 a[20:23], a[180:183], v[240:243], a[20:23]
    v_exp_f32 v198, v198
    v_mfma_f32_16x16x32_bf16 a[52:55], a[180:183], v[244:247], a[52:55]
    v_exp_f32 v199, v199
    v_mfma_f32_16x16x32_bf16 a[24:27], a[184:187], v[240:243], a[24:27]
    v_exp_f32 v204, v204
    v_mfma_f32_16x16x32_bf16 a[56:59], a[184:187], v[244:247], a[56:59]
    v_cvt_pk_bf16_f32 v226, v196, v197
    v_cvt_pk_bf16_f32 v227, v198, v199
    v_mfma_f32_16x16x32_bf16 a[28:31], a[188:191], v[240:243], a[28:31]
    v_exp_f32 v205, v205
    v_mfma_f32_16x16x32_bf16 a[60:63], a[188:191], v[244:247], a[60:63]
    v_exp_f32 v206, v206
    v_mfma_f32_16x16x32_bf16 v[96:99], v[50:53], v[240:243], v[96:99]
    v_exp_f32 v207, v207
    v_mfma_f32_16x16x32_bf16 v[100:103], v[50:53], v[244:247], v[100:103]
    s_waitcnt vmcnt(15)
    s_barrier
    v_mfma_f32_16x16x32_bf16 v[208:211], a[128:131], v[160:163], 0
    v_cvt_pk_bf16_f32 v230, v204, v205
    v_cvt_pk_bf16_f32 v231, v206, v207
    v_mfma_f32_16x16x32_bf16 v[208:211], a[136:139], v[164:167], v[208:211]
    v_and_b32 v54, 15, v0
    v_lshlrev_b32 v54, 4, v54
    v_mfma_f32_16x16x32_bf16 v[208:211], a[144:147], v[168:171], v[208:211]
    v_add_u32 v54, 160768, v54
    v_mfma_f32_16x16x32_bf16 v[208:211], a[152:155], v[172:175], v[208:211]
    s_lshl_b32 s24, s5, 2
    v_add_u32 v55, s24, v54
    v_mfma_f32_16x16x32_bf16 v[216:219], a[128:131], v[176:179], 0
    ds_read_b64 a[128:129], v1 offset:8192
L_warm0_7:
    s_cbranch_execz L_warm0_8
    ds_read_b64 a[130:131], v2 offset:8192
    v_mfma_f32_16x16x32_bf16 v[216:219], a[136:139], v[180:183], v[216:219]
    v_exp_f32 v208, v208
    v_mfma_f32_16x16x32_bf16 v[216:219], a[144:147], v[184:187], v[216:219]
    ds_read_b64 a[136:137], v3 offset:8192
    ds_read_b64 a[138:139], v4 offset:8192
    v_mfma_f32_16x16x32_bf16 v[216:219], a[152:155], v[188:191], v[216:219]
    v_exp_f32 v209, v209
    v_mfma_f32_16x16x32_bf16 v[212:215], a[132:135], v[160:163], 0
    ds_read_b64 a[144:145], v5 offset:8192
    ds_read_b64 a[146:147], v6 offset:8192
    v_mfma_f32_16x16x32_bf16 v[212:215], a[140:143], v[164:167], v[212:215]
    v_exp_f32 v210, v210
    v_mfma_f32_16x16x32_bf16 v[212:215], a[148:151], v[168:171], v[212:215]
    s_add_u32 s22, s22, 0x2000
    ds_read_b64 a[152:153], v7 offset:8192
    ds_read_b64 a[154:155], v8 offset:8192
    v_mfma_f32_16x16x32_bf16 v[212:215], a[156:159], v[172:175], v[212:215]
    s_and_b32 s22, s22, 0x1ffff
    v_exp_f32 v211, v211
    v_mfma_f32_16x16x32_bf16 v[220:223], a[132:135], v[176:179], 0
    s_add_u32 m0, s20, 16384
    ds_read_b64 a[132:133], v1 offset:12288
    ds_read_b64 a[134:135], v2 offset:12288
    v_mfma_f32_16x16x32_bf16 v[220:223], a[140:143], v[180:183], v[220:223]
    buffer_load_dwordx4 v19, s[40:43], s22 offen offset:0 lds
    v_mfma_f32_16x16x32_bf16 v[220:223], a[148:151], v[184:187], v[220:223]
    ds_read_b64 a[140:141], v3 offset:12288
    ds_read_b64 a[142:143], v4 offset:12288
    v_mfma_f32_16x16x32_bf16 v[220:223], a[156:159], v[188:191], v[220:223]
    v_exp_f32 v216, v216
    v_mfma_f32_16x16x32_bf16 a[64:67], a[160:163], v[248:251], a[64:67]
    ds_read_b64 a[148:149], v5 offset:12288
    ds_read_b64 a[150:151], v6 offset:12288
    v_mfma_f32_16x16x32_bf16 a[96:99], a[160:163], v[252:255], a[96:99]
    v_cvt_pk_bf16_f32 v232, v208, v209
    v_cvt_pk_bf16_f32 v233, v210, v211
    v_mfma_f32_16x16x32_bf16 a[68:71], a[164:167], v[248:251], a[68:71]
    ds_read_b64 a[156:157], v7 offset:12288
    ds_read_b64 a[158:159], v8 offset:12288
    v_mfma_f32_16x16x32_bf16 a[100:103], a[164:167], v[252:255], a[100:103]
    ds_read_b64_tr_b16 a[160:161], v9 offset:0
    ds_read_b64_tr_b16 a[162:163], v9 offset:4096
    v_mfma_f32_16x16x32_bf16 a[72:75], a[168:171], v[248:251], a[72:75]
    buffer_load_dwordx4 v20, s[40:43], s22 offen offset:1024 lds
    v_mfma_f32_16x16x32_bf16 a[104:107], a[168:171], v[252:255], a[104:107]
    ds_read_b64_tr_b16 a[164:165], v10 offset:0
    ds_read_b64_tr_b16 a[166:167], v10 offset:4096
    v_mfma_f32_16x16x32_bf16 a[76:79], a[172:175], v[248:251], a[76:79]
    v_exp_f32 v217, v217
    v_mfma_f32_16x16x32_bf16 a[108:111], a[172:175], v[252:255], a[108:111]
    ds_read_b64_tr_b16 a[168:169], v11 offset:0
    ds_read_b64_tr_b16 a[170:171], v11 offset:4096
    v_mfma_f32_16x16x32_bf16 a[80:83], a[176:179], v[248:251], a[80:83]
    s_cmp_lt_u32 s7, 11
    s_cselect_b32 s90, 128, s62
    v_and_b32 v56, 15, v0
    v_mfma_f32_16x16x32_bf16 a[112:115], a[176:179], v[252:255], a[112:115]
    s_add_u32 m0, s16, 98304
    ds_read_b64_tr_b16 a[172:173], v12 offset:0
    ds_read_b64_tr_b16 a[174:175], v12 offset:4096
    v_mfma_f32_16x16x32_bf16 a[84:87], a[180:183], v[248:251], a[84:87]
    buffer_load_dwordx4 v44, s[60:63], s90 offen offset:0 lds
    v_mfma_f32_16x16x32_bf16 a[116:119], a[180:183], v[252:255], a[116:119]
    ds_read_b64_tr_b16 a[176:177], v13 offset:0
    ds_read_b64_tr_b16 a[178:179], v13 offset:4096
    v_mfma_f32_16x16x32_bf16 a[88:91], a[184:187], v[248:251], a[88:91]
    v_exp_f32 v218, v218
    v_mfma_f32_16x16x32_bf16 a[120:123], a[184:187], v[252:255], a[120:123]
    ds_read_b64_tr_b16 a[180:181], v14 offset:0
    ds_read_b64_tr_b16 a[182:183], v14 offset:4096
    v_mfma_f32_16x16x32_bf16 a[92:95], a[188:191], v[248:251], a[92:95]
    v_exp_f32 v219, v219
    v_mfma_f32_16x16x32_bf16 a[124:127], a[188:191], v[252:255], a[124:127]
    ds_read_b64_tr_b16 a[184:185], v15 offset:0
    ds_read_b64_tr_b16 a[186:187], v15 offset:4096
    v_mfma_f32_16x16x32_bf16 v[104:107], v[50:53], v[248:251], v[104:107]
    v_exp_f32 v212, v212
    v_mfma_f32_16x16x32_bf16 v[108:111], v[50:53], v[252:255], v[108:111]
    s_add_u32 m0, s16, 98304
    s_waitcnt lgkmcnt(14)
    ds_read_b64_tr_b16 a[188:189], v16 offset:0
    ds_read_b64_tr_b16 a[190:191], v16 offset:4096
    v_mfma_f32_16x16x32_bf16 v[192:195], a[128:131], v[128:131], 0
    buffer_load_dwordx4 v45, s[60:63], s90 offen offset:1024 lds
    v_mfma_f32_16x16x32_bf16 v[192:195], a[136:139], v[132:135], v[192:195]
    v_cvt_pk_bf16_f32 v236, v216, v217
    v_cvt_pk_bf16_f32 v237, v218, v219
    v_mfma_f32_16x16x32_bf16 v[192:195], a[144:147], v[136:139], v[192:195]
    v_exp_f32 v213, v213
    v_mfma_f32_16x16x32_bf16 v[192:195], a[152:155], v[140:143], v[192:195]
    v_exp_f32 v214, v214
    v_mfma_f32_16x16x32_bf16 v[200:203], a[128:131], v[144:147], 0
    v_exp_f32 v215, v215
    v_mfma_f32_16x16x32_bf16 v[200:203], a[136:139], v[148:151], v[200:203]
    v_exp_f32 v220, v220
    v_mfma_f32_16x16x32_bf16 v[200:203], a[144:147], v[152:155], v[200:203]
    buffer_load_dwordx4 v46, s[60:63], s90 offen offset:2048 lds
    v_mfma_f32_16x16x32_bf16 v[200:203], a[152:155], v[156:159], v[200:203]
    v_cvt_pk_bf16_f32 v234, v212, v213
    v_cvt_pk_bf16_f32 v235, v214, v215
    v_mfma_f32_16x16x32_bf16 v[196:199], a[132:135], v[128:131], 0
    buffer_load_dword v26, off, s[76:79], s97 offset:256 sc1
    v_mfma_f32_16x16x32_bf16 v[196:199], a[140:143], v[132:135], v[196:199]
    v_exp_f32 v221, v221
    v_mfma_f32_16x16x32_bf16 v[196:199], a[148:151], v[136:139], v[196:199]
    v_exp_f32 v222, v222
    v_mfma_f32_16x16x32_bf16 v[196:199], a[156:159], v[140:143], v[196:199]
    v_exp_f32 v223, v223
    v_mfma_f32_16x16x32_bf16 v[204:207], a[132:135], v[144:147], 0
    buffer_load_dwordx4 v47, s[60:63], s90 offen offset:3072 lds
    v_mfma_f32_16x16x32_bf16 v[204:207], a[140:143], v[148:151], v[204:207]
    v_cvt_pk_bf16_f32 v238, v220, v221
    v_cvt_pk_bf16_f32 v239, v222, v223
    v_mfma_f32_16x16x32_bf16 v[204:207], a[148:151], v[152:155], v[204:207]
    v_exp_f32 v192, v192
    v_mfma_f32_16x16x32_bf16 v[204:207], a[156:159], v[156:159], v[204:207]
    s_waitcnt lgkmcnt(0)
    v_exp_f32 v193, v193
    v_mfma_f32_16x16x32_bf16 a[0:3], a[160:163], v[224:227], a[0:3]
    v_exp_f32 v194, v194
    v_mfma_f32_16x16x32_bf16 a[32:35], a[160:163], v[228:231], a[32:35]
    v_exp_f32 v195, v195
    v_mfma_f32_16x16x32_bf16 a[4:7], a[164:167], v[224:227], a[4:7]
    buffer_load_dword v39, v27, s[48:51], s0 offen offset:2048
    v_mfma_f32_16x16x32_bf16 a[36:39], a[164:167], v[228:231], a[36:39]
    v_exp_f32 v200, v200
    v_mfma_f32_16x16x32_bf16 a[8:11], a[168:171], v[224:227], a[8:11]
    v_cvt_pk_bf16_f32 v240, v192, v193
    v_cvt_pk_bf16_f32 v241, v194, v195
    v_mfma_f32_16x16x32_bf16 a[40:43], a[168:171], v[228:231], a[40:43]
    v_exp_f32 v201, v201
    v_mfma_f32_16x16x32_bf16 a[12:15], a[172:175], v[224:227], a[12:15]
    v_exp_f32 v202, v202
    v_mfma_f32_16x16x32_bf16 a[44:47], a[172:175], v[228:231], a[44:47]
    v_exp_f32 v203, v203
    v_mfma_f32_16x16x32_bf16 a[16:19], a[176:179], v[224:227], a[16:19]
    v_exp_f32 v196, v196
    v_mfma_f32_16x16x32_bf16 a[48:51], a[176:179], v[228:231], a[48:51]
    v_cvt_pk_bf16_f32 v244, v200, v201
    v_cvt_pk_bf16_f32 v245, v202, v203
    v_mfma_f32_16x16x32_bf16 a[20:23], a[180:183], v[224:227], a[20:23]
    v_exp_f32 v197, v197
    v_mfma_f32_16x16x32_bf16 a[52:55], a[180:183], v[228:231], a[52:55]
    v_exp_f32 v198, v198
    v_mfma_f32_16x16x32_bf16 a[24:27], a[184:187], v[224:227], a[24:27]
    v_exp_f32 v199, v199
    v_mfma_f32_16x16x32_bf16 a[56:59], a[184:187], v[228:231], a[56:59]
    v_exp_f32 v204, v204
    v_mfma_f32_16x16x32_bf16 a[28:31], a[188:191], v[224:227], a[28:31]
    v_cvt_pk_bf16_f32 v242, v196, v197
    v_cvt_pk_bf16_f32 v243, v198, v199
    v_mfma_f32_16x16x32_bf16 a[60:63], a[188:191], v[228:231], a[60:63]
    v_exp_f32 v205, v205
    v_mfma_f32_16x16x32_bf16 v[96:99], v[50:53], v[224:227], v[96:99]
    v_exp_f32 v206, v206
    v_mfma_f32_16x16x32_bf16 v[100:103], v[50:53], v[228:231], v[100:103]
    s_waitcnt vmcnt(13)
    s_barrier
    v_mfma_f32_16x16x32_bf16 v[208:211], a[128:131], v[160:163], 0
    v_exp_f32 v207, v207
    v_mfma_f32_16x16x32_bf16 v[208:211], a[136:139], v[164:167], v[208:211]
    v_cvt_pk_bf16_f32 v246, v204, v205
    v_cvt_pk_bf16_f32 v247, v206, v207
    v_mfma_f32_16x16x32_bf16 v[208:211], a[144:147], v[168:171], v[208:211]
    v_lshrrev_b32 v57, 4, v0
    v_lshlrev_b32 v56, 3, v56
    v_mfma_f32_16x16x32_bf16 v[208:211], a[152:155], v[172:175], v[208:211]
    v_lshl_add_u32 v56, v57, 12, v56
    v_mfma_f32_16x16x32_bf16 v[216:219], a[128:131], v[176:179], 0
    ds_read_b64 a[128:129], v1 offset:16384
    ds_read_b64 a[130:131], v2 offset:16384
    v_mfma_f32_16x16x32_bf16 v[216:219], a[136:139], v[180:183], v[216:219]
    v_exp_f32 v208, v208
    v_mfma_f32_16x16x32_bf16 v[216:219], a[144:147], v[184:187], v[216:219]
    ds_read_b64 a[136:137], v3 offset:16384
    ds_read_b64 a[138:139], v4 offset:16384
    v_mfma_f32_16x16x32_bf16 v[216:219], a[152:155], v[188:191], v[216:219]
    v_exp_f32 v209, v209
    v_mfma_f32_16x16x32_bf16 v[212:215], a[132:135], v[160:163], 0
    ds_read_b64 a[144:145], v5 offset:16384
    ds_read_b64 a[146:147], v6 offset:16384
    v_mfma_f32_16x16x32_bf16 v[212:215], a[140:143], v[164:167], v[212:215]
    v_exp_f32 v210, v210
    v_mfma_f32_16x16x32_bf16 v[212:215], a[148:151], v[168:171], v[212:215]
    s_add_u32 s22, s22, 0x2000
    ds_read_b64 a[152:153], v7 offset:16384
    ds_read_b64 a[154:155], v8 offset:16384
    v_mfma_f32_16x16x32_bf16 v[212:215], a[156:159], v[172:175], v[212:215]
    s_and_b32 s22, s22, 0x1ffff
    v_exp_f32 v211, v211
    v_mfma_f32_16x16x32_bf16 v[220:223], a[132:135], v[176:179], 0
    s_add_u32 m0, s20, 0
    ds_read_b64 a[132:133], v1 offset:20480
    ds_read_b64 a[134:135], v2 offset:20480
    v_mfma_f32_16x16x32_bf16 v[220:223], a[140:143], v[180:183], v[220:223]
    buffer_load_dwordx4 v19, s[40:43], s22 offen offset:0 lds
    v_mfma_f32_16x16x32_bf16 v[220:223], a[148:151], v[184:187], v[220:223]
    ds_read_b64 a[140:141], v3 offset:20480
    ds_read_b64 a[142:143], v4 offset:20480
    v_mfma_f32_16x16x32_bf16 v[220:223], a[156:159], v[188:191], v[220:223]
    v_exp_f32 v216, v216
    v_mfma_f32_16x16x32_bf16 a[64:67], a[160:163], v[232:235], a[64:67]
    ds_read_b64 a[148:149], v5 offset:20480
    ds_read_b64 a[150:151], v6 offset:20480
    v_mfma_f32_16x16x32_bf16 a[96:99], a[160:163], v[236:239], a[96:99]
    v_cvt_pk_bf16_f32 v248, v208, v209
    v_cvt_pk_bf16_f32 v249, v210, v211
    v_mfma_f32_16x16x32_bf16 a[68:71], a[164:167], v[232:235], a[68:71]
    ds_read_b64 a[156:157], v7 offset:20480
    ds_read_b64 a[158:159], v8 offset:20480
    v_mfma_f32_16x16x32_bf16 a[100:103], a[164:167], v[236:239], a[100:103]
    ds_read_b64_tr_b16 a[160:161], v9 offset:8192
    ds_read_b64_tr_b16 a[162:163], v9 offset:12288
    v_mfma_f32_16x16x32_bf16 a[72:75], a[168:171], v[232:235], a[72:75]
    buffer_load_dwordx4 v20, s[40:43], s22 offen offset:1024 lds
    v_mfma_f32_16x16x32_bf16 a[104:107], a[168:171], v[236:239], a[104:107]
    ds_read_b64_tr_b16 a[164:165], v10 offset:8192
    ds_read_b64_tr_b16 a[166:167], v10 offset:12288
    v_mfma_f32_16x16x32_bf16 a[76:79], a[172:175], v[232:235], a[76:79]
    v_exp_f32 v217, v217
    v_mfma_f32_16x16x32_bf16 a[108:111], a[172:175], v[236:239], a[108:111]
    ds_read_b64_tr_b16 a[168:169], v11 offset:8192
    ds_read_b64_tr_b16 a[170:171], v11 offset:12288
    v_mfma_f32_16x16x32_bf16 a[80:83], a[176:179], v[232:235], a[80:83]
    s_cmp_lt_u32 s7, 11
    s_cselect_b32 s90, 176256, s62
    v_mfma_f32_16x16x32_bf16 a[112:115], a[176:179], v[236:239], a[112:115]
    s_add_u32 m0, s16, 102400
    ds_read_b64_tr_b16 a[172:173], v12 offset:8192
    ds_read_b64_tr_b16 a[174:175], v12 offset:12288
    v_mfma_f32_16x16x32_bf16 a[84:87], a[180:183], v[232:235], a[84:87]
    buffer_load_dwordx4 v44, s[60:63], s90 offen offset:0 lds
    v_mfma_f32_16x16x32_bf16 a[116:119], a[180:183], v[236:239], a[116:119]
    ds_read_b64_tr_b16 a[176:177], v13 offset:8192
    ds_read_b64_tr_b16 a[178:179], v13 offset:12288
    v_mfma_f32_16x16x32_bf16 a[88:91], a[184:187], v[232:235], a[88:91]
    v_exp_f32 v218, v218
    v_mfma_f32_16x16x32_bf16 a[120:123], a[184:187], v[236:239], a[120:123]
    ds_read_b64_tr_b16 a[180:181], v14 offset:8192
    ds_read_b64_tr_b16 a[182:183], v14 offset:12288
    v_mfma_f32_16x16x32_bf16 a[92:95], a[188:191], v[232:235], a[92:95]
    v_exp_f32 v219, v219
    v_mfma_f32_16x16x32_bf16 a[124:127], a[188:191], v[236:239], a[124:127]
    ds_read_b64_tr_b16 a[184:185], v15 offset:8192
    ds_read_b64_tr_b16 a[186:187], v15 offset:12288
    v_mfma_f32_16x16x32_bf16 v[104:107], v[50:53], v[232:235], v[104:107]
    v_exp_f32 v212, v212
    v_mfma_f32_16x16x32_bf16 v[108:111], v[50:53], v[236:239], v[108:111]
    s_add_u32 m0, s16, 102400
    s_waitcnt lgkmcnt(14)
    ds_read_b64_tr_b16 a[188:189], v16 offset:8192
    ds_read_b64_tr_b16 a[190:191], v16 offset:12288
    v_mfma_f32_16x16x32_bf16 v[192:195], a[128:131], v[128:131], 0
    buffer_load_dwordx4 v45, s[60:63], s90 offen offset:1024 lds
    v_mfma_f32_16x16x32_bf16 v[192:195], a[136:139], v[132:135], v[192:195]
    v_cvt_pk_bf16_f32 v252, v216, v217
    v_cvt_pk_bf16_f32 v253, v218, v219
    v_mfma_f32_16x16x32_bf16 v[192:195], a[144:147], v[136:139], v[192:195]
    v_exp_f32 v213, v213
    v_mfma_f32_16x16x32_bf16 v[192:195], a[152:155], v[140:143], v[192:195]
    v_exp_f32 v214, v214
    v_mfma_f32_16x16x32_bf16 v[200:203], a[128:131], v[144:147], 0
    v_exp_f32 v215, v215
    v_mfma_f32_16x16x32_bf16 v[200:203], a[136:139], v[148:151], v[200:203]
    v_exp_f32 v220, v220
    v_mfma_f32_16x16x32_bf16 v[200:203], a[144:147], v[152:155], v[200:203]
    s_waitcnt vmcnt(6)
    v_cmp_gt_u32 vcc, 16, v26
    s_cbranch_vccnz L_spin_7
    L_back_8:
    v_mfma_f32_16x16x32_bf16 v[200:203], a[152:155], v[156:159], v[200:203]
    s_lshl_b32 s94, s11, 15
    buffer_load_dwordx4 v46, s[60:63], s90 offen offset:2048 lds
    v_mfma_f32_16x16x32_bf16 v[196:199], a[132:135], v[128:131], 0
    s_add_u32 s94, s94, 3145728
    v_cvt_pk_bf16_f32 v250, v212, v213
    v_cvt_pk_bf16_f32 v251, v214, v215
    v_mfma_f32_16x16x32_bf16 v[196:199], a[140:143], v[132:135], v[196:199]
    s_add_u32 s93, s5, 0
    v_exp_f32 v221, v221
    v_mfma_f32_16x16x32_bf16 v[196:199], a[148:151], v[136:139], v[196:199]
    s_and_b32 s93, s93, 3
    v_exp_f32 v222, v222
    v_mfma_f32_16x16x32_bf16 v[196:199], a[156:159], v[140:143], v[196:199]
    s_lshl_b32 s93, s93, 12
    v_exp_f32 v223, v223
    v_mfma_f32_16x16x32_bf16 v[204:207], a[132:135], v[144:147], 0
    s_add_u32 s93, s93, s94
    buffer_load_dwordx4 v47, s[60:63], s90 offen offset:3072 lds
    v_mfma_f32_16x16x32_bf16 v[204:207], a[140:143], v[148:151], v[204:207]
    s_add_u32 s28, s93, 0x4000
    buffer_load_dwordx4 a[192:195], v25, s[76:79], s93 offen offset:0 sc1
    v_mfma_f32_16x16x32_bf16 v[204:207], a[148:151], v[152:155], v[204:207]
    v_cvt_pk_bf16_f32 v254, v220, v221
    v_cvt_pk_bf16_f32 v255, v222, v223
    v_mfma_f32_16x16x32_bf16 v[204:207], a[156:159], v[156:159], v[204:207]
    s_waitcnt lgkmcnt(0)
    v_exp_f32 v192, v192
    v_mfma_f32_16x16x32_bf16 a[0:3], a[160:163], v[240:243], a[0:3]
    s_lshl_b32 s30, s8, 20
    buffer_load_dwordx4 a[196:199], v25, s[76:79], s28 offen offset:0 sc1
    v_mfma_f32_16x16x32_bf16 a[32:35], a[160:163], v[244:247], a[32:35]
    s_lshl_b32 s31, s5, 15
    v_exp_f32 v193, v193
    v_mfma_f32_16x16x32_bf16 a[4:7], a[164:167], v[240:243], a[4:7]
    s_add_u32 s30, s30, s31
    v_exp_f32 v194, v194
    v_mfma_f32_16x16x32_bf16 a[36:39], a[164:167], v[244:247], a[36:39]
    s_lshl_b32 s31, s9, 8
    v_exp_f32 v195, v195
    v_mfma_f32_16x16x32_bf16 a[8:11], a[168:171], v[240:243], a[8:11]
    s_add_u32 s30, s30, s31
    buffer_load_dwordx4 a[200:203], v25, s[76:79], s93 offen offset:1024 sc1
    v_mfma_f32_16x16x32_bf16 a[40:43], a[168:171], v[244:247], a[40:43]
    v_exp_f32 v200, v200
    v_mfma_f32_16x16x32_bf16 a[12:15], a[172:175], v[240:243], a[12:15]
    v_cvt_pk_bf16_f32 v224, v192, v193
    v_cvt_pk_bf16_f32 v225, v194, v195
    v_mfma_f32_16x16x32_bf16 a[44:47], a[172:175], v[244:247], a[44:47]
    v_exp_f32 v201, v201
    v_mfma_f32_16x16x32_bf16 a[16:19], a[176:179], v[240:243], a[16:19]
    buffer_load_dwordx4 a[204:207], v25, s[76:79], s28 offen offset:1024 sc1
    v_mfma_f32_16x16x32_bf16 a[48:51], a[176:179], v[244:247], a[48:51]
    v_exp_f32 v202, v202
    v_mfma_f32_16x16x32_bf16 a[20:23], a[180:183], v[240:243], a[20:23]
    v_exp_f32 v203, v203
    v_mfma_f32_16x16x32_bf16 a[52:55], a[180:183], v[244:247], a[52:55]
    v_exp_f32 v196, v196
    v_mfma_f32_16x16x32_bf16 a[24:27], a[184:187], v[240:243], a[24:27]
    buffer_load_dwordx4 a[208:211], v25, s[76:79], s93 offen offset:2048 sc1
    v_mfma_f32_16x16x32_bf16 a[56:59], a[184:187], v[244:247], a[56:59]
    v_cvt_pk_bf16_f32 v228, v200, v201
    v_cvt_pk_bf16_f32 v229, v202, v203
    v_mfma_f32_16x16x32_bf16 a[28:31], a[188:191], v[240:243], a[28:31]
    v_exp_f32 v197, v197
    v_mfma_f32_16x16x32_bf16 a[60:63], a[188:191], v[244:247], a[60:63]
    v_exp_f32 v198, v198
    v_mfma_f32_16x16x32_bf16 v[96:99], v[50:53], v[240:243], v[96:99]
    buffer_load_dwordx4 a[212:215], v25, s[76:79], s28 offen offset:2048 sc1
    v_mfma_f32_16x16x32_bf16 v[100:103], v[50:53], v[244:247], v[100:103]
    s_barrier
    v_mfma_f32_16x16x32_bf16 v[208:211], a[128:131], v[160:163], 0
    v_exp_f32 v199, v199
    v_mfma_f32_16x16x32_bf16 v[208:211], a[136:139], v[164:167], v[208:211]
    v_exp_f32 v204, v204
    v_mfma_f32_16x16x32_bf16 v[208:211], a[144:147], v[168:171], v[208:211]
    buffer_load_dwordx4 a[216:219], v25, s[76:79], s93 offen offset:3072 sc1
    v_mfma_f32_16x16x32_bf16 v[208:211], a[152:155], v[172:175], v[208:211]
    v_cvt_pk_bf16_f32 v226, v196, v197
    v_cvt_pk_bf16_f32 v227, v198, v199
    v_mfma_f32_16x16x32_bf16 v[216:219], a[128:131], v[176:179], 0
    ds_read_b64 a[128:129], v1 offset:24576
    ds_read_b64 a[130:131], v2 offset:24576
    v_mfma_f32_16x16x32_bf16 v[216:219], a[136:139], v[180:183], v[216:219]
    v_exp_f32 v205, v205
    v_mfma_f32_16x16x32_bf16 v[216:219], a[144:147], v[184:187], v[216:219]
    ds_read_b64 a[136:137], v3 offset:24576
    ds_read_b64 a[138:139], v4 offset:24576
    v_mfma_f32_16x16x32_bf16 v[216:219], a[152:155], v[188:191], v[216:219]
    s_add_u32 s93, s5, 1
    buffer_load_dwordx4 a[220:223], v25, s[76:79], s28 offen offset:3072 sc1
    v_mfma_f32_16x16x32_bf16 v[212:215], a[132:135], v[160:163], 0
    s_and_b32 s93, s93, 3
    ds_read_b64 a[144:145], v5 offset:24576
    ds_read_b64 a[146:147], v6 offset:24576
    v_mfma_f32_16x16x32_bf16 v[212:215], a[140:143], v[164:167], v[212:215]
    s_lshl_b32 s93, s93, 12
    v_exp_f32 v206, v206
    v_mfma_f32_16x16x32_bf16 v[212:215], a[148:151], v[168:171], v[212:215]
    s_add_u32 s93, s93, s94
    ds_read_b64 a[152:153], v7 offset:24576
    ds_read_b64 a[154:155], v8 offset:24576
    v_mfma_f32_16x16x32_bf16 v[212:215], a[156:159], v[172:175], v[212:215]
    s_add_u32 s28, s93, 0x4000
    buffer_load_dwordx4 a[224:227], v25, s[76:79], s93 offen offset:0 sc1
    v_mfma_f32_16x16x32_bf16 v[220:223], a[132:135], v[176:179], 0
    ds_read_b64 a[132:133], v1 offset:28672
    ds_read_b64 a[134:135], v2 offset:28672
    v_mfma_f32_16x16x32_bf16 v[220:223], a[140:143], v[180:183], v[220:223]
    v_exp_f32 v207, v207
    v_mfma_f32_16x16x32_bf16 v[220:223], a[148:151], v[184:187], v[220:223]
    ds_read_b64 a[140:141], v3 offset:28672
    ds_read_b64 a[142:143], v4 offset:28672
    v_mfma_f32_16x16x32_bf16 v[220:223], a[156:159], v[188:191], v[220:223]
    buffer_load_dwordx4 a[228:231], v25, s[76:79], s28 offen offset:0 sc1
    v_mfma_f32_16x16x32_bf16 a[64:67], a[160:163], v[248:251], a[64:67]
    ds_read_b64 a[148:149], v5 offset:28672
    ds_read_b64 a[150:151], v6 offset:28672
    v_mfma_f32_16x16x32_bf16 a[96:99], a[160:163], v[252:255], a[96:99]
    v_cvt_pk_bf16_f32 v230, v204, v205
    v_cvt_pk_bf16_f32 v231, v206, v207
    v_mfma_f32_16x16x32_bf16 a[68:71], a[164:167], v[248:251], a[68:71]
    ds_read_b64 a[156:157], v7 offset:28672
    ds_read_b64 a[158:159], v8 offset:28672
    v_mfma_f32_16x16x32_bf16 a[100:103], a[164:167], v[252:255], a[100:103]
    ds_read_b64_tr_b16 a[160:161], v9 offset:16384
    ds_read_b64_tr_b16 a[162:163], v9 offset:20480
    v_mfma_f32_16x16x32_bf16 a[72:75], a[168:171], v[248:251], a[72:75]
    buffer_load_dwordx4 a[232:235], v25, s[76:79], s93 offen offset:1024 sc1
    v_mfma_f32_16x16x32_bf16 a[104:107], a[168:171], v[252:255], a[104:107]
    ds_read_b64_tr_b16 a[164:165], v10 offset:16384
    ds_read_b64_tr_b16 a[166:167], v10 offset:20480
    v_mfma_f32_16x16x32_bf16 a[76:79], a[172:175], v[248:251], a[76:79]
    buffer_load_dwordx4 a[236:239], v25, s[76:79], s28 offen offset:1024 sc1
    v_mfma_f32_16x16x32_bf16 a[108:111], a[172:175], v[252:255], a[108:111]
    ds_read_b64_tr_b16 a[168:169], v11 offset:16384
    ds_read_b64_tr_b16 a[170:171], v11 offset:20480
    v_mfma_f32_16x16x32_bf16 a[80:83], a[176:179], v[248:251], a[80:83]
    v_exp_f32 v208, v208
    v_mfma_f32_16x16x32_bf16 a[112:115], a[176:179], v[252:255], a[112:115]
    ds_read_b64_tr_b16 a[172:173], v12 offset:16384
    ds_read_b64_tr_b16 a[174:175], v12 offset:20480
    v_mfma_f32_16x16x32_bf16 a[84:87], a[180:183], v[248:251], a[84:87]
    buffer_load_dwordx4 a[240:243], v25, s[76:79], s93 offen offset:2048 sc1
    v_mfma_f32_16x16x32_bf16 a[116:119], a[180:183], v[252:255], a[116:119]
    ds_read_b64_tr_b16 a[176:177], v13 offset:16384
    ds_read_b64_tr_b16 a[178:179], v13 offset:20480
    v_mfma_f32_16x16x32_bf16 a[88:91], a[184:187], v[248:251], a[88:91]
    v_exp_f32 v209, v209
    v_mfma_f32_16x16x32_bf16 a[120:123], a[184:187], v[252:255], a[120:123]
    ds_read_b64_tr_b16 a[180:181], v14 offset:16384
    ds_read_b64_tr_b16 a[182:183], v14 offset:20480
    v_mfma_f32_16x16x32_bf16 a[92:95], a[188:191], v[248:251], a[92:95]
    buffer_load_dwordx4 a[244:247], v25, s[76:79], s28 offen offset:2048 sc1
    v_mfma_f32_16x16x32_bf16 a[124:127], a[188:191], v[252:255], a[124:127]
    ds_read_b64_tr_b16 a[184:185], v15 offset:16384
    ds_read_b64_tr_b16 a[186:187], v15 offset:20480
    v_mfma_f32_16x16x32_bf16 v[104:107], v[50:53], v[248:251], v[104:107]
    v_exp_f32 v210, v210
    v_mfma_f32_16x16x32_bf16 v[108:111], v[50:53], v[252:255], v[108:111]
    s_waitcnt lgkmcnt(14)
    ds_read_b64_tr_b16 a[188:189], v16 offset:16384
    ds_read_b64_tr_b16 a[190:191], v16 offset:20480
    v_mfma_f32_16x16x32_bf16 v[192:195], a[128:131], v[128:131], 0
    s_sub_u32 s24, s16, 98304
    buffer_load_dwordx4 a[248:251], v25, s[76:79], s93 offen offset:3072 sc1
    v_mfma_f32_16x16x32_bf16 v[192:195], a[136:139], v[132:135], v[192:195]
    v_exp_f32 v211, v211
    v_mfma_f32_16x16x32_bf16 v[192:195], a[144:147], v[136:139], v[192:195]
    v_exp_f32 v216, v216
    v_mfma_f32_16x16x32_bf16 v[192:195], a[152:155], v[140:143], v[192:195]
    v_cvt_pk_bf16_f32 v232, v208, v209
    v_cvt_pk_bf16_f32 v233, v210, v211
    v_mfma_f32_16x16x32_bf16 v[200:203], a[128:131], v[144:147], 0
    buffer_load_dwordx4 a[252:255], v25, s[76:79], s28 offen offset:3072 sc1
    v_mfma_f32_16x16x32_bf16 v[200:203], a[136:139], v[148:151], v[200:203]
    v_exp_f32 v217, v217
    v_mfma_f32_16x16x32_bf16 v[200:203], a[144:147], v[152:155], v[200:203]
    v_exp_f32 v218, v218
    v_mfma_f32_16x16x32_bf16 v[200:203], a[152:155], v[156:159], v[200:203]
    v_exp_f32 v219, v219
    v_mfma_f32_16x16x32_bf16 v[196:199], a[132:135], v[128:131], 0
    buffer_load_dwordx2 v[28:29], v56, s[76:79], s96 offen offset:0 sc1
    v_mfma_f32_16x16x32_bf16 v[196:199], a[140:143], v[132:135], v[196:199]
    v_exp_f32 v212, v212
    v_mfma_f32_16x16x32_bf16 v[196:199], a[148:151], v[136:139], v[196:199]
    buffer_load_dwordx2 v[30:31], v56, s[76:79], s96 offen offset:1024 sc1
    v_mfma_f32_16x16x32_bf16 v[196:199], a[156:159], v[140:143], v[196:199]
    v_cvt_pk_bf16_f32 v236, v216, v217
    v_cvt_pk_bf16_f32 v237, v218, v219
    v_mfma_f32_16x16x32_bf16 v[204:207], a[132:135], v[144:147], 0
    buffer_load_dwordx2 v[32:33], v56, s[76:79], s96 offen offset:2048 sc1
    v_mfma_f32_16x16x32_bf16 v[204:207], a[140:143], v[148:151], v[204:207]
    v_exp_f32 v213, v213
    v_mfma_f32_16x16x32_bf16 v[204:207], a[148:151], v[152:155], v[204:207]
    buffer_load_dwordx2 v[34:35], v56, s[76:79], s96 offen offset:3072 sc1
    v_mfma_f32_16x16x32_bf16 v[204:207], a[156:159], v[156:159], v[204:207]
    s_waitcnt lgkmcnt(0)
    v_exp_f32 v214, v214
    v_mfma_f32_16x16x32_bf16 a[0:3], a[160:163], v[224:227], a[0:3]
    buffer_load_dwordx2 v[36:37], v56, s[76:79], s96 offen offset:128 sc1
    v_mfma_f32_16x16x32_bf16 a[32:35], a[160:163], v[228:231], a[32:35]
    v_exp_f32 v215, v215
    v_mfma_f32_16x16x32_bf16 a[4:7], a[164:167], v[224:227], a[4:7]
    s_waitcnt vmcnt(27)
    buffer_load_dwordx2 v[38:39], v56, s[76:79], s96 offen offset:1152 sc1
    v_mfma_f32_16x16x32_bf16 a[36:39], a[164:167], v[228:231], a[36:39]
    v_exp_f32 v220, v220
    v_mfma_f32_16x16x32_bf16 a[8:11], a[168:171], v[224:227], a[8:11]
    buffer_load_dwordx2 v[40:41], v56, s[76:79], s96 offen offset:2176 sc1
    v_mfma_f32_16x16x32_bf16 a[40:43], a[168:171], v[228:231], a[40:43]
    v_cvt_pk_bf16_f32 v234, v212, v213
    v_cvt_pk_bf16_f32 v235, v214, v215
    v_mfma_f32_16x16x32_bf16 a[12:15], a[172:175], v[224:227], a[12:15]
    buffer_load_dwordx2 v[42:43], v56, s[76:79], s96 offen offset:3200 sc1
    v_mfma_f32_16x16x32_bf16 a[44:47], a[172:175], v[228:231], a[44:47]
    v_exp_f32 v221, v221
    v_mfma_f32_16x16x32_bf16 a[16:19], a[176:179], v[224:227], a[16:19]
    v_exp_f32 v222, v222
    v_mfma_f32_16x16x32_bf16 a[48:51], a[176:179], v[228:231], a[48:51]
    v_exp_f32 v223, v223
    v_mfma_f32_16x16x32_bf16 a[20:23], a[180:183], v[224:227], a[20:23]
    v_cvt_pk_bf16_f32 v238, v220, v221
    v_cvt_pk_bf16_f32 v239, v222, v223
    v_mfma_f32_16x16x32_bf16 a[52:55], a[180:183], v[228:231], a[52:55]
    v_exp_f32 v192, v192
    v_mfma_f32_16x16x32_bf16 a[24:27], a[184:187], v[224:227], a[24:27]
    v_exp_f32 v193, v193
    v_mfma_f32_16x16x32_bf16 a[56:59], a[184:187], v[228:231], a[56:59]
    v_exp_f32 v194, v194
    v_mfma_f32_16x16x32_bf16 a[28:31], a[188:191], v[224:227], a[28:31]
    v_exp_f32 v195, v195
    v_and_b32 v44, 0xff, v19
    v_lshrrev_b32 v45, 4, v0
    v_lshl_add_u32 v44, v45, 10, v44
    v_add_u32 v44, s30, v44
    v_xor_b32 v45, 0x80, v44
    v_add_u32 v46, 6144, v44
    v_add_u32 v47, 9216, v45
    v_add_u32 v45, 3072, v45
    v_mfma_f32_16x16x32_bf16 a[60:63], a[188:191], v[228:231], a[60:63]
    v_exp_f32 v200, v200
    v_mfma_f32_16x16x32_bf16 v[96:99], v[50:53], v[224:227], v[96:99]
    v_cvt_pk_bf16_f32 v240, v192, v193
    v_cvt_pk_bf16_f32 v241, v194, v195
    v_mfma_f32_16x16x32_bf16 v[100:103], v[50:53], v[228:231], v[100:103]
    s_waitcnt vmcnt(24)
    s_barrier
    s_add_u32 s31, s4, 0
    s_and_b32 s31, s31, 7
    v_mfma_f32_16x16x32_bf16 v[208:211], a[128:131], v[160:163], 0
    s_lshl_b32 s31, s31, 17
    v_exp_f32 v201, v201
    v_mfma_f32_16x16x32_bf16 v[208:211], a[136:139], v[164:167], v[208:211]
    s_add_u32 m0, s16, 65536
    v_exp_f32 v202, v202
    v_mfma_f32_16x16x32_bf16 v[208:211], a[144:147], v[168:171], v[208:211]
    buffer_load_dwordx4 v44, s[48:51], s31 offen offset:0 lds
    v_mfma_f32_16x16x32_bf16 v[208:211], a[152:155], v[172:175], v[208:211]
    v_exp_f32 v203, v203
    v_mfma_f32_16x16x32_bf16 v[216:219], a[128:131], v[176:179], 0
    v_exp_f32 v196, v196
    v_mfma_f32_16x16x32_bf16 v[216:219], a[136:139], v[180:183], v[216:219]
    v_cvt_pk_bf16_f32 v244, v200, v201
    v_cvt_pk_bf16_f32 v245, v202, v203
    v_mfma_f32_16x16x32_bf16 v[216:219], a[144:147], v[184:187], v[216:219]
    buffer_load_dwordx4 v45, s[48:51], s31 offen offset:1024 lds
    v_mfma_f32_16x16x32_bf16 v[216:219], a[152:155], v[188:191], v[216:219]
    v_exp_f32 v197, v197
    v_mfma_f32_16x16x32_bf16 v[212:215], a[132:135], v[160:163], 0
    v_exp_f32 v198, v198
    v_mfma_f32_16x16x32_bf16 v[212:215], a[140:143], v[164:167], v[212:215]
    v_exp_f32 v199, v199
    v_mfma_f32_16x16x32_bf16 v[212:215], a[148:151], v[168:171], v[212:215]
    buffer_load_dwordx4 v46, s[48:51], s31 offen offset:2048 lds
    v_mfma_f32_16x16x32_bf16 v[212:215], a[156:159], v[172:175], v[212:215]
    v_exp_f32 v204, v204
    v_mfma_f32_16x16x32_bf16 v[220:223], a[132:135], v[176:179], 0
    v_cvt_pk_bf16_f32 v242, v196, v197
    v_cvt_pk_bf16_f32 v243, v198, v199
    v_mfma_f32_16x16x32_bf16 v[220:223], a[140:143], v[180:183], v[220:223]
    v_exp_f32 v205, v205
    v_mfma_f32_16x16x32_bf16 v[220:223], a[148:151], v[184:187], v[220:223]
    buffer_load_dwordx4 v47, s[48:51], s31 offen offset:3072 lds
    v_mfma_f32_16x16x32_bf16 v[220:223], a[156:159], v[188:191], v[220:223]
    v_exp_f32 v206, v206
    v_mfma_f32_16x16x32_bf16 a[64:67], a[160:163], v[232:235], a[64:67]
    s_add_u32 s31, s31, 0x4000
    v_exp_f32 v207, v207
    v_mfma_f32_16x16x32_bf16 a[96:99], a[160:163], v[236:239], a[96:99]
    s_add_u32 m0, s16, 69632
    s_add_u32 s93, s5, 2
    ds_read_b64_tr_b16 a[160:161], v9 offset:0
    ds_read_b64_tr_b16 a[162:163], v9 offset:4096
    v_mfma_f32_16x16x32_bf16 a[68:71], a[164:167], v[232:235], a[68:71]
    s_and_b32 s93, s93, 3
    buffer_load_dwordx4 v44, s[48:51], s31 offen offset:0 lds
    v_mfma_f32_16x16x32_bf16 a[100:103], a[164:167], v[236:239], a[100:103]
    s_lshl_b32 s93, s93, 12
    ds_read_b64_tr_b16 a[164:165], v10 offset:0
    ds_read_b64_tr_b16 a[166:167], v10 offset:4096
    v_mfma_f32_16x16x32_bf16 a[72:75], a[168:171], v[232:235], a[72:75]
    s_add_u32 s93, s93, s94
    buffer_load_dwordx4 a[128:131], v25, s[76:79], s93 offen offset:0 sc1
    v_mfma_f32_16x16x32_bf16 a[104:107], a[168:171], v[236:239], a[104:107]
    s_add_u32 s28, s93, 0x4000
    ds_read_b64_tr_b16 a[168:169], v11 offset:0
    ds_read_b64_tr_b16 a[170:171], v11 offset:4096
    v_mfma_f32_16x16x32_bf16 a[76:79], a[172:175], v[232:235], a[76:79]
    buffer_load_dwordx4 v45, s[48:51], s31 offen offset:1024 lds
    v_mfma_f32_16x16x32_bf16 a[108:111], a[172:175], v[236:239], a[108:111]
L_warm0_8:
    s_cbranch_execz L_warm_ret0
    ds_read_b64_tr_b16 a[172:173], v12 offset:0
    ds_read_b64_tr_b16 a[174:175], v12 offset:4096
    v_mfma_f32_16x16x32_bf16 a[80:83], a[176:179], v[232:235], a[80:83]
    buffer_load_dwordx4 a[132:135], v25, s[76:79], s28 offen offset:0 sc1
    v_mfma_f32_16x16x32_bf16 a[112:115], a[176:179], v[236:239], a[112:115]
    ds_read_b64_tr_b16 a[176:177], v13 offset:0
    ds_read_b64_tr_b16 a[178:179], v13 offset:4096
    v_mfma_f32_16x16x32_bf16 a[84:87], a[180:183], v[232:235], a[84:87]
    buffer_load_dwordx4 v46, s[48:51], s31 offen offset:2048 lds
    v_mfma_f32_16x16x32_bf16 a[116:119], a[180:183], v[236:239], a[116:119]
    ds_read_b64_tr_b16 a[180:181], v14 offset:0
    ds_read_b64_tr_b16 a[182:183], v14 offset:4096
    v_mfma_f32_16x16x32_bf16 a[88:91], a[184:187], v[232:235], a[88:91]
    buffer_load_dwordx4 a[136:139], v25, s[76:79], s93 offen offset:1024 sc1
    v_mfma_f32_16x16x32_bf16 a[120:123], a[184:187], v[236:239], a[120:123]
    ds_read_b64_tr_b16 a[184:185], v15 offset:0
    ds_read_b64_tr_b16 a[186:187], v15 offset:4096
    v_mfma_f32_16x16x32_bf16 a[92:95], a[188:191], v[232:235], a[92:95]
    buffer_load_dwordx4 v47, s[48:51], s31 offen offset:3072 lds
    v_mfma_f32_16x16x32_bf16 a[124:127], a[188:191], v[236:239], a[124:127]
    ds_read_b64_tr_b16 a[188:189], v16 offset:0
    ds_read_b64_tr_b16 a[190:191], v16 offset:4096
    v_mfma_f32_16x16x32_bf16 v[104:107], v[50:53], v[232:235], v[104:107]
    buffer_load_dwordx4 a[140:143], v25, s[76:79], s28 offen offset:1024 sc1
    v_cvt_pk_bf16_f32 v246, v204, v205
    v_cvt_pk_bf16_f32 v247, v206, v207
    v_mfma_f32_16x16x32_bf16 v[108:111], v[50:53], v[236:239], v[108:111]
    s_waitcnt lgkmcnt(0)
    v_exp_f32 v208, v208
    v_mfma_f32_16x16x32_bf16 v[96:99], v[50:53], v[240:243], v[96:99]
    v_exp_f32 v209, v209
    v_mfma_f32_16x16x32_bf16 v[100:103], v[50:53], v[244:247], v[100:103]
    v_exp_f32 v210, v210
    v_mfma_f32_16x16x32_bf16 a[0:3], a[160:163], v[240:243], a[0:3]
    buffer_load_dwordx4 a[144:147], v25, s[76:79], s93 offen offset:2048 sc1
    v_mfma_f32_16x16x32_bf16 a[32:35], a[160:163], v[244:247], a[32:35]
    v_exp_f32 v211, v211
    v_mfma_f32_16x16x32_bf16 a[4:7], a[164:167], v[240:243], a[4:7]
    v_exp_f32 v216, v216
    v_mfma_f32_16x16x32_bf16 a[36:39], a[164:167], v[244:247], a[36:39]
    v_cvt_pk_bf16_f32 v248, v208, v209
    v_cvt_pk_bf16_f32 v249, v210, v211
    v_mfma_f32_16x16x32_bf16 a[8:11], a[168:171], v[240:243], a[8:11]
    buffer_load_dwordx4 a[148:151], v25, s[76:79], s28 offen offset:2048 sc1
    v_mfma_f32_16x16x32_bf16 a[40:43], a[168:171], v[244:247], a[40:43]
    v_exp_f32 v217, v217
    v_mfma_f32_16x16x32_bf16 a[12:15], a[172:175], v[240:243], a[12:15]
    v_exp_f32 v218, v218
    v_add_u32 v1, s24, v48
    v_add_u32 v3, s16, v48
    v_add_u32 v2, s24, v49
    v_add_u32 v4, s16, v49
    v_mfma_f32_16x16x32_bf16 a[44:47], a[172:175], v[244:247], a[44:47]
    s_xor_b32 s96, s95, 0x40000
    v_exp_f32 v219, v219
    v_mfma_f32_16x16x32_bf16 a[16:19], a[176:179], v[240:243], a[16:19]
    buffer_load_dwordx4 a[152:155], v25, s[76:79], s93 offen offset:3072 sc1
    v_mfma_f32_16x16x32_bf16 a[48:51], a[176:179], v[244:247], a[48:51]
    v_exp_f32 v212, v212
    v_mfma_f32_16x16x32_bf16 a[20:23], a[180:183], v[240:243], a[20:23]
    v_cvt_pk_bf16_f32 v252, v216, v217
    v_cvt_pk_bf16_f32 v253, v218, v219
    v_mfma_f32_16x16x32_bf16 a[52:55], a[180:183], v[244:247], a[52:55]
    v_exp_f32 v213, v213
    v_mfma_f32_16x16x32_bf16 a[24:27], a[184:187], v[240:243], a[24:27]
    buffer_load_dwordx4 a[156:159], v25, s[76:79], s28 offen offset:3072 sc1
    v_mfma_f32_16x16x32_bf16 a[56:59], a[184:187], v[244:247], a[56:59]
    v_exp_f32 v214, v214
    v_mfma_f32_16x16x32_bf16 a[28:31], a[188:191], v[240:243], a[28:31]
    v_exp_f32 v215, v215
    v_exp_f32 v220, v220
    v_cvt_pk_bf16_f32 v250, v212, v213
    v_cvt_pk_bf16_f32 v251, v214, v215
    v_exp_f32 v221, v221
    v_exp_f32 v222, v222
    v_exp_f32 v223, v223
    v_cvt_pk_bf16_f32 v254, v220, v221
    v_cvt_pk_bf16_f32 v255, v222, v223
    v_mfma_f32_16x16x32_bf16 a[60:63], a[188:191], v[244:247], a[60:63]
    v_mfma_f32_16x16x32_bf16 v[104:107], v[50:53], v[248:251], v[104:107]
    v_subrev_u32 v56, 0x26800000, v96
    v_subrev_u32 v57, 0x26800000, v100
    v_mfma_f32_16x16x32_bf16 v[108:111], v[50:53], v[252:255], v[108:111]
    ds_read_b64_tr_b16 v[192:193], v1 offset:0
    ds_read_b64_tr_b16 v[194:195], v1 offset:1024
    v_mfma_f32_16x16x32_bf16 a[64:67], a[160:163], v[248:251], a[64:67]
    v_subrev_u32 v58, 0x26800000, v104
    v_mfma_f32_16x16x32_bf16 a[96:99], a[160:163], v[252:255], a[96:99]
    s_add_u32 s93, s5, 3
    ds_read_b64_tr_b16 v[196:197], v1 offset:2048
    ds_read_b64_tr_b16 v[198:199], v1 offset:3072
    v_mfma_f32_16x16x32_bf16 a[68:71], a[164:167], v[248:251], a[68:71]
    s_and_b32 s93, s93, 3
    v_subrev_u32 v59, 0x26800000, v108
    v_max_u32 v56, v56, v57
    v_mfma_f32_16x16x32_bf16 a[100:103], a[164:167], v[252:255], a[100:103]
    s_lshl_b32 s93, s93, 12
    ds_read_b64_tr_b16 v[200:201], v1 offset:4096
    ds_read_b64_tr_b16 v[202:203], v1 offset:5120
    v_mfma_f32_16x16x32_bf16 a[72:75], a[168:171], v[248:251], a[72:75]
    s_add_u32 s93, s93, s94
    buffer_load_dwordx4 a[160:163], v25, s[76:79], s93 offen offset:0 sc1
    v_mfma_f32_16x16x32_bf16 a[104:107], a[168:171], v[252:255], a[104:107]
    s_add_u32 s28, s93, 0x4000
    ds_read_b64_tr_b16 v[204:205], v1 offset:6144
    ds_read_b64_tr_b16 v[206:207], v1 offset:7168
    v_mfma_f32_16x16x32_bf16 a[76:79], a[172:175], v[248:251], a[76:79]
    v_max3_u32 v56, v56, v58, v59
    v_mfma_f32_16x16x32_bf16 a[108:111], a[172:175], v[252:255], a[108:111]
    ds_read_b64_tr_b16 v[208:209], v2 offset:0
    ds_read_b64_tr_b16 v[210:211], v2 offset:1024
    v_mfma_f32_16x16x32_bf16 a[80:83], a[176:179], v[248:251], a[80:83]
    buffer_load_dwordx4 a[164:167], v25, s[76:79], s28 offen offset:0 sc1
    v_mfma_f32_16x16x32_bf16 a[112:115], a[176:179], v[252:255], a[112:115]
    ds_read_b64_tr_b16 v[212:213], v2 offset:2048
    ds_read_b64_tr_b16 v[214:215], v2 offset:3072
    v_mfma_f32_16x16x32_bf16 a[84:87], a[180:183], v[248:251], a[84:87]
    v_rcp_f32 v21, v96
    v_mfma_f32_16x16x32_bf16 a[116:119], a[180:183], v[252:255], a[116:119]
    ds_read_b64_tr_b16 v[216:217], v2 offset:4096
    ds_read_b64_tr_b16 v[218:219], v2 offset:5120
    v_mfma_f32_16x16x32_bf16 a[88:91], a[184:187], v[248:251], a[88:91]
    buffer_load_dwordx4 a[168:171], v25, s[76:79], s93 offen offset:1024 sc1
    v_mfma_f32_16x16x32_bf16 a[120:123], a[184:187], v[252:255], a[120:123]
    ds_read_b64_tr_b16 v[220:221], v2 offset:6144
    ds_read_b64_tr_b16 v[222:223], v2 offset:7168
    v_mfma_f32_16x16x32_bf16 a[92:95], a[188:191], v[248:251], a[92:95]
    v_rcp_f32 v22, v100
    v_rcp_f32 v23, v104
    v_rcp_f32 v24, v108
    v_mfma_f32_16x16x32_bf16 a[124:127], a[188:191], v[252:255], a[124:127]
    s_waitcnt vmcnt(35) lgkmcnt(8)
    v_cmp_lt_u32 vcc, 0x32000000, v56
    s_nop 5
    s_cbranch_vccnz L_redo
    L_redo_back:
    v_mfma_f32_16x16x32_bf16 v[112:115], v[50:53], v[192:195], 0
    buffer_load_dwordx4 a[172:175], v25, s[76:79], s28 offen offset:1024 sc1
    v_mfma_f32_16x16x32_bf16 v[112:115], v[50:53], v[196:199], v[112:115]
    v_accvgpr_read_b32 v17, a0
    v_accvgpr_read_b32 v18, a1
    v_mfma_f32_16x16x32_bf16 v[112:115], v[50:53], v[200:203], v[112:115]
    v_mul_f32 v17, v17, v21
    v_mul_f32 v18, v18, v21
    v_mfma_f32_16x16x32_bf16 v[112:115], v[50:53], v[204:207], v[112:115]
    v_cvt_pk_bf16_f32 v128, v17, v18
    v_accvgpr_read_b32 v19, a2
    v_mfma_f32_16x16x32_bf16 v[64:67], v[192:195], a[192:195], 0
    buffer_load_dwordx4 a[176:179], v25, s[76:79], s93 offen offset:2048 sc1
    v_mfma_f32_16x16x32_bf16 v[64:67], v[196:199], a[200:203], v[64:67]
    v_accvgpr_read_b32 v20, a3
    v_mul_f32 v19, v19, v21
    v_mfma_f32_16x16x32_bf16 v[64:67], v[200:203], a[208:211], v[64:67]
    v_mul_f32 v20, v20, v21
    v_cvt_pk_bf16_f32 v129, v19, v20
    v_mfma_f32_16x16x32_bf16 v[64:67], v[204:207], a[216:219], v[64:67]
    v_accvgpr_read_b32 v17, a4
    v_accvgpr_read_b32 v18, a5
    v_mfma_f32_16x16x32_bf16 v[72:75], v[192:195], a[196:199], 0
    buffer_load_dwordx4 a[180:183], v25, s[76:79], s28 offen offset:2048 sc1
    v_mfma_f32_16x16x32_bf16 v[72:75], v[196:199], a[204:207], v[72:75]
    ds_read_b64_tr_b16 v[192:193], v1 offset:32768
    ds_read_b64_tr_b16 v[194:195], v1 offset:33792
    v_mfma_f32_16x16x32_bf16 v[72:75], v[200:203], a[212:215], v[72:75]
    v_mul_f32 v17, v17, v21
    v_mul_f32 v18, v18, v21
    v_mfma_f32_16x16x32_bf16 v[72:75], v[204:207], a[220:223], v[72:75]
    s_waitcnt lgkmcnt(6)
    ds_read_b64_tr_b16 v[196:197], v1 offset:34816
    ds_read_b64_tr_b16 v[198:199], v1 offset:35840
    v_mfma_f32_16x16x32_bf16 v[116:119], v[50:53], v[208:211], 0
    buffer_load_dwordx4 a[184:187], v25, s[76:79], s93 offen offset:3072 sc1
    v_mfma_f32_16x16x32_bf16 v[116:119], v[50:53], v[212:215], v[116:119]
    s_waitcnt lgkmcnt(4)
    ds_read_b64_tr_b16 v[200:201], v1 offset:36864
    ds_read_b64_tr_b16 v[202:203], v1 offset:37888
    v_mfma_f32_16x16x32_bf16 v[116:119], v[50:53], v[216:219], v[116:119]
    v_cvt_pk_bf16_f32 v130, v17, v18
    v_accvgpr_read_b32 v19, a6
    v_mfma_f32_16x16x32_bf16 v[116:119], v[50:53], v[220:223], v[116:119]
    ds_read_b64_tr_b16 v[204:205], v1 offset:38912
    ds_read_b64_tr_b16 v[206:207], v1 offset:39936
    v_mfma_f32_16x16x32_bf16 v[68:71], v[208:211], a[192:195], 0
    buffer_load_dwordx4 a[188:191], v25, s[76:79], s28 offen offset:3072 sc1
    v_mfma_f32_16x16x32_bf16 v[68:71], v[212:215], a[200:203], v[68:71]
    v_accvgpr_read_b32 v20, a7
    v_mul_f32 v19, v19, v21
    v_mfma_f32_16x16x32_bf16 v[68:71], v[216:219], a[208:211], v[68:71]
    v_mul_f32 v20, v20, v21
    v_cvt_pk_bf16_f32 v131, v19, v20
    v_mfma_f32_16x16x32_bf16 v[68:71], v[220:223], a[216:219], v[68:71]
    v_accvgpr_read_b32 v17, a8
    v_accvgpr_read_b32 v18, a9
    v_mfma_f32_16x16x32_bf16 v[76:79], v[208:211], a[196:199], 0
    buffer_store_dwordx4 v[128:131], v25, s[76:79], s95 offen offset:0 sc1
    v_mfma_f32_16x16x32_bf16 v[76:79], v[212:215], a[204:207], v[76:79]
    ds_read_b64_tr_b16 v[208:209], v2 offset:32768
    ds_read_b64_tr_b16 v[210:211], v2 offset:33792
    v_mfma_f32_16x16x32_bf16 v[76:79], v[216:219], a[212:215], v[76:79]
    s_xor_b32 s28, s27, 0x40000
    v_mul_f32 v17, v17, v21
    v_mul_f32 v18, v18, v21
    v_mfma_f32_16x16x32_bf16 v[76:79], v[220:223], a[220:223], v[76:79]
    s_waitcnt lgkmcnt(6)
    ds_read_b64_tr_b16 v[212:213], v2 offset:34816
    ds_read_b64_tr_b16 v[214:215], v2 offset:35840
    v_mfma_f32_16x16x32_bf16 v[120:123], v[50:53], v[192:195], 0
    v_cvt_pk_bf16_f32 v132, v17, v18
    v_accvgpr_read_b32 v19, a10
    v_accvgpr_read_b32 v20, a11
    v_mul_f32 v19, v19, v21
    v_mul_f32 v20, v20, v21
    v_cvt_pk_bf16_f32 v133, v19, v20
    v_accvgpr_read_b32 v17, a12
    v_accvgpr_read_b32 v18, a13
    v_mul_f32 v17, v17, v21
    v_mul_f32 v18, v18, v21
    v_cvt_pk_bf16_f32 v134, v17, v18
    v_accvgpr_read_b32 v19, a14
    v_accvgpr_read_b32 v20, a15
    v_mul_f32 v19, v19, v21
    v_mul_f32 v20, v20, v21
    v_cvt_pk_bf16_f32 v135, v19, v20
    v_mfma_f32_16x16x32_bf16 v[120:123], v[50:53], v[196:199], v[120:123]
    s_waitcnt lgkmcnt(4)
    buffer_store_dwordx4 v[132:135], v25, s[76:79], s95 offen offset:1024 sc1
    ds_read_b64_tr_b16 v[216:217], v2 offset:36864
    ds_read_b64_tr_b16 v[218:219], v2 offset:37888
    v_mfma_f32_16x16x32_bf16 v[120:123], v[50:53], v[200:203], v[120:123]
    v_accvgpr_read_b32 v17, a16
    v_accvgpr_read_b32 v18, a17
    v_mfma_f32_16x16x32_bf16 v[120:123], v[50:53], v[204:207], v[120:123]
    ds_read_b64_tr_b16 v[220:221], v2 offset:38912
    ds_read_b64_tr_b16 v[222:223], v2 offset:39936
    v_mfma_f32_16x16x32_bf16 v[80:83], v[192:195], a[192:195], 0
    v_mul_f32 v17, v17, v21
    v_mul_f32 v18, v18, v21
    v_mfma_f32_16x16x32_bf16 v[80:83], v[196:199], a[200:203], v[80:83]
    v_cvt_pk_bf16_f32 v136, v17, v18
    v_accvgpr_read_b32 v19, a18
    v_mfma_f32_16x16x32_bf16 v[80:83], v[200:203], a[208:211], v[80:83]
    v_accvgpr_read_b32 v20, a19
    v_mul_f32 v19, v19, v21
    v_mfma_f32_16x16x32_bf16 v[80:83], v[204:207], a[216:219], v[80:83]
    v_mul_f32 v20, v20, v21
    v_cvt_pk_bf16_f32 v137, v19, v20
    v_mfma_f32_16x16x32_bf16 v[88:91], v[192:195], a[196:199], 0
    v_accvgpr_read_b32 v17, a20
    v_accvgpr_read_b32 v18, a21
    v_mul_f32 v17, v17, v21
    v_mul_f32 v18, v18, v21
    v_cvt_pk_bf16_f32 v138, v17, v18
    v_accvgpr_read_b32 v19, a22
    v_accvgpr_read_b32 v20, a23
    v_mul_f32 v19, v19, v21
    v_mul_f32 v20, v20, v21
    v_cvt_pk_bf16_f32 v139, v19, v20
    v_mfma_f32_16x16x32_bf16 v[88:91], v[196:199], a[204:207], v[88:91]
    buffer_store_dwordx4 v[136:139], v25, s[76:79], s95 offen offset:2048 sc1
    ds_read_b64_tr_b16 v[192:193], v3 offset:0
    ds_read_b64_tr_b16 v[194:195], v3 offset:1024
    v_mfma_f32_16x16x32_bf16 v[88:91], v[200:203], a[212:215], v[88:91]
    v_accvgpr_read_b32 v17, a24
    v_accvgpr_read_b32 v18, a25
    v_mfma_f32_16x16x32_bf16 v[88:91], v[204:207], a[220:223], v[88:91]
    s_waitcnt lgkmcnt(6)
    ds_read_b64_tr_b16 v[196:197], v3 offset:2048
    ds_read_b64_tr_b16 v[198:199], v3 offset:3072
    v_mfma_f32_16x16x32_bf16 v[124:127], v[50:53], v[208:211], 0
    v_mul_f32 v17, v17, v21
    v_mul_f32 v18, v18, v21
    v_mfma_f32_16x16x32_bf16 v[124:127], v[50:53], v[212:215], v[124:127]
    s_waitcnt lgkmcnt(4)
    ds_read_b64_tr_b16 v[200:201], v3 offset:4096
    ds_read_b64_tr_b16 v[202:203], v3 offset:5120
    v_mfma_f32_16x16x32_bf16 v[124:127], v[50:53], v[216:219], v[124:127]
    v_cvt_pk_bf16_f32 v140, v17, v18
    v_accvgpr_read_b32 v19, a26
    v_accvgpr_read_b32 v20, a27
    v_mul_f32 v19, v19, v21
    v_mul_f32 v20, v20, v21
    v_cvt_pk_bf16_f32 v141, v19, v20
    v_accvgpr_read_b32 v17, a28
    v_accvgpr_read_b32 v18, a29
    v_mul_f32 v17, v17, v21
    v_mul_f32 v18, v18, v21
    v_cvt_pk_bf16_f32 v142, v17, v18
    v_accvgpr_read_b32 v19, a30
    v_accvgpr_read_b32 v20, a31
    v_mul_f32 v19, v19, v21
    v_mul_f32 v20, v20, v21
    v_cvt_pk_bf16_f32 v143, v19, v20
    v_mfma_f32_16x16x32_bf16 v[124:127], v[50:53], v[220:223], v[124:127]
    buffer_store_dwordx4 v[140:143], v25, s[76:79], s95 offen offset:3072 sc1
    ds_read_b64_tr_b16 v[204:205], v3 offset:6144
    ds_read_b64_tr_b16 v[206:207], v3 offset:7168
    v_mfma_f32_16x16x32_bf16 v[84:87], v[208:211], a[192:195], 0
    v_accvgpr_read_b32 v17, a32
    v_accvgpr_read_b32 v18, a33
    v_mfma_f32_16x16x32_bf16 v[84:87], v[212:215], a[200:203], v[84:87]
    v_mul_f32 v17, v17, v22
    v_mul_f32 v18, v18, v22
    v_mfma_f32_16x16x32_bf16 v[84:87], v[216:219], a[208:211], v[84:87]
    v_cvt_pk_bf16_f32 v144, v17, v18
    v_accvgpr_read_b32 v19, a34
    v_mfma_f32_16x16x32_bf16 v[84:87], v[220:223], a[216:219], v[84:87]
    v_accvgpr_read_b32 v20, a35
    v_mul_f32 v19, v19, v22
    v_mfma_f32_16x16x32_bf16 v[92:95], v[208:211], a[196:199], 0
    v_mul_f32 v20, v20, v22
    v_cvt_pk_bf16_f32 v145, v19, v20
    v_mfma_f32_16x16x32_bf16 v[92:95], v[212:215], a[204:207], v[92:95]
    ds_read_b64_tr_b16 v[208:209], v4 offset:0
    ds_read_b64_tr_b16 v[210:211], v4 offset:1024
    v_mfma_f32_16x16x32_bf16 v[92:95], v[216:219], a[212:215], v[92:95]
    v_accvgpr_read_b32 v17, a36
    v_accvgpr_read_b32 v18, a37
    v_mfma_f32_16x16x32_bf16 v[92:95], v[220:223], a[220:223], v[92:95]
    s_waitcnt lgkmcnt(6)
    ds_read_b64_tr_b16 v[212:213], v4 offset:2048
    ds_read_b64_tr_b16 v[214:215], v4 offset:3072
    v_mfma_f32_16x16x32_bf16 v[224:227], v[50:53], v[192:195], 0
    s_add_u32 s24, s5, 1
    v_mul_f32 v17, v17, v22
    v_mul_f32 v18, v18, v22
    v_cvt_pk_bf16_f32 v146, v17, v18
    v_accvgpr_read_b32 v19, a38
    v_accvgpr_read_b32 v20, a39
    v_mul_f32 v19, v19, v22
    v_mul_f32 v20, v20, v22
    v_cvt_pk_bf16_f32 v147, v19, v20
    v_mfma_f32_16x16x32_bf16 v[224:227], v[50:53], v[196:199], v[224:227]
    s_waitcnt lgkmcnt(4)
    buffer_store_dwordx4 v[144:147], v25, s[76:79], s27 offen offset:0 sc1
    ds_read_b64_tr_b16 v[216:217], v4 offset:4096
    ds_read_b64_tr_b16 v[218:219], v4 offset:5120
    s_and_b32 s24, s24, 3
    v_mfma_f32_16x16x32_bf16 v[224:227], v[50:53], v[200:203], v[224:227]
    s_lshl_b32 s24, s24, 13
    v_accvgpr_read_b32 v17, a40
    v_accvgpr_read_b32 v18, a41
    v_mfma_f32_16x16x32_bf16 v[224:227], v[50:53], v[204:207], v[224:227]
    s_sub_u32 s25, s24, 98304
    ds_read_b64_tr_b16 v[220:221], v4 offset:6144
    ds_read_b64_tr_b16 v[222:223], v4 offset:7168
    v_mfma_f32_16x16x32_bf16 v[96:99], v[192:195], a[192:195], 0
    v_add_u32 v5, s25, v48
    v_add_u32 v7, s24, v48
    v_mfma_f32_16x16x32_bf16 v[96:99], v[196:199], a[200:203], v[96:99]
    v_mul_f32 v17, v17, v22
    v_mul_f32 v18, v18, v22
    v_mfma_f32_16x16x32_bf16 v[96:99], v[200:203], a[208:211], v[96:99]
    v_cvt_pk_bf16_f32 v148, v17, v18
    v_accvgpr_read_b32 v19, a42
    v_accvgpr_read_b32 v20, a43
    v_mul_f32 v19, v19, v22
    v_mul_f32 v20, v20, v22
    v_cvt_pk_bf16_f32 v149, v19, v20
    v_accvgpr_read_b32 v17, a44
    v_accvgpr_read_b32 v18, a45
    v_mul_f32 v17, v17, v22
    v_mul_f32 v18, v18, v22
    v_cvt_pk_bf16_f32 v150, v17, v18
    v_accvgpr_read_b32 v19, a46
    v_accvgpr_read_b32 v20, a47
    v_mul_f32 v19, v19, v22
    v_mul_f32 v20, v20, v22
    v_cvt_pk_bf16_f32 v151, v19, v20
    v_add_u32 v6, s25, v49
    v_add_u32 v8, s24, v49
    v_mfma_f32_16x16x32_bf16 v[96:99], v[204:207], a[216:219], v[96:99]
    buffer_store_dwordx4 v[148:151], v25, s[76:79], s27 offen offset:1024 sc1
    v_mfma_f32_16x16x32_bf16 v[104:107], v[192:195], a[196:199], 0
    v_accvgpr_read_b32 v17, a48
    v_accvgpr_read_b32 v18, a49
    v_mfma_f32_16x16x32_bf16 v[104:107], v[196:199], a[204:207], v[104:107]
    ds_read_b64_tr_b16 v[192:193], v5 offset:0
    ds_read_b64_tr_b16 v[194:195], v5 offset:1024
    v_mfma_f32_16x16x32_bf16 v[104:107], v[200:203], a[212:215], v[104:107]
    v_mul_f32 v17, v17, v22
    v_mul_f32 v18, v18, v22
    v_mfma_f32_16x16x32_bf16 v[104:107], v[204:207], a[220:223], v[104:107]
    s_waitcnt lgkmcnt(6)
    ds_read_b64_tr_b16 v[196:197], v5 offset:2048
    ds_read_b64_tr_b16 v[198:199], v5 offset:3072
    v_mfma_f32_16x16x32_bf16 v[228:231], v[50:53], v[208:211], 0
    v_cvt_pk_bf16_f32 v152, v17, v18
    v_accvgpr_read_b32 v19, a50
    v_mfma_f32_16x16x32_bf16 v[228:231], v[50:53], v[212:215], v[228:231]
    s_waitcnt lgkmcnt(4)
    ds_read_b64_tr_b16 v[200:201], v5 offset:4096
    ds_read_b64_tr_b16 v[202:203], v5 offset:5120
    v_mfma_f32_16x16x32_bf16 v[228:231], v[50:53], v[216:219], v[228:231]
    v_accvgpr_read_b32 v20, a51
    v_mul_f32 v19, v19, v22
    v_mfma_f32_16x16x32_bf16 v[228:231], v[50:53], v[220:223], v[228:231]
    ds_read_b64_tr_b16 v[204:205], v5 offset:6144
    ds_read_b64_tr_b16 v[206:207], v5 offset:7168
    v_mfma_f32_16x16x32_bf16 v[100:103], v[208:211], a[192:195], 0
    v_mul_f32 v20, v20, v22
    v_cvt_pk_bf16_f32 v153, v19, v20
    v_mfma_f32_16x16x32_bf16 v[100:103], v[212:215], a[200:203], v[100:103]
    v_accvgpr_read_b32 v17, a52
    v_accvgpr_read_b32 v18, a53
    v_mul_f32 v17, v17, v22
    v_mul_f32 v18, v18, v22
    v_cvt_pk_bf16_f32 v154, v17, v18
    v_accvgpr_read_b32 v19, a54
    v_accvgpr_read_b32 v20, a55
    v_mul_f32 v19, v19, v22
    v_mul_f32 v20, v20, v22
    v_cvt_pk_bf16_f32 v155, v19, v20
    v_mfma_f32_16x16x32_bf16 v[100:103], v[216:219], a[208:211], v[100:103]
    buffer_store_dwordx4 v[152:155], v25, s[76:79], s27 offen offset:2048 sc1
    v_mfma_f32_16x16x32_bf16 v[100:103], v[220:223], a[216:219], v[100:103]
    v_accvgpr_read_b32 v17, a56
    v_accvgpr_read_b32 v18, a57
    v_mfma_f32_16x16x32_bf16 v[108:111], v[208:211], a[196:199], 0
    v_mul_f32 v17, v17, v22
    v_mul_f32 v18, v18, v22
    v_mfma_f32_16x16x32_bf16 v[108:111], v[212:215], a[204:207], v[108:111]
    ds_read_b64_tr_b16 v[208:209], v6 offset:0
    ds_read_b64_tr_b16 v[210:211], v6 offset:1024
    v_mfma_f32_16x16x32_bf16 v[108:111], v[216:219], a[212:215], v[108:111]
    v_cvt_pk_bf16_f32 v156, v17, v18
    v_accvgpr_read_b32 v19, a58
    v_mfma_f32_16x16x32_bf16 v[108:111], v[220:223], a[220:223], v[108:111]
    s_waitcnt vmcnt(39) lgkmcnt(6)
    ds_read_b64_tr_b16 v[212:213], v6 offset:2048
    ds_read_b64_tr_b16 v[214:215], v6 offset:3072
    v_accvgpr_read_b32 v20, a59
    v_mul_f32 v19, v19, v22
    v_mul_f32 v20, v20, v22
    v_cvt_pk_bf16_f32 v157, v19, v20
    v_accvgpr_read_b32 v17, a60
    v_accvgpr_read_b32 v18, a61
    v_mul_f32 v17, v17, v22
    v_mul_f32 v18, v18, v22
    v_cvt_pk_bf16_f32 v158, v17, v18
    v_accvgpr_read_b32 v19, a62
    v_accvgpr_read_b32 v20, a63
    v_mul_f32 v19, v19, v22
    v_mul_f32 v20, v20, v22
    v_cvt_pk_bf16_f32 v159, v19, v20
    v_mfma_f32_16x16x32_bf16 v[64:67], v[192:195], a[224:227], v[64:67]
    buffer_store_dwordx4 v[156:159], v25, s[76:79], s27 offen offset:3072 sc1
    v_mfma_f32_16x16x32_bf16 v[64:67], v[196:199], a[232:235], v[64:67]
    s_waitcnt lgkmcnt(4)
    ds_read_b64_tr_b16 v[216:217], v6 offset:4096
    ds_read_b64_tr_b16 v[218:219], v6 offset:5120
    v_mfma_f32_16x16x32_bf16 v[64:67], v[200:203], a[240:243], v[64:67]
    v_accvgpr_read_b32 v17, a64
    v_accvgpr_read_b32 v18, a65
    v_mfma_f32_16x16x32_bf16 v[64:67], v[204:207], a[248:251], v[64:67]
    ds_read_b64_tr_b16 v[220:221], v6 offset:6144
    ds_read_b64_tr_b16 v[222:223], v6 offset:7168
    v_mfma_f32_16x16x32_bf16 v[72:75], v[192:195], a[228:231], v[72:75]
    v_mul_f32 v17, v17, v23
    v_mul_f32 v18, v18, v23
    v_mfma_f32_16x16x32_bf16 v[72:75], v[196:199], a[236:239], v[72:75]
    ds_read_b64_tr_b16 v[192:193], v5 offset:32768
    ds_read_b64_tr_b16 v[194:195], v5 offset:33792
    v_mfma_f32_16x16x32_bf16 v[72:75], v[200:203], a[244:247], v[72:75]
    v_cvt_pk_bf16_f32 v160, v17, v18
    v_accvgpr_read_b32 v19, a66
    v_mfma_f32_16x16x32_bf16 v[72:75], v[204:207], a[252:255], v[72:75]
    s_waitcnt lgkmcnt(6)
    ds_read_b64_tr_b16 v[196:197], v5 offset:34816
    ds_read_b64_tr_b16 v[198:199], v5 offset:35840
    v_mfma_f32_16x16x32_bf16 v[68:71], v[208:211], a[224:227], v[68:71]
    v_accvgpr_read_b32 v20, a67
    v_mul_f32 v19, v19, v23
    v_mfma_f32_16x16x32_bf16 v[68:71], v[212:215], a[232:235], v[68:71]
    s_waitcnt lgkmcnt(4)
    ds_read_b64_tr_b16 v[200:201], v5 offset:36864
    ds_read_b64_tr_b16 v[202:203], v5 offset:37888
    v_mfma_f32_16x16x32_bf16 v[68:71], v[216:219], a[240:243], v[68:71]
    v_mul_f32 v20, v20, v23
    v_cvt_pk_bf16_f32 v161, v19, v20
    v_mfma_f32_16x16x32_bf16 v[68:71], v[220:223], a[248:251], v[68:71]
    ds_read_b64_tr_b16 v[204:205], v5 offset:38912
    ds_read_b64_tr_b16 v[206:207], v5 offset:39936
    v_mfma_f32_16x16x32_bf16 v[76:79], v[208:211], a[228:231], v[76:79]
    ds_write_b32 v55, v112 offset:0
    v_mfma_f32_16x16x32_bf16 v[76:79], v[212:215], a[236:239], v[76:79]
    ds_read_b64_tr_b16 v[208:209], v6 offset:32768
    ds_read_b64_tr_b16 v[210:211], v6 offset:33792
    v_mfma_f32_16x16x32_bf16 v[76:79], v[216:219], a[244:247], v[76:79]
    ds_write_b32 v55, v116 offset:256
    v_mfma_f32_16x16x32_bf16 v[76:79], v[220:223], a[252:255], v[76:79]
    s_waitcnt lgkmcnt(8)
    ds_read_b64_tr_b16 v[212:213], v6 offset:34816
    ds_read_b64_tr_b16 v[214:215], v6 offset:35840
    v_mfma_f32_16x16x32_bf16 v[80:83], v[192:195], a[224:227], v[80:83]
    ds_write_b32 v55, v120 offset:512
    v_mfma_f32_16x16x32_bf16 v[80:83], v[196:199], a[232:235], v[80:83]
    s_waitcnt lgkmcnt(7)
    ds_read_b64_tr_b16 v[216:217], v6 offset:36864
    ds_read_b64_tr_b16 v[218:219], v6 offset:37888
    v_mfma_f32_16x16x32_bf16 v[80:83], v[200:203], a[240:243], v[80:83]
    ds_write_b32 v55, v124 offset:768
    v_mfma_f32_16x16x32_bf16 v[80:83], v[204:207], a[248:251], v[80:83]
    ds_read_b64_tr_b16 v[220:221], v6 offset:38912
    ds_read_b64_tr_b16 v[222:223], v6 offset:39936
    v_mfma_f32_16x16x32_bf16 v[88:91], v[192:195], a[228:231], v[88:91]
    ds_write_b32 v55, v224 offset:1024
    v_mfma_f32_16x16x32_bf16 v[88:91], v[196:199], a[236:239], v[88:91]
    ds_read_b64_tr_b16 v[192:193], v7 offset:0
    ds_read_b64_tr_b16 v[194:195], v7 offset:1024
    v_mfma_f32_16x16x32_bf16 v[88:91], v[200:203], a[244:247], v[88:91]
    ds_write_b32 v55, v228 offset:1280
    v_mfma_f32_16x16x32_bf16 v[88:91], v[204:207], a[252:255], v[88:91]
    s_waitcnt lgkmcnt(10)
    ds_read_b64_tr_b16 v[196:197], v7 offset:2048
    ds_read_b64_tr_b16 v[198:199], v7 offset:3072
    v_mfma_f32_16x16x32_bf16 v[84:87], v[208:211], a[224:227], v[84:87]
    v_accvgpr_read_b32 v17, a68
    v_accvgpr_read_b32 v18, a69
    v_mfma_f32_16x16x32_bf16 v[84:87], v[212:215], a[232:235], v[84:87]
    s_waitcnt lgkmcnt(6)
    ds_read_b64_tr_b16 v[200:201], v7 offset:4096
    ds_read_b64_tr_b16 v[202:203], v7 offset:5120
    v_mfma_f32_16x16x32_bf16 v[84:87], v[216:219], a[240:243], v[84:87]
    v_mul_f32 v17, v17, v23
    v_mul_f32 v18, v18, v23
    v_mfma_f32_16x16x32_bf16 v[84:87], v[220:223], a[248:251], v[84:87]
    ds_read_b64_tr_b16 v[204:205], v7 offset:6144
    ds_read_b64_tr_b16 v[206:207], v7 offset:7168
    v_cvt_pk_bf16_f32 v162, v17, v18
    v_accvgpr_read_b32 v19, a70
    v_accvgpr_read_b32 v20, a71
    v_mul_f32 v19, v19, v23
    v_mul_f32 v20, v20, v23
    v_cvt_pk_bf16_f32 v163, v19, v20
    v_mfma_f32_16x16x32_bf16 v[92:95], v[208:211], a[228:231], v[92:95]
    s_add_u32 s24, s5, 2
    buffer_store_dwordx4 v[160:163], v25, s[76:79], s96 offen offset:0 sc1
    v_mfma_f32_16x16x32_bf16 v[92:95], v[212:215], a[236:239], v[92:95]
    s_and_b32 s24, s24, 3
    ds_read_b64_tr_b16 v[208:209], v8 offset:0
    ds_read_b64_tr_b16 v[210:211], v8 offset:1024
    v_mfma_f32_16x16x32_bf16 v[92:95], v[216:219], a[244:247], v[92:95]
    s_lshl_b32 s24, s24, 13
    v_accvgpr_read_b32 v17, a72
    v_accvgpr_read_b32 v18, a73
    v_mfma_f32_16x16x32_bf16 v[92:95], v[220:223], a[252:255], v[92:95]
    s_waitcnt lgkmcnt(6)
    ds_read_b64_tr_b16 v[212:213], v8 offset:2048
    ds_read_b64_tr_b16 v[214:215], v8 offset:3072
    s_sub_u32 s25, s24, 98304
    v_mfma_f32_16x16x32_bf16 v[96:99], v[192:195], a[224:227], v[96:99]
    v_add_u32 v1, s25, v48
    v_add_u32 v3, s24, v48
    v_mfma_f32_16x16x32_bf16 v[96:99], v[196:199], a[232:235], v[96:99]
    s_waitcnt lgkmcnt(4)
    ds_read_b64_tr_b16 v[216:217], v8 offset:4096
    ds_read_b64_tr_b16 v[218:219], v8 offset:5120
    v_mfma_f32_16x16x32_bf16 v[96:99], v[200:203], a[240:243], v[96:99]
    v_add_u32 v2, s25, v49
    v_add_u32 v4, s24, v49
    v_mfma_f32_16x16x32_bf16 v[96:99], v[204:207], a[248:251], v[96:99]
    ds_read_b64_tr_b16 v[220:221], v8 offset:6144
    ds_read_b64_tr_b16 v[222:223], v8 offset:7168
    v_mfma_f32_16x16x32_bf16 v[104:107], v[192:195], a[228:231], v[104:107]
    s_waitcnt vmcnt(22)
    s_barrier
    v_mfma_f32_16x16x32_bf16 v[104:107], v[196:199], a[236:239], v[104:107]
    ds_read_b64_tr_b16 v[192:193], v1 offset:0
    ds_read_b64_tr_b16 v[194:195], v1 offset:1024
    v_mfma_f32_16x16x32_bf16 v[104:107], v[200:203], a[244:247], v[104:107]
    ds_read_b128 v[232:235], v54 offset:0
    ds_read_b128 v[236:239], v54 offset:256
    v_mfma_f32_16x16x32_bf16 v[104:107], v[204:207], a[252:255], v[104:107]
    s_waitcnt lgkmcnt(8)
    ds_read_b64_tr_b16 v[196:197], v1 offset:2048
    ds_read_b64_tr_b16 v[198:199], v1 offset:3072
    v_mfma_f32_16x16x32_bf16 v[100:103], v[208:211], a[224:227], v[100:103]
    ds_read_b128 v[240:243], v54 offset:512
    ds_read_b128 v[244:247], v54 offset:768
    v_mul_f32 v17, v17, v23
    v_mul_f32 v18, v18, v23
    v_cvt_pk_bf16_f32 v164, v17, v18
    v_accvgpr_read_b32 v19, a74
    v_accvgpr_read_b32 v20, a75
    v_mul_f32 v19, v19, v23
L_warm0_9:
    s_cbranch_execz L_warm0_10
    v_mul_f32 v20, v20, v23
    v_cvt_pk_bf16_f32 v165, v19, v20
    v_accvgpr_read_b32 v17, a76
    v_accvgpr_read_b32 v18, a77
    v_mul_f32 v17, v17, v23
    v_mul_f32 v18, v18, v23
    v_cvt_pk_bf16_f32 v166, v17, v18
    v_accvgpr_read_b32 v19, a78
    v_accvgpr_read_b32 v20, a79
    v_mul_f32 v19, v19, v23
    v_mul_f32 v20, v20, v23
    v_cvt_pk_bf16_f32 v167, v19, v20
    v_mfma_f32_16x16x32_bf16 v[100:103], v[212:215], a[232:235], v[100:103]
    s_waitcnt lgkmcnt(8)
    buffer_store_dwordx4 v[164:167], v25, s[76:79], s96 offen offset:1024 sc1
    ds_read_b64_tr_b16 v[200:201], v1 offset:4096
    ds_read_b64_tr_b16 v[202:203], v1 offset:5120
    v_mfma_f32_16x16x32_bf16 v[100:103], v[216:219], a[240:243], v[100:103]
    ds_read_b128 v[248:251], v54 offset:1024
    ds_read_b128 v[252:255], v54 offset:1280
    v_mfma_f32_16x16x32_bf16 v[100:103], v[220:223], a[248:251], v[100:103]
    ds_read_b64_tr_b16 v[204:205], v1 offset:6144
    ds_read_b64_tr_b16 v[206:207], v1 offset:7168
    v_mfma_f32_16x16x32_bf16 v[108:111], v[208:211], a[228:231], v[108:111]
    v_accvgpr_read_b32 v17, a80
    v_accvgpr_read_b32 v18, a81
    v_mfma_f32_16x16x32_bf16 v[108:111], v[212:215], a[236:239], v[108:111]
    ds_read_b64_tr_b16 v[208:209], v2 offset:0
    ds_read_b64_tr_b16 v[210:211], v2 offset:1024
    v_mfma_f32_16x16x32_bf16 v[108:111], v[216:219], a[244:247], v[108:111]
    v_mul_f32 v17, v17, v23
    v_mul_f32 v18, v18, v23
    v_mfma_f32_16x16x32_bf16 v[108:111], v[220:223], a[252:255], v[108:111]
    s_waitcnt vmcnt(18) lgkmcnt(10)
    ds_read_b64_tr_b16 v[212:213], v2 offset:2048
    ds_read_b64_tr_b16 v[214:215], v2 offset:3072
    v_mfma_f32_16x16x32_bf16 v[64:67], v[192:195], a[128:131], v[64:67]
    v_cvt_pk_bf16_f32 v168, v17, v18
    v_accvgpr_read_b32 v19, a82
    v_mfma_f32_16x16x32_bf16 v[64:67], v[196:199], a[136:139], v[64:67]
    s_waitcnt lgkmcnt(4)
    ds_read_b64_tr_b16 v[216:217], v2 offset:4096
    ds_read_b64_tr_b16 v[218:219], v2 offset:5120
    v_mfma_f32_16x16x32_bf16 v[64:67], v[200:203], a[144:147], v[64:67]
    v_accvgpr_read_b32 v20, a83
    v_mul_f32 v19, v19, v23
    v_mfma_f32_16x16x32_bf16 v[64:67], v[204:207], a[152:155], v[64:67]
    ds_read_b64_tr_b16 v[220:221], v2 offset:6144
    ds_read_b64_tr_b16 v[222:223], v2 offset:7168
    v_mfma_f32_16x16x32_bf16 v[72:75], v[192:195], a[132:135], v[72:75]
    v_mul_f32 v20, v20, v23
    v_cvt_pk_bf16_f32 v169, v19, v20
    v_mfma_f32_16x16x32_bf16 v[72:75], v[196:199], a[140:143], v[72:75]
    ds_read_b64_tr_b16 v[192:193], v1 offset:32768
    ds_read_b64_tr_b16 v[194:195], v1 offset:33792
    v_accvgpr_read_b32 v17, a84
    v_accvgpr_read_b32 v18, a85
    v_mul_f32 v17, v17, v23
    v_mul_f32 v18, v18, v23
    v_cvt_pk_bf16_f32 v170, v17, v18
    v_accvgpr_read_b32 v19, a86
    v_accvgpr_read_b32 v20, a87
    v_mul_f32 v19, v19, v23
    v_mul_f32 v20, v20, v23
    v_cvt_pk_bf16_f32 v171, v19, v20
    v_mfma_f32_16x16x32_bf16 v[72:75], v[200:203], a[148:151], v[72:75]
    buffer_store_dwordx4 v[168:171], v25, s[76:79], s96 offen offset:2048 sc1
    v_mfma_f32_16x16x32_bf16 v[72:75], v[204:207], a[156:159], v[72:75]
    s_waitcnt lgkmcnt(6)
    ds_read_b64_tr_b16 v[196:197], v1 offset:34816
    ds_read_b64_tr_b16 v[198:199], v1 offset:35840
    v_mfma_f32_16x16x32_bf16 v[68:71], v[208:211], a[128:131], v[68:71]
    v_accvgpr_read_b32 v17, a88
    v_accvgpr_read_b32 v18, a89
    v_mfma_f32_16x16x32_bf16 v[68:71], v[212:215], a[136:139], v[68:71]
    s_waitcnt lgkmcnt(4)
    ds_read_b64_tr_b16 v[200:201], v1 offset:36864
    ds_read_b64_tr_b16 v[202:203], v1 offset:37888
    v_mfma_f32_16x16x32_bf16 v[68:71], v[216:219], a[144:147], v[68:71]
    v_mul_f32 v17, v17, v23
    v_mul_f32 v18, v18, v23
    v_mfma_f32_16x16x32_bf16 v[68:71], v[220:223], a[152:155], v[68:71]
    ds_read_b64_tr_b16 v[204:205], v1 offset:38912
    ds_read_b64_tr_b16 v[206:207], v1 offset:39936
    v_mfma_f32_16x16x32_bf16 v[76:79], v[208:211], a[132:135], v[76:79]
    v_cvt_pk_bf16_f32 v172, v17, v18
    v_accvgpr_read_b32 v19, a90
    v_mfma_f32_16x16x32_bf16 v[76:79], v[212:215], a[140:143], v[76:79]
    ds_read_b64_tr_b16 v[208:209], v2 offset:32768
    ds_read_b64_tr_b16 v[210:211], v2 offset:33792
    v_mfma_f32_16x16x32_bf16 v[76:79], v[216:219], a[148:151], v[76:79]
    v_accvgpr_read_b32 v20, a91
    v_mul_f32 v19, v19, v23
    v_mfma_f32_16x16x32_bf16 v[76:79], v[220:223], a[156:159], v[76:79]
    s_waitcnt lgkmcnt(6)
    ds_read_b64_tr_b16 v[212:213], v2 offset:34816
    ds_read_b64_tr_b16 v[214:215], v2 offset:35840
    v_mfma_f32_16x16x32_bf16 v[80:83], v[192:195], a[128:131], v[80:83]
    v_mul_f32 v20, v20, v23
    v_cvt_pk_bf16_f32 v173, v19, v20
    v_mfma_f32_16x16x32_bf16 v[80:83], v[196:199], a[136:139], v[80:83]
    s_waitcnt lgkmcnt(4)
    ds_read_b64_tr_b16 v[216:217], v2 offset:36864
    ds_read_b64_tr_b16 v[218:219], v2 offset:37888
    v_mfma_f32_16x16x32_bf16 v[80:83], v[200:203], a[144:147], v[80:83]
    v_accvgpr_read_b32 v17, a92
    v_accvgpr_read_b32 v18, a93
    v_mul_f32 v17, v17, v23
    v_mul_f32 v18, v18, v23
    v_cvt_pk_bf16_f32 v174, v17, v18
    v_accvgpr_read_b32 v19, a94
    v_accvgpr_read_b32 v20, a95
    v_mul_f32 v19, v19, v23
    v_mul_f32 v20, v20, v23
    v_cvt_pk_bf16_f32 v175, v19, v20
    v_mfma_f32_16x16x32_bf16 v[80:83], v[204:207], a[152:155], v[80:83]
    buffer_store_dwordx4 v[172:175], v25, s[76:79], s96 offen offset:3072 sc1
    ds_read_b64_tr_b16 v[220:221], v2 offset:38912
    ds_read_b64_tr_b16 v[222:223], v2 offset:39936
    v_mfma_f32_16x16x32_bf16 v[88:91], v[192:195], a[132:135], v[88:91]
    v_accvgpr_read_b32 v17, a96
    v_accvgpr_read_b32 v18, a97
    v_mfma_f32_16x16x32_bf16 v[88:91], v[196:199], a[140:143], v[88:91]
    ds_read_b64_tr_b16 v[192:193], v3 offset:0
    ds_read_b64_tr_b16 v[194:195], v3 offset:1024
    v_mfma_f32_16x16x32_bf16 v[88:91], v[200:203], a[148:151], v[88:91]
    v_mul_f32 v17, v17, v24
    v_mul_f32 v18, v18, v24
    v_mfma_f32_16x16x32_bf16 v[88:91], v[204:207], a[156:159], v[88:91]
    s_waitcnt lgkmcnt(6)
    ds_read_b64_tr_b16 v[196:197], v3 offset:2048
    ds_read_b64_tr_b16 v[198:199], v3 offset:3072
    v_mfma_f32_16x16x32_bf16 v[84:87], v[208:211], a[128:131], v[84:87]
    v_cvt_pk_bf16_f32 v176, v17, v18
    v_accvgpr_read_b32 v19, a98
    v_mfma_f32_16x16x32_bf16 v[84:87], v[212:215], a[136:139], v[84:87]
    s_waitcnt lgkmcnt(4)
    ds_read_b64_tr_b16 v[200:201], v3 offset:4096
    ds_read_b64_tr_b16 v[202:203], v3 offset:5120
    v_mfma_f32_16x16x32_bf16 v[84:87], v[216:219], a[144:147], v[84:87]
    v_accvgpr_read_b32 v20, a99
    v_mul_f32 v19, v19, v24
    v_mfma_f32_16x16x32_bf16 v[84:87], v[220:223], a[152:155], v[84:87]
    ds_read_b64_tr_b16 v[204:205], v3 offset:6144
    ds_read_b64_tr_b16 v[206:207], v3 offset:7168
    v_mfma_f32_16x16x32_bf16 v[92:95], v[208:211], a[132:135], v[92:95]
    s_add_u32 s24, s5, 3
    v_mul_f32 v20, v20, v24
    v_cvt_pk_bf16_f32 v177, v19, v20
    v_mfma_f32_16x16x32_bf16 v[92:95], v[212:215], a[140:143], v[92:95]
    s_and_b32 s24, s24, 3
    ds_read_b64_tr_b16 v[208:209], v4 offset:0
    ds_read_b64_tr_b16 v[210:211], v4 offset:1024
    v_mfma_f32_16x16x32_bf16 v[92:95], v[216:219], a[148:151], v[92:95]
    s_lshl_b32 s24, s24, 13
    v_accvgpr_read_b32 v17, a100
    v_accvgpr_read_b32 v18, a101
    v_mfma_f32_16x16x32_bf16 v[92:95], v[220:223], a[156:159], v[92:95]
    s_waitcnt lgkmcnt(6)
    ds_read_b64_tr_b16 v[212:213], v4 offset:2048
    ds_read_b64_tr_b16 v[214:215], v4 offset:3072
    s_sub_u32 s25, s24, 98304
    v_mul_f32 v17, v17, v24
    v_mul_f32 v18, v18, v24
    v_cvt_pk_bf16_f32 v178, v17, v18
    v_accvgpr_read_b32 v19, a102
    v_accvgpr_read_b32 v20, a103
    v_mul_f32 v19, v19, v24
    v_mul_f32 v20, v20, v24
    v_cvt_pk_bf16_f32 v179, v19, v20
    v_mfma_f32_16x16x32_bf16 v[96:99], v[192:195], a[128:131], v[96:99]
    buffer_store_dwordx4 v[176:179], v25, s[76:79], s28 offen offset:0 sc1
    v_add_u32 v5, s25, v48
    v_add_u32 v7, s24, v48
    v_mfma_f32_16x16x32_bf16 v[96:99], v[196:199], a[136:139], v[96:99]
    s_waitcnt lgkmcnt(4)
    ds_read_b64_tr_b16 v[216:217], v4 offset:4096
    ds_read_b64_tr_b16 v[218:219], v4 offset:5120
    v_mfma_f32_16x16x32_bf16 v[96:99], v[200:203], a[144:147], v[96:99]
    v_add_u32 v6, s25, v49
    v_add_u32 v8, s24, v49
    v_mfma_f32_16x16x32_bf16 v[96:99], v[204:207], a[152:155], v[96:99]
    ds_read_b64_tr_b16 v[220:221], v4 offset:6144
    ds_read_b64_tr_b16 v[222:223], v4 offset:7168
    v_mfma_f32_16x16x32_bf16 v[104:107], v[192:195], a[132:135], v[104:107]
    v_accvgpr_read_b32 v17, a104
    v_accvgpr_read_b32 v18, a105
    v_mfma_f32_16x16x32_bf16 v[104:107], v[196:199], a[140:143], v[104:107]
    ds_read_b64_tr_b16 v[192:193], v5 offset:0
    ds_read_b64_tr_b16 v[194:195], v5 offset:1024
    v_mfma_f32_16x16x32_bf16 v[104:107], v[200:203], a[148:151], v[104:107]
    v_mul_f32 v17, v17, v24
    v_mul_f32 v18, v18, v24
    v_mfma_f32_16x16x32_bf16 v[104:107], v[204:207], a[156:159], v[104:107]
    s_waitcnt lgkmcnt(6)
    ds_read_b64_tr_b16 v[196:197], v5 offset:2048
    ds_read_b64_tr_b16 v[198:199], v5 offset:3072
    v_mfma_f32_16x16x32_bf16 v[100:103], v[208:211], a[128:131], v[100:103]
    v_cvt_pk_bf16_f32 v180, v17, v18
    v_accvgpr_read_b32 v19, a106
    v_mfma_f32_16x16x32_bf16 v[100:103], v[212:215], a[136:139], v[100:103]
    s_waitcnt lgkmcnt(4)
    ds_read_b64_tr_b16 v[200:201], v5 offset:4096
    ds_read_b64_tr_b16 v[202:203], v5 offset:5120
    v_mfma_f32_16x16x32_bf16 v[100:103], v[216:219], a[144:147], v[100:103]
    v_accvgpr_read_b32 v20, a107
    v_mul_f32 v19, v19, v24
    v_mfma_f32_16x16x32_bf16 v[100:103], v[220:223], a[152:155], v[100:103]
    ds_read_b64_tr_b16 v[204:205], v5 offset:6144
    ds_read_b64_tr_b16 v[206:207], v5 offset:7168
    v_mfma_f32_16x16x32_bf16 v[108:111], v[208:211], a[132:135], v[108:111]
    v_mul_f32 v20, v20, v24
    v_cvt_pk_bf16_f32 v181, v19, v20
    v_accvgpr_read_b32 v17, a108
    v_accvgpr_read_b32 v18, a109
    v_mul_f32 v17, v17, v24
    v_mul_f32 v18, v18, v24
    v_cvt_pk_bf16_f32 v182, v17, v18
    v_accvgpr_read_b32 v19, a110
    v_accvgpr_read_b32 v20, a111
    v_mul_f32 v19, v19, v24
    v_mul_f32 v20, v20, v24
    v_cvt_pk_bf16_f32 v183, v19, v20
    v_mfma_f32_16x16x32_bf16 v[108:111], v[212:215], a[140:143], v[108:111]
    buffer_store_dwordx4 v[180:183], v25, s[76:79], s28 offen offset:1024 sc1
    ds_read_b64_tr_b16 v[208:209], v6 offset:0
    ds_read_b64_tr_b16 v[210:211], v6 offset:1024
    v_mfma_f32_16x16x32_bf16 v[108:111], v[216:219], a[148:151], v[108:111]
    v_accvgpr_read_b32 v17, a112
    v_accvgpr_read_b32 v18, a113
    v_mfma_f32_16x16x32_bf16 v[108:111], v[220:223], a[156:159], v[108:111]
    s_waitcnt vmcnt(14) lgkmcnt(6)
    ds_read_b64_tr_b16 v[212:213], v6 offset:2048
    ds_read_b64_tr_b16 v[214:215], v6 offset:3072
    v_mfma_f32_16x16x32_bf16 v[64:67], v[192:195], a[160:163], v[64:67]
    v_mul_f32 v17, v17, v24
    v_mul_f32 v18, v18, v24
    v_mfma_f32_16x16x32_bf16 v[64:67], v[196:199], a[168:171], v[64:67]
    s_waitcnt lgkmcnt(4)
    ds_read_b64_tr_b16 v[216:217], v6 offset:4096
    ds_read_b64_tr_b16 v[218:219], v6 offset:5120
    v_mfma_f32_16x16x32_bf16 v[64:67], v[200:203], a[176:179], v[64:67]
    v_cvt_pk_bf16_f32 v184, v17, v18
    v_accvgpr_read_b32 v19, a114
    v_mfma_f32_16x16x32_bf16 v[64:67], v[204:207], a[184:187], v[64:67]
    ds_read_b64_tr_b16 v[220:221], v6 offset:6144
    ds_read_b64_tr_b16 v[222:223], v6 offset:7168
    v_mfma_f32_16x16x32_bf16 v[72:75], v[192:195], a[164:167], v[72:75]
    v_accvgpr_read_b32 v20, a115
    v_mul_f32 v19, v19, v24
    v_mfma_f32_16x16x32_bf16 v[72:75], v[196:199], a[172:175], v[72:75]
    ds_read_b64_tr_b16 v[192:193], v5 offset:32768
    ds_read_b64_tr_b16 v[194:195], v5 offset:33792
    v_mfma_f32_16x16x32_bf16 v[72:75], v[200:203], a[180:183], v[72:75]
    v_mul_f32 v20, v20, v24
    v_cvt_pk_bf16_f32 v185, v19, v20
    v_mfma_f32_16x16x32_bf16 v[72:75], v[204:207], a[188:191], v[72:75]
    s_waitcnt lgkmcnt(6)
    ds_read_b64_tr_b16 v[196:197], v5 offset:34816
    ds_read_b64_tr_b16 v[198:199], v5 offset:35840
    v_mfma_f32_16x16x32_bf16 v[68:71], v[208:211], a[160:163], v[68:71]
    v_accvgpr_read_b32 v17, a116
    v_accvgpr_read_b32 v18, a117
    v_mfma_f32_16x16x32_bf16 v[68:71], v[212:215], a[168:171], v[68:71]
    s_waitcnt lgkmcnt(4)
    ds_read_b64_tr_b16 v[200:201], v5 offset:36864
    ds_read_b64_tr_b16 v[202:203], v5 offset:37888
    v_mul_f32 v17, v17, v24
    v_mul_f32 v18, v18, v24
    v_cvt_pk_bf16_f32 v186, v17, v18
    v_accvgpr_read_b32 v19, a118
    v_accvgpr_read_b32 v20, a119
    v_mul_f32 v19, v19, v24
    v_mul_f32 v20, v20, v24
    v_cvt_pk_bf16_f32 v187, v19, v20
    v_mfma_f32_16x16x32_bf16 v[68:71], v[216:219], a[176:179], v[68:71]
    buffer_store_dwordx4 v[184:187], v25, s[76:79], s28 offen offset:2048 sc1
    v_mfma_f32_16x16x32_bf16 v[68:71], v[220:223], a[184:187], v[68:71]
    ds_read_b64_tr_b16 v[204:205], v5 offset:38912
    ds_read_b64_tr_b16 v[206:207], v5 offset:39936
    v_mfma_f32_16x16x32_bf16 v[76:79], v[208:211], a[164:167], v[76:79]
    v_accvgpr_read_b32 v17, a120
    v_accvgpr_read_b32 v18, a121
    v_mfma_f32_16x16x32_bf16 v[76:79], v[212:215], a[172:175], v[76:79]
    ds_read_b64_tr_b16 v[208:209], v6 offset:32768
    ds_read_b64_tr_b16 v[210:211], v6 offset:33792
    v_mfma_f32_16x16x32_bf16 v[76:79], v[216:219], a[180:183], v[76:79]
    v_mul_f32 v17, v17, v24
    v_mul_f32 v18, v18, v24
    v_mfma_f32_16x16x32_bf16 v[76:79], v[220:223], a[188:191], v[76:79]
    s_waitcnt lgkmcnt(6)
    ds_read_b64_tr_b16 v[212:213], v6 offset:34816
    ds_read_b64_tr_b16 v[214:215], v6 offset:35840
    v_mfma_f32_16x16x32_bf16 v[80:83], v[192:195], a[160:163], v[80:83]
    v_cvt_pk_bf16_f32 v188, v17, v18
    v_accvgpr_read_b32 v19, a122
    v_mfma_f32_16x16x32_bf16 v[80:83], v[196:199], a[168:171], v[80:83]
    s_waitcnt lgkmcnt(4)
    ds_read_b64_tr_b16 v[216:217], v6 offset:36864
    ds_read_b64_tr_b16 v[218:219], v6 offset:37888
    v_mfma_f32_16x16x32_bf16 v[80:83], v[200:203], a[176:179], v[80:83]
    v_accvgpr_read_b32 v20, a123
    v_mul_f32 v19, v19, v24
    v_mfma_f32_16x16x32_bf16 v[80:83], v[204:207], a[184:187], v[80:83]
    ds_read_b64_tr_b16 v[220:221], v6 offset:38912
    ds_read_b64_tr_b16 v[222:223], v6 offset:39936
    v_mfma_f32_16x16x32_bf16 v[88:91], v[192:195], a[164:167], v[88:91]
    v_mul_f32 v20, v20, v24
    v_cvt_pk_bf16_f32 v189, v19, v20
    v_mfma_f32_16x16x32_bf16 v[88:91], v[196:199], a[172:175], v[88:91]
    ds_read_b64_tr_b16 v[192:193], v7 offset:0
    ds_read_b64_tr_b16 v[194:195], v7 offset:1024
    v_mfma_f32_16x16x32_bf16 v[88:91], v[200:203], a[180:183], v[88:91]
    v_accvgpr_read_b32 v17, a124
    v_accvgpr_read_b32 v18, a125
    v_mul_f32 v17, v17, v24
    v_mul_f32 v18, v18, v24
    v_cvt_pk_bf16_f32 v190, v17, v18
    v_accvgpr_read_b32 v19, a126
    v_accvgpr_read_b32 v20, a127
    v_mul_f32 v19, v19, v24
    v_mul_f32 v20, v20, v24
    v_cvt_pk_bf16_f32 v191, v19, v20
    v_mfma_f32_16x16x32_bf16 v[88:91], v[204:207], a[188:191], v[88:91]
    s_waitcnt lgkmcnt(6)
    buffer_store_dwordx4 v[188:191], v25, s[76:79], s28 offen offset:3072 sc1
    ds_read_b64_tr_b16 v[196:197], v7 offset:2048
    ds_read_b64_tr_b16 v[198:199], v7 offset:3072
    v_mfma_f32_16x16x32_bf16 v[84:87], v[208:211], a[160:163], v[84:87]
    v_add_f32 v28, v28, v30
    v_add_f32 v29, v29, v31
    v_mfma_f32_16x16x32_bf16 v[84:87], v[212:215], a[168:171], v[84:87]
    s_waitcnt lgkmcnt(4)
    ds_read_b64_tr_b16 v[200:201], v7 offset:4096
    ds_read_b64_tr_b16 v[202:203], v7 offset:5120
    v_mfma_f32_16x16x32_bf16 v[84:87], v[216:219], a[176:179], v[84:87]
    v_add_f32 v28, v28, v32
    v_add_f32 v29, v29, v33
    v_mfma_f32_16x16x32_bf16 v[84:87], v[220:223], a[184:187], v[84:87]
    ds_read_b64_tr_b16 v[204:205], v7 offset:6144
    ds_read_b64_tr_b16 v[206:207], v7 offset:7168
    v_mfma_f32_16x16x32_bf16 v[92:95], v[208:211], a[164:167], v[92:95]
    v_add_f32 v28, v28, v34
    v_add_f32 v29, v29, v35
    v_mfma_f32_16x16x32_bf16 v[92:95], v[212:215], a[172:175], v[92:95]
    ds_read_b64_tr_b16 v[208:209], v8 offset:0
    ds_read_b64_tr_b16 v[210:211], v8 offset:1024
    v_mfma_f32_16x16x32_bf16 v[92:95], v[216:219], a[180:183], v[92:95]
    v_add_f32 v36, v36, v38
    v_add_f32 v37, v37, v39
    v_mfma_f32_16x16x32_bf16 v[92:95], v[220:223], a[188:191], v[92:95]
    s_waitcnt lgkmcnt(6)
    ds_read_b64_tr_b16 v[212:213], v8 offset:2048
    ds_read_b64_tr_b16 v[214:215], v8 offset:3072
    v_mfma_f32_16x16x32_bf16 v[96:99], v[192:195], a[160:163], v[96:99]
    v_add_f32 v36, v36, v40
    v_add_f32 v37, v37, v41
    v_mfma_f32_16x16x32_bf16 v[96:99], v[196:199], a[168:171], v[96:99]
    s_waitcnt lgkmcnt(4)
    ds_read_b64_tr_b16 v[216:217], v8 offset:4096
    ds_read_b64_tr_b16 v[218:219], v8 offset:5120
    v_mfma_f32_16x16x32_bf16 v[96:99], v[200:203], a[176:179], v[96:99]
    v_add_f32 v36, v36, v42
    v_add_f32 v37, v37, v43
    v_mfma_f32_16x16x32_bf16 v[96:99], v[204:207], a[184:187], v[96:99]
    ds_read_b64_tr_b16 v[220:221], v8 offset:6144
    ds_read_b64_tr_b16 v[222:223], v8 offset:7168
    v_mfma_f32_16x16x32_bf16 v[104:107], v[192:195], a[164:167], v[104:107]
    v_mov_b32 v56, v28
    v_mov_b32 v57, v29
    v_mfma_f32_16x16x32_bf16 v[104:107], v[196:199], a[172:175], v[104:107]
    v_mov_b32 v58, v36
    v_mov_b32 v59, v37
    v_mfma_f32_16x16x32_bf16 v[104:107], v[200:203], a[180:183], v[104:107]
    v_permlane16_swap_b32 v28, v56
    v_mfma_f32_16x16x32_bf16 v[104:107], v[204:207], a[188:191], v[104:107]
    s_waitcnt lgkmcnt(4)
    v_permlane16_swap_b32 v29, v57
    v_mfma_f32_16x16x32_bf16 v[100:103], v[208:211], a[160:163], v[100:103]
    v_permlane16_swap_b32 v36, v58
    v_mfma_f32_16x16x32_bf16 v[100:103], v[212:215], a[168:171], v[100:103]
    s_waitcnt lgkmcnt(0)
    v_permlane16_swap_b32 v37, v59
    v_mfma_f32_16x16x32_bf16 v[100:103], v[216:219], a[176:179], v[100:103]
    s_barrier
    v_mfma_f32_16x16x32_bf16 v[100:103], v[220:223], a[184:187], v[100:103]
    v_add_f32 v28, v28, v56
    v_add_f32 v29, v29, v57
    v_mfma_f32_16x16x32_bf16 v[108:111], v[208:211], a[164:167], v[108:111]
    v_add_f32 v36, v36, v58
    v_add_f32 v37, v37, v59
    v_mfma_f32_16x16x32_bf16 v[108:111], v[212:215], a[172:175], v[108:111]
    v_mov_b32 v56, v28
    v_mov_b32 v57, v29
    v_mov_b32 v58, v36
    v_mov_b32 v59, v37
    v_permlane32_swap_b32 v28, v56
    v_permlane32_swap_b32 v29, v57
    v_permlane32_swap_b32 v36, v58
    v_permlane32_swap_b32 v37, v59
    v_add_f32 v28, v28, v56
    v_add_f32 v29, v29, v57
    v_add_f32 v36, v36, v58
    v_add_f32 v37, v37, v59
    v_cmp_gt_u32 vcc, 16, v0
    v_mul_f32 v28, 0x3b000000, v28
    v_mul_f32 v29, 0x3b000000, v29
    v_fma_f32 v29, -v28, v28, v29
    v_max_f32 v29, 0, v29
    v_add_f32 v29, 0x3727c5ac, v29
    v_rsq_f32 v29, v29
    v_sub_f32 v56, 0, v28
    v_cndmask_b32 v56, 0, v56, vcc
    v_cvt_pk_bf16_f32 v57, v56, v56
    v_and_b32 v57, 0xffff0000, v57
    v_sub_f32 v57, v56, v57
    v_cvt_pk_bf16_f32 v124, v56, v57
    v_mov_b32 v125, v124
    v_mul_f32 v36, 0x3b000000, v36
    v_mul_f32 v37, 0x3b000000, v37
    v_fma_f32 v37, -v36, v36, v37
    v_max_f32 v37, 0, v37
    v_add_f32 v37, 0x3727c5ac, v37
    v_rsq_f32 v37, v37
    v_sub_f32 v56, 0, v36
    v_cndmask_b32 v56, 0, v56, vcc
    v_cvt_pk_bf16_f32 v57, v56, v56
    v_and_b32 v57, 0xffff0000, v57
    v_sub_f32 v57, v56, v57
    v_cvt_pk_bf16_f32 v126, v56, v57
    v_mov_b32 v127, v126
    v_add_f32 v232, v232, v233
    v_add_f32 v234, v234, v235
    v_add_f32 v232, v232, v234
    v_cvt_pk_bf16_f32 v112, v232, v232
    v_and_b32 v56, 0xffff0000, v112
    v_sub_f32 v56, v232, v56
    v_cvt_pk_bf16_f32 v113, v56, v56
    v_add_f32 v236, v236, v237
    v_add_f32 v238, v238, v239
    v_add_f32 v236, v236, v238
    v_cvt_pk_bf16_f32 v114, v236, v236
    v_and_b32 v56, 0xffff0000, v114
    v_sub_f32 v56, v236, v56
    v_cvt_pk_bf16_f32 v115, v56, v56
    v_add_f32 v240, v240, v241
    v_add_f32 v242, v242, v243
    v_add_f32 v240, v240, v242
    v_cvt_pk_bf16_f32 v116, v240, v240
    v_and_b32 v56, 0xffff0000, v116
    v_sub_f32 v56, v240, v56
    v_cvt_pk_bf16_f32 v117, v56, v56
    v_add_f32 v244, v244, v245
    v_add_f32 v246, v246, v247
    v_add_f32 v244, v244, v246
    v_cvt_pk_bf16_f32 v118, v244, v244
    v_and_b32 v56, 0xffff0000, v118
    v_sub_f32 v56, v244, v56
    v_cvt_pk_bf16_f32 v119, v56, v56
    v_add_f32 v248, v248, v249
    v_add_f32 v250, v250, v251
    v_add_f32 v248, v248, v250
    v_cvt_pk_bf16_f32 v120, v248, v248
    v_and_b32 v56, 0xffff0000, v120
    v_sub_f32 v56, v248, v56
    v_cvt_pk_bf16_f32 v121, v56, v56
    v_add_f32 v252, v252, v253
    v_add_f32 v254, v254, v255
    v_add_f32 v252, v252, v254
    v_cvt_pk_bf16_f32 v122, v252, v252
    v_and_b32 v56, 0xffff0000, v122
    v_sub_f32 v56, v252, v56
    v_cvt_pk_bf16_f32 v123, v56, v56
    v_mfma_f32_16x16x32_bf16 v[108:111], v[216:219], a[180:183], v[108:111]
    v_add_u32 v9, 4294901760, v9
    v_add_u32 v10, 4294901760, v10
    v_mfma_f32_16x16x32_bf16 v[108:111], v[220:223], a[188:191], v[108:111]
    v_add_u32 v11, 4294901760, v11
    v_add_u32 v12, 4294901760, v12
    v_mfma_f32_16x16x16_bf16 v[64:67], v[112:113], v[124:125], v[64:67]
    v_add_u32 v13, 4294901760, v13
    v_add_u32 v14, 4294901760, v14
    v_add_u32 v15, 4294901760, v15
    v_mfma_f32_16x16x16_bf16 v[72:75], v[112:113], v[126:127], v[72:75]
    v_add_u32 v16, 4294901760, v16
    v_mfma_f32_16x16x16_bf16 v[68:71], v[114:115], v[124:125], v[68:71]
    s_mul_i32 s14, s11, 88064
    s_lshl_b32 s31, s91, 4
    s_add_u32 s14, s14, s31
    s_add_u32 s14, s14, 5242880
    v_mfma_f32_16x16x16_bf16 v[76:79], v[114:115], v[126:127], v[76:79]
    s_add_u32 s15, s14, 44032
    s_cmp_lt_u32 s7, 11
    s_cselect_b32 s31, 0, 0x80000000
    v_or_b32 v27, s31, v25
    v_mfma_f32_16x16x16_bf16 v[80:83], v[116:117], v[124:125], v[80:83]
    s_lshl_b32 s92, s8, 7
    s_add_u32 s92, s92, s23
    s_lshl_b32 s12, s11, 18
    s_lshl_b32 s31, s8, 15
    v_mfma_f32_16x16x16_bf16 v[88:91], v[116:117], v[126:127], v[88:91]
    s_add_u32 s12, s12, s31
    s_add_u32 s12, s12, 16777216
    v_mfma_f32_16x16x16_bf16 v[84:87], v[118:119], v[124:125], v[84:87]
    v_mfma_f32_16x16x16_bf16 v[92:95], v[118:119], v[126:127], v[92:95]
    v_mfma_f32_16x16x16_bf16 v[96:99], v[120:121], v[124:125], v[96:99]
    v_mfma_f32_16x16x16_bf16 v[104:107], v[120:121], v[126:127], v[104:107]
    v_mfma_f32_16x16x16_bf16 v[100:103], v[122:123], v[124:125], v[100:103]
    v_mfma_f32_16x16x16_bf16 v[108:111], v[122:123], v[126:127], v[108:111]
    s_mov_b32 s0, 0xc0135761
    s_mov_b32 s1, 1.0
    s_waitcnt vmcnt(0)
    s_barrier
    buffer_atomic_add v62, v63, s[76:79], s92 offen offset:768 sc1
    v_pk_mul_f32 v[64:65], v[64:65], v[28:29] op_sel:[0,1] op_sel_hi:[1,1]
    v_pk_mul_f32 v[66:67], v[66:67], v[28:29] op_sel:[0,1] op_sel_hi:[1,1]
    s_and_b32 s31, s4, 7
    s_cmp_ge_u32 0, s31
    s_cselect_b32 s31, 1, 0
    v_pk_mul_f32 v[54:55], v[64:65], v[64:65]
    s_lshl_b32 s31, s31, 17
    v_pk_mul_f32 v[56:57], v[66:67], v[66:67]
    s_add_u32 m0, s16, 0
    v_pk_fma_f32 v[54:55], v[54:55], v[60:61], s[0:1] op_sel:[0,1,0] op_sel_hi:[1,1,0]
    buffer_load_dwordx4 v44, s[48:51], s31 offen offset:0 lds
    v_pk_fma_f32 v[56:57], v[56:57], v[60:61], s[0:1] op_sel:[0,1,0] op_sel_hi:[1,1,0]
    v_pk_mul_f32 v[54:55], v[54:55], v[64:65]
    v_pk_mul_f32 v[56:57], v[56:57], v[66:67]
    v_exp_f32 v54, v54
    v_exp_f32 v55, v55
    v_exp_f32 v56, v56
    v_exp_f32 v57, v57
    v_pk_add_f32 v[54:55], v[54:55], s[0:1] op_sel:[0,1] op_sel_hi:[1,1]
    v_pk_add_f32 v[56:57], v[56:57], s[0:1] op_sel:[0,1] op_sel_hi:[1,1]
    v_rcp_f32 v54, v54
    buffer_load_dwordx4 v45, s[48:51], s31 offen offset:1024 lds
    v_rcp_f32 v55, v55
    v_rcp_f32 v56, v56
    v_rcp_f32 v57, v57
    v_pk_mul_f32 v[64:65], v[64:65], v[54:55]
    v_pk_mul_f32 v[66:67], v[66:67], v[56:57]
    v_cvt_pk_bf16_f32 v160, v64, v65
    v_cvt_pk_bf16_f32 v161, v66, v67
    v_pk_mul_f32 v[68:69], v[68:69], v[28:29] op_sel:[0,1] op_sel_hi:[1,1]
    v_pk_mul_f32 v[70:71], v[70:71], v[28:29] op_sel:[0,1] op_sel_hi:[1,1]
    v_pk_mul_f32 v[54:55], v[68:69], v[68:69]
    buffer_load_dwordx4 v46, s[48:51], s31 offen offset:2048 lds
    v_pk_mul_f32 v[56:57], v[70:71], v[70:71]
    v_pk_fma_f32 v[54:55], v[54:55], v[60:61], s[0:1] op_sel:[0,1,0] op_sel_hi:[1,1,0]
    v_pk_fma_f32 v[56:57], v[56:57], v[60:61], s[0:1] op_sel:[0,1,0] op_sel_hi:[1,1,0]
    v_pk_mul_f32 v[54:55], v[54:55], v[68:69]
    v_pk_mul_f32 v[56:57], v[56:57], v[70:71]
    v_exp_f32 v54, v54
    v_exp_f32 v55, v55
    v_exp_f32 v56, v56
    v_exp_f32 v57, v57
    v_pk_add_f32 v[54:55], v[54:55], s[0:1] op_sel:[0,1] op_sel_hi:[1,1]
    buffer_load_dwordx4 v47, s[48:51], s31 offen offset:3072 lds
    v_pk_add_f32 v[56:57], v[56:57], s[0:1] op_sel:[0,1] op_sel_hi:[1,1]
    v_rcp_f32 v54, v54
    v_rcp_f32 v55, v55
    v_rcp_f32 v56, v56
    v_rcp_f32 v57, v57
    v_pk_mul_f32 v[68:69], v[68:69], v[54:55]
    v_pk_mul_f32 v[70:71], v[70:71], v[56:57]
    v_cvt_pk_bf16_f32 v162, v68, v69
    s_add_u32 s31, s31, 0x4000
    v_cvt_pk_bf16_f32 v163, v70, v71
    s_add_u32 m0, s16, 4096
    v_pk_mul_f32 v[72:73], v[72:73], v[36:37] op_sel:[0,1] op_sel_hi:[1,1]
    buffer_load_dwordx4 v44, s[48:51], s31 offen offset:0 lds
    v_pk_mul_f32 v[74:75], v[74:75], v[36:37] op_sel:[0,1] op_sel_hi:[1,1]
    v_pk_mul_f32 v[54:55], v[72:73], v[72:73]
    v_pk_mul_f32 v[56:57], v[74:75], v[74:75]
    v_pk_fma_f32 v[54:55], v[54:55], v[60:61], s[0:1] op_sel:[0,1,0] op_sel_hi:[1,1,0]
    v_pk_fma_f32 v[56:57], v[56:57], v[60:61], s[0:1] op_sel:[0,1,0] op_sel_hi:[1,1,0]
    v_pk_mul_f32 v[54:55], v[54:55], v[72:73]
    v_pk_mul_f32 v[56:57], v[56:57], v[74:75]
    v_exp_f32 v54, v54
    v_exp_f32 v55, v55
    v_exp_f32 v56, v56
    buffer_load_dwordx4 v45, s[48:51], s31 offen offset:1024 lds
    v_exp_f32 v57, v57
    v_pk_add_f32 v[54:55], v[54:55], s[0:1] op_sel:[0,1] op_sel_hi:[1,1]
    v_pk_add_f32 v[56:57], v[56:57], s[0:1] op_sel:[0,1] op_sel_hi:[1,1]
    v_rcp_f32 v54, v54
    v_rcp_f32 v55, v55
    v_rcp_f32 v56, v56
    v_rcp_f32 v57, v57
    v_pk_mul_f32 v[72:73], v[72:73], v[54:55]
    v_pk_mul_f32 v[74:75], v[74:75], v[56:57]
    v_cvt_pk_bf16_f32 v164, v72, v73
    buffer_load_dwordx4 v46, s[48:51], s31 offen offset:2048 lds
    v_cvt_pk_bf16_f32 v165, v74, v75
    v_pk_mul_f32 v[76:77], v[76:77], v[36:37] op_sel:[0,1] op_sel_hi:[1,1]
    v_pk_mul_f32 v[78:79], v[78:79], v[36:37] op_sel:[0,1] op_sel_hi:[1,1]
    v_pk_mul_f32 v[54:55], v[76:77], v[76:77]
    v_pk_mul_f32 v[56:57], v[78:79], v[78:79]
    v_pk_fma_f32 v[54:55], v[54:55], v[60:61], s[0:1] op_sel:[0,1,0] op_sel_hi:[1,1,0]
    v_pk_fma_f32 v[56:57], v[56:57], v[60:61], s[0:1] op_sel:[0,1,0] op_sel_hi:[1,1,0]
    v_pk_mul_f32 v[54:55], v[54:55], v[76:77]
    v_pk_mul_f32 v[56:57], v[56:57], v[78:79]
    v_exp_f32 v54, v54
    buffer_load_dwordx4 v47, s[48:51], s31 offen offset:3072 lds
    v_exp_f32 v55, v55
    v_exp_f32 v56, v56
    v_exp_f32 v57, v57
    v_pk_add_f32 v[54:55], v[54:55], s[0:1] op_sel:[0,1] op_sel_hi:[1,1]
    v_pk_add_f32 v[56:57], v[56:57], s[0:1] op_sel:[0,1] op_sel_hi:[1,1]
    v_rcp_f32 v54, v54
    v_rcp_f32 v55, v55
    v_rcp_f32 v56, v56
    v_rcp_f32 v57, v57
    v_pk_mul_f32 v[76:77], v[76:77], v[54:55]
    v_pk_mul_f32 v[78:79], v[78:79], v[56:57]
    v_cvt_pk_bf16_f32 v166, v76, v77
L_warm0_10:
    s_cbranch_execz L_warm_ret0
    v_cvt_pk_bf16_f32 v167, v78, v79
    buffer_store_dwordx4 v[160:163], v25, s[76:79], s14 offen offset:0 sc1
    buffer_store_dwordx4 v[164:167], v25, s[76:79], s15 offen offset:0 sc1
    ds_read_b64_tr_b16 v[192:193], v9 offset:0
    ds_read_b64_tr_b16 v[194:195], v9 offset:4096
    ds_read_b64_tr_b16 v[196:197], v9 offset:8192
    ds_read_b64_tr_b16 v[198:199], v9 offset:12288
    ds_read_b64_tr_b16 v[200:201], v9 offset:16384
    ds_read_b64_tr_b16 v[202:203], v9 offset:20480
    ds_read_b64_tr_b16 v[204:205], v9 offset:24576
    ds_read_b64_tr_b16 v[206:207], v9 offset:28672
    ds_read_b64_tr_b16 v[208:209], v10 offset:0
    ds_read_b64_tr_b16 v[210:211], v10 offset:4096
    ds_read_b64_tr_b16 v[212:213], v10 offset:8192
    ds_read_b64_tr_b16 v[214:215], v10 offset:12288
    ds_read_b64_tr_b16 v[216:217], v10 offset:16384
    ds_read_b64_tr_b16 v[218:219], v10 offset:20480
    ds_read_b64_tr_b16 v[220:221], v10 offset:24576
    ds_read_b64_tr_b16 v[222:223], v10 offset:28672
    s_waitcnt lgkmcnt(14)
    v_mfma_f32_16x16x32_bf16 v[64:67], v[192:195], v[128:131], 0
    v_mul_f32 v80, v80, v29
    v_mul_f32 v81, v81, v29
    v_mul_f32 v54, v80, v80
    v_mul_f32 v55, v81, v81
    v_fmaak_f32 v54, v54, v61, 0xc0135761
    v_fmaak_f32 v55, v55, v61, 0xc0135761
    v_mul_f32 v54, v54, v80
    v_mul_f32 v55, v55, v81
    v_exp_f32 v54, v54
    v_exp_f32 v55, v55
    s_waitcnt lgkmcnt(12)
    v_mfma_f32_16x16x32_bf16 v[64:67], v[196:199], v[132:135], v[64:67]
    s_and_b32 s31, s4, 7
    s_cmp_ge_u32 1, s31
    s_cselect_b32 s31, 2, 1
    s_waitcnt lgkmcnt(10)
    v_mfma_f32_16x16x32_bf16 v[64:67], v[200:203], v[136:139], v[64:67]
    s_lshl_b32 s31, s31, 17
    v_add_f32 v54, 1.0, v54
    v_add_f32 v55, 1.0, v55
    v_rcp_f32 v54, v54
    v_rcp_f32 v55, v55
    v_mul_f32 v80, v80, v54
    v_mul_f32 v81, v81, v55
    v_cvt_pk_bf16_f32 v168, v80, v81
    s_waitcnt lgkmcnt(8)
    v_mfma_f32_16x16x32_bf16 v[64:67], v[204:207], v[140:143], v[64:67]
    s_add_u32 m0, s16, 32768
    v_mfma_f32_16x16x32_bf16 v[72:75], v[192:195], v[144:147], 0
    buffer_load_dwordx4 v44, s[48:51], s31 offen offset:0 lds
    v_mul_f32 v82, v82, v29
    v_mul_f32 v83, v83, v29
    v_mul_f32 v56, v82, v82
    v_mul_f32 v57, v83, v83
    v_fmaak_f32 v56, v56, v61, 0xc0135761
    v_fmaak_f32 v57, v57, v61, 0xc0135761
    v_mul_f32 v56, v56, v82
    v_mul_f32 v57, v57, v83
    v_exp_f32 v56, v56
    v_exp_f32 v57, v57
    v_mfma_f32_16x16x32_bf16 v[72:75], v[196:199], v[148:151], v[72:75]
    ds_read_b64_tr_b16 v[192:193], v11 offset:0
    ds_read_b64_tr_b16 v[194:195], v11 offset:4096
    v_mfma_f32_16x16x32_bf16 v[72:75], v[200:203], v[152:155], v[72:75]
    v_add_f32 v56, 1.0, v56
    v_add_f32 v57, 1.0, v57
    v_rcp_f32 v56, v56
    v_rcp_f32 v57, v57
    v_mul_f32 v82, v82, v56
    v_mul_f32 v83, v83, v57
    v_cvt_pk_bf16_f32 v169, v82, v83
    v_mfma_f32_16x16x32_bf16 v[72:75], v[204:207], v[156:159], v[72:75]
    s_waitcnt lgkmcnt(6)
    ds_read_b64_tr_b16 v[196:197], v11 offset:8192
    ds_read_b64_tr_b16 v[198:199], v11 offset:12288
    v_mfma_f32_16x16x32_bf16 v[68:71], v[208:211], v[128:131], 0
    buffer_load_dwordx4 v45, s[48:51], s31 offen offset:1024 lds
    v_mul_f32 v84, v84, v29
    v_mul_f32 v85, v85, v29
    v_mul_f32 v54, v84, v84
    v_mul_f32 v55, v85, v85
    v_fmaak_f32 v54, v54, v61, 0xc0135761
    v_fmaak_f32 v55, v55, v61, 0xc0135761
    v_mul_f32 v54, v54, v84
    v_mul_f32 v55, v55, v85
    v_exp_f32 v54, v54
    v_exp_f32 v55, v55
    v_mfma_f32_16x16x32_bf16 v[68:71], v[212:215], v[132:135], v[68:71]
    s_waitcnt lgkmcnt(4)
    ds_read_b64_tr_b16 v[200:201], v11 offset:16384
    ds_read_b64_tr_b16 v[202:203], v11 offset:20480
    v_mfma_f32_16x16x32_bf16 v[68:71], v[216:219], v[136:139], v[68:71]
    v_add_f32 v54, 1.0, v54
    v_add_f32 v55, 1.0, v55
    v_rcp_f32 v54, v54
    v_rcp_f32 v55, v55
    v_mul_f32 v84, v84, v54
    v_mul_f32 v85, v85, v55
    v_cvt_pk_bf16_f32 v170, v84, v85
    v_mfma_f32_16x16x32_bf16 v[68:71], v[220:223], v[140:143], v[68:71]
    ds_read_b64_tr_b16 v[204:205], v11 offset:24576
    ds_read_b64_tr_b16 v[206:207], v11 offset:28672
    v_mfma_f32_16x16x32_bf16 v[76:79], v[208:211], v[144:147], 0
    buffer_load_dwordx4 v46, s[48:51], s31 offen offset:2048 lds
    v_mul_f32 v86, v86, v29
    v_mul_f32 v87, v87, v29
    v_mul_f32 v56, v86, v86
    v_mul_f32 v57, v87, v87
    v_fmaak_f32 v56, v56, v61, 0xc0135761
    v_fmaak_f32 v57, v57, v61, 0xc0135761
    v_mul_f32 v56, v56, v86
    v_mul_f32 v57, v57, v87
    v_exp_f32 v56, v56
    v_exp_f32 v57, v57
    v_mfma_f32_16x16x32_bf16 v[76:79], v[212:215], v[148:151], v[76:79]
    ds_read_b64_tr_b16 v[208:209], v12 offset:0
    ds_read_b64_tr_b16 v[210:211], v12 offset:4096
    v_mfma_f32_16x16x32_bf16 v[76:79], v[216:219], v[152:155], v[76:79]
    v_add_f32 v56, 1.0, v56
    v_add_f32 v57, 1.0, v57
    v_rcp_f32 v56, v56
    v_rcp_f32 v57, v57
    v_mul_f32 v86, v86, v56
    v_mul_f32 v87, v87, v57
    v_cvt_pk_bf16_f32 v171, v86, v87
    v_mfma_f32_16x16x32_bf16 v[76:79], v[220:223], v[156:159], v[76:79]
    s_waitcnt lgkmcnt(6)
    ds_read_b64_tr_b16 v[212:213], v12 offset:8192
    ds_read_b64_tr_b16 v[214:215], v12 offset:12288
    v_mfma_f32_16x16x32_bf16 v[112:115], v[192:195], v[128:131], 0
    buffer_load_dwordx4 v47, s[48:51], s31 offen offset:3072 lds
    v_mul_f32 v88, v88, v37
    v_mul_f32 v89, v89, v37
    v_mul_f32 v54, v88, v88
    v_mul_f32 v55, v89, v89
    v_fmaak_f32 v54, v54, v61, 0xc0135761
    v_fmaak_f32 v55, v55, v61, 0xc0135761
    v_mul_f32 v54, v54, v88
    v_mul_f32 v55, v55, v89
    v_exp_f32 v54, v54
    v_exp_f32 v55, v55
    v_mfma_f32_16x16x32_bf16 v[112:115], v[196:199], v[132:135], v[112:115]
    s_waitcnt lgkmcnt(4)
    ds_read_b64_tr_b16 v[216:217], v12 offset:16384
    ds_read_b64_tr_b16 v[218:219], v12 offset:20480
    v_mfma_f32_16x16x32_bf16 v[112:115], v[200:203], v[136:139], v[112:115]
    s_add_u32 s31, s31, 0x4000
    v_add_f32 v54, 1.0, v54
    v_add_f32 v55, 1.0, v55
    v_rcp_f32 v54, v54
    v_rcp_f32 v55, v55
    v_mul_f32 v88, v88, v54
    v_mul_f32 v89, v89, v55
    v_cvt_pk_bf16_f32 v172, v88, v89
    v_mfma_f32_16x16x32_bf16 v[112:115], v[204:207], v[140:143], v[112:115]
    s_add_u32 m0, s16, 36864
    ds_read_b64_tr_b16 v[220:221], v12 offset:24576
    ds_read_b64_tr_b16 v[222:223], v12 offset:28672
    v_mfma_f32_16x16x32_bf16 v[120:123], v[192:195], v[144:147], 0
    buffer_load_dwordx4 v44, s[48:51], s31 offen offset:0 lds
    v_mul_f32 v90, v90, v37
    v_mul_f32 v91, v91, v37
    v_mul_f32 v56, v90, v90
    v_mul_f32 v57, v91, v91
    v_fmaak_f32 v56, v56, v61, 0xc0135761
    v_fmaak_f32 v57, v57, v61, 0xc0135761
    v_mul_f32 v56, v56, v90
    v_mul_f32 v57, v57, v91
    v_exp_f32 v56, v56
    v_exp_f32 v57, v57
    v_mfma_f32_16x16x32_bf16 v[120:123], v[196:199], v[148:151], v[120:123]
    ds_read_b64_tr_b16 v[192:193], v13 offset:0
    ds_read_b64_tr_b16 v[194:195], v13 offset:4096
    v_mfma_f32_16x16x32_bf16 v[120:123], v[200:203], v[152:155], v[120:123]
    v_add_f32 v56, 1.0, v56
    v_add_f32 v57, 1.0, v57
    v_rcp_f32 v56, v56
    v_rcp_f32 v57, v57
    v_mul_f32 v90, v90, v56
    v_mul_f32 v91, v91, v57
    v_cvt_pk_bf16_f32 v173, v90, v91
    v_mfma_f32_16x16x32_bf16 v[120:123], v[204:207], v[156:159], v[120:123]
    s_waitcnt lgkmcnt(6)
    ds_read_b64_tr_b16 v[196:197], v13 offset:8192
    ds_read_b64_tr_b16 v[198:199], v13 offset:12288
    v_mfma_f32_16x16x32_bf16 v[116:119], v[208:211], v[128:131], 0
    buffer_load_dwordx4 v45, s[48:51], s31 offen offset:1024 lds
    v_mul_f32 v92, v92, v37
    v_mul_f32 v93, v93, v37
    v_mul_f32 v54, v92, v92
    v_mul_f32 v55, v93, v93
    v_fmaak_f32 v54, v54, v61, 0xc0135761
    v_fmaak_f32 v55, v55, v61, 0xc0135761
    v_mul_f32 v54, v54, v92
    v_mul_f32 v55, v55, v93
    v_exp_f32 v54, v54
    v_exp_f32 v55, v55
    v_mfma_f32_16x16x32_bf16 v[116:119], v[212:215], v[132:135], v[116:119]
    s_waitcnt lgkmcnt(4)
    ds_read_b64_tr_b16 v[200:201], v13 offset:16384
    ds_read_b64_tr_b16 v[202:203], v13 offset:20480
    v_mfma_f32_16x16x32_bf16 v[116:119], v[216:219], v[136:139], v[116:119]
    v_add_f32 v54, 1.0, v54
    v_add_f32 v55, 1.0, v55
    v_rcp_f32 v54, v54
    v_rcp_f32 v55, v55
    v_mul_f32 v92, v92, v54
    v_mul_f32 v93, v93, v55
    v_cvt_pk_bf16_f32 v174, v92, v93
    v_mfma_f32_16x16x32_bf16 v[116:119], v[220:223], v[140:143], v[116:119]
    ds_read_b64_tr_b16 v[204:205], v13 offset:24576
    ds_read_b64_tr_b16 v[206:207], v13 offset:28672
    v_mfma_f32_16x16x32_bf16 v[124:127], v[208:211], v[144:147], 0
    buffer_load_dwordx4 v46, s[48:51], s31 offen offset:2048 lds
    v_mul_f32 v94, v94, v37
    v_mul_f32 v95, v95, v37
    v_mul_f32 v56, v94, v94
    v_mul_f32 v57, v95, v95
    v_fmaak_f32 v56, v56, v61, 0xc0135761
    v_fmaak_f32 v57, v57, v61, 0xc0135761
    v_mul_f32 v56, v56, v94
    v_mul_f32 v57, v57, v95
    v_exp_f32 v56, v56
    v_exp_f32 v57, v57
    v_mfma_f32_16x16x32_bf16 v[124:127], v[212:215], v[148:151], v[124:127]
    ds_read_b64_tr_b16 v[208:209], v14 offset:0
    ds_read_b64_tr_b16 v[210:211], v14 offset:4096
    v_mfma_f32_16x16x32_bf16 v[124:127], v[216:219], v[152:155], v[124:127]
    v_add_f32 v56, 1.0, v56
    v_add_f32 v57, 1.0, v57
    v_rcp_f32 v56, v56
    v_rcp_f32 v57, v57
    v_mul_f32 v94, v94, v56
    v_mul_f32 v95, v95, v57
    v_cvt_pk_bf16_f32 v175, v94, v95
    v_mfma_f32_16x16x32_bf16 v[124:127], v[220:223], v[156:159], v[124:127]
    s_waitcnt lgkmcnt(6)
    ds_read_b64_tr_b16 v[212:213], v14 offset:8192
    ds_read_b64_tr_b16 v[214:215], v14 offset:12288
    v_mfma_f32_16x16x32_bf16 v[224:227], v[192:195], v[128:131], 0
    buffer_load_dwordx4 v47, s[48:51], s31 offen offset:3072 lds
    v_mul_f32 v96, v96, v29
    v_mul_f32 v97, v97, v29
    v_mul_f32 v54, v96, v96
    v_mul_f32 v55, v97, v97
    v_fmaak_f32 v54, v54, v61, 0xc0135761
    v_fmaak_f32 v55, v55, v61, 0xc0135761
    v_mul_f32 v54, v54, v96
    v_mul_f32 v55, v55, v97
    v_exp_f32 v54, v54
    v_exp_f32 v55, v55
    v_mfma_f32_16x16x32_bf16 v[224:227], v[196:199], v[132:135], v[224:227]
    s_and_b32 s31, s4, 7
    s_cmp_ge_u32 2, s31
    s_cselect_b32 s31, 3, 2
    buffer_store_dwordx4 v[168:171], v25, s[76:79], s14 offen offset:1024 sc1
    ds_read_b64_tr_b16 v[216:217], v14 offset:16384
    ds_read_b64_tr_b16 v[218:219], v14 offset:20480
    s_waitcnt lgkmcnt(6)
    v_mfma_f32_16x16x32_bf16 v[224:227], v[200:203], v[136:139], v[224:227]
    s_lshl_b32 s31, s31, 17
    v_add_f32 v54, 1.0, v54
    v_add_f32 v55, 1.0, v55
    v_rcp_f32 v54, v54
    v_rcp_f32 v55, v55
    v_mul_f32 v96, v96, v54
    v_mul_f32 v97, v97, v55
    v_cvt_pk_bf16_f32 v176, v96, v97
    v_mfma_f32_16x16x32_bf16 v[224:227], v[204:207], v[140:143], v[224:227]
    s_add_u32 m0, s16, 98304
    buffer_store_dwordx4 v[172:175], v25, s[76:79], s15 offen offset:1024 sc1
    ds_read_b64_tr_b16 v[220:221], v14 offset:24576
    ds_read_b64_tr_b16 v[222:223], v14 offset:28672
    v_mfma_f32_16x16x32_bf16 v[232:235], v[192:195], v[144:147], 0
    buffer_load_dwordx4 v44, s[48:51], s31 offen offset:0 lds
    v_mul_f32 v98, v98, v29
    v_mul_f32 v99, v99, v29
    v_mul_f32 v56, v98, v98
    v_mul_f32 v57, v99, v99
    v_fmaak_f32 v56, v56, v61, 0xc0135761
    v_fmaak_f32 v57, v57, v61, 0xc0135761
    v_mul_f32 v56, v56, v98
    v_mul_f32 v57, v57, v99
    v_exp_f32 v56, v56
    v_exp_f32 v57, v57
    v_mfma_f32_16x16x32_bf16 v[232:235], v[196:199], v[148:151], v[232:235]
    ds_read_b64_tr_b16 v[192:193], v15 offset:0
    ds_read_b64_tr_b16 v[194:195], v15 offset:4096
    v_mfma_f32_16x16x32_bf16 v[232:235], v[200:203], v[152:155], v[232:235]
    v_add_f32 v56, 1.0, v56
    v_add_f32 v57, 1.0, v57
    v_rcp_f32 v56, v56
    v_rcp_f32 v57, v57
    v_mul_f32 v98, v98, v56
    v_mul_f32 v99, v99, v57
    v_cvt_pk_bf16_f32 v177, v98, v99
    v_mfma_f32_16x16x32_bf16 v[232:235], v[204:207], v[156:159], v[232:235]
    s_waitcnt lgkmcnt(6)
    buffer_load_dwordx4 v45, s[48:51], s31 offen offset:1024 lds
    ds_read_b64_tr_b16 v[196:197], v15 offset:8192
    ds_read_b64_tr_b16 v[198:199], v15 offset:12288
    v_mfma_f32_16x16x32_bf16 v[228:231], v[208:211], v[128:131], 0
    v_mul_f32 v100, v100, v29
    v_mul_f32 v101, v101, v29
    v_mul_f32 v54, v100, v100
    v_mul_f32 v55, v101, v101
    v_fmaak_f32 v54, v54, v61, 0xc0135761
    v_fmaak_f32 v55, v55, v61, 0xc0135761
    v_mul_f32 v54, v54, v100
    v_mul_f32 v55, v55, v101
    v_exp_f32 v54, v54
    v_exp_f32 v55, v55
    v_mfma_f32_16x16x32_bf16 v[228:231], v[212:215], v[132:135], v[228:231]
    s_waitcnt lgkmcnt(4)
    ds_read_b64_tr_b16 v[200:201], v15 offset:16384
    ds_read_b64_tr_b16 v[202:203], v15 offset:20480
    v_mfma_f32_16x16x32_bf16 v[228:231], v[216:219], v[136:139], v[228:231]
    buffer_load_dwordx4 v46, s[48:51], s31 offen offset:2048 lds
    v_add_f32 v54, 1.0, v54
    v_add_f32 v55, 1.0, v55
    v_rcp_f32 v54, v54
    v_rcp_f32 v55, v55
    v_mul_f32 v100, v100, v54
    v_mul_f32 v101, v101, v55
    v_cvt_pk_bf16_f32 v178, v100, v101
    v_mfma_f32_16x16x32_bf16 v[228:231], v[220:223], v[140:143], v[228:231]
    ds_read_b64_tr_b16 v[204:205], v15 offset:24576
    ds_read_b64_tr_b16 v[206:207], v15 offset:28672
    v_mfma_f32_16x16x32_bf16 v[236:239], v[208:211], v[144:147], 0
    v_mul_f32 v102, v102, v29
    v_mul_f32 v103, v103, v29
    v_mul_f32 v56, v102, v102
    v_mul_f32 v57, v103, v103
    v_fmaak_f32 v56, v56, v61, 0xc0135761
    v_fmaak_f32 v57, v57, v61, 0xc0135761
    v_mul_f32 v56, v56, v102
    v_mul_f32 v57, v57, v103
    v_exp_f32 v56, v56
    v_exp_f32 v57, v57
    v_mfma_f32_16x16x32_bf16 v[236:239], v[212:215], v[148:151], v[236:239]
    ds_read_b64_tr_b16 v[208:209], v16 offset:0
    ds_read_b64_tr_b16 v[210:211], v16 offset:4096
    v_mfma_f32_16x16x32_bf16 v[236:239], v[216:219], v[152:155], v[236:239]
    buffer_load_dwordx4 v47, s[48:51], s31 offen offset:3072 lds
    v_add_f32 v56, 1.0, v56
    v_add_f32 v57, 1.0, v57
    v_rcp_f32 v56, v56
    v_rcp_f32 v57, v57
    v_mul_f32 v102, v102, v56
    v_mul_f32 v103, v103, v57
    v_cvt_pk_bf16_f32 v179, v102, v103
    v_mfma_f32_16x16x32_bf16 v[236:239], v[220:223], v[156:159], v[236:239]
    s_add_u32 s31, s31, 0x4000
    ds_read_b64_tr_b16 v[212:213], v16 offset:8192
    ds_read_b64_tr_b16 v[214:215], v16 offset:12288
    s_waitcnt lgkmcnt(8)
    v_mfma_f32_16x16x32_bf16 v[240:243], v[192:195], v[128:131], 0
    s_add_u32 m0, s16, 102400
    v_mul_f32 v104, v104, v37
    v_mul_f32 v105, v105, v37
    v_mul_f32 v54, v104, v104
    v_mul_f32 v55, v105, v105
    v_fmaak_f32 v54, v54, v61, 0xc0135761
    v_fmaak_f32 v55, v55, v61, 0xc0135761
    v_mul_f32 v54, v54, v104
    v_mul_f32 v55, v55, v105
    v_exp_f32 v54, v54
    v_exp_f32 v55, v55
    v_mfma_f32_16x16x32_bf16 v[240:243], v[196:199], v[132:135], v[240:243]
    s_waitcnt lgkmcnt(4)
    buffer_load_dwordx4 v44, s[48:51], s31 offen offset:0 lds
    ds_read_b64_tr_b16 v[216:217], v16 offset:16384
    ds_read_b64_tr_b16 v[218:219], v16 offset:20480
    v_mfma_f32_16x16x32_bf16 v[240:243], v[200:203], v[136:139], v[240:243]
    s_waitcnt vmcnt(17)
    s_barrier
    v_add_f32 v54, 1.0, v54
    v_add_f32 v55, 1.0, v55
    v_rcp_f32 v54, v54
    v_rcp_f32 v55, v55
    v_mul_f32 v104, v104, v54
    v_mul_f32 v105, v105, v55
    v_cvt_pk_bf16_f32 v180, v104, v105
    v_mfma_f32_16x16x32_bf16 v[240:243], v[204:207], v[140:143], v[240:243]
    ds_read_b64_tr_b16 v[220:221], v16 offset:24576
    ds_read_b64_tr_b16 v[222:223], v16 offset:28672
    v_mfma_f32_16x16x32_bf16 v[248:251], v[192:195], v[144:147], 0
    buffer_load_dwordx4 v45, s[48:51], s31 offen offset:1024 lds
    buffer_load_dword v26, off, s[76:79], s92 offset:768 sc1
    v_mul_f32 v106, v106, v37
    v_mul_f32 v107, v107, v37
    v_mul_f32 v56, v106, v106
    v_mul_f32 v57, v107, v107
    v_fmaak_f32 v56, v56, v61, 0xc0135761
    v_fmaak_f32 v57, v57, v61, 0xc0135761
    v_mul_f32 v56, v56, v106
    v_mul_f32 v57, v57, v107
    v_exp_f32 v56, v56
    v_exp_f32 v57, v57
    v_add_u32 v9, 4294901760, v9
    v_mfma_f32_16x16x32_bf16 v[248:251], v[196:199], v[148:151], v[248:251]
    ds_read_b64_tr_b16 v[192:193], v9 offset:0
    ds_read_b64_tr_b16 v[194:195], v9 offset:4096
    v_mfma_f32_16x16x32_bf16 v[248:251], v[200:203], v[152:155], v[248:251]
    v_add_f32 v56, 1.0, v56
    v_add_f32 v57, 1.0, v57
    v_rcp_f32 v56, v56
    v_rcp_f32 v57, v57
    v_mul_f32 v106, v106, v56
    v_mul_f32 v107, v107, v57
    v_cvt_pk_bf16_f32 v181, v106, v107
    v_mfma_f32_16x16x32_bf16 v[248:251], v[204:207], v[156:159], v[248:251]
    s_waitcnt lgkmcnt(6)
    ds_read_b64_tr_b16 v[196:197], v9 offset:8192
    ds_read_b64_tr_b16 v[198:199], v9 offset:12288
    v_mfma_f32_16x16x32_bf16 v[244:247], v[208:211], v[128:131], 0
    buffer_load_dwordx4 v46, s[48:51], s31 offen offset:2048 lds
    v_mul_f32 v108, v108, v37
    v_mul_f32 v109, v109, v37
    v_mul_f32 v54, v108, v108
    v_mul_f32 v55, v109, v109
    v_fmaak_f32 v54, v54, v61, 0xc0135761
    v_fmaak_f32 v55, v55, v61, 0xc0135761
    v_mul_f32 v54, v54, v108
    v_mul_f32 v55, v55, v109
    v_exp_f32 v54, v54
    v_exp_f32 v55, v55
    v_mfma_f32_16x16x32_bf16 v[244:247], v[212:215], v[132:135], v[244:247]
    s_waitcnt lgkmcnt(4)
    ds_read_b64_tr_b16 v[200:201], v9 offset:16384
    ds_read_b64_tr_b16 v[202:203], v9 offset:20480
    v_mfma_f32_16x16x32_bf16 v[244:247], v[216:219], v[136:139], v[244:247]
    v_add_f32 v54, 1.0, v54
    v_add_f32 v55, 1.0, v55
    v_rcp_f32 v54, v54
    v_rcp_f32 v55, v55
    v_mul_f32 v108, v108, v54
    v_mul_f32 v109, v109, v55
    v_cvt_pk_bf16_f32 v182, v108, v109
    v_mfma_f32_16x16x32_bf16 v[244:247], v[220:223], v[140:143], v[244:247]
    buffer_load_dwordx4 v47, s[48:51], s31 offen offset:3072 lds
    ds_read_b64_tr_b16 v[204:205], v9 offset:24576
    ds_read_b64_tr_b16 v[206:207], v9 offset:28672
    v_mfma_f32_16x16x32_bf16 v[252:255], v[208:211], v[144:147], 0
    v_mul_f32 v110, v110, v37
    v_mul_f32 v111, v111, v37
    v_mul_f32 v56, v110, v110
    v_mul_f32 v57, v111, v111
    v_fmaak_f32 v56, v56, v61, 0xc0135761
    v_fmaak_f32 v57, v57, v61, 0xc0135761
    v_mul_f32 v56, v56, v110
    v_mul_f32 v57, v57, v111
    v_exp_f32 v56, v56
    v_exp_f32 v57, v57
    v_add_u32 v10, 4294901760, v10
    v_mfma_f32_16x16x32_bf16 v[252:255], v[212:215], v[148:151], v[252:255]
    ds_read_b64_tr_b16 v[208:209], v10 offset:0
    ds_read_b64_tr_b16 v[210:211], v10 offset:4096
    v_mfma_f32_16x16x32_bf16 v[252:255], v[216:219], v[152:155], v[252:255]
    v_add_f32 v56, 1.0, v56
    v_add_f32 v57, 1.0, v57
    v_rcp_f32 v56, v56
    v_rcp_f32 v57, v57
    v_mul_f32 v110, v110, v56
    v_mul_f32 v111, v111, v57
    v_cvt_pk_bf16_f32 v183, v110, v111
    v_mfma_f32_16x16x32_bf16 v[252:255], v[220:223], v[156:159], v[252:255]
    ds_read_b64_tr_b16 v[212:213], v10 offset:8192
    ds_read_b64_tr_b16 v[214:215], v10 offset:12288
    s_waitcnt vmcnt(2)
    v_cmp_gt_u32 vcc, 8, v26
    s_cbranch_vccnz L_spin_9
L_back_10:
    s_and_b32 s28, s4, 7
    s_cmp_ge_u32 0, s28
    s_cselect_b32 s28, 1, 0
    s_lshl_b32 s28, s28, 12
    s_add_u32 s13, s28, s12
    s_add_u32 s92, s13, 0x20000
    buffer_load_dwordx4 a[0:3], v25, s[76:79], s13 offen offset:0 sc1
    buffer_load_dwordx4 a[4:7], v25, s[76:79], s92 offen offset:0 sc1
    buffer_load_dwordx4 a[8:11], v25, s[76:79], s13 offen offset:1024 sc1
    buffer_load_dwordx4 a[12:15], v25, s[76:79], s92 offen offset:1024 sc1
    buffer_load_dwordx4 a[16:19], v25, s[76:79], s13 offen offset:2048 sc1
    buffer_load_dwordx4 a[20:23], v25, s[76:79], s92 offen offset:2048 sc1
    buffer_load_dwordx4 a[24:27], v25, s[76:79], s13 offen offset:3072 sc1
    buffer_load_dwordx4 a[28:31], v25, s[76:79], s92 offen offset:3072 sc1
    s_and_b32 s28, s4, 7
    s_cmp_ge_u32 1, s28
    s_cselect_b32 s28, 2, 1
    s_lshl_b32 s28, s28, 12
    s_add_u32 s13, s28, s12
    s_add_u32 s92, s13, 0x20000
    buffer_load_dwordx4 a[32:35], v25, s[76:79], s13 offen offset:0 sc1
    buffer_load_dwordx4 a[36:39], v25, s[76:79], s92 offen offset:0 sc1
    buffer_load_dwordx4 a[40:43], v25, s[76:79], s13 offen offset:1024 sc1
    buffer_load_dwordx4 a[44:47], v25, s[76:79], s92 offen offset:1024 sc1
    buffer_load_dwordx4 a[48:51], v25, s[76:79], s13 offen offset:2048 sc1
    buffer_load_dwordx4 a[52:55], v25, s[76:79], s92 offen offset:2048 sc1
    buffer_load_dwordx4 a[56:59], v25, s[76:79], s13 offen offset:3072 sc1
    buffer_load_dwordx4 a[60:63], v25, s[76:79], s92 offen offset:3072 sc1
    buffer_store_dwordx4 v[176:179], v27, s[76:79], s14 offen offset:2048 sc1
    buffer_store_dwordx4 v[180:183], v27, s[76:79], s15 offen offset:2048 sc1
    s_barrier
    s_mov_b64 exec, 0
    s_cmp_eq_u32 s5, 0
    s_cbranch_scc1 L_warm1_0
    s_cmp_eq_u32 s5, 1
    s_cbranch_scc1 L_warm1_1
    s_cmp_eq_u32 s5, 2
    s_cbranch_scc1 L_warm1_2
    s_branch L_warm1_3
L_warm_ret1:
    s_mov_b64 exec, -1
    ds_read_b64_tr_b16 v[216:217], v10 offset:16384
    ds_read_b64_tr_b16 v[218:219], v10 offset:20480
    ds_read_b64_tr_b16 v[220:221], v10 offset:24576
    ds_read_b64_tr_b16 v[222:223], v10 offset:28672
    s_and_b32 s28, s4, 7
    s_cmp_ge_u32 2, s28
    s_cselect_b32 s28, 3, 2
    s_waitcnt vmcnt(10) lgkmcnt(8)
    s_lshl_b32 s28, s28, 12
    v_mfma_f32_16x16x32_bf16 v[64:67], v[192:195], a[0:3], v[64:67]
    v_lshrrev_b32 v50, 3, v0
    v_lshrrev_b32 v51, 4, v0
    v_mfma_f32_16x16x32_bf16 v[64:67], v[196:199], a[8:11], v[64:67]
    s_and_b32 s31, s4, 7
    s_cmp_ge_u32 3, s31
    s_cselect_b32 s31, 4, 3
    s_add_u32 s13, s28, s12
    v_mfma_f32_16x16x32_bf16 v[64:67], v[200:203], a[16:19], v[64:67]
    s_lshl_b32 s31, s31, 17
    buffer_load_dwordx4 a[64:67], v25, s[76:79], s13 offen offset:0 sc1
    v_mfma_f32_16x16x32_bf16 v[64:67], v[204:207], a[24:27], v[64:67]
    s_add_u32 m0, s16, 131072
    s_add_u32 s92, s13, 0x20000
    v_lshlrev_b32 v52, 1, v51
    v_mfma_f32_16x16x32_bf16 v[72:75], v[192:195], a[4:7], v[72:75]
    v_and_b32 v53, 7, v0
    v_add_u32 v11, 4294901760, v11
    v_mfma_f32_16x16x32_bf16 v[72:75], v[196:199], a[12:15], v[72:75]
    ds_read_b64_tr_b16 v[192:193], v11 offset:0
    ds_read_b64_tr_b16 v[194:195], v11 offset:4096
    v_mfma_f32_16x16x32_bf16 v[72:75], v[200:203], a[20:23], v[72:75]
    buffer_load_dwordx4 v44, s[48:51], s31 offen offset:0 lds
    v_mfma_f32_16x16x32_bf16 v[72:75], v[204:207], a[28:31], v[72:75]
    s_waitcnt lgkmcnt(6)
    ds_read_b64_tr_b16 v[196:197], v11 offset:8192
    ds_read_b64_tr_b16 v[198:199], v11 offset:12288
    v_mfma_f32_16x16x32_bf16 v[68:71], v[208:211], a[0:3], v[68:71]
    buffer_load_dwordx4 v45, s[48:51], s31 offen offset:1024 lds
    v_mfma_f32_16x16x32_bf16 v[68:71], v[212:215], a[8:11], v[68:71]
    s_waitcnt lgkmcnt(4)
    ds_read_b64_tr_b16 v[200:201], v11 offset:16384
    ds_read_b64_tr_b16 v[202:203], v11 offset:20480
    v_mfma_f32_16x16x32_bf16 v[68:71], v[216:219], a[16:19], v[68:71]
    buffer_load_dwordx4 a[68:71], v25, s[76:79], s92 offen offset:0 sc1
    v_mfma_f32_16x16x32_bf16 v[68:71], v[220:223], a[24:27], v[68:71]
    ds_read_b64_tr_b16 v[204:205], v11 offset:24576
    ds_read_b64_tr_b16 v[206:207], v11 offset:28672
    v_mfma_f32_16x16x32_bf16 v[76:79], v[208:211], a[4:7], v[76:79]
    v_xor_b32 v52, v52, v53
    v_add_u32 v12, 4294901760, v12
    v_mfma_f32_16x16x32_bf16 v[76:79], v[212:215], a[12:15], v[76:79]
    ds_read_b64_tr_b16 v[208:209], v12 offset:0
    ds_read_b64_tr_b16 v[210:211], v12 offset:4096
    v_mfma_f32_16x16x32_bf16 v[76:79], v[216:219], a[20:23], v[76:79]
    buffer_load_dwordx4 v46, s[48:51], s31 offen offset:2048 lds
    v_mfma_f32_16x16x32_bf16 v[76:79], v[220:223], a[28:31], v[76:79]
    s_waitcnt lgkmcnt(6)
    ds_read_b64_tr_b16 v[212:213], v12 offset:8192
    ds_read_b64_tr_b16 v[214:215], v12 offset:12288
    v_mfma_f32_16x16x32_bf16 v[112:115], v[192:195], a[0:3], v[112:115]
    buffer_load_dwordx4 v47, s[48:51], s31 offen offset:3072 lds
    v_mfma_f32_16x16x32_bf16 v[112:115], v[196:199], a[8:11], v[112:115]
    s_waitcnt lgkmcnt(4)
    ds_read_b64_tr_b16 v[216:217], v12 offset:16384
    ds_read_b64_tr_b16 v[218:219], v12 offset:20480
    v_mfma_f32_16x16x32_bf16 v[112:115], v[200:203], a[16:19], v[112:115]
    s_add_u32 s31, s31, 0x4000
    buffer_load_dwordx4 a[72:75], v25, s[76:79], s13 offen offset:1024 sc1
    v_mfma_f32_16x16x32_bf16 v[112:115], v[204:207], a[24:27], v[112:115]
    s_add_u32 m0, s16, 135168
    ds_read_b64_tr_b16 v[220:221], v12 offset:24576
    ds_read_b64_tr_b16 v[222:223], v12 offset:28672
    v_mfma_f32_16x16x32_bf16 v[120:123], v[192:195], a[4:7], v[120:123]
    v_lshlrev_b32 v52, 4, v52
    v_add_u32 v13, 4294901760, v13
    v_mfma_f32_16x16x32_bf16 v[120:123], v[196:199], a[12:15], v[120:123]
    ds_read_b64_tr_b16 v[192:193], v13 offset:0
    ds_read_b64_tr_b16 v[194:195], v13 offset:4096
    v_mfma_f32_16x16x32_bf16 v[120:123], v[200:203], a[20:23], v[120:123]
    buffer_load_dwordx4 v44, s[48:51], s31 offen offset:0 lds
    v_mfma_f32_16x16x32_bf16 v[120:123], v[204:207], a[28:31], v[120:123]
    s_waitcnt lgkmcnt(6)
    ds_read_b64_tr_b16 v[196:197], v13 offset:8192
    ds_read_b64_tr_b16 v[198:199], v13 offset:12288
    v_mfma_f32_16x16x32_bf16 v[116:119], v[208:211], a[0:3], v[116:119]
    buffer_load_dwordx4 v45, s[48:51], s31 offen offset:1024 lds
    v_mfma_f32_16x16x32_bf16 v[116:119], v[212:215], a[8:11], v[116:119]
    s_waitcnt lgkmcnt(4)
    ds_read_b64_tr_b16 v[200:201], v13 offset:16384
    ds_read_b64_tr_b16 v[202:203], v13 offset:20480
    v_mfma_f32_16x16x32_bf16 v[116:119], v[216:219], a[16:19], v[116:119]
    buffer_load_dwordx4 a[76:79], v25, s[76:79], s92 offen offset:1024 sc1
    v_mfma_f32_16x16x32_bf16 v[116:119], v[220:223], a[24:27], v[116:119]
    ds_read_b64_tr_b16 v[204:205], v13 offset:24576
    ds_read_b64_tr_b16 v[206:207], v13 offset:28672
    v_mfma_f32_16x16x32_bf16 v[124:127], v[208:211], a[4:7], v[124:127]
    v_lshl_add_u32 v50, v50, 10, v52
    v_add_u32 v14, 4294901760, v14
    v_mfma_f32_16x16x32_bf16 v[124:127], v[212:215], a[12:15], v[124:127]
    s_and_b32 s24, s8, 1
    ds_read_b64_tr_b16 v[208:209], v14 offset:0
    ds_read_b64_tr_b16 v[210:211], v14 offset:4096
    v_mfma_f32_16x16x32_bf16 v[124:127], v[216:219], a[20:23], v[124:127]
    s_lshl_b32 s24, s24, 7
    buffer_load_dwordx4 v46, s[48:51], s31 offen offset:2048 lds
    v_mfma_f32_16x16x32_bf16 v[124:127], v[220:223], a[28:31], v[124:127]
    s_waitcnt lgkmcnt(6)
    ds_read_b64_tr_b16 v[212:213], v14 offset:8192
    ds_read_b64_tr_b16 v[214:215], v14 offset:12288
    v_mfma_f32_16x16x32_bf16 v[224:227], v[192:195], a[0:3], v[224:227]
    buffer_load_dwordx4 v47, s[48:51], s31 offen offset:3072 lds
    s_waitcnt vmcnt(12)
    s_barrier
    v_mfma_f32_16x16x32_bf16 v[224:227], v[196:199], a[8:11], v[224:227]
    s_and_b32 s31, s4, 7
    s_cmp_ge_u32 4, s31
    s_cselect_b32 s31, 5, 4
    ds_read_b64_tr_b16 v[216:217], v14 offset:16384
    ds_read_b64_tr_b16 v[218:219], v14 offset:20480
    s_waitcnt lgkmcnt(6)
    v_mfma_f32_16x16x32_bf16 v[224:227], v[200:203], a[16:19], v[224:227]
    s_lshl_b32 s31, s31, 17
    buffer_atomic_add v62, v63, s[76:79], s97 offen offset:512 sc1
    buffer_load_dwordx4 a[80:83], v25, s[76:79], s13 offen offset:2048 sc1
    v_mfma_f32_16x16x32_bf16 v[224:227], v[204:207], a[24:27], v[224:227]
    s_add_u32 m0, s16, 65536
    ds_read_b64_tr_b16 v[220:221], v14 offset:24576
    ds_read_b64_tr_b16 v[222:223], v14 offset:28672
    v_mfma_f32_16x16x32_bf16 v[232:235], v[192:195], a[4:7], v[232:235]
    s_lshl_b32 s25, s9, 8
    s_add_u32 s24, s24, s25
    v_add_u32 v15, 4294901760, v15
    v_mfma_f32_16x16x32_bf16 v[232:235], v[196:199], a[12:15], v[232:235]
    ds_read_b64_tr_b16 v[192:193], v15 offset:0
    ds_read_b64_tr_b16 v[194:195], v15 offset:4096
    v_mfma_f32_16x16x32_bf16 v[232:235], v[200:203], a[20:23], v[232:235]
    buffer_load_dwordx4 v44, s[48:51], s31 offen offset:0 lds
    v_mfma_f32_16x16x32_bf16 v[232:235], v[204:207], a[28:31], v[232:235]
    s_waitcnt lgkmcnt(6)
    ds_read_b64_tr_b16 v[196:197], v15 offset:8192
    ds_read_b64_tr_b16 v[198:199], v15 offset:12288
    v_mfma_f32_16x16x32_bf16 v[228:231], v[208:211], a[0:3], v[228:231]
    buffer_load_dwordx4 v45, s[48:51], s31 offen offset:1024 lds
    v_mfma_f32_16x16x32_bf16 v[228:231], v[212:215], a[8:11], v[228:231]
    s_waitcnt lgkmcnt(4)
    ds_read_b64_tr_b16 v[200:201], v15 offset:16384
    ds_read_b64_tr_b16 v[202:203], v15 offset:20480
    v_mfma_f32_16x16x32_bf16 v[228:231], v[216:219], a[16:19], v[228:231]
    buffer_load_dwordx4 a[84:87], v25, s[76:79], s92 offen offset:2048 sc1
    v_mfma_f32_16x16x32_bf16 v[228:231], v[220:223], a[24:27], v[228:231]
    ds_read_b64_tr_b16 v[204:205], v15 offset:24576
    ds_read_b64_tr_b16 v[206:207], v15 offset:28672
    v_mfma_f32_16x16x32_bf16 v[236:239], v[208:211], a[4:7], v[236:239]
    v_add_u32 v36, s24, v50
L_warm1_0:
    s_cbranch_execz L_warm_ret1
    v_add_u32 v16, 4294901760, v16
    v_mfma_f32_16x16x32_bf16 v[236:239], v[212:215], a[12:15], v[236:239]
    ds_read_b64_tr_b16 v[208:209], v16 offset:0
    ds_read_b64_tr_b16 v[210:211], v16 offset:4096
    v_mfma_f32_16x16x32_bf16 v[236:239], v[216:219], a[20:23], v[236:239]
    buffer_load_dwordx4 v46, s[48:51], s31 offen offset:2048 lds
    v_mfma_f32_16x16x32_bf16 v[236:239], v[220:223], a[28:31], v[236:239]
    s_waitcnt lgkmcnt(6)
    ds_read_b64_tr_b16 v[212:213], v16 offset:8192
    ds_read_b64_tr_b16 v[214:215], v16 offset:12288
    v_mfma_f32_16x16x32_bf16 v[240:243], v[192:195], a[0:3], v[240:243]
    buffer_load_dwordx4 v47, s[48:51], s31 offen offset:3072 lds
    v_mfma_f32_16x16x32_bf16 v[240:243], v[196:199], a[8:11], v[240:243]
    s_waitcnt lgkmcnt(4)
    ds_read_b64_tr_b16 v[216:217], v16 offset:16384
    ds_read_b64_tr_b16 v[218:219], v16 offset:20480
    v_mfma_f32_16x16x32_bf16 v[240:243], v[200:203], a[16:19], v[240:243]
    s_add_u32 s31, s31, 0x4000
    s_barrier
    buffer_load_dwordx4 a[88:91], v25, s[76:79], s13 offen offset:3072 sc1
    v_mfma_f32_16x16x32_bf16 v[240:243], v[204:207], a[24:27], v[240:243]
    s_add_u32 m0, s16, 69632
    ds_read_b64_tr_b16 v[220:221], v16 offset:24576
    ds_read_b64_tr_b16 v[222:223], v16 offset:28672
    v_mfma_f32_16x16x32_bf16 v[248:251], v[192:195], a[4:7], v[248:251]
    buffer_load_dwordx4 v44, s[48:51], s31 offen offset:0 lds
    v_mfma_f32_16x16x32_bf16 v[248:251], v[196:199], a[12:15], v[248:251]
    ds_read_b64_tr_b16 v[192:193], v9 offset:32768
    ds_read_b64_tr_b16 v[194:195], v9 offset:36864
    v_mfma_f32_16x16x32_bf16 v[248:251], v[200:203], a[20:23], v[248:251]
    v_add_u32 v37, 7168, v36
    v_add_u32 v38, 14336, v36
    v_mfma_f32_16x16x32_bf16 v[248:251], v[204:207], a[28:31], v[248:251]
    s_waitcnt lgkmcnt(6)
    ds_read_b64_tr_b16 v[196:197], v9 offset:40960
    ds_read_b64_tr_b16 v[198:199], v9 offset:45056
    v_mfma_f32_16x16x32_bf16 v[244:247], v[208:211], a[0:3], v[244:247]
    buffer_load_dwordx4 v45, s[48:51], s31 offen offset:1024 lds
    v_mfma_f32_16x16x32_bf16 v[244:247], v[212:215], a[8:11], v[244:247]
    s_waitcnt lgkmcnt(4)
    ds_read_b64_tr_b16 v[200:201], v9 offset:49152
    ds_read_b64_tr_b16 v[202:203], v9 offset:53248
    v_mfma_f32_16x16x32_bf16 v[244:247], v[216:219], a[16:19], v[244:247]
    buffer_load_dwordx4 a[92:95], v25, s[76:79], s92 offen offset:3072 sc1
    v_mfma_f32_16x16x32_bf16 v[244:247], v[220:223], a[24:27], v[244:247]
    ds_read_b64_tr_b16 v[204:205], v9 offset:57344
    ds_read_b64_tr_b16 v[206:207], v9 offset:61440
    v_mfma_f32_16x16x32_bf16 v[252:255], v[208:211], a[4:7], v[252:255]
    buffer_load_dwordx4 v46, s[48:51], s31 offen offset:2048 lds
    v_mfma_f32_16x16x32_bf16 v[252:255], v[212:215], a[12:15], v[252:255]
    ds_read_b64_tr_b16 v[208:209], v10 offset:32768
    ds_read_b64_tr_b16 v[210:211], v10 offset:36864
    v_mfma_f32_16x16x32_bf16 v[252:255], v[216:219], a[20:23], v[252:255]
    s_and_b32 s28, s4, 7
    s_cmp_ge_u32 3, s28
    s_cselect_b32 s28, 4, 3
    v_mfma_f32_16x16x32_bf16 v[252:255], v[220:223], a[28:31], v[252:255]
    s_lshl_b32 s28, s28, 12
    ds_read_b64_tr_b16 v[212:213], v10 offset:40960
    ds_read_b64_tr_b16 v[214:215], v10 offset:45056
    s_waitcnt lgkmcnt(8)
    v_mfma_f32_16x16x32_bf16 v[64:67], v[192:195], a[32:35], v[64:67]
    s_barrier
    v_mfma_f32_16x16x32_bf16 v[64:67], v[196:199], a[40:43], v[64:67]
    s_add_u32 s13, s28, s12
    ds_read_b64_tr_b16 v[216:217], v10 offset:49152
    ds_read_b64_tr_b16 v[218:219], v10 offset:53248
    s_waitcnt lgkmcnt(6)
    v_mfma_f32_16x16x32_bf16 v[64:67], v[200:203], a[48:51], v[64:67]
    buffer_load_dwordx4 v47, s[48:51], s31 offen offset:3072 lds
    v_mfma_f32_16x16x32_bf16 v[64:67], v[204:207], a[56:59], v[64:67]
    s_and_b32 s31, s4, 7
    ds_read_b64_tr_b16 v[220:221], v10 offset:57344
    ds_read_b64_tr_b16 v[222:223], v10 offset:61440
    s_cmp_ge_u32 5, s31
    s_cselect_b32 s31, 6, 5
    s_add_u32 s92, s13, 0x20000
    v_mfma_f32_16x16x32_bf16 v[72:75], v[192:195], a[36:39], v[72:75]
    s_lshl_b32 s31, s31, 17
    buffer_load_dwordx4 a[96:99], v25, s[76:79], s13 offen offset:0 sc1
    v_mfma_f32_16x16x32_bf16 v[72:75], v[196:199], a[44:47], v[72:75]
    s_add_u32 m0, s16, 0
    ds_read_b64_tr_b16 v[192:193], v11 offset:32768
    ds_read_b64_tr_b16 v[194:195], v11 offset:36864
    v_mfma_f32_16x16x32_bf16 v[72:75], v[200:203], a[52:55], v[72:75]
    buffer_load_dwordx4 v44, s[48:51], s31 offen offset:0 lds
    v_mfma_f32_16x16x32_bf16 v[72:75], v[204:207], a[60:63], v[72:75]
    s_waitcnt lgkmcnt(6)
    ds_read_b64_tr_b16 v[196:197], v11 offset:40960
    ds_read_b64_tr_b16 v[198:199], v11 offset:45056
    v_mfma_f32_16x16x32_bf16 v[68:71], v[208:211], a[32:35], v[68:71]
    v_add_u32 v39, 21504, v36
    v_mfma_f32_16x16x32_bf16 v[68:71], v[212:215], a[40:43], v[68:71]
    s_waitcnt lgkmcnt(4)
    ds_read_b64_tr_b16 v[200:201], v11 offset:49152
    ds_read_b64_tr_b16 v[202:203], v11 offset:53248
    v_mfma_f32_16x16x32_bf16 v[68:71], v[216:219], a[48:51], v[68:71]
    s_and_b32 s24, s8, 2
    buffer_load_dwordx4 a[100:103], v25, s[76:79], s92 offen offset:0 sc1
    v_mfma_f32_16x16x32_bf16 v[68:71], v[220:223], a[56:59], v[68:71]
    s_lshl_b32 s24, s24, 1
    ds_read_b64_tr_b16 v[204:205], v11 offset:57344
    ds_read_b64_tr_b16 v[206:207], v11 offset:61440
    v_mfma_f32_16x16x32_bf16 v[76:79], v[208:211], a[36:39], v[76:79]
    s_lshl_b32 s25, s3, 3
    s_add_u32 s24, s24, s25
    s_add_u32 s10, s24, s6
    v_mfma_f32_16x16x32_bf16 v[76:79], v[212:215], a[44:47], v[76:79]
    s_mul_i32 s24, s10, 88064
    ds_read_b64_tr_b16 v[208:209], v12 offset:32768
    ds_read_b64_tr_b16 v[210:211], v12 offset:36864
    v_mfma_f32_16x16x32_bf16 v[76:79], v[216:219], a[52:55], v[76:79]
    s_add_u32 s24, s24, 5242880
    buffer_load_dwordx4 v45, s[48:51], s31 offen offset:1024 lds
    v_mfma_f32_16x16x32_bf16 v[76:79], v[220:223], a[60:63], v[76:79]
    s_waitcnt lgkmcnt(6)
    ds_read_b64_tr_b16 v[212:213], v12 offset:40960
    ds_read_b64_tr_b16 v[214:215], v12 offset:45056
    v_mfma_f32_16x16x32_bf16 v[112:115], v[192:195], a[32:35], v[112:115]
    v_add_u32 v40, s24, v25
    v_add_u32 v41, 43008, v40
    v_mfma_f32_16x16x32_bf16 v[112:115], v[196:199], a[40:43], v[112:115]
    s_waitcnt lgkmcnt(4)
    ds_read_b64_tr_b16 v[216:217], v12 offset:49152
    ds_read_b64_tr_b16 v[218:219], v12 offset:53248
    v_mfma_f32_16x16x32_bf16 v[112:115], v[200:203], a[48:51], v[112:115]
    buffer_load_dwordx4 a[104:107], v25, s[76:79], s13 offen offset:1024 sc1
    v_mfma_f32_16x16x32_bf16 v[112:115], v[204:207], a[56:59], v[112:115]
    ds_read_b64_tr_b16 v[220:221], v12 offset:57344
    ds_read_b64_tr_b16 v[222:223], v12 offset:61440
    v_mfma_f32_16x16x32_bf16 v[120:123], v[192:195], a[36:39], v[120:123]
    v_add_u32 v42, 174080, v40
    v_add_u32 v43, 217088, v40
    v_mfma_f32_16x16x32_bf16 v[120:123], v[196:199], a[44:47], v[120:123]
    ds_read_b64_tr_b16 v[192:193], v13 offset:32768
    ds_read_b64_tr_b16 v[194:195], v13 offset:36864
    v_mfma_f32_16x16x32_bf16 v[120:123], v[200:203], a[52:55], v[120:123]
    buffer_load_dwordx4 v46, s[48:51], s31 offen offset:2048 lds
    v_mfma_f32_16x16x32_bf16 v[120:123], v[204:207], a[60:63], v[120:123]
    s_waitcnt lgkmcnt(6)
    ds_read_b64_tr_b16 v[196:197], v13 offset:40960
    ds_read_b64_tr_b16 v[198:199], v13 offset:45056
    v_mfma_f32_16x16x32_bf16 v[116:119], v[208:211], a[32:35], v[116:119]
    v_bfe_u32 v50, v0, 2, 2
    v_lshl_add_u32 v50, v51, 2, v50
    v_mfma_f32_16x16x32_bf16 v[116:119], v[212:215], a[40:43], v[116:119]
    s_waitcnt lgkmcnt(4)
    ds_read_b64_tr_b16 v[200:201], v13 offset:49152
    ds_read_b64_tr_b16 v[202:203], v13 offset:53248
    v_mfma_f32_16x16x32_bf16 v[116:119], v[216:219], a[48:51], v[116:119]
    buffer_load_dwordx4 a[108:111], v25, s[76:79], s92 offen offset:1024 sc1
    v_mfma_f32_16x16x32_bf16 v[116:119], v[220:223], a[56:59], v[116:119]
    ds_read_b64_tr_b16 v[204:205], v13 offset:57344
    ds_read_b64_tr_b16 v[206:207], v13 offset:61440
    v_mfma_f32_16x16x32_bf16 v[124:127], v[208:211], a[36:39], v[124:127]
    v_bfe_u32 v52, v50, 1, 2
    v_mfma_f32_16x16x32_bf16 v[124:127], v[212:215], a[44:47], v[124:127]
    s_and_b32 s24, s5, 1
    ds_read_b64_tr_b16 v[208:209], v14 offset:32768
    ds_read_b64_tr_b16 v[210:211], v14 offset:36864
    v_mfma_f32_16x16x32_bf16 v[124:127], v[216:219], a[52:55], v[124:127]
    s_lshl_b32 s27, s24, 1
    buffer_load_dwordx4 v47, s[48:51], s31 offen offset:3072 lds
    v_mfma_f32_16x16x32_bf16 v[124:127], v[220:223], a[60:63], v[124:127]
    s_waitcnt lgkmcnt(6)
    ds_read_b64_tr_b16 v[212:213], v14 offset:40960
    ds_read_b64_tr_b16 v[214:215], v14 offset:45056
    v_mfma_f32_16x16x32_bf16 v[224:227], v[192:195], a[32:35], v[224:227]
    v_xor_b32 v52, s27, v52
    v_lshlrev_b32 v50, 7, v50
    v_mfma_f32_16x16x32_bf16 v[224:227], v[196:199], a[40:43], v[224:227]
    s_waitcnt lgkmcnt(4)
    ds_read_b64_tr_b16 v[216:217], v14 offset:49152
    ds_read_b64_tr_b16 v[218:219], v14 offset:53248
    v_mfma_f32_16x16x32_bf16 v[224:227], v[200:203], a[48:51], v[224:227]
    buffer_load_dwordx4 a[112:115], v25, s[76:79], s13 offen offset:2048 sc1
    v_mfma_f32_16x16x32_bf16 v[224:227], v[204:207], a[56:59], v[224:227]
    ds_read_b64_tr_b16 v[220:221], v14 offset:57344
    ds_read_b64_tr_b16 v[222:223], v14 offset:61440
    v_mfma_f32_16x16x32_bf16 v[232:235], v[192:195], a[36:39], v[232:235]
    s_add_u32 s31, s31, 0x4000
    v_lshl_add_u32 v50, v52, 5, v50
    v_and_b32 v52, 3, v0
    v_mfma_f32_16x16x32_bf16 v[232:235], v[196:199], a[44:47], v[232:235]
    s_add_u32 m0, s16, 4096
    ds_read_b64_tr_b16 v[192:193], v15 offset:32768
    ds_read_b64_tr_b16 v[194:195], v15 offset:36864
    v_mfma_f32_16x16x32_bf16 v[232:235], v[200:203], a[52:55], v[232:235]
    buffer_load_dwordx4 v44, s[48:51], s31 offen offset:0 lds
    v_mfma_f32_16x16x32_bf16 v[232:235], v[204:207], a[60:63], v[232:235]
    s_waitcnt lgkmcnt(6)
    ds_read_b64_tr_b16 v[196:197], v15 offset:40960
    ds_read_b64_tr_b16 v[198:199], v15 offset:45056
    v_mfma_f32_16x16x32_bf16 v[228:231], v[208:211], a[32:35], v[228:231]
    v_lshl_add_u32 v17, v52, 3, v50
    v_xor_b32 v18, 32, v17
    v_mfma_f32_16x16x32_bf16 v[228:231], v[212:215], a[40:43], v[228:231]
    s_waitcnt lgkmcnt(4)
    ds_read_b64_tr_b16 v[200:201], v15 offset:49152
    ds_read_b64_tr_b16 v[202:203], v15 offset:53248
    v_mfma_f32_16x16x32_bf16 v[228:231], v[216:219], a[48:51], v[228:231]
    s_lshr_b32 s25, s5, 1
    buffer_load_dwordx4 a[116:119], v25, s[76:79], s92 offen offset:2048 sc1
    v_mfma_f32_16x16x32_bf16 v[228:231], v[220:223], a[56:59], v[228:231]
    s_lshl_b32 s27, s25, 11
    ds_read_b64_tr_b16 v[204:205], v15 offset:57344
    ds_read_b64_tr_b16 v[206:207], v15 offset:61440
    v_mfma_f32_16x16x32_bf16 v[236:239], v[208:211], a[36:39], v[236:239]
    s_add_u32 s27, s27, 4096
    v_add_u32 v23, s27, v25
    v_add_u32 v19, 65536, v17
    v_mfma_f32_16x16x32_bf16 v[236:239], v[212:215], a[44:47], v[236:239]
    ds_read_b64_tr_b16 v[208:209], v16 offset:32768
    ds_read_b64_tr_b16 v[210:211], v16 offset:36864
    v_mfma_f32_16x16x32_bf16 v[236:239], v[216:219], a[52:55], v[236:239]
    buffer_load_dwordx4 v45, s[48:51], s31 offen offset:1024 lds
    v_mfma_f32_16x16x32_bf16 v[236:239], v[220:223], a[60:63], v[236:239]
    s_waitcnt lgkmcnt(6)
    ds_read_b64_tr_b16 v[212:213], v16 offset:40960
    ds_read_b64_tr_b16 v[214:215], v16 offset:45056
    v_mfma_f32_16x16x32_bf16 v[240:243], v[192:195], a[32:35], v[240:243]
    v_add_u32 v20, 65536, v18
    v_add_u32 v24, 65536, v23
    v_mfma_f32_16x16x32_bf16 v[240:243], v[196:199], a[40:43], v[240:243]
    s_waitcnt lgkmcnt(4)
    ds_read_b64_tr_b16 v[216:217], v16 offset:49152
    ds_read_b64_tr_b16 v[218:219], v16 offset:53248
    v_mfma_f32_16x16x32_bf16 v[240:243], v[200:203], a[48:51], v[240:243]
    s_barrier
    buffer_load_dwordx4 a[120:123], v25, s[76:79], s13 offen offset:3072 sc1
    v_mfma_f32_16x16x32_bf16 v[240:243], v[204:207], a[56:59], v[240:243]
    ds_read_b64_tr_b16 v[220:221], v16 offset:57344
    ds_read_b64_tr_b16 v[222:223], v16 offset:61440
    v_mfma_f32_16x16x32_bf16 v[248:251], v[192:195], a[36:39], v[248:251]
    v_add_u32 v21, 131072, v17
    v_add_u32 v9, 65536, v9
    v_mfma_f32_16x16x32_bf16 v[248:251], v[196:199], a[44:47], v[248:251]
    ds_read_b64_tr_b16 v[192:193], v9 offset:32768
    ds_read_b64_tr_b16 v[194:195], v9 offset:36864
    v_mfma_f32_16x16x32_bf16 v[248:251], v[200:203], a[52:55], v[248:251]
    buffer_load_dwordx4 v46, s[48:51], s31 offen offset:2048 lds
    v_mfma_f32_16x16x32_bf16 v[248:251], v[204:207], a[60:63], v[248:251]
    s_waitcnt lgkmcnt(6)
    ds_read_b64_tr_b16 v[196:197], v9 offset:40960
    ds_read_b64_tr_b16 v[198:199], v9 offset:45056
    v_mfma_f32_16x16x32_bf16 v[244:247], v[208:211], a[32:35], v[244:247]
    v_add_u32 v22, 131072, v18
    v_add_u32 v27, 131072, v23
    v_mfma_f32_16x16x32_bf16 v[244:247], v[212:215], a[40:43], v[244:247]
    s_waitcnt lgkmcnt(4)
    ds_read_b64_tr_b16 v[200:201], v9 offset:49152
    ds_read_b64_tr_b16 v[202:203], v9 offset:53248
    v_mfma_f32_16x16x32_bf16 v[244:247], v[216:219], a[48:51], v[244:247]
    s_lshl_b32 s27, s25, 1
    buffer_load_dwordx4 a[124:127], v25, s[76:79], s92 offen offset:3072 sc1
    v_mfma_f32_16x16x32_bf16 v[244:247], v[220:223], a[56:59], v[244:247]
    s_add_u32 s21, s10, s27
    ds_read_b64_tr_b16 v[204:205], v9 offset:57344
    ds_read_b64_tr_b16 v[206:207], v9 offset:61440
    v_mfma_f32_16x16x32_bf16 v[252:255], v[208:211], a[36:39], v[252:255]
    s_and_b32 s27, s8, 1
    s_lshl_b32 s27, s27, 1
    v_add_u32 v10, 65536, v10
    v_mfma_f32_16x16x32_bf16 v[252:255], v[212:215], a[44:47], v[252:255]
    s_add_u32 s27, s27, s24
    ds_read_b64_tr_b16 v[208:209], v10 offset:32768
    ds_read_b64_tr_b16 v[210:211], v10 offset:36864
    v_mfma_f32_16x16x32_bf16 v[252:255], v[216:219], a[52:55], v[252:255]
    s_and_b32 s28, s4, 7
    buffer_load_dwordx4 v47, s[48:51], s31 offen offset:3072 lds
    s_cmp_ge_u32 4, s28
    s_cselect_b32 s28, 5, 4
    v_mfma_f32_16x16x32_bf16 v[252:255], v[220:223], a[60:63], v[252:255]
    s_lshl_b32 s28, s28, 12
    ds_read_b64_tr_b16 v[212:213], v10 offset:40960
    ds_read_b64_tr_b16 v[214:215], v10 offset:45056
    s_waitcnt vmcnt(18) lgkmcnt(8)
    v_mfma_f32_16x16x32_bf16 v[64:67], v[192:195], a[64:67], v[64:67]
    s_barrier
    v_mfma_f32_16x16x32_bf16 v[64:67], v[196:199], a[72:75], v[64:67]
    s_add_u32 s13, s28, s12
    ds_read_b64_tr_b16 v[216:217], v10 offset:49152
    ds_read_b64_tr_b16 v[218:219], v10 offset:53248
    s_waitcnt lgkmcnt(6)
    v_mfma_f32_16x16x32_bf16 v[64:67], v[200:203], a[80:83], v[64:67]
    s_lshl_b32 s22, s9, 2
    buffer_load_dwordx4 a[128:131], v25, s[76:79], s13 offen offset:0 sc1
    v_mfma_f32_16x16x32_bf16 v[64:67], v[204:207], a[88:91], v[64:67]
    s_and_b32 s31, s4, 7
    ds_read_b64_tr_b16 v[220:221], v10 offset:57344
    ds_read_b64_tr_b16 v[222:223], v10 offset:61440
    s_cmp_ge_u32 6, s31
    s_cselect_b32 s31, 7, 6
    s_add_u32 s92, s13, 0x20000
    v_mfma_f32_16x16x32_bf16 v[72:75], v[192:195], a[68:71], v[72:75]
    s_add_u32 s22, s22, s27
    s_lshl_b32 s31, s31, 17
    v_add_u32 v11, 65536, v11
    v_mfma_f32_16x16x32_bf16 v[72:75], v[196:199], a[76:79], v[72:75]
    s_add_u32 m0, s16, 32768
    ds_read_b64_tr_b16 v[192:193], v11 offset:32768
    ds_read_b64_tr_b16 v[194:195], v11 offset:36864
    v_mfma_f32_16x16x32_bf16 v[72:75], v[200:203], a[84:87], v[72:75]
    s_lshl_b32 s24, s6, 2
    buffer_load_dwordx4 v44, s[48:51], s31 offen offset:0 lds
    v_mfma_f32_16x16x32_bf16 v[72:75], v[204:207], a[92:95], v[72:75]
    s_waitcnt lgkmcnt(6)
    ds_read_b64_tr_b16 v[196:197], v11 offset:40960
    ds_read_b64_tr_b16 v[198:199], v11 offset:45056
    v_mfma_f32_16x16x32_bf16 v[68:71], v[208:211], a[64:67], v[68:71]
    s_add_u32 s24, s24, s9
    s_lshl_b32 s90, s24, 7
    s_add_u32 s90, s90, s23
    v_mfma_f32_16x16x32_bf16 v[68:71], v[212:215], a[72:75], v[68:71]
    s_waitcnt lgkmcnt(4)
    ds_read_b64_tr_b16 v[200:201], v11 offset:49152
    ds_read_b64_tr_b16 v[202:203], v11 offset:53248
    v_mfma_f32_16x16x32_bf16 v[68:71], v[216:219], a[80:83], v[68:71]
    s_lshl_b32 s28, s3, 3
    buffer_load_dwordx4 a[132:135], v25, s[76:79], s92 offen offset:0 sc1
    v_mfma_f32_16x16x32_bf16 v[68:71], v[220:223], a[88:91], v[68:71]
    s_add_u32 s24, s24, s28
    ds_read_b64_tr_b16 v[204:205], v11 offset:57344
    ds_read_b64_tr_b16 v[206:207], v11 offset:61440
    v_mfma_f32_16x16x32_bf16 v[76:79], v[208:211], a[68:71], v[76:79]
    s_lshl_b32 s24, s24, 17
    s_add_u32 s24, s24, 33554432
    v_add_u32 v12, 65536, v12
    v_mfma_f32_16x16x32_bf16 v[76:79], v[212:215], a[76:79], v[76:79]
    s_lshl_b32 s93, s8, 2
    ds_read_b64_tr_b16 v[208:209], v12 offset:32768
    ds_read_b64_tr_b16 v[210:211], v12 offset:36864
    v_mfma_f32_16x16x32_bf16 v[76:79], v[216:219], a[84:87], v[76:79]
    s_add_u32 s93, s93, s5
    buffer_load_dwordx4 v45, s[48:51], s31 offen offset:1024 lds
    v_mfma_f32_16x16x32_bf16 v[76:79], v[220:223], a[92:95], v[76:79]
    s_waitcnt lgkmcnt(6)
    ds_read_b64_tr_b16 v[212:213], v12 offset:40960
    ds_read_b64_tr_b16 v[214:215], v12 offset:45056
    v_mfma_f32_16x16x32_bf16 v[112:115], v[192:195], a[64:67], v[112:115]
    s_lshl_b32 s93, s93, 13
    s_add_u32 s93, s93, s24
    s_lshl_b32 s27, s27, 11
    v_mfma_f32_16x16x32_bf16 v[112:115], v[196:199], a[72:75], v[112:115]
    s_waitcnt lgkmcnt(4)
    ds_read_b64_tr_b16 v[216:217], v12 offset:49152
    ds_read_b64_tr_b16 v[218:219], v12 offset:53248
    v_mfma_f32_16x16x32_bf16 v[112:115], v[200:203], a[80:83], v[112:115]
    s_add_u32 s94, s24, s27
    buffer_load_dwordx4 a[136:139], v25, s[76:79], s13 offen offset:1024 sc1
    v_mfma_f32_16x16x32_bf16 v[112:115], v[204:207], a[88:91], v[112:115]
    s_and_b32 s27, s8, 2
    ds_read_b64_tr_b16 v[220:221], v12 offset:57344
    ds_read_b64_tr_b16 v[222:223], v12 offset:61440
    v_mfma_f32_16x16x32_bf16 v[120:123], v[192:195], a[68:71], v[120:123]
    buffer_load_dword v26, off, s[76:79], s97 offset:512 sc1
    v_add_u32 v13, 65536, v13
    v_mfma_f32_16x16x32_bf16 v[120:123], v[196:199], a[76:79], v[120:123]
    s_add_u32 s27, s27, s25
    ds_read_b64_tr_b16 v[192:193], v13 offset:32768
    ds_read_b64_tr_b16 v[194:195], v13 offset:36864
    v_mfma_f32_16x16x32_bf16 v[120:123], v[200:203], a[84:87], v[120:123]
    s_lshl_b32 s27, s27, 13
    buffer_load_dwordx4 v46, s[48:51], s31 offen offset:2048 lds
    v_mfma_f32_16x16x32_bf16 v[120:123], v[204:207], a[92:95], v[120:123]
    s_waitcnt lgkmcnt(6)
    ds_read_b64_tr_b16 v[196:197], v13 offset:40960
    ds_read_b64_tr_b16 v[198:199], v13 offset:45056
    v_mfma_f32_16x16x32_bf16 v[116:119], v[208:211], a[64:67], v[116:119]
    s_add_u32 s94, s94, s27
    v_and_b32 v50, 15, v0
    v_lshlrev_b32 v51, 3, v51
    v_mfma_f32_16x16x32_bf16 v[116:119], v[212:215], a[72:75], v[116:119]
    s_waitcnt lgkmcnt(4)
    ds_read_b64_tr_b16 v[200:201], v13 offset:49152
    ds_read_b64_tr_b16 v[202:203], v13 offset:53248
    v_mfma_f32_16x16x32_bf16 v[116:119], v[216:219], a[80:83], v[116:119]
    buffer_load_dwordx4 a[140:143], v25, s[76:79], s92 offen offset:1024 sc1
    v_mfma_f32_16x16x32_bf16 v[116:119], v[220:223], a[88:91], v[116:119]
    ds_read_b64_tr_b16 v[204:205], v13 offset:57344
    ds_read_b64_tr_b16 v[206:207], v13 offset:61440
    v_mfma_f32_16x16x32_bf16 v[124:127], v[208:211], a[68:71], v[124:127]
    v_lshl_add_u32 v59, v50, 10, v51
    v_add_u32 v14, 65536, v14
    v_mfma_f32_16x16x32_bf16 v[124:127], v[212:215], a[76:79], v[124:127]
    s_lshl_b32 s24, s21, 15
    ds_read_b64_tr_b16 v[208:209], v14 offset:32768
    ds_read_b64_tr_b16 v[210:211], v14 offset:36864
    v_mfma_f32_16x16x32_bf16 v[124:127], v[216:219], a[84:87], v[124:127]
    s_lshl_b32 s25, s22, 6
    buffer_load_dwordx4 v47, s[48:51], s31 offen offset:3072 lds
    v_mfma_f32_16x16x32_bf16 v[124:127], v[220:223], a[92:95], v[124:127]
    s_waitcnt lgkmcnt(6)
    ds_read_b64_tr_b16 v[212:213], v14 offset:40960
    ds_read_b64_tr_b16 v[214:215], v14 offset:45056
    v_mfma_f32_16x16x32_bf16 v[224:227], v[192:195], a[64:67], v[224:227]
    s_add_u32 s95, s24, s25
    s_add_u32 s91, s95, 0x4000
    s_lshl_b32 s25, s22, 10
    v_mfma_f32_16x16x32_bf16 v[224:227], v[196:199], a[72:75], v[224:227]
    s_waitcnt lgkmcnt(4)
    ds_read_b64_tr_b16 v[216:217], v14 offset:49152
    ds_read_b64_tr_b16 v[218:219], v14 offset:53248
    v_mfma_f32_16x16x32_bf16 v[224:227], v[200:203], a[80:83], v[224:227]
    s_add_u32 s24, s24, s25
    buffer_load_dwordx4 a[144:147], v25, s[76:79], s13 offen offset:2048 sc1
    v_mfma_f32_16x16x32_bf16 v[224:227], v[204:207], a[88:91], v[224:227]
    s_add_u32 s96, s24, 3145728
    ds_read_b64_tr_b16 v[220:221], v14 offset:57344
    ds_read_b64_tr_b16 v[222:223], v14 offset:61440
    v_mfma_f32_16x16x32_bf16 v[232:235], v[192:195], a[68:71], v[232:235]
    s_add_u32 s21, s96, 0x4000
    s_add_u32 s31, s31, 0x4000
    v_add_u32 v15, 65536, v15
    v_mfma_f32_16x16x32_bf16 v[232:235], v[196:199], a[76:79], v[232:235]
    s_add_u32 m0, s16, 36864
    ds_read_b64_tr_b16 v[192:193], v15 offset:32768
    ds_read_b64_tr_b16 v[194:195], v15 offset:36864
    v_mfma_f32_16x16x32_bf16 v[232:235], v[200:203], a[84:87], v[232:235]
    buffer_load_dwordx4 v44, s[48:51], s31 offen offset:0 lds
    v_mfma_f32_16x16x32_bf16 v[232:235], v[204:207], a[92:95], v[232:235]
    s_waitcnt lgkmcnt(6)
    ds_read_b64_tr_b16 v[196:197], v15 offset:40960
    ds_read_b64_tr_b16 v[198:199], v15 offset:45056
    v_mfma_f32_16x16x32_bf16 v[228:231], v[208:211], a[64:67], v[228:231]
    v_mfma_f32_16x16x32_bf16 v[228:231], v[212:215], a[72:75], v[228:231]
    s_waitcnt lgkmcnt(4)
    ds_read_b64_tr_b16 v[200:201], v15 offset:49152
    ds_read_b64_tr_b16 v[202:203], v15 offset:53248
    v_mfma_f32_16x16x32_bf16 v[228:231], v[216:219], a[80:83], v[228:231]
    buffer_load_dwordx4 a[148:151], v25, s[76:79], s92 offen offset:2048 sc1
    v_mfma_f32_16x16x32_bf16 v[228:231], v[220:223], a[88:91], v[228:231]
    ds_read_b64_tr_b16 v[204:205], v15 offset:57344
    ds_read_b64_tr_b16 v[206:207], v15 offset:61440
    v_mfma_f32_16x16x32_bf16 v[236:239], v[208:211], a[68:71], v[236:239]
    v_add_u32 v16, 65536, v16
    v_mfma_f32_16x16x32_bf16 v[236:239], v[212:215], a[76:79], v[236:239]
    ds_read_b64_tr_b16 v[208:209], v16 offset:32768
    ds_read_b64_tr_b16 v[210:211], v16 offset:36864
    v_mfma_f32_16x16x32_bf16 v[236:239], v[216:219], a[84:87], v[236:239]
    buffer_load_dwordx4 v45, s[48:51], s31 offen offset:1024 lds
    v_mfma_f32_16x16x32_bf16 v[236:239], v[220:223], a[92:95], v[236:239]
    s_waitcnt lgkmcnt(6)
    ds_read_b64_tr_b16 v[212:213], v16 offset:40960
    ds_read_b64_tr_b16 v[214:215], v16 offset:45056
    v_mfma_f32_16x16x32_bf16 v[240:243], v[192:195], a[64:67], v[240:243]
    v_mfma_f32_16x16x32_bf16 v[240:243], v[196:199], a[72:75], v[240:243]
    s_waitcnt lgkmcnt(4)
    ds_read_b64_tr_b16 v[216:217], v16 offset:49152
    ds_read_b64_tr_b16 v[218:219], v16 offset:53248
    v_mfma_f32_16x16x32_bf16 v[240:243], v[200:203], a[80:83], v[240:243]
    s_barrier
    buffer_load_dwordx4 a[152:155], v25, s[76:79], s13 offen offset:3072 sc1
    v_mfma_f32_16x16x32_bf16 v[240:243], v[204:207], a[88:91], v[240:243]
    ds_read_b64_tr_b16 v[220:221], v16 offset:57344
    ds_read_b64_tr_b16 v[222:223], v16 offset:61440
    v_mfma_f32_16x16x32_bf16 v[248:251], v[192:195], a[68:71], v[248:251]
    v_add_u32 v9, 65536, v9
    v_mfma_f32_16x16x32_bf16 v[248:251], v[196:199], a[76:79], v[248:251]
    ds_read_b64_tr_b16 v[192:193], v9 offset:0
    ds_read_b64_tr_b16 v[194:195], v9 offset:4096
    v_mfma_f32_16x16x32_bf16 v[248:251], v[200:203], a[84:87], v[248:251]
    buffer_load_dwordx4 v46, s[48:51], s31 offen offset:2048 lds
    v_mfma_f32_16x16x32_bf16 v[248:251], v[204:207], a[92:95], v[248:251]
    s_waitcnt lgkmcnt(6)
    ds_read_b64_tr_b16 v[196:197], v9 offset:8192
    ds_read_b64_tr_b16 v[198:199], v9 offset:12288
    v_mfma_f32_16x16x32_bf16 v[244:247], v[208:211], a[64:67], v[244:247]
    v_mfma_f32_16x16x32_bf16 v[244:247], v[212:215], a[72:75], v[244:247]
    s_waitcnt lgkmcnt(4)
    ds_read_b64_tr_b16 v[200:201], v9 offset:16384
    ds_read_b64_tr_b16 v[202:203], v9 offset:20480
    v_mfma_f32_16x16x32_bf16 v[244:247], v[216:219], a[80:83], v[244:247]
    buffer_load_dwordx4 a[156:159], v25, s[76:79], s92 offen offset:3072 sc1
    v_mfma_f32_16x16x32_bf16 v[244:247], v[220:223], a[88:91], v[244:247]
    ds_read_b64_tr_b16 v[204:205], v9 offset:24576
    ds_read_b64_tr_b16 v[206:207], v9 offset:28672
    v_mfma_f32_16x16x32_bf16 v[252:255], v[208:211], a[68:71], v[252:255]
    s_waitcnt vmcnt(10)
    v_cmp_gt_u32 vcc, 16, v26
    s_cbranch_vccnz L_spin_11
    L_back_12:
    v_add_u32 v10, 65536, v10
    v_mfma_f32_16x16x32_bf16 v[252:255], v[212:215], a[76:79], v[252:255]
    ds_read_b64_tr_b16 v[208:209], v10 offset:0
    ds_read_b64_tr_b16 v[210:211], v10 offset:4096
    v_mfma_f32_16x16x32_bf16 v[252:255], v[216:219], a[84:87], v[252:255]
    s_and_b32 s28, s4, 7
    buffer_load_dwordx4 v47, s[48:51], s31 offen offset:3072 lds
    s_cmp_ge_u32 5, s28
    s_cselect_b32 s28, 6, 5
    v_mfma_f32_16x16x32_bf16 v[252:255], v[220:223], a[92:95], v[252:255]
    s_lshl_b32 s28, s28, 12
    ds_read_b64_tr_b16 v[212:213], v10 offset:8192
    ds_read_b64_tr_b16 v[214:215], v10 offset:12288
    s_waitcnt lgkmcnt(8)
    v_mfma_f32_16x16x32_bf16 v[64:67], v[192:195], a[96:99], v[64:67]
    s_barrier
    v_mfma_f32_16x16x32_bf16 v[64:67], v[196:199], a[104:107], v[64:67]
    s_add_u32 s13, s28, s12
    ds_read_b64_tr_b16 v[216:217], v10 offset:16384
    ds_read_b64_tr_b16 v[218:219], v10 offset:20480
    s_waitcnt lgkmcnt(6)
    v_mfma_f32_16x16x32_bf16 v[64:67], v[200:203], a[112:115], v[64:67]
    buffer_load_dwordx4 a[160:163], v25, s[76:79], s13 offen offset:0 sc1
    v_mfma_f32_16x16x32_bf16 v[64:67], v[204:207], a[120:123], v[64:67]
    s_add_u32 s92, s13, 0x20000
    ds_read_b64_tr_b16 v[220:221], v10 offset:24576
    ds_read_b64_tr_b16 v[222:223], v10 offset:28672
    v_mfma_f32_16x16x32_bf16 v[72:75], v[192:195], a[100:103], v[72:75]
    s_lshl_b32 s30, s5, 15
    v_add_u32 v11, 65536, v11
    v_mfma_f32_16x16x32_bf16 v[72:75], v[196:199], a[108:111], v[72:75]
    s_add_u32 m0, s16, 98304
    ds_read_b64_tr_b16 v[192:193], v11 offset:0
    ds_read_b64_tr_b16 v[194:195], v11 offset:4096
    v_mfma_f32_16x16x32_bf16 v[72:75], v[200:203], a[116:119], v[72:75]
    buffer_load_dwordx4 v36, s[64:67], s30 offen offset:0 lds
    v_mfma_f32_16x16x32_bf16 v[72:75], v[204:207], a[124:127], v[72:75]
    s_waitcnt lgkmcnt(6)
    ds_read_b64_tr_b16 v[196:197], v11 offset:8192
    ds_read_b64_tr_b16 v[198:199], v11 offset:12288
    v_mfma_f32_16x16x32_bf16 v[68:71], v[208:211], a[96:99], v[68:71]
    v_mfma_f32_16x16x32_bf16 v[68:71], v[212:215], a[104:107], v[68:71]
    s_waitcnt lgkmcnt(4)
    ds_read_b64_tr_b16 v[200:201], v11 offset:16384
    ds_read_b64_tr_b16 v[202:203], v11 offset:20480
    v_mfma_f32_16x16x32_bf16 v[68:71], v[216:219], a[112:115], v[68:71]
    buffer_load_dwordx4 a[164:167], v25, s[76:79], s92 offen offset:0 sc1
    v_mfma_f32_16x16x32_bf16 v[68:71], v[220:223], a[120:123], v[68:71]
    ds_read_b64_tr_b16 v[204:205], v11 offset:24576
    ds_read_b64_tr_b16 v[206:207], v11 offset:28672
    v_mfma_f32_16x16x32_bf16 v[76:79], v[208:211], a[100:103], v[76:79]
    v_add_u32 v12, 65536, v12
    v_mfma_f32_16x16x32_bf16 v[76:79], v[212:215], a[108:111], v[76:79]
    ds_read_b64_tr_b16 v[208:209], v12 offset:0
    ds_read_b64_tr_b16 v[210:211], v12 offset:4096
    v_mfma_f32_16x16x32_bf16 v[76:79], v[216:219], a[116:119], v[76:79]
    s_lshl_b32 s29, s5, 10
    buffer_load_dwordx4 v37, s[64:67], s30 offen offset:1024 lds
    v_mfma_f32_16x16x32_bf16 v[76:79], v[220:223], a[124:127], v[76:79]
    s_waitcnt lgkmcnt(6)
    ds_read_b64_tr_b16 v[212:213], v12 offset:8192
    ds_read_b64_tr_b16 v[214:215], v12 offset:12288
    v_mfma_f32_16x16x32_bf16 v[112:115], v[192:195], a[96:99], v[112:115]
    v_mfma_f32_16x16x32_bf16 v[112:115], v[196:199], a[104:107], v[112:115]
    s_waitcnt lgkmcnt(4)
    ds_read_b64_tr_b16 v[216:217], v12 offset:16384
    ds_read_b64_tr_b16 v[218:219], v12 offset:20480
    v_mfma_f32_16x16x32_bf16 v[112:115], v[200:203], a[112:115], v[112:115]
    buffer_load_dwordx4 a[168:171], v25, s[76:79], s13 offen offset:1024 sc1
    v_mfma_f32_16x16x32_bf16 v[112:115], v[204:207], a[120:123], v[112:115]
    ds_read_b64_tr_b16 v[220:221], v12 offset:24576
    ds_read_b64_tr_b16 v[222:223], v12 offset:28672
    v_mfma_f32_16x16x32_bf16 v[120:123], v[192:195], a[100:103], v[120:123]
    v_add_u32 v13, 65536, v13
    v_mfma_f32_16x16x32_bf16 v[120:123], v[196:199], a[108:111], v[120:123]
    ds_read_b64_tr_b16 v[192:193], v13 offset:0
    ds_read_b64_tr_b16 v[194:195], v13 offset:4096
    v_mfma_f32_16x16x32_bf16 v[120:123], v[200:203], a[116:119], v[120:123]
    buffer_load_dwordx4 v38, s[64:67], s30 offen offset:2048 lds
    v_mfma_f32_16x16x32_bf16 v[120:123], v[204:207], a[124:127], v[120:123]
    s_waitcnt lgkmcnt(6)
    ds_read_b64_tr_b16 v[196:197], v13 offset:8192
    ds_read_b64_tr_b16 v[198:199], v13 offset:12288
    v_mfma_f32_16x16x32_bf16 v[116:119], v[208:211], a[96:99], v[116:119]
    v_mfma_f32_16x16x32_bf16 v[116:119], v[212:215], a[104:107], v[116:119]
    s_waitcnt lgkmcnt(4)
    ds_read_b64_tr_b16 v[200:201], v13 offset:16384
    ds_read_b64_tr_b16 v[202:203], v13 offset:20480
    v_mfma_f32_16x16x32_bf16 v[116:119], v[216:219], a[112:115], v[116:119]
    buffer_load_dwordx4 a[172:175], v25, s[76:79], s92 offen offset:1024 sc1
    v_mfma_f32_16x16x32_bf16 v[116:119], v[220:223], a[120:123], v[116:119]
    ds_read_b64_tr_b16 v[204:205], v13 offset:24576
    ds_read_b64_tr_b16 v[206:207], v13 offset:28672
L_warm1_1:
    s_cbranch_execz L_warm_ret1
    v_mfma_f32_16x16x32_bf16 v[124:127], v[208:211], a[100:103], v[124:127]
    v_add_u32 v14, 65536, v14
    v_mfma_f32_16x16x32_bf16 v[124:127], v[212:215], a[108:111], v[124:127]
    ds_read_b64_tr_b16 v[208:209], v14 offset:0
    ds_read_b64_tr_b16 v[210:211], v14 offset:4096
    v_mfma_f32_16x16x32_bf16 v[124:127], v[216:219], a[116:119], v[124:127]
    buffer_load_dwordx4 v39, s[64:67], s30 offen offset:3072 lds
    v_mfma_f32_16x16x32_bf16 v[124:127], v[220:223], a[124:127], v[124:127]
    s_waitcnt lgkmcnt(6)
    ds_read_b64_tr_b16 v[212:213], v14 offset:8192
    ds_read_b64_tr_b16 v[214:215], v14 offset:12288
    v_mfma_f32_16x16x32_bf16 v[224:227], v[192:195], a[96:99], v[224:227]
    v_mfma_f32_16x16x32_bf16 v[224:227], v[196:199], a[104:107], v[224:227]
    s_waitcnt lgkmcnt(4)
    ds_read_b64_tr_b16 v[216:217], v14 offset:16384
    ds_read_b64_tr_b16 v[218:219], v14 offset:20480
    v_mfma_f32_16x16x32_bf16 v[224:227], v[200:203], a[112:115], v[224:227]
    buffer_load_dwordx4 a[176:179], v25, s[76:79], s13 offen offset:2048 sc1
    v_mfma_f32_16x16x32_bf16 v[224:227], v[204:207], a[120:123], v[224:227]
    ds_read_b64_tr_b16 v[220:221], v14 offset:24576
    ds_read_b64_tr_b16 v[222:223], v14 offset:28672
    v_mfma_f32_16x16x32_bf16 v[232:235], v[192:195], a[100:103], v[232:235]
    v_add_u32 v15, 65536, v15
    v_mfma_f32_16x16x32_bf16 v[232:235], v[196:199], a[108:111], v[232:235]
    s_add_u32 m0, s16, 102400
    ds_read_b64_tr_b16 v[192:193], v15 offset:0
    ds_read_b64_tr_b16 v[194:195], v15 offset:4096
    v_mfma_f32_16x16x32_bf16 v[232:235], v[200:203], a[116:119], v[232:235]
    buffer_load_dwordx4 v40, s[76:79], s29 offen offset:0 sc1 lds
    v_mfma_f32_16x16x32_bf16 v[232:235], v[204:207], a[124:127], v[232:235]
    s_waitcnt lgkmcnt(6)
    ds_read_b64_tr_b16 v[196:197], v15 offset:8192
    ds_read_b64_tr_b16 v[198:199], v15 offset:12288
    v_mfma_f32_16x16x32_bf16 v[228:231], v[208:211], a[96:99], v[228:231]
    v_mfma_f32_16x16x32_bf16 v[228:231], v[212:215], a[104:107], v[228:231]
    s_waitcnt lgkmcnt(4)
    ds_read_b64_tr_b16 v[200:201], v15 offset:16384
    ds_read_b64_tr_b16 v[202:203], v15 offset:20480
    v_mfma_f32_16x16x32_bf16 v[228:231], v[216:219], a[112:115], v[228:231]
    buffer_load_dwordx4 a[180:183], v25, s[76:79], s92 offen offset:2048 sc1
    v_mfma_f32_16x16x32_bf16 v[228:231], v[220:223], a[120:123], v[228:231]
    ds_read_b64_tr_b16 v[204:205], v15 offset:24576
    ds_read_b64_tr_b16 v[206:207], v15 offset:28672
    v_mfma_f32_16x16x32_bf16 v[236:239], v[208:211], a[100:103], v[236:239]
    v_add_u32 v16, 65536, v16
    v_mfma_f32_16x16x32_bf16 v[236:239], v[212:215], a[108:111], v[236:239]
    ds_read_b64_tr_b16 v[208:209], v16 offset:0
    ds_read_b64_tr_b16 v[210:211], v16 offset:4096
    v_mfma_f32_16x16x32_bf16 v[236:239], v[216:219], a[116:119], v[236:239]
    buffer_load_dwordx4 v41, s[76:79], s29 offen offset:1024 sc1 lds
    v_mfma_f32_16x16x32_bf16 v[236:239], v[220:223], a[124:127], v[236:239]
    s_waitcnt lgkmcnt(6)
    ds_read_b64_tr_b16 v[212:213], v16 offset:8192
    ds_read_b64_tr_b16 v[214:215], v16 offset:12288
    v_mfma_f32_16x16x32_bf16 v[240:243], v[192:195], a[96:99], v[240:243]
    v_mfma_f32_16x16x32_bf16 v[240:243], v[196:199], a[104:107], v[240:243]
    s_waitcnt lgkmcnt(4)
    ds_read_b64_tr_b16 v[216:217], v16 offset:16384
    ds_read_b64_tr_b16 v[218:219], v16 offset:20480
    v_mfma_f32_16x16x32_bf16 v[240:243], v[200:203], a[112:115], v[240:243]
    s_barrier
    buffer_load_dwordx4 a[184:187], v25, s[76:79], s13 offen offset:3072 sc1
    v_mfma_f32_16x16x32_bf16 v[240:243], v[204:207], a[120:123], v[240:243]
    ds_read_b64_tr_b16 v[220:221], v16 offset:24576
    ds_read_b64_tr_b16 v[222:223], v16 offset:28672
    v_mfma_f32_16x16x32_bf16 v[248:251], v[192:195], a[100:103], v[248:251]
    v_add_u32 v9, 4294901760, v9
    v_mfma_f32_16x16x32_bf16 v[248:251], v[196:199], a[108:111], v[248:251]
    ds_read_b64_tr_b16 v[192:193], v9 offset:0
    ds_read_b64_tr_b16 v[194:195], v9 offset:4096
    v_mfma_f32_16x16x32_bf16 v[248:251], v[200:203], a[116:119], v[248:251]
    buffer_load_dwordx4 v42, s[76:79], s29 offen offset:2048 sc1 lds
    v_mfma_f32_16x16x32_bf16 v[248:251], v[204:207], a[124:127], v[248:251]
    s_waitcnt lgkmcnt(6)
    ds_read_b64_tr_b16 v[196:197], v9 offset:8192
    ds_read_b64_tr_b16 v[198:199], v9 offset:12288
    v_mfma_f32_16x16x32_bf16 v[244:247], v[208:211], a[96:99], v[244:247]
    v_mfma_f32_16x16x32_bf16 v[244:247], v[212:215], a[104:107], v[244:247]
    s_waitcnt lgkmcnt(4)
    ds_read_b64_tr_b16 v[200:201], v9 offset:16384
    ds_read_b64_tr_b16 v[202:203], v9 offset:20480
    v_mfma_f32_16x16x32_bf16 v[244:247], v[216:219], a[112:115], v[244:247]
    buffer_load_dwordx4 a[188:191], v25, s[76:79], s92 offen offset:3072 sc1
    v_mfma_f32_16x16x32_bf16 v[244:247], v[220:223], a[120:123], v[244:247]
    ds_read_b64_tr_b16 v[204:205], v9 offset:24576
    ds_read_b64_tr_b16 v[206:207], v9 offset:28672
    v_mfma_f32_16x16x32_bf16 v[252:255], v[208:211], a[100:103], v[252:255]
    v_add_u32 v10, 4294901760, v10
    v_mfma_f32_16x16x32_bf16 v[252:255], v[212:215], a[108:111], v[252:255]
    ds_read_b64_tr_b16 v[208:209], v10 offset:0
    ds_read_b64_tr_b16 v[210:211], v10 offset:4096
    v_mfma_f32_16x16x32_bf16 v[252:255], v[216:219], a[116:119], v[252:255]
    s_and_b32 s28, s4, 7
    buffer_load_dwordx4 v43, s[76:79], s29 offen offset:3072 sc1 lds
    s_cmp_ge_u32 6, s28
    s_cselect_b32 s28, 7, 6
    v_mfma_f32_16x16x32_bf16 v[252:255], v[220:223], a[124:127], v[252:255]
    s_lshl_b32 s28, s28, 12
    ds_read_b64_tr_b16 v[212:213], v10 offset:8192
    ds_read_b64_tr_b16 v[214:215], v10 offset:12288
    s_waitcnt vmcnt(17) lgkmcnt(8)
    v_mfma_f32_16x16x32_bf16 v[64:67], v[192:195], a[128:131], v[64:67]
    s_barrier
    v_mfma_f32_16x16x32_bf16 v[64:67], v[196:199], a[136:139], v[64:67]
    s_add_u32 s13, s28, s12
    ds_read_b64_tr_b16 v[216:217], v10 offset:16384
    ds_read_b64_tr_b16 v[218:219], v10 offset:20480
    s_waitcnt lgkmcnt(6)
    v_mfma_f32_16x16x32_bf16 v[64:67], v[200:203], a[144:147], v[64:67]
    buffer_load_dwordx4 a[192:195], v25, s[76:79], s13 offen offset:0 sc1
    v_mfma_f32_16x16x32_bf16 v[64:67], v[204:207], a[152:155], v[64:67]
    s_add_u32 s92, s13, 0x20000
    ds_read_b64_tr_b16 v[220:221], v10 offset:24576
    ds_read_b64_tr_b16 v[222:223], v10 offset:28672
    v_mfma_f32_16x16x32_bf16 v[72:75], v[192:195], a[132:135], v[72:75]
    s_add_u32 s30, s30, 0x20000
    v_add_u32 v11, 4294901760, v11
    v_mfma_f32_16x16x32_bf16 v[72:75], v[196:199], a[140:143], v[72:75]
    s_add_u32 m0, s16, 131072
    ds_read_b64_tr_b16 v[192:193], v11 offset:0
    ds_read_b64_tr_b16 v[194:195], v11 offset:4096
    v_mfma_f32_16x16x32_bf16 v[72:75], v[200:203], a[148:151], v[72:75]
    buffer_load_dwordx4 v36, s[64:67], s30 offen offset:0 lds
    v_mfma_f32_16x16x32_bf16 v[72:75], v[204:207], a[156:159], v[72:75]
    s_waitcnt lgkmcnt(6)
    ds_read_b64_tr_b16 v[196:197], v11 offset:8192
    ds_read_b64_tr_b16 v[198:199], v11 offset:12288
    v_mfma_f32_16x16x32_bf16 v[68:71], v[208:211], a[128:131], v[68:71]
    v_mfma_f32_16x16x32_bf16 v[68:71], v[212:215], a[136:139], v[68:71]
    s_waitcnt lgkmcnt(4)
    ds_read_b64_tr_b16 v[200:201], v11 offset:16384
    ds_read_b64_tr_b16 v[202:203], v11 offset:20480
    v_mfma_f32_16x16x32_bf16 v[68:71], v[216:219], a[144:147], v[68:71]
    buffer_load_dwordx4 a[196:199], v25, s[76:79], s92 offen offset:0 sc1
    v_mfma_f32_16x16x32_bf16 v[68:71], v[220:223], a[152:155], v[68:71]
    ds_read_b64_tr_b16 v[204:205], v11 offset:24576
    ds_read_b64_tr_b16 v[206:207], v11 offset:28672
    v_mfma_f32_16x16x32_bf16 v[76:79], v[208:211], a[132:135], v[76:79]
    v_add_u32 v12, 4294901760, v12
    v_mfma_f32_16x16x32_bf16 v[76:79], v[212:215], a[140:143], v[76:79]
    ds_read_b64_tr_b16 v[208:209], v12 offset:0
    ds_read_b64_tr_b16 v[210:211], v12 offset:4096
    v_mfma_f32_16x16x32_bf16 v[76:79], v[216:219], a[148:151], v[76:79]
    s_add_u32 s29, s29, 0x1000
    buffer_load_dwordx4 v37, s[64:67], s30 offen offset:1024 lds
    v_mfma_f32_16x16x32_bf16 v[76:79], v[220:223], a[156:159], v[76:79]
    s_waitcnt lgkmcnt(6)
    ds_read_b64_tr_b16 v[212:213], v12 offset:8192
    ds_read_b64_tr_b16 v[214:215], v12 offset:12288
    v_mfma_f32_16x16x32_bf16 v[112:115], v[192:195], a[128:131], v[112:115]
    v_mfma_f32_16x16x32_bf16 v[112:115], v[196:199], a[136:139], v[112:115]
    s_waitcnt lgkmcnt(4)
    ds_read_b64_tr_b16 v[216:217], v12 offset:16384
    ds_read_b64_tr_b16 v[218:219], v12 offset:20480
    v_mfma_f32_16x16x32_bf16 v[112:115], v[200:203], a[144:147], v[112:115]
    buffer_load_dwordx4 a[200:203], v25, s[76:79], s13 offen offset:1024 sc1
    v_mfma_f32_16x16x32_bf16 v[112:115], v[204:207], a[152:155], v[112:115]
    ds_read_b64_tr_b16 v[220:221], v12 offset:24576
    ds_read_b64_tr_b16 v[222:223], v12 offset:28672
    v_mfma_f32_16x16x32_bf16 v[120:123], v[192:195], a[132:135], v[120:123]
    v_add_u32 v13, 4294901760, v13
    v_mfma_f32_16x16x32_bf16 v[120:123], v[196:199], a[140:143], v[120:123]
    ds_read_b64_tr_b16 v[192:193], v13 offset:0
    ds_read_b64_tr_b16 v[194:195], v13 offset:4096
    v_mfma_f32_16x16x32_bf16 v[120:123], v[200:203], a[148:151], v[120:123]
    buffer_load_dwordx4 v38, s[64:67], s30 offen offset:2048 lds
    v_mfma_f32_16x16x32_bf16 v[120:123], v[204:207], a[156:159], v[120:123]
    s_waitcnt lgkmcnt(6)
    ds_read_b64_tr_b16 v[196:197], v13 offset:8192
    ds_read_b64_tr_b16 v[198:199], v13 offset:12288
    v_mfma_f32_16x16x32_bf16 v[116:119], v[208:211], a[128:131], v[116:119]
    v_mfma_f32_16x16x32_bf16 v[116:119], v[212:215], a[136:139], v[116:119]
    s_waitcnt lgkmcnt(4)
    ds_read_b64_tr_b16 v[200:201], v13 offset:16384
    ds_read_b64_tr_b16 v[202:203], v13 offset:20480
    v_mfma_f32_16x16x32_bf16 v[116:119], v[216:219], a[144:147], v[116:119]
    buffer_load_dwordx4 a[204:207], v25, s[76:79], s92 offen offset:1024 sc1
    v_mfma_f32_16x16x32_bf16 v[116:119], v[220:223], a[152:155], v[116:119]
    ds_read_b64_tr_b16 v[204:205], v13 offset:24576
    ds_read_b64_tr_b16 v[206:207], v13 offset:28672
    v_mfma_f32_16x16x32_bf16 v[124:127], v[208:211], a[132:135], v[124:127]
    v_add_u32 v14, 4294901760, v14
    v_mfma_f32_16x16x32_bf16 v[124:127], v[212:215], a[140:143], v[124:127]
    ds_read_b64_tr_b16 v[208:209], v14 offset:0
    ds_read_b64_tr_b16 v[210:211], v14 offset:4096
    v_mfma_f32_16x16x32_bf16 v[124:127], v[216:219], a[148:151], v[124:127]
    buffer_load_dwordx4 v39, s[64:67], s30 offen offset:3072 lds
    v_mfma_f32_16x16x32_bf16 v[124:127], v[220:223], a[156:159], v[124:127]
    s_waitcnt lgkmcnt(6)
    ds_read_b64_tr_b16 v[212:213], v14 offset:8192
    ds_read_b64_tr_b16 v[214:215], v14 offset:12288
    v_mfma_f32_16x16x32_bf16 v[224:227], v[192:195], a[128:131], v[224:227]
    v_mfma_f32_16x16x32_bf16 v[224:227], v[196:199], a[136:139], v[224:227]
    s_waitcnt lgkmcnt(4)
    ds_read_b64_tr_b16 v[216:217], v14 offset:16384
    ds_read_b64_tr_b16 v[218:219], v14 offset:20480
    v_mfma_f32_16x16x32_bf16 v[224:227], v[200:203], a[144:147], v[224:227]
    buffer_load_dwordx4 a[208:211], v25, s[76:79], s13 offen offset:2048 sc1
    v_mfma_f32_16x16x32_bf16 v[224:227], v[204:207], a[152:155], v[224:227]
    ds_read_b64_tr_b16 v[220:221], v14 offset:24576
    ds_read_b64_tr_b16 v[222:223], v14 offset:28672
    v_mfma_f32_16x16x32_bf16 v[232:235], v[192:195], a[132:135], v[232:235]
    v_add_u32 v15, 4294901760, v15
    v_mfma_f32_16x16x32_bf16 v[232:235], v[196:199], a[140:143], v[232:235]
    s_add_u32 m0, s16, 135168
    ds_read_b64_tr_b16 v[192:193], v15 offset:0
    ds_read_b64_tr_b16 v[194:195], v15 offset:4096
    v_mfma_f32_16x16x32_bf16 v[232:235], v[200:203], a[148:151], v[232:235]
    buffer_load_dwordx4 v40, s[76:79], s29 offen offset:0 sc1 lds
    v_mfma_f32_16x16x32_bf16 v[232:235], v[204:207], a[156:159], v[232:235]
    s_waitcnt lgkmcnt(6)
    ds_read_b64_tr_b16 v[196:197], v15 offset:8192
    ds_read_b64_tr_b16 v[198:199], v15 offset:12288
    v_mfma_f32_16x16x32_bf16 v[228:231], v[208:211], a[128:131], v[228:231]
    v_mfma_f32_16x16x32_bf16 v[228:231], v[212:215], a[136:139], v[228:231]
    s_waitcnt lgkmcnt(4)
    ds_read_b64_tr_b16 v[200:201], v15 offset:16384
    ds_read_b64_tr_b16 v[202:203], v15 offset:20480
    v_mfma_f32_16x16x32_bf16 v[228:231], v[216:219], a[144:147], v[228:231]
    s_waitcnt vmcnt(10)
    s_barrier
    buffer_load_dwordx4 a[212:215], v25, s[76:79], s92 offen offset:2048 sc1
    v_mfma_f32_16x16x32_bf16 v[228:231], v[220:223], a[152:155], v[228:231]
    ds_read_b64_tr_b16 v[204:205], v15 offset:24576
    ds_read_b64_tr_b16 v[206:207], v15 offset:28672
    v_mfma_f32_16x16x32_bf16 v[236:239], v[208:211], a[132:135], v[236:239]
    ds_read_b64_tr_b16 v[144:145], v19 offset:32768
    ds_read_b64_tr_b16 v[146:147], v19 offset:34816
    v_add_u32 v16, 4294901760, v16
    v_mfma_f32_16x16x32_bf16 v[236:239], v[212:215], a[140:143], v[236:239]
    ds_read_b64_tr_b16 v[208:209], v16 offset:0
    ds_read_b64_tr_b16 v[210:211], v16 offset:4096
    ds_read_b64_tr_b16 v[148:149], v20 offset:32768
    ds_read_b64_tr_b16 v[150:151], v20 offset:34816
    v_mfma_f32_16x16x32_bf16 v[236:239], v[216:219], a[148:151], v[236:239]
    ds_read_b128 v[152:155], v24 offset:32768
    ds_read_b128 v[156:159], v24 offset:33792
    v_mfma_f32_16x16x32_bf16 v[236:239], v[220:223], a[156:159], v[236:239]
    s_waitcnt lgkmcnt(12)
    ds_read_b64_tr_b16 v[212:213], v16 offset:8192
    ds_read_b64_tr_b16 v[214:215], v16 offset:12288
    v_mfma_f32_16x16x32_bf16 v[240:243], v[192:195], a[128:131], v[240:243]
    buffer_load_dwordx4 v41, s[76:79], s29 offen offset:1024 sc1 lds
    v_mfma_f32_16x16x32_bf16 v[240:243], v[196:199], a[136:139], v[240:243]
    s_waitcnt lgkmcnt(10)
    ds_read_b64_tr_b16 v[216:217], v16 offset:16384
    ds_read_b64_tr_b16 v[218:219], v16 offset:20480
    v_mfma_f32_16x16x32_bf16 v[240:243], v[200:203], a[144:147], v[240:243]
    s_barrier
    buffer_load_dwordx4 a[216:219], v25, s[76:79], s13 offen offset:3072 sc1
    v_mfma_f32_16x16x32_bf16 v[240:243], v[204:207], a[152:155], v[240:243]
    ds_read_b64_tr_b16 v[220:221], v16 offset:24576
    ds_read_b64_tr_b16 v[222:223], v16 offset:28672
    v_mfma_f32_16x16x32_bf16 v[248:251], v[192:195], a[132:135], v[248:251]
    v_add_u32 v9, 4294901760, v9
    v_mfma_f32_16x16x32_bf16 v[248:251], v[196:199], a[140:143], v[248:251]
    ds_read_b64_tr_b16 v[192:193], v9 offset:0
    ds_read_b64_tr_b16 v[194:195], v9 offset:4096
    v_mfma_f32_16x16x32_bf16 v[248:251], v[200:203], a[148:151], v[248:251]
    buffer_load_dwordx4 v42, s[76:79], s29 offen offset:2048 sc1 lds
    v_mfma_f32_16x16x32_bf16 v[248:251], v[204:207], a[156:159], v[248:251]
    s_waitcnt lgkmcnt(6)
    ds_read_b64_tr_b16 v[196:197], v9 offset:8192
    ds_read_b64_tr_b16 v[198:199], v9 offset:12288
    v_mfma_f32_16x16x32_bf16 v[244:247], v[208:211], a[128:131], v[244:247]
    v_mfma_f32_16x16x32_bf16 v[244:247], v[212:215], a[136:139], v[244:247]
    s_waitcnt lgkmcnt(4)
    ds_read_b64_tr_b16 v[200:201], v9 offset:16384
    ds_read_b64_tr_b16 v[202:203], v9 offset:20480
    v_mfma_f32_16x16x32_bf16 v[244:247], v[216:219], a[144:147], v[244:247]
    buffer_load_dwordx4 a[220:223], v25, s[76:79], s92 offen offset:3072 sc1
    v_mfma_f32_16x16x32_bf16 v[244:247], v[220:223], a[152:155], v[244:247]
    ds_read_b64_tr_b16 v[204:205], v9 offset:24576
    ds_read_b64_tr_b16 v[206:207], v9 offset:28672
    v_mfma_f32_16x16x32_bf16 v[252:255], v[208:211], a[132:135], v[252:255]
    ds_read_b64_tr_b16 v[160:161], v19 offset:40960
    ds_read_b64_tr_b16 v[162:163], v19 offset:43008
    v_add_u32 v10, 4294901760, v10
    v_mfma_f32_16x16x32_bf16 v[252:255], v[212:215], a[140:143], v[252:255]
    ds_read_b64_tr_b16 v[208:209], v10 offset:0
    ds_read_b64_tr_b16 v[210:211], v10 offset:4096
    ds_read_b64_tr_b16 v[164:165], v20 offset:40960
    ds_read_b64_tr_b16 v[166:167], v20 offset:43008
    v_mfma_f32_16x16x32_bf16 v[252:255], v[216:219], a[148:151], v[252:255]
    buffer_load_dwordx4 v43, s[76:79], s29 offen offset:3072 sc1 lds
    ds_read_b128 v[168:171], v24 offset:40960
    ds_read_b128 v[172:175], v24 offset:41984
    v_mfma_f32_16x16x32_bf16 v[252:255], v[220:223], a[156:159], v[252:255]
    s_waitcnt lgkmcnt(12)
    ds_read_b64_tr_b16 v[212:213], v10 offset:8192
    ds_read_b64_tr_b16 v[214:215], v10 offset:12288
    v_mfma_f32_16x16x32_bf16 v[64:67], v[192:195], a[160:163], v[64:67]
    s_barrier
    v_mfma_f32_16x16x32_bf16 v[64:67], v[196:199], a[168:171], v[64:67]
    s_waitcnt lgkmcnt(10)
    ds_read_b64_tr_b16 v[216:217], v10 offset:16384
    ds_read_b64_tr_b16 v[218:219], v10 offset:20480
    v_mfma_f32_16x16x32_bf16 v[64:67], v[200:203], a[176:179], v[64:67]
    v_mfma_f32_16x16x32_bf16 v[64:67], v[204:207], a[184:187], v[64:67]
    ds_read_b64_tr_b16 v[220:221], v10 offset:24576
    ds_read_b64_tr_b16 v[222:223], v10 offset:28672
    v_mfma_f32_16x16x32_bf16 v[72:75], v[192:195], a[164:167], v[72:75]
    s_add_u32 s30, s30, 0x20000
    v_add_u32 v11, 4294901760, v11
    v_mfma_f32_16x16x32_bf16 v[72:75], v[196:199], a[172:175], v[72:75]
    s_add_u32 m0, s16, 65536
    ds_read_b64_tr_b16 v[192:193], v11 offset:0
    ds_read_b64_tr_b16 v[194:195], v11 offset:4096
    v_mfma_f32_16x16x32_bf16 v[72:75], v[200:203], a[180:183], v[72:75]
    buffer_load_dwordx4 v36, s[64:67], s30 offen offset:0 lds
    v_mfma_f32_16x16x32_bf16 v[72:75], v[204:207], a[188:191], v[72:75]
    s_waitcnt lgkmcnt(6)
    ds_read_b64_tr_b16 v[196:197], v11 offset:8192
    ds_read_b64_tr_b16 v[198:199], v11 offset:12288
    v_mfma_f32_16x16x32_bf16 v[68:71], v[208:211], a[160:163], v[68:71]
    v_mfma_f32_16x16x32_bf16 v[68:71], v[212:215], a[168:171], v[68:71]
    s_waitcnt lgkmcnt(4)
    ds_read_b64_tr_b16 v[200:201], v11 offset:16384
    ds_read_b64_tr_b16 v[202:203], v11 offset:20480
    v_mfma_f32_16x16x32_bf16 v[68:71], v[216:219], a[176:179], v[68:71]
    v_mfma_f32_16x16x32_bf16 v[68:71], v[220:223], a[184:187], v[68:71]
    ds_read_b64_tr_b16 v[204:205], v11 offset:24576
    ds_read_b64_tr_b16 v[206:207], v11 offset:28672
    v_mfma_f32_16x16x32_bf16 v[76:79], v[208:211], a[164:167], v[76:79]
    v_add_u32 v12, 4294901760, v12
    v_mfma_f32_16x16x32_bf16 v[76:79], v[212:215], a[172:175], v[76:79]
    ds_read_b64_tr_b16 v[208:209], v12 offset:0
    ds_read_b64_tr_b16 v[210:211], v12 offset:4096
    v_mfma_f32_16x16x32_bf16 v[76:79], v[216:219], a[180:183], v[76:79]
    s_add_u32 s29, s29, 0x1000
    buffer_load_dwordx4 v37, s[64:67], s30 offen offset:1024 lds
    v_mfma_f32_16x16x32_bf16 v[76:79], v[220:223], a[188:191], v[76:79]
    ds_read_b64_tr_b16 v[212:213], v12 offset:8192
    ds_read_b64_tr_b16 v[214:215], v12 offset:12288
    v_mfma_f32_16x16x32_bf16 v[128:131], v[144:147], v[152:155], 0
    ds_read_b64_tr_b16 v[176:177], v19 offset:49152
    ds_read_b64_tr_b16 v[178:179], v19 offset:51200
    v_mfma_f32_16x16x32_bf16 v[136:139], v[144:147], v[156:159], 0
    ds_read_b64_tr_b16 v[180:181], v20 offset:49152
    ds_read_b64_tr_b16 v[182:183], v20 offset:51200
    v_mfma_f32_16x16x32_bf16 v[132:135], v[148:151], v[152:155], 0
    ds_read_b128 v[184:187], v24 offset:49152
    ds_read_b128 v[188:191], v24 offset:50176
    v_mfma_f32_16x16x32_bf16 v[140:143], v[148:151], v[156:159], 0
    s_waitcnt lgkmcnt(14)
    v_mfma_f32_16x16x32_bf16 v[112:115], v[192:195], a[160:163], v[112:115]
    buffer_load_dwordx2 v[80:81], v59, s[32:35], s95 offen offset:0
    v_mfma_f32_16x16x32_bf16 v[112:115], v[196:199], a[168:171], v[112:115]
    s_waitcnt lgkmcnt(10)
    ds_read_b64_tr_b16 v[216:217], v12 offset:16384
    ds_read_b64_tr_b16 v[218:219], v12 offset:20480
    v_mfma_f32_16x16x32_bf16 v[112:115], v[200:203], a[176:179], v[112:115]
    v_mfma_f32_16x16x32_bf16 v[112:115], v[204:207], a[184:187], v[112:115]
    ds_read_b64_tr_b16 v[220:221], v12 offset:24576
    ds_read_b64_tr_b16 v[222:223], v12 offset:28672
    v_mfma_f32_16x16x32_bf16 v[120:123], v[192:195], a[164:167], v[120:123]
    v_add_u32 v13, 4294901760, v13
    v_mfma_f32_16x16x32_bf16 v[120:123], v[196:199], a[172:175], v[120:123]
    ds_read_b64_tr_b16 v[192:193], v13 offset:0
    ds_read_b64_tr_b16 v[194:195], v13 offset:4096
    v_mfma_f32_16x16x32_bf16 v[120:123], v[200:203], a[180:183], v[120:123]
    buffer_load_dwordx2 v[82:83], v59, s[32:35], s95 offen offset:32
    v_mfma_f32_16x16x32_bf16 v[120:123], v[204:207], a[188:191], v[120:123]
    s_waitcnt lgkmcnt(12)
    ds_read_b64_tr_b16 v[196:197], v13 offset:8192
    ds_read_b64_tr_b16 v[198:199], v13 offset:12288
    v_mfma_f32_16x16x32_bf16 v[116:119], v[208:211], a[160:163], v[116:119]
    buffer_load_dwordx4 v38, s[64:67], s30 offen offset:2048 lds
    v_mfma_f32_16x16x32_bf16 v[116:119], v[212:215], a[168:171], v[116:119]
    s_waitcnt lgkmcnt(4)
    ds_read_b64_tr_b16 v[200:201], v13 offset:16384
    ds_read_b64_tr_b16 v[202:203], v13 offset:20480
    v_mfma_f32_16x16x32_bf16 v[116:119], v[216:219], a[176:179], v[116:119]
    v_mfma_f32_16x16x32_bf16 v[116:119], v[220:223], a[184:187], v[116:119]
    ds_read_b64_tr_b16 v[204:205], v13 offset:24576
    ds_read_b64_tr_b16 v[206:207], v13 offset:28672
    v_mfma_f32_16x16x32_bf16 v[124:127], v[208:211], a[164:167], v[124:127]
    v_add_u32 v14, 4294901760, v14
    v_mfma_f32_16x16x32_bf16 v[124:127], v[212:215], a[172:175], v[124:127]
    ds_read_b64_tr_b16 v[208:209], v14 offset:0
    ds_read_b64_tr_b16 v[210:211], v14 offset:4096
    v_mfma_f32_16x16x32_bf16 v[124:127], v[216:219], a[180:183], v[124:127]
    buffer_load_dwordx4 v39, s[64:67], s30 offen offset:3072 lds
    v_mfma_f32_16x16x32_bf16 v[124:127], v[220:223], a[188:191], v[124:127]
    ds_read_b64_tr_b16 v[212:213], v14 offset:8192
    ds_read_b64_tr_b16 v[214:215], v14 offset:12288
    v_mfma_f32_16x16x32_bf16 v[128:131], v[160:163], v[168:171], v[128:131]
    buffer_load_dwordx2 v[84:85], v59, s[32:35], s91 offen offset:0
    ds_read_b64_tr_b16 v[144:145], v19 offset:57344
    ds_read_b64_tr_b16 v[146:147], v19 offset:59392
    v_mfma_f32_16x16x32_bf16 v[136:139], v[160:163], v[172:175], v[136:139]
    ds_read_b64_tr_b16 v[148:149], v20 offset:57344
    ds_read_b64_tr_b16 v[150:151], v20 offset:59392
    v_mfma_f32_16x16x32_bf16 v[132:135], v[164:167], v[168:171], v[132:135]
    ds_read_b128 v[152:155], v24 offset:57344
    ds_read_b128 v[156:159], v24 offset:58368
    v_mfma_f32_16x16x32_bf16 v[140:143], v[164:167], v[172:175], v[140:143]
    s_waitcnt lgkmcnt(14)
    v_mfma_f32_16x16x32_bf16 v[224:227], v[192:195], a[160:163], v[224:227]
    buffer_load_dwordx2 v[86:87], v59, s[32:35], s91 offen offset:32
    v_mfma_f32_16x16x32_bf16 v[224:227], v[196:199], a[168:171], v[224:227]
    s_waitcnt lgkmcnt(10)
    ds_read_b64_tr_b16 v[216:217], v14 offset:16384
    ds_read_b64_tr_b16 v[218:219], v14 offset:20480
    v_mfma_f32_16x16x32_bf16 v[224:227], v[200:203], a[176:179], v[224:227]
    v_mfma_f32_16x16x32_bf16 v[224:227], v[204:207], a[184:187], v[224:227]
    ds_read_b64_tr_b16 v[220:221], v14 offset:24576
    ds_read_b64_tr_b16 v[222:223], v14 offset:28672
    v_mfma_f32_16x16x32_bf16 v[232:235], v[192:195], a[164:167], v[232:235]
    v_add_u32 v15, 4294901760, v15
    v_mfma_f32_16x16x32_bf16 v[232:235], v[196:199], a[172:175], v[232:235]
    s_add_u32 m0, s16, 69632
    ds_read_b64_tr_b16 v[192:193], v15 offset:0
    ds_read_b64_tr_b16 v[194:195], v15 offset:4096
    v_mfma_f32_16x16x32_bf16 v[232:235], v[200:203], a[180:183], v[232:235]
    buffer_load_dwordx4 v40, s[76:79], s29 offen offset:0 sc1 lds
    v_mfma_f32_16x16x32_bf16 v[232:235], v[204:207], a[188:191], v[232:235]
    s_waitcnt lgkmcnt(12)
    ds_read_b64_tr_b16 v[196:197], v15 offset:8192
    ds_read_b64_tr_b16 v[198:199], v15 offset:12288
    v_mfma_f32_16x16x32_bf16 v[228:231], v[208:211], a[160:163], v[228:231]
    v_mfma_f32_16x16x32_bf16 v[228:231], v[212:215], a[168:171], v[228:231]
    s_waitcnt lgkmcnt(4)
    ds_read_b64_tr_b16 v[200:201], v15 offset:16384
    ds_read_b64_tr_b16 v[202:203], v15 offset:20480
    v_mfma_f32_16x16x32_bf16 v[228:231], v[216:219], a[176:179], v[228:231]
    s_waitcnt vmcnt(9)
    s_barrier
    v_mfma_f32_16x16x32_bf16 v[228:231], v[220:223], a[184:187], v[228:231]
    ds_read_b64_tr_b16 v[204:205], v15 offset:24576
    ds_read_b64_tr_b16 v[206:207], v15 offset:28672
    v_mfma_f32_16x16x32_bf16 v[236:239], v[208:211], a[164:167], v[236:239]
    v_add_u32 v16, 4294901760, v16
    v_mfma_f32_16x16x32_bf16 v[236:239], v[212:215], a[172:175], v[236:239]
    ds_read_b64_tr_b16 v[208:209], v16 offset:0
    ds_read_b64_tr_b16 v[210:211], v16 offset:4096
    v_mfma_f32_16x16x32_bf16 v[236:239], v[216:219], a[180:183], v[236:239]
    buffer_load_dwordx4 v[28:31], v25, s[76:79], s96 offen sc1
    buffer_load_dwordx4 v41, s[76:79], s29 offen offset:1024 sc1 lds
    v_mfma_f32_16x16x32_bf16 v[236:239], v[220:223], a[188:191], v[236:239]
    ds_read_b64_tr_b16 v[212:213], v16 offset:8192
    ds_read_b64_tr_b16 v[214:215], v16 offset:12288
    v_mfma_f32_16x16x32_bf16 v[128:131], v[176:179], v[184:187], v[128:131]
    buffer_load_dwordx4 v[32:35], v25, s[76:79], s21 offen sc1
    ds_read_b64_tr_b16 v[160:161], v21 offset:0
    ds_read_b64_tr_b16 v[162:163], v21 offset:2048
    v_mfma_f32_16x16x32_bf16 v[136:139], v[176:179], v[188:191], v[136:139]
    ds_read_b64_tr_b16 v[164:165], v22 offset:0
    ds_read_b64_tr_b16 v[166:167], v22 offset:2048
    v_mfma_f32_16x16x32_bf16 v[132:135], v[180:183], v[184:187], v[132:135]
    ds_read_b128 v[168:171], v27 offset:0
    ds_read_b128 v[172:175], v27 offset:1024
    v_mfma_f32_16x16x32_bf16 v[140:143], v[180:183], v[188:191], v[140:143]
    s_waitcnt lgkmcnt(14)
    v_mfma_f32_16x16x32_bf16 v[240:243], v[192:195], a[160:163], v[240:243]
    v_mfma_f32_16x16x32_bf16 v[240:243], v[196:199], a[168:171], v[240:243]
    s_waitcnt lgkmcnt(10)
    ds_read_b64_tr_b16 v[216:217], v16 offset:16384
    ds_read_b64_tr_b16 v[218:219], v16 offset:20480
    v_mfma_f32_16x16x32_bf16 v[240:243], v[200:203], a[176:179], v[240:243]
    s_barrier
    v_mfma_f32_16x16x32_bf16 v[240:243], v[204:207], a[184:187], v[240:243]
    ds_read_b64_tr_b16 v[220:221], v16 offset:24576
    ds_read_b64_tr_b16 v[222:223], v16 offset:28672
    v_mfma_f32_16x16x32_bf16 v[248:251], v[192:195], a[164:167], v[248:251]
    v_mfma_f32_16x16x32_bf16 v[248:251], v[196:199], a[172:175], v[248:251]
    ds_read_b64_tr_b16 v[192:193], v9 offset:32768
    ds_read_b64_tr_b16 v[194:195], v9 offset:36864
    v_mfma_f32_16x16x32_bf16 v[248:251], v[200:203], a[180:183], v[248:251]
    buffer_load_dwordx4 v42, s[76:79], s29 offen offset:2048 sc1 lds
    v_mfma_f32_16x16x32_bf16 v[248:251], v[204:207], a[188:191], v[248:251]
    s_waitcnt lgkmcnt(12)
    ds_read_b64_tr_b16 v[196:197], v9 offset:40960
    ds_read_b64_tr_b16 v[198:199], v9 offset:45056
    v_mfma_f32_16x16x32_bf16 v[244:247], v[208:211], a[160:163], v[244:247]
    v_mfma_f32_16x16x32_bf16 v[244:247], v[212:215], a[168:171], v[244:247]
    s_waitcnt lgkmcnt(4)
    ds_read_b64_tr_b16 v[200:201], v9 offset:49152
    ds_read_b64_tr_b16 v[202:203], v9 offset:53248
    v_mfma_f32_16x16x32_bf16 v[244:247], v[216:219], a[176:179], v[244:247]
    v_mfma_f32_16x16x32_bf16 v[244:247], v[220:223], a[184:187], v[244:247]
    ds_read_b64_tr_b16 v[204:205], v9 offset:57344
    ds_read_b64_tr_b16 v[206:207], v9 offset:61440
    v_mfma_f32_16x16x32_bf16 v[252:255], v[208:211], a[164:167], v[252:255]
    v_mfma_f32_16x16x32_bf16 v[252:255], v[212:215], a[172:175], v[252:255]
    ds_read_b64_tr_b16 v[208:209], v10 offset:32768
    ds_read_b64_tr_b16 v[210:211], v10 offset:36864
    v_mfma_f32_16x16x32_bf16 v[252:255], v[216:219], a[180:183], v[252:255]
    buffer_load_dwordx4 v43, s[76:79], s29 offen offset:3072 sc1 lds
    v_mfma_f32_16x16x32_bf16 v[252:255], v[220:223], a[188:191], v[252:255]
    ds_read_b64_tr_b16 v[212:213], v10 offset:40960
    ds_read_b64_tr_b16 v[214:215], v10 offset:45056
    v_mfma_f32_16x16x32_bf16 v[128:131], v[144:147], v[152:155], v[128:131]
    ds_read_b64_tr_b16 v[176:177], v21 offset:8192
    ds_read_b64_tr_b16 v[178:179], v21 offset:10240
    v_mfma_f32_16x16x32_bf16 v[136:139], v[144:147], v[156:159], v[136:139]
    ds_read_b64_tr_b16 v[180:181], v22 offset:8192
    ds_read_b64_tr_b16 v[182:183], v22 offset:10240
    v_mfma_f32_16x16x32_bf16 v[132:135], v[148:151], v[152:155], v[132:135]
    ds_read_b128 v[184:187], v27 offset:8192
    ds_read_b128 v[188:191], v27 offset:9216
    v_mfma_f32_16x16x32_bf16 v[140:143], v[148:151], v[156:159], v[140:143]
    s_waitcnt lgkmcnt(14)
    v_mfma_f32_16x16x32_bf16 v[64:67], v[192:195], a[192:195], v[64:67]
    s_barrier
    s_add_u32 s30, s30, 0x20000
    v_mfma_f32_16x16x32_bf16 v[64:67], v[196:199], a[200:203], v[64:67]
    s_add_u32 m0, s16, 0
    ds_read_b64_tr_b16 v[216:217], v10 offset:49152
    ds_read_b64_tr_b16 v[218:219], v10 offset:53248
    s_waitcnt lgkmcnt(12)
    v_mfma_f32_16x16x32_bf16 v[64:67], v[200:203], a[208:211], v[64:67]
    buffer_load_dwordx4 v36, s[64:67], s30 offen offset:0 lds
    v_mfma_f32_16x16x32_bf16 v[64:67], v[204:207], a[216:219], v[64:67]
    ds_read_b64_tr_b16 v[220:221], v10 offset:57344
    ds_read_b64_tr_b16 v[222:223], v10 offset:61440
    v_mfma_f32_16x16x32_bf16 v[72:75], v[192:195], a[196:199], v[72:75]
    v_mfma_f32_16x16x32_bf16 v[72:75], v[196:199], a[204:207], v[72:75]
    ds_read_b64_tr_b16 v[192:193], v11 offset:32768
    ds_read_b64_tr_b16 v[194:195], v11 offset:36864
    v_mfma_f32_16x16x32_bf16 v[72:75], v[200:203], a[212:215], v[72:75]
    s_add_u32 s29, s29, 0x1000
    buffer_load_dwordx4 v37, s[64:67], s30 offen offset:1024 lds
    v_mfma_f32_16x16x32_bf16 v[72:75], v[204:207], a[220:223], v[72:75]
    s_waitcnt lgkmcnt(12)
    ds_read_b64_tr_b16 v[196:197], v11 offset:40960
    ds_read_b64_tr_b16 v[198:199], v11 offset:45056
    v_mfma_f32_16x16x32_bf16 v[68:71], v[208:211], a[192:195], v[68:71]
    v_mfma_f32_16x16x32_bf16 v[68:71], v[212:215], a[200:203], v[68:71]
    s_waitcnt lgkmcnt(4)
    ds_read_b64_tr_b16 v[200:201], v11 offset:49152
    ds_read_b64_tr_b16 v[202:203], v11 offset:53248
    v_mfma_f32_16x16x32_bf16 v[68:71], v[216:219], a[208:211], v[68:71]
    buffer_load_dwordx4 v38, s[64:67], s30 offen offset:2048 lds
    v_mfma_f32_16x16x32_bf16 v[68:71], v[220:223], a[216:219], v[68:71]
    ds_read_b64_tr_b16 v[204:205], v11 offset:57344
    ds_read_b64_tr_b16 v[206:207], v11 offset:61440
    v_mfma_f32_16x16x32_bf16 v[76:79], v[208:211], a[196:199], v[76:79]
    v_mfma_f32_16x16x32_bf16 v[76:79], v[212:215], a[204:207], v[76:79]
    ds_read_b64_tr_b16 v[208:209], v12 offset:32768
    ds_read_b64_tr_b16 v[210:211], v12 offset:36864
    v_mfma_f32_16x16x32_bf16 v[76:79], v[216:219], a[212:215], v[76:79]
    buffer_load_dwordx4 v39, s[64:67], s30 offen offset:3072 lds
L_warm1_2:
    s_cbranch_execz L_warm_ret1
    v_mfma_f32_16x16x32_bf16 v[76:79], v[220:223], a[220:223], v[76:79]
    ds_read_b64_tr_b16 v[212:213], v12 offset:40960
    ds_read_b64_tr_b16 v[214:215], v12 offset:45056
    v_mfma_f32_16x16x32_bf16 v[128:131], v[160:163], v[168:171], v[128:131]
    ds_read_b64_tr_b16 v[144:145], v21 offset:16384
    ds_read_b64_tr_b16 v[146:147], v21 offset:18432
    v_mfma_f32_16x16x32_bf16 v[136:139], v[160:163], v[172:175], v[136:139]
    ds_read_b64_tr_b16 v[148:149], v22 offset:16384
    ds_read_b64_tr_b16 v[150:151], v22 offset:18432
    v_mfma_f32_16x16x32_bf16 v[132:135], v[164:167], v[168:171], v[132:135]
    ds_read_b128 v[152:155], v27 offset:16384
    ds_read_b128 v[156:159], v27 offset:17408
    v_mfma_f32_16x16x32_bf16 v[140:143], v[164:167], v[172:175], v[140:143]
    s_waitcnt lgkmcnt(14)
    v_cvt_pk_bf16_f32 v64, v64, v65
    v_cvt_pk_bf16_f32 v65, v66, v67
    v_mfma_f32_16x16x32_bf16 v[112:115], v[192:195], a[192:195], v[112:115]
    v_cvt_pk_bf16_f32 v66, v68, v69
    v_cvt_pk_bf16_f32 v67, v70, v71
    v_mfma_f32_16x16x32_bf16 v[112:115], v[196:199], a[200:203], v[112:115]
    s_add_u32 m0, s16, 4096
    ds_read_b64_tr_b16 v[216:217], v12 offset:49152
    ds_read_b64_tr_b16 v[218:219], v12 offset:53248
    buffer_store_dwordx4 v[64:67], v25, s[76:79], s93 offen offset:0 sc1
    s_waitcnt lgkmcnt(12)
    v_mfma_f32_16x16x32_bf16 v[112:115], v[200:203], a[208:211], v[112:115]
    buffer_load_dwordx4 v40, s[76:79], s29 offen offset:0 sc1 lds
    v_mfma_f32_16x16x32_bf16 v[112:115], v[204:207], a[216:219], v[112:115]
    ds_read_b64_tr_b16 v[220:221], v12 offset:57344
    ds_read_b64_tr_b16 v[222:223], v12 offset:61440
    v_mfma_f32_16x16x32_bf16 v[120:123], v[192:195], a[196:199], v[120:123]
    v_cvt_pk_bf16_f32 v68, v72, v73
    v_cvt_pk_bf16_f32 v69, v74, v75
    v_cvt_pk_bf16_f32 v70, v76, v77
    v_cvt_pk_bf16_f32 v71, v78, v79
    v_mfma_f32_16x16x32_bf16 v[120:123], v[196:199], a[204:207], v[120:123]
    buffer_store_dwordx4 v[68:71], v25, s[76:79], s93 offen offset:1024 sc1
    ds_read_b64_tr_b16 v[192:193], v13 offset:32768
    ds_read_b64_tr_b16 v[194:195], v13 offset:36864
    v_mfma_f32_16x16x32_bf16 v[120:123], v[200:203], a[212:215], v[120:123]
    buffer_load_dwordx4 v41, s[76:79], s29 offen offset:1024 sc1 lds
    v_mfma_f32_16x16x32_bf16 v[120:123], v[204:207], a[220:223], v[120:123]
    s_waitcnt lgkmcnt(12)
    ds_read_b64_tr_b16 v[196:197], v13 offset:40960
    ds_read_b64_tr_b16 v[198:199], v13 offset:45056
    v_mfma_f32_16x16x32_bf16 v[116:119], v[208:211], a[192:195], v[116:119]
    v_mfma_f32_16x16x32_bf16 v[116:119], v[212:215], a[200:203], v[116:119]
    s_waitcnt lgkmcnt(4)
    ds_read_b64_tr_b16 v[200:201], v13 offset:49152
    ds_read_b64_tr_b16 v[202:203], v13 offset:53248
    v_mfma_f32_16x16x32_bf16 v[116:119], v[216:219], a[208:211], v[116:119]
    buffer_load_dwordx4 v42, s[76:79], s29 offen offset:2048 sc1 lds
    v_mfma_f32_16x16x32_bf16 v[116:119], v[220:223], a[216:219], v[116:119]
    ds_read_b64_tr_b16 v[204:205], v13 offset:57344
    ds_read_b64_tr_b16 v[206:207], v13 offset:61440
    v_mfma_f32_16x16x32_bf16 v[124:127], v[208:211], a[196:199], v[124:127]
    v_mfma_f32_16x16x32_bf16 v[124:127], v[212:215], a[204:207], v[124:127]
    ds_read_b64_tr_b16 v[208:209], v14 offset:32768
    ds_read_b64_tr_b16 v[210:211], v14 offset:36864
    v_mfma_f32_16x16x32_bf16 v[124:127], v[216:219], a[212:215], v[124:127]
    buffer_load_dwordx4 v43, s[76:79], s29 offen offset:3072 sc1 lds
    v_mfma_f32_16x16x32_bf16 v[124:127], v[220:223], a[220:223], v[124:127]
    ds_read_b64_tr_b16 v[212:213], v14 offset:40960
    ds_read_b64_tr_b16 v[214:215], v14 offset:45056
    v_mfma_f32_16x16x32_bf16 v[128:131], v[176:179], v[184:187], v[128:131]
    ds_read_b64_tr_b16 v[160:161], v21 offset:24576
    ds_read_b64_tr_b16 v[162:163], v21 offset:26624
    v_mfma_f32_16x16x32_bf16 v[136:139], v[176:179], v[188:191], v[136:139]
    ds_read_b64_tr_b16 v[164:165], v22 offset:24576
    ds_read_b64_tr_b16 v[166:167], v22 offset:26624
    v_mfma_f32_16x16x32_bf16 v[132:135], v[180:183], v[184:187], v[132:135]
    ds_read_b128 v[168:171], v27 offset:24576
    ds_read_b128 v[172:175], v27 offset:25600
    v_mfma_f32_16x16x32_bf16 v[140:143], v[180:183], v[188:191], v[140:143]
    s_waitcnt lgkmcnt(14)
    v_cvt_pk_bf16_f32 v112, v112, v113
    v_cvt_pk_bf16_f32 v113, v114, v115
    v_mfma_f32_16x16x32_bf16 v[224:227], v[192:195], a[192:195], v[224:227]
    s_add_u32 s30, s30, 0x20000
    v_cvt_pk_bf16_f32 v114, v116, v117
    v_cvt_pk_bf16_f32 v115, v118, v119
    v_mfma_f32_16x16x32_bf16 v[224:227], v[196:199], a[200:203], v[224:227]
    s_add_u32 m0, s16, 98304
    ds_read_b64_tr_b16 v[216:217], v14 offset:49152
    ds_read_b64_tr_b16 v[218:219], v14 offset:53248
    buffer_store_dwordx4 v[112:115], v25, s[76:79], s93 offen offset:2048 sc1
    s_waitcnt lgkmcnt(12)
    v_mfma_f32_16x16x32_bf16 v[224:227], v[200:203], a[208:211], v[224:227]
    buffer_load_dwordx4 v36, s[64:67], s30 offen offset:0 lds
    v_mfma_f32_16x16x32_bf16 v[224:227], v[204:207], a[216:219], v[224:227]
    ds_read_b64_tr_b16 v[220:221], v14 offset:57344
    ds_read_b64_tr_b16 v[222:223], v14 offset:61440
    v_mfma_f32_16x16x32_bf16 v[232:235], v[192:195], a[196:199], v[232:235]
    v_cvt_pk_bf16_f32 v116, v120, v121
    v_cvt_pk_bf16_f32 v117, v122, v123
    v_cvt_pk_bf16_f32 v118, v124, v125
    v_cvt_pk_bf16_f32 v119, v126, v127
    v_mfma_f32_16x16x32_bf16 v[232:235], v[196:199], a[204:207], v[232:235]
    buffer_store_dwordx4 v[116:119], v25, s[76:79], s93 offen offset:3072 sc1
    ds_read_b64_tr_b16 v[192:193], v15 offset:32768
    ds_read_b64_tr_b16 v[194:195], v15 offset:36864
    v_mfma_f32_16x16x32_bf16 v[232:235], v[200:203], a[212:215], v[232:235]
    s_add_u32 s29, s29, 0x1000
    buffer_load_dwordx4 v37, s[64:67], s30 offen offset:1024 lds
    v_mfma_f32_16x16x32_bf16 v[232:235], v[204:207], a[220:223], v[232:235]
    s_waitcnt lgkmcnt(12)
    ds_read_b64_tr_b16 v[196:197], v15 offset:40960
    ds_read_b64_tr_b16 v[198:199], v15 offset:45056
    v_mfma_f32_16x16x32_bf16 v[228:231], v[208:211], a[192:195], v[228:231]
    v_mfma_f32_16x16x32_bf16 v[228:231], v[212:215], a[200:203], v[228:231]
    s_waitcnt lgkmcnt(4)
    ds_read_b64_tr_b16 v[200:201], v15 offset:49152
    ds_read_b64_tr_b16 v[202:203], v15 offset:53248
    v_mfma_f32_16x16x32_bf16 v[228:231], v[216:219], a[208:211], v[228:231]
    s_waitcnt vmcnt(14)
    s_barrier
    v_mfma_f32_16x16x32_bf16 v[228:231], v[220:223], a[216:219], v[228:231]
    ds_read_b64_tr_b16 v[204:205], v15 offset:57344
    ds_read_b64_tr_b16 v[206:207], v15 offset:61440
    v_mfma_f32_16x16x32_bf16 v[236:239], v[208:211], a[196:199], v[236:239]
    buffer_load_dwordx4 v38, s[64:67], s30 offen offset:2048 lds
    v_mfma_f32_16x16x32_bf16 v[236:239], v[212:215], a[204:207], v[236:239]
    ds_read_b64_tr_b16 v[208:209], v16 offset:32768
    ds_read_b64_tr_b16 v[210:211], v16 offset:36864
    v_mfma_f32_16x16x32_bf16 v[236:239], v[216:219], a[212:215], v[236:239]
    buffer_load_dwordx4 v39, s[64:67], s30 offen offset:3072 lds
    v_mfma_f32_16x16x32_bf16 v[236:239], v[220:223], a[220:223], v[236:239]
    ds_read_b64_tr_b16 v[212:213], v16 offset:40960
    ds_read_b64_tr_b16 v[214:215], v16 offset:45056
    v_mfma_f32_16x16x32_bf16 v[128:131], v[144:147], v[152:155], v[128:131]
    ds_read_b64_tr_b16 v[176:177], v19 offset:0
    ds_read_b64_tr_b16 v[178:179], v19 offset:2048
    v_mfma_f32_16x16x32_bf16 v[136:139], v[144:147], v[156:159], v[136:139]
    ds_read_b64_tr_b16 v[180:181], v20 offset:0
    ds_read_b64_tr_b16 v[182:183], v20 offset:2048
    v_mfma_f32_16x16x32_bf16 v[132:135], v[148:151], v[152:155], v[132:135]
    ds_read_b128 v[184:187], v24 offset:0
    ds_read_b128 v[188:191], v24 offset:1024
    v_mfma_f32_16x16x32_bf16 v[140:143], v[148:151], v[156:159], v[140:143]
    s_waitcnt lgkmcnt(14)
    v_cvt_pk_bf16_f32 v224, v224, v225
    v_cvt_pk_bf16_f32 v225, v226, v227
    v_mfma_f32_16x16x32_bf16 v[240:243], v[192:195], a[192:195], v[240:243]
    s_add_u32 s93, s93, 4096
    v_cvt_pk_bf16_f32 v226, v228, v229
    v_cvt_pk_bf16_f32 v227, v230, v231
    v_mfma_f32_16x16x32_bf16 v[240:243], v[196:199], a[200:203], v[240:243]
    s_add_u32 m0, s16, 102400
    ds_read_b64_tr_b16 v[216:217], v16 offset:49152
    ds_read_b64_tr_b16 v[218:219], v16 offset:53248
    buffer_store_dwordx4 v[224:227], v25, s[76:79], s93 offen offset:0 sc1
    s_waitcnt lgkmcnt(12)
    v_mfma_f32_16x16x32_bf16 v[240:243], v[200:203], a[208:211], v[240:243]
    s_barrier
    v_mfma_f32_16x16x32_bf16 v[240:243], v[204:207], a[216:219], v[240:243]
    ds_read_b64_tr_b16 v[220:221], v16 offset:57344
    ds_read_b64_tr_b16 v[222:223], v16 offset:61440
    v_mfma_f32_16x16x32_bf16 v[248:251], v[192:195], a[196:199], v[248:251]
    buffer_load_dwordx4 v40, s[76:79], s29 offen offset:0 sc1 lds
    v_cvt_pk_bf16_f32 v228, v232, v233
    v_cvt_pk_bf16_f32 v229, v234, v235
    v_cvt_pk_bf16_f32 v230, v236, v237
    v_cvt_pk_bf16_f32 v231, v238, v239
    v_mfma_f32_16x16x32_bf16 v[248:251], v[196:199], a[204:207], v[248:251]
    buffer_store_dwordx4 v[228:231], v25, s[76:79], s93 offen offset:1024 sc1
    v_mfma_f32_16x16x32_bf16 v[248:251], v[200:203], a[212:215], v[248:251]
    buffer_load_dwordx4 v41, s[76:79], s29 offen offset:1024 sc1 lds
    v_mfma_f32_16x16x32_bf16 v[248:251], v[204:207], a[220:223], v[248:251]
    s_waitcnt lgkmcnt(10)
    v_mfma_f32_16x16x32_bf16 v[244:247], v[208:211], a[192:195], v[244:247]
    v_mfma_f32_16x16x32_bf16 v[244:247], v[212:215], a[200:203], v[244:247]
    s_waitcnt lgkmcnt(0)
    v_mfma_f32_16x16x32_bf16 v[244:247], v[216:219], a[208:211], v[244:247]
    buffer_load_dwordx4 v42, s[76:79], s29 offen offset:2048 sc1 lds
    v_mfma_f32_16x16x32_bf16 v[244:247], v[220:223], a[216:219], v[244:247]
    v_mfma_f32_16x16x32_bf16 v[252:255], v[208:211], a[196:199], v[252:255]
    v_mfma_f32_16x16x32_bf16 v[252:255], v[212:215], a[204:207], v[252:255]
    v_mfma_f32_16x16x32_bf16 v[252:255], v[216:219], a[212:215], v[252:255]
    buffer_load_dwordx4 v43, s[76:79], s29 offen offset:3072 sc1 lds
    v_mfma_f32_16x16x32_bf16 v[252:255], v[220:223], a[220:223], v[252:255]
    v_mfma_f32_16x16x32_bf16 v[128:131], v[160:163], v[168:171], v[128:131]
    ds_read_b64_tr_b16 v[144:145], v19 offset:8192
    ds_read_b64_tr_b16 v[146:147], v19 offset:10240
    v_mfma_f32_16x16x32_bf16 v[136:139], v[160:163], v[172:175], v[136:139]
    ds_read_b64_tr_b16 v[148:149], v20 offset:8192
    ds_read_b64_tr_b16 v[150:151], v20 offset:10240
    v_mfma_f32_16x16x32_bf16 v[132:135], v[164:167], v[168:171], v[132:135]
    ds_read_b128 v[152:155], v24 offset:8192
    ds_read_b128 v[156:159], v24 offset:9216
    v_mfma_f32_16x16x32_bf16 v[140:143], v[164:167], v[172:175], v[140:143]
    v_cvt_pk_bf16_f32 v240, v240, v241
    v_cvt_pk_bf16_f32 v241, v242, v243
    v_mfma_f32_16x16x32_bf16 v[128:131], v[176:179], v[184:187], v[128:131]
    s_barrier
    s_add_u32 s30, s30, 0x20000
    v_cvt_pk_bf16_f32 v242, v244, v245
    v_cvt_pk_bf16_f32 v243, v246, v247
    v_mfma_f32_16x16x32_bf16 v[136:139], v[176:179], v[188:191], v[136:139]
    s_add_u32 m0, s16, 32768
    buffer_store_dwordx4 v[240:243], v25, s[76:79], s93 offen offset:2048 sc1
    ds_read_b64_tr_b16 v[160:161], v19 offset:16384
    ds_read_b64_tr_b16 v[162:163], v19 offset:18432
    v_mfma_f32_16x16x32_bf16 v[132:135], v[180:183], v[184:187], v[132:135]
    ds_read_b64_tr_b16 v[164:165], v20 offset:16384
    ds_read_b64_tr_b16 v[166:167], v20 offset:18432
    v_mfma_f32_16x16x32_bf16 v[140:143], v[180:183], v[188:191], v[140:143]
    s_waitcnt lgkmcnt(4)
    ds_read_b128 v[168:171], v24 offset:16384
    ds_read_b128 v[172:175], v24 offset:17408
    v_mfma_f32_16x16x32_bf16 v[128:131], v[144:147], v[152:155], v[128:131]
    s_add_u32 s29, s29, 0x1000
    buffer_load_dwordx4 v36, s[64:67], s30 offen offset:0 lds
    buffer_load_dwordx4 v37, s[64:67], s30 offen offset:1024 lds
    v_cvt_pk_bf16_f32 v244, v248, v249
    v_cvt_pk_bf16_f32 v245, v250, v251
    v_cvt_pk_bf16_f32 v246, v252, v253
    v_cvt_pk_bf16_f32 v247, v254, v255
    v_mfma_f32_16x16x32_bf16 v[136:139], v[144:147], v[156:159], v[136:139]
    buffer_store_dwordx4 v[244:247], v25, s[76:79], s93 offen offset:3072 sc1
    ds_read_b64_tr_b16 v[176:177], v19 offset:24576
    ds_read_b64_tr_b16 v[178:179], v19 offset:26624
    v_mfma_f32_16x16x32_bf16 v[132:135], v[148:151], v[152:155], v[132:135]
    buffer_load_dwordx4 v38, s[64:67], s30 offen offset:2048 lds
    ds_read_b64_tr_b16 v[180:181], v20 offset:24576
    ds_read_b64_tr_b16 v[182:183], v20 offset:26624
    v_mfma_f32_16x16x32_bf16 v[140:143], v[148:151], v[156:159], v[140:143]
    s_waitcnt lgkmcnt(4)
    ds_read_b128 v[184:187], v24 offset:24576
    ds_read_b128 v[188:191], v24 offset:25600
    v_mfma_f32_16x16x32_bf16 v[128:131], v[160:163], v[168:171], v[128:131]
    buffer_load_dwordx4 v39, s[64:67], s30 offen offset:3072 lds
    s_waitcnt vmcnt(2) lgkmcnt(0)
    s_barrier
    v_mfma_f32_16x16x32_bf16 v[136:139], v[160:163], v[172:175], v[136:139]
    s_add_u32 m0, s16, 36864
    buffer_atomic_add v62, v63, s[76:79], s90 offen offset:1280 sc1
    ds_read_b64_tr_b16 v[144:145], v17 offset:0
    ds_read_b64_tr_b16 v[146:147], v17 offset:2048
    v_mfma_f32_16x16x32_bf16 v[132:135], v[164:167], v[168:171], v[132:135]
    ds_read_b64_tr_b16 v[148:149], v18 offset:0
    ds_read_b64_tr_b16 v[150:151], v18 offset:2048
    v_mfma_f32_16x16x32_bf16 v[140:143], v[164:167], v[172:175], v[140:143]
    ds_read_b128 v[152:155], v23 offset:0
    ds_read_b128 v[156:159], v23 offset:1024
    v_mfma_f32_16x16x32_bf16 v[128:131], v[176:179], v[184:187], v[128:131]
    buffer_load_dwordx4 v40, s[76:79], s29 offen offset:0 sc1 lds
    buffer_load_dwordx4 v41, s[76:79], s29 offen offset:1024 sc1 lds
    v_mfma_f32_16x16x32_bf16 v[136:139], v[176:179], v[188:191], v[136:139]
    ds_read_b64_tr_b16 v[160:161], v17 offset:8192
    ds_read_b64_tr_b16 v[162:163], v17 offset:10240
    v_mfma_f32_16x16x32_bf16 v[132:135], v[180:183], v[184:187], v[132:135]
    ds_read_b64_tr_b16 v[164:165], v18 offset:8192
    ds_read_b64_tr_b16 v[166:167], v18 offset:10240
    v_mfma_f32_16x16x32_bf16 v[140:143], v[180:183], v[188:191], v[140:143]
    s_waitcnt lgkmcnt(4)
    ds_read_b128 v[168:171], v23 offset:8192
    ds_read_b128 v[172:175], v23 offset:9216
    v_mfma_f32_16x16x32_bf16 v[128:131], v[144:147], v[152:155], v[128:131]
    s_add_u32 s30, s30, 0x20000
    buffer_load_dwordx4 v42, s[76:79], s29 offen offset:2048 sc1 lds
    buffer_load_dwordx4 v43, s[76:79], s29 offen offset:3072 sc1 lds
    v_mfma_f32_16x16x32_bf16 v[136:139], v[144:147], v[156:159], v[136:139]
    s_add_u32 m0, s16, 131072
    ds_read_b64_tr_b16 v[176:177], v17 offset:16384
    ds_read_b64_tr_b16 v[178:179], v17 offset:18432
    v_mfma_f32_16x16x32_bf16 v[132:135], v[148:151], v[152:155], v[132:135]
    ds_read_b64_tr_b16 v[180:181], v18 offset:16384
    ds_read_b64_tr_b16 v[182:183], v18 offset:18432
    v_mfma_f32_16x16x32_bf16 v[140:143], v[148:151], v[156:159], v[140:143]
    s_waitcnt lgkmcnt(4)
    ds_read_b128 v[184:187], v23 offset:16384
    ds_read_b128 v[188:191], v23 offset:17408
    v_mfma_f32_16x16x32_bf16 v[128:131], v[160:163], v[168:171], v[128:131]
    s_add_u32 s29, s29, 0x1000
    buffer_load_dwordx4 v36, s[64:67], s30 offen offset:0 lds
    buffer_load_dwordx4 v37, s[64:67], s30 offen offset:1024 lds
    v_mfma_f32_16x16x32_bf16 v[136:139], v[160:163], v[172:175], v[136:139]
    ds_read_b64_tr_b16 v[144:145], v17 offset:24576
    ds_read_b64_tr_b16 v[146:147], v17 offset:26624
    v_mfma_f32_16x16x32_bf16 v[132:135], v[164:167], v[168:171], v[132:135]
    buffer_load_dwordx4 v38, s[64:67], s30 offen offset:2048 lds
    ds_read_b64_tr_b16 v[148:149], v18 offset:24576
    ds_read_b64_tr_b16 v[150:151], v18 offset:26624
    v_mfma_f32_16x16x32_bf16 v[140:143], v[164:167], v[172:175], v[140:143]
    s_waitcnt lgkmcnt(4)
    ds_read_b128 v[152:155], v23 offset:24576
    ds_read_b128 v[156:159], v23 offset:25600
    v_mfma_f32_16x16x32_bf16 v[128:131], v[176:179], v[184:187], v[128:131]
    buffer_load_dwordx4 v39, s[64:67], s30 offen offset:3072 lds
    s_waitcnt lgkmcnt(0)
    s_barrier
    v_mfma_f32_16x16x32_bf16 v[136:139], v[176:179], v[188:191], v[136:139]
    s_add_u32 m0, s16, 135168
    ds_read_b64_tr_b16 v[160:161], v19 offset:32768
    ds_read_b64_tr_b16 v[162:163], v19 offset:34816
    v_mfma_f32_16x16x32_bf16 v[132:135], v[180:183], v[184:187], v[132:135]
    ds_read_b64_tr_b16 v[164:165], v20 offset:32768
    ds_read_b64_tr_b16 v[166:167], v20 offset:34816
    v_mfma_f32_16x16x32_bf16 v[140:143], v[180:183], v[188:191], v[140:143]
    ds_read_b128 v[168:171], v24 offset:32768
    ds_read_b128 v[172:175], v24 offset:33792
    v_mfma_f32_16x16x32_bf16 v[128:131], v[144:147], v[152:155], v[128:131]
    buffer_load_dwordx4 v40, s[76:79], s29 offen offset:0 sc1 lds
    buffer_load_dwordx4 v41, s[76:79], s29 offen offset:1024 sc1 lds
    v_mfma_f32_16x16x32_bf16 v[136:139], v[144:147], v[156:159], v[136:139]
    ds_read_b64_tr_b16 v[176:177], v19 offset:40960
    ds_read_b64_tr_b16 v[178:179], v19 offset:43008
    v_mfma_f32_16x16x32_bf16 v[132:135], v[148:151], v[152:155], v[132:135]
    ds_read_b64_tr_b16 v[180:181], v20 offset:40960
    ds_read_b64_tr_b16 v[182:183], v20 offset:43008
    v_mfma_f32_16x16x32_bf16 v[140:143], v[148:151], v[156:159], v[140:143]
    s_waitcnt lgkmcnt(4)
    ds_read_b128 v[184:187], v24 offset:40960
    ds_read_b128 v[188:191], v24 offset:41984
    v_mfma_f32_16x16x32_bf16 v[128:131], v[160:163], v[168:171], v[128:131]
    s_add_u32 s30, s30, 0x20000
    buffer_load_dwordx4 v42, s[76:79], s29 offen offset:2048 sc1 lds
    buffer_load_dwordx4 v43, s[76:79], s29 offen offset:3072 sc1 lds
    v_mfma_f32_16x16x32_bf16 v[136:139], v[160:163], v[172:175], v[136:139]
    s_add_u32 m0, s16, 65536
    ds_read_b64_tr_b16 v[144:145], v19 offset:49152
    ds_read_b64_tr_b16 v[146:147], v19 offset:51200
    v_mfma_f32_16x16x32_bf16 v[132:135], v[164:167], v[168:171], v[132:135]
    ds_read_b64_tr_b16 v[148:149], v20 offset:49152
    ds_read_b64_tr_b16 v[150:151], v20 offset:51200
    v_mfma_f32_16x16x32_bf16 v[140:143], v[164:167], v[172:175], v[140:143]
    s_waitcnt lgkmcnt(4)
    ds_read_b128 v[152:155], v24 offset:49152
    ds_read_b128 v[156:159], v24 offset:50176
    v_mfma_f32_16x16x32_bf16 v[128:131], v[176:179], v[184:187], v[128:131]
    s_add_u32 s29, s29, 0x1000
    buffer_load_dwordx4 v36, s[64:67], s30 offen offset:0 lds
    buffer_load_dwordx4 v37, s[64:67], s30 offen offset:1024 lds
    v_mfma_f32_16x16x32_bf16 v[136:139], v[176:179], v[188:191], v[136:139]
    ds_read_b64_tr_b16 v[160:161], v19 offset:57344
    ds_read_b64_tr_b16 v[162:163], v19 offset:59392
    v_mfma_f32_16x16x32_bf16 v[132:135], v[180:183], v[184:187], v[132:135]
    buffer_load_dwordx4 v38, s[64:67], s30 offen offset:2048 lds
    ds_read_b64_tr_b16 v[164:165], v20 offset:57344
    ds_read_b64_tr_b16 v[166:167], v20 offset:59392
    v_mfma_f32_16x16x32_bf16 v[140:143], v[180:183], v[188:191], v[140:143]
    s_waitcnt lgkmcnt(4)
    ds_read_b128 v[168:171], v24 offset:57344
    ds_read_b128 v[172:175], v24 offset:58368
    v_mfma_f32_16x16x32_bf16 v[128:131], v[144:147], v[152:155], v[128:131]
    buffer_load_dwordx4 v39, s[64:67], s30 offen offset:3072 lds
    s_waitcnt vmcnt(12) lgkmcnt(0)
    s_barrier
    v_mfma_f32_16x16x32_bf16 v[136:139], v[144:147], v[156:159], v[136:139]
    s_add_u32 m0, s16, 69632
    ds_read_b64_tr_b16 v[176:177], v17 offset:32768
    ds_read_b64_tr_b16 v[178:179], v17 offset:34816
    v_mfma_f32_16x16x32_bf16 v[132:135], v[148:151], v[152:155], v[132:135]
    ds_read_b64_tr_b16 v[180:181], v18 offset:32768
    ds_read_b64_tr_b16 v[182:183], v18 offset:34816
    v_mfma_f32_16x16x32_bf16 v[140:143], v[148:151], v[156:159], v[140:143]
    ds_read_b128 v[184:187], v23 offset:32768
    ds_read_b128 v[188:191], v23 offset:33792
    v_mfma_f32_16x16x32_bf16 v[128:131], v[160:163], v[168:171], v[128:131]
    buffer_load_dwordx4 v40, s[76:79], s29 offen offset:0 sc1 lds
    buffer_load_dwordx4 v41, s[76:79], s29 offen offset:1024 sc1 lds
    v_mfma_f32_16x16x32_bf16 v[136:139], v[160:163], v[172:175], v[136:139]
    ds_read_b64_tr_b16 v[144:145], v17 offset:40960
    ds_read_b64_tr_b16 v[146:147], v17 offset:43008
    v_mfma_f32_16x16x32_bf16 v[132:135], v[164:167], v[168:171], v[132:135]
    ds_read_b64_tr_b16 v[148:149], v18 offset:40960
    ds_read_b64_tr_b16 v[150:151], v18 offset:43008
    v_mfma_f32_16x16x32_bf16 v[140:143], v[164:167], v[172:175], v[140:143]
    s_waitcnt lgkmcnt(4)
    ds_read_b128 v[152:155], v23 offset:40960
    ds_read_b128 v[156:159], v23 offset:41984
    v_mfma_f32_16x16x32_bf16 v[128:131], v[176:179], v[184:187], v[128:131]
    s_add_u32 s30, s30, 0x20000
    buffer_load_dwordx4 v42, s[76:79], s29 offen offset:2048 sc1 lds
    buffer_load_dwordx4 v43, s[76:79], s29 offen offset:3072 sc1 lds
    v_mfma_f32_16x16x32_bf16 v[136:139], v[176:179], v[188:191], v[136:139]
    s_add_u32 m0, s16, 0
    ds_read_b64_tr_b16 v[160:161], v17 offset:49152
    ds_read_b64_tr_b16 v[162:163], v17 offset:51200
    v_mfma_f32_16x16x32_bf16 v[132:135], v[180:183], v[184:187], v[132:135]
    ds_read_b64_tr_b16 v[164:165], v18 offset:49152
    ds_read_b64_tr_b16 v[166:167], v18 offset:51200
    v_mfma_f32_16x16x32_bf16 v[140:143], v[180:183], v[188:191], v[140:143]
    s_waitcnt lgkmcnt(4)
    ds_read_b128 v[168:171], v23 offset:49152
    ds_read_b128 v[172:175], v23 offset:50176
    v_mfma_f32_16x16x32_bf16 v[128:131], v[144:147], v[152:155], v[128:131]
    s_add_u32 s29, s29, 0x1000
    buffer_load_dwordx4 v36, s[64:67], s30 offen offset:0 lds
    buffer_load_dwordx4 v37, s[64:67], s30 offen offset:1024 lds
    v_mfma_f32_16x16x32_bf16 v[136:139], v[144:147], v[156:159], v[136:139]
    ds_read_b64_tr_b16 v[176:177], v17 offset:57344
    ds_read_b64_tr_b16 v[178:179], v17 offset:59392
    v_mfma_f32_16x16x32_bf16 v[132:135], v[148:151], v[152:155], v[132:135]
    buffer_load_dwordx4 v38, s[64:67], s30 offen offset:2048 lds
    ds_read_b64_tr_b16 v[180:181], v18 offset:57344
    ds_read_b64_tr_b16 v[182:183], v18 offset:59392
    v_mfma_f32_16x16x32_bf16 v[140:143], v[148:151], v[156:159], v[140:143]
    s_waitcnt lgkmcnt(4)
    ds_read_b128 v[184:187], v23 offset:57344
    ds_read_b128 v[188:191], v23 offset:58368
    v_mfma_f32_16x16x32_bf16 v[128:131], v[160:163], v[168:171], v[128:131]
    buffer_load_dwordx4 v39, s[64:67], s30 offen offset:3072 lds
    s_waitcnt vmcnt(12) lgkmcnt(0)
    s_barrier
    v_mfma_f32_16x16x32_bf16 v[136:139], v[160:163], v[172:175], v[136:139]
    s_add_u32 m0, s16, 4096
    ds_read_b64_tr_b16 v[144:145], v21 offset:0
    ds_read_b64_tr_b16 v[146:147], v21 offset:2048
    v_mfma_f32_16x16x32_bf16 v[132:135], v[164:167], v[168:171], v[132:135]
    ds_read_b64_tr_b16 v[148:149], v22 offset:0
    ds_read_b64_tr_b16 v[150:151], v22 offset:2048
    v_mfma_f32_16x16x32_bf16 v[140:143], v[164:167], v[172:175], v[140:143]
    ds_read_b128 v[152:155], v27 offset:0
    ds_read_b128 v[156:159], v27 offset:1024
    v_mfma_f32_16x16x32_bf16 v[128:131], v[176:179], v[184:187], v[128:131]
    buffer_load_dwordx4 v40, s[76:79], s29 offen offset:0 sc1 lds
    buffer_load_dwordx4 v41, s[76:79], s29 offen offset:1024 sc1 lds
    v_mfma_f32_16x16x32_bf16 v[136:139], v[176:179], v[188:191], v[136:139]
    ds_read_b64_tr_b16 v[160:161], v21 offset:8192
    ds_read_b64_tr_b16 v[162:163], v21 offset:10240
    v_mfma_f32_16x16x32_bf16 v[132:135], v[180:183], v[184:187], v[132:135]
    ds_read_b64_tr_b16 v[164:165], v22 offset:8192
    ds_read_b64_tr_b16 v[166:167], v22 offset:10240
    v_mfma_f32_16x16x32_bf16 v[140:143], v[180:183], v[188:191], v[140:143]
    s_waitcnt lgkmcnt(4)
    ds_read_b128 v[168:171], v27 offset:8192
    ds_read_b128 v[172:175], v27 offset:9216
    v_mfma_f32_16x16x32_bf16 v[128:131], v[144:147], v[152:155], v[128:131]
    s_add_u32 s30, s30, 0x20000
    buffer_load_dwordx4 v42, s[76:79], s29 offen offset:2048 sc1 lds
    buffer_load_dwordx4 v43, s[76:79], s29 offen offset:3072 sc1 lds
    v_mfma_f32_16x16x32_bf16 v[136:139], v[144:147], v[156:159], v[136:139]
    s_add_u32 m0, s16, 98304
    ds_read_b64_tr_b16 v[176:177], v21 offset:16384
    ds_read_b64_tr_b16 v[178:179], v21 offset:18432
    v_mfma_f32_16x16x32_bf16 v[132:135], v[148:151], v[152:155], v[132:135]
    ds_read_b64_tr_b16 v[180:181], v22 offset:16384
    ds_read_b64_tr_b16 v[182:183], v22 offset:18432
    v_mfma_f32_16x16x32_bf16 v[140:143], v[148:151], v[156:159], v[140:143]
    s_waitcnt lgkmcnt(4)
    ds_read_b128 v[184:187], v27 offset:16384
    ds_read_b128 v[188:191], v27 offset:17408
    v_mfma_f32_16x16x32_bf16 v[128:131], v[160:163], v[168:171], v[128:131]
    s_add_u32 s29, s29, 0x1000
    buffer_load_dwordx4 v36, s[64:67], s30 offen offset:0 lds
    buffer_load_dwordx4 v37, s[64:67], s30 offen offset:1024 lds
    v_mfma_f32_16x16x32_bf16 v[136:139], v[160:163], v[172:175], v[136:139]
    ds_read_b64_tr_b16 v[144:145], v21 offset:24576
    ds_read_b64_tr_b16 v[146:147], v21 offset:26624
    v_mfma_f32_16x16x32_bf16 v[132:135], v[164:167], v[168:171], v[132:135]
    buffer_load_dwordx4 v38, s[64:67], s30 offen offset:2048 lds
    ds_read_b64_tr_b16 v[148:149], v22 offset:24576
    ds_read_b64_tr_b16 v[150:151], v22 offset:26624
    v_mfma_f32_16x16x32_bf16 v[140:143], v[164:167], v[172:175], v[140:143]
    s_waitcnt lgkmcnt(4)
    ds_read_b128 v[152:155], v27 offset:24576
    ds_read_b128 v[156:159], v27 offset:25600
    v_mfma_f32_16x16x32_bf16 v[128:131], v[176:179], v[184:187], v[128:131]
    buffer_load_dwordx4 v39, s[64:67], s30 offen offset:3072 lds
    s_waitcnt vmcnt(12) lgkmcnt(0)
    s_barrier
    buffer_load_dword v26, off, s[76:79], s90 offset:1280 sc1
    v_mfma_f32_16x16x32_bf16 v[136:139], v[176:179], v[188:191], v[136:139]
    s_add_u32 m0, s16, 102400
    ds_read_b64_tr_b16 v[160:161], v19 offset:0
    ds_read_b64_tr_b16 v[162:163], v19 offset:2048
    v_mfma_f32_16x16x32_bf16 v[132:135], v[180:183], v[184:187], v[132:135]
    ds_read_b64_tr_b16 v[164:165], v20 offset:0
    ds_read_b64_tr_b16 v[166:167], v20 offset:2048
    v_mfma_f32_16x16x32_bf16 v[140:143], v[180:183], v[188:191], v[140:143]
    ds_read_b128 v[168:171], v24 offset:0
    ds_read_b128 v[172:175], v24 offset:1024
    v_mfma_f32_16x16x32_bf16 v[128:131], v[144:147], v[152:155], v[128:131]
    buffer_load_dwordx4 v40, s[76:79], s29 offen offset:0 sc1 lds
    buffer_load_dwordx4 v41, s[76:79], s29 offen offset:1024 sc1 lds
    v_mfma_f32_16x16x32_bf16 v[136:139], v[144:147], v[156:159], v[136:139]
    ds_read_b64_tr_b16 v[176:177], v19 offset:8192
    ds_read_b64_tr_b16 v[178:179], v19 offset:10240
    v_mfma_f32_16x16x32_bf16 v[132:135], v[148:151], v[152:155], v[132:135]
    ds_read_b64_tr_b16 v[180:181], v20 offset:8192
    ds_read_b64_tr_b16 v[182:183], v20 offset:10240
    v_mfma_f32_16x16x32_bf16 v[140:143], v[148:151], v[156:159], v[140:143]
    s_waitcnt lgkmcnt(4)
    ds_read_b128 v[184:187], v24 offset:8192
    ds_read_b128 v[188:191], v24 offset:9216
    v_mfma_f32_16x16x32_bf16 v[128:131], v[160:163], v[168:171], v[128:131]
    s_add_u32 s30, s30, 0x20000
    buffer_load_dwordx4 v42, s[76:79], s29 offen offset:2048 sc1 lds
    buffer_load_dwordx4 v43, s[76:79], s29 offen offset:3072 sc1 lds
    v_mfma_f32_16x16x32_bf16 v[136:139], v[160:163], v[172:175], v[136:139]
    s_add_u32 m0, s16, 32768
    ds_read_b64_tr_b16 v[144:145], v19 offset:16384
    ds_read_b64_tr_b16 v[146:147], v19 offset:18432
    v_mfma_f32_16x16x32_bf16 v[132:135], v[164:167], v[168:171], v[132:135]
    ds_read_b64_tr_b16 v[148:149], v20 offset:16384
    ds_read_b64_tr_b16 v[150:151], v20 offset:18432
    v_mfma_f32_16x16x32_bf16 v[140:143], v[164:167], v[172:175], v[140:143]
    s_waitcnt lgkmcnt(4)
    ds_read_b128 v[152:155], v24 offset:16384
    ds_read_b128 v[156:159], v24 offset:17408
    v_mfma_f32_16x16x32_bf16 v[128:131], v[176:179], v[184:187], v[128:131]
    s_add_u32 s29, s29, 0x1000
    buffer_load_dwordx4 v36, s[64:67], s30 offen offset:0 lds
    buffer_load_dwordx4 v37, s[64:67], s30 offen offset:1024 lds
    v_mfma_f32_16x16x32_bf16 v[136:139], v[176:179], v[188:191], v[136:139]
    ds_read_b64_tr_b16 v[160:161], v19 offset:24576
    ds_read_b64_tr_b16 v[162:163], v19 offset:26624
    v_mfma_f32_16x16x32_bf16 v[132:135], v[180:183], v[184:187], v[132:135]
    buffer_load_dwordx4 v38, s[64:67], s30 offen offset:2048 lds
    ds_read_b64_tr_b16 v[164:165], v20 offset:24576
    ds_read_b64_tr_b16 v[166:167], v20 offset:26624
    v_mfma_f32_16x16x32_bf16 v[140:143], v[180:183], v[188:191], v[140:143]
    s_waitcnt lgkmcnt(4)
    ds_read_b128 v[168:171], v24 offset:24576
    ds_read_b128 v[172:175], v24 offset:25600
    v_mfma_f32_16x16x32_bf16 v[128:131], v[144:147], v[152:155], v[128:131]
    buffer_load_dwordx4 v39, s[64:67], s30 offen offset:3072 lds
    s_waitcnt vmcnt(13) lgkmcnt(0)
    s_barrier
    v_mfma_f32_16x16x32_bf16 v[136:139], v[144:147], v[156:159], v[136:139]
    s_add_u32 m0, s16, 36864
    ds_read_b64_tr_b16 v[176:177], v17 offset:0
    ds_read_b64_tr_b16 v[178:179], v17 offset:2048
    v_mfma_f32_16x16x32_bf16 v[132:135], v[148:151], v[152:155], v[132:135]
    ds_read_b64_tr_b16 v[180:181], v18 offset:0
    ds_read_b64_tr_b16 v[182:183], v18 offset:2048
    v_mfma_f32_16x16x32_bf16 v[140:143], v[148:151], v[156:159], v[140:143]
    ds_read_b128 v[184:187], v23 offset:0
    ds_read_b128 v[188:191], v23 offset:1024
    v_mfma_f32_16x16x32_bf16 v[128:131], v[160:163], v[168:171], v[128:131]
    buffer_load_dwordx4 v40, s[76:79], s29 offen offset:0 sc1 lds
    buffer_load_dwordx4 v41, s[76:79], s29 offen offset:1024 sc1 lds
L_warm1_3:
    s_cbranch_execz L_warm_ret1
    v_mfma_f32_16x16x32_bf16 v[136:139], v[160:163], v[172:175], v[136:139]
    ds_read_b64_tr_b16 v[144:145], v17 offset:8192
    ds_read_b64_tr_b16 v[146:147], v17 offset:10240
    v_mfma_f32_16x16x32_bf16 v[132:135], v[164:167], v[168:171], v[132:135]
    ds_read_b64_tr_b16 v[148:149], v18 offset:8192
    ds_read_b64_tr_b16 v[150:151], v18 offset:10240
    v_mfma_f32_16x16x32_bf16 v[140:143], v[164:167], v[172:175], v[140:143]
    s_waitcnt lgkmcnt(4)
    ds_read_b128 v[152:155], v23 offset:8192
    ds_read_b128 v[156:159], v23 offset:9216
    v_mfma_f32_16x16x32_bf16 v[128:131], v[176:179], v[184:187], v[128:131]
    buffer_load_dwordx4 v42, s[76:79], s29 offen offset:2048 sc1 lds
    buffer_load_dwordx4 v43, s[76:79], s29 offen offset:3072 sc1 lds
    v_mfma_f32_16x16x32_bf16 v[136:139], v[176:179], v[188:191], v[136:139]
    ds_read_b64_tr_b16 v[160:161], v17 offset:16384
    ds_read_b64_tr_b16 v[162:163], v17 offset:18432
    v_mfma_f32_16x16x32_bf16 v[132:135], v[180:183], v[184:187], v[132:135]
    ds_read_b64_tr_b16 v[164:165], v18 offset:16384
    ds_read_b64_tr_b16 v[166:167], v18 offset:18432
    v_mfma_f32_16x16x32_bf16 v[140:143], v[180:183], v[188:191], v[140:143]
    s_waitcnt lgkmcnt(4)
    ds_read_b128 v[168:171], v23 offset:16384
    ds_read_b128 v[172:175], v23 offset:17408
    v_mfma_f32_16x16x32_bf16 v[128:131], v[144:147], v[152:155], v[128:131]
    v_mfma_f32_16x16x32_bf16 v[136:139], v[144:147], v[156:159], v[136:139]
    ds_read_b64_tr_b16 v[176:177], v17 offset:24576
    ds_read_b64_tr_b16 v[178:179], v17 offset:26624
    v_mfma_f32_16x16x32_bf16 v[132:135], v[148:151], v[152:155], v[132:135]
    ds_read_b64_tr_b16 v[180:181], v18 offset:24576
    ds_read_b64_tr_b16 v[182:183], v18 offset:26624
    v_mfma_f32_16x16x32_bf16 v[140:143], v[148:151], v[156:159], v[140:143]
    s_waitcnt lgkmcnt(4)
    ds_read_b128 v[184:187], v23 offset:24576
    ds_read_b128 v[188:191], v23 offset:25600
    v_mfma_f32_16x16x32_bf16 v[128:131], v[160:163], v[168:171], v[128:131]
    s_waitcnt vmcnt(8) lgkmcnt(0)
    s_barrier
    v_mfma_f32_16x16x32_bf16 v[136:139], v[160:163], v[172:175], v[136:139]
    ds_read_b64_tr_b16 v[144:145], v19 offset:32768
    ds_read_b64_tr_b16 v[146:147], v19 offset:34816
    v_mfma_f32_16x16x32_bf16 v[132:135], v[164:167], v[168:171], v[132:135]
    ds_read_b64_tr_b16 v[148:149], v20 offset:32768
    ds_read_b64_tr_b16 v[150:151], v20 offset:34816
    v_mfma_f32_16x16x32_bf16 v[140:143], v[164:167], v[172:175], v[140:143]
    ds_read_b128 v[152:155], v24 offset:32768
    ds_read_b128 v[156:159], v24 offset:33792
    v_mfma_f32_16x16x32_bf16 v[128:131], v[176:179], v[184:187], v[128:131]
    v_mfma_f32_16x16x32_bf16 v[136:139], v[176:179], v[188:191], v[136:139]
    ds_read_b64_tr_b16 v[160:161], v19 offset:40960
    ds_read_b64_tr_b16 v[162:163], v19 offset:43008
    v_mfma_f32_16x16x32_bf16 v[132:135], v[180:183], v[184:187], v[132:135]
    ds_read_b64_tr_b16 v[164:165], v20 offset:40960
    ds_read_b64_tr_b16 v[166:167], v20 offset:43008
    v_mfma_f32_16x16x32_bf16 v[140:143], v[180:183], v[188:191], v[140:143]
    s_waitcnt lgkmcnt(4)
    ds_read_b128 v[168:171], v24 offset:40960
    ds_read_b128 v[172:175], v24 offset:41984
    v_mfma_f32_16x16x32_bf16 v[128:131], v[144:147], v[152:155], v[128:131]
    v_cmp_gt_u32 vcc, 4, v26
    s_cbranch_vccnz L_spin_13
    L_back_14:
    v_mfma_f32_16x16x32_bf16 v[136:139], v[144:147], v[156:159], v[136:139]
    ds_read_b64_tr_b16 v[176:177], v19 offset:49152
    ds_read_b64_tr_b16 v[178:179], v19 offset:51200
    buffer_load_dwordx4 v[96:99], v25, s[76:79], s94 offen offset:0 sc1
    v_mfma_f32_16x16x32_bf16 v[132:135], v[148:151], v[152:155], v[132:135]
    ds_read_b64_tr_b16 v[180:181], v20 offset:49152
    ds_read_b64_tr_b16 v[182:183], v20 offset:51200
    buffer_load_dwordx4 v[100:103], v25, s[76:79], s94 offen offset:1024 sc1
    v_mfma_f32_16x16x32_bf16 v[140:143], v[148:151], v[156:159], v[140:143]
    s_add_u32 s94, s94, 0x8000
    ds_read_b128 v[184:187], v24 offset:49152
    ds_read_b128 v[188:191], v24 offset:50176
    s_waitcnt lgkmcnt(6)
    v_mfma_f32_16x16x32_bf16 v[128:131], v[160:163], v[168:171], v[128:131]
    buffer_load_dwordx4 v[104:107], v25, s[76:79], s94 offen offset:0 sc1
    buffer_load_dwordx4 v[108:111], v25, s[76:79], s94 offen offset:1024 sc1
    v_mfma_f32_16x16x32_bf16 v[136:139], v[160:163], v[172:175], v[136:139]
    s_add_u32 s94, s94, 0x8000
    buffer_load_dwordx4 v[112:115], v25, s[76:79], s94 offen offset:0 sc1
    ds_read_b64_tr_b16 v[144:145], v19 offset:57344
    ds_read_b64_tr_b16 v[146:147], v19 offset:59392
    v_mfma_f32_16x16x32_bf16 v[132:135], v[164:167], v[168:171], v[132:135]
    buffer_load_dwordx4 v[116:119], v25, s[76:79], s94 offen offset:1024 sc1
    ds_read_b64_tr_b16 v[148:149], v20 offset:57344
    ds_read_b64_tr_b16 v[150:151], v20 offset:59392
    v_mfma_f32_16x16x32_bf16 v[140:143], v[164:167], v[172:175], v[140:143]
    s_add_u32 s94, s94, 0x8000
    buffer_load_dwordx4 v[120:123], v25, s[76:79], s94 offen offset:0 sc1
    ds_read_b128 v[152:155], v24 offset:57344
    ds_read_b128 v[156:159], v24 offset:58368
    s_waitcnt lgkmcnt(6)
    v_mfma_f32_16x16x32_bf16 v[128:131], v[176:179], v[184:187], v[128:131]
    buffer_load_dwordx4 v[124:127], v25, s[76:79], s94 offen offset:1024 sc1
    s_waitcnt vmcnt(8) lgkmcnt(0)
    s_barrier
    v_mfma_f32_16x16x32_bf16 v[136:139], v[176:179], v[188:191], v[136:139]
    ds_read_b64_tr_b16 v[160:161], v17 offset:32768
    ds_read_b64_tr_b16 v[162:163], v17 offset:34816
    v_mfma_f32_16x16x32_bf16 v[132:135], v[180:183], v[184:187], v[132:135]
    ds_read_b64_tr_b16 v[164:165], v18 offset:32768
    ds_read_b64_tr_b16 v[166:167], v18 offset:34816
    v_mfma_f32_16x16x32_bf16 v[140:143], v[180:183], v[188:191], v[140:143]
    ds_read_b128 v[168:171], v23 offset:32768
    ds_read_b128 v[172:175], v23 offset:33792
    v_mfma_f32_16x16x32_bf16 v[128:131], v[144:147], v[152:155], v[128:131]
    v_mfma_f32_16x16x32_bf16 v[136:139], v[144:147], v[156:159], v[136:139]
    ds_read_b64_tr_b16 v[176:177], v17 offset:40960
    ds_read_b64_tr_b16 v[178:179], v17 offset:43008
    v_mfma_f32_16x16x32_bf16 v[132:135], v[148:151], v[152:155], v[132:135]
    ds_read_b64_tr_b16 v[180:181], v18 offset:40960
    ds_read_b64_tr_b16 v[182:183], v18 offset:43008
    v_mfma_f32_16x16x32_bf16 v[140:143], v[148:151], v[156:159], v[140:143]
    s_waitcnt lgkmcnt(4)
    ds_read_b128 v[184:187], v23 offset:40960
    ds_read_b128 v[188:191], v23 offset:41984
    v_mfma_f32_16x16x32_bf16 v[128:131], v[160:163], v[168:171], v[128:131]
    v_mfma_f32_16x16x32_bf16 v[136:139], v[160:163], v[172:175], v[136:139]
    ds_read_b64_tr_b16 v[144:145], v17 offset:49152
    ds_read_b64_tr_b16 v[146:147], v17 offset:51200
    v_mfma_f32_16x16x32_bf16 v[132:135], v[164:167], v[168:171], v[132:135]
    ds_read_b64_tr_b16 v[148:149], v18 offset:49152
    ds_read_b64_tr_b16 v[150:151], v18 offset:51200
    v_mfma_f32_16x16x32_bf16 v[140:143], v[164:167], v[172:175], v[140:143]
    s_waitcnt lgkmcnt(4)
    ds_read_b128 v[152:155], v23 offset:49152
    ds_read_b128 v[156:159], v23 offset:50176
    v_mfma_f32_16x16x32_bf16 v[128:131], v[176:179], v[184:187], v[128:131]
    v_mfma_f32_16x16x32_bf16 v[136:139], v[176:179], v[188:191], v[136:139]
    v_mfma_f32_16x16x32_bf16 v[132:135], v[180:183], v[184:187], v[132:135]
    v_mfma_f32_16x16x32_bf16 v[140:143], v[180:183], v[188:191], v[140:143]
    s_waitcnt lgkmcnt(0)
    v_mfma_f32_16x16x32_bf16 v[128:131], v[144:147], v[152:155], v[128:131]
    v_mfma_f32_16x16x32_bf16 v[136:139], v[144:147], v[156:159], v[136:139]
    v_mfma_f32_16x16x32_bf16 v[132:135], v[148:151], v[152:155], v[132:135]
    v_mfma_f32_16x16x32_bf16 v[140:143], v[148:151], v[156:159], v[140:143]
    s_mov_b32 s0, 0xbfb8aa3b
    s_mov_b32 s1, 1.0
    v_lshlrev_b32 v54, 16, v28
    v_and_b32 v55, 0xffff0000, v28
    v_lshlrev_b32 v56, 16, v29
    v_and_b32 v57, 0xffff0000, v29
    v_pk_add_f32 v[128:129], v[128:129], v[54:55]
    v_pk_add_f32 v[130:131], v[130:131], v[56:57]
    v_pk_mul_f32 v[54:55], v[128:129], s[0:1] op_sel_hi:[1,0]
    v_pk_mul_f32 v[56:57], v[130:131], s[0:1] op_sel_hi:[1,0]
    v_exp_f32 v54, v54
    v_exp_f32 v55, v55
    v_exp_f32 v56, v56
    v_exp_f32 v57, v57
    v_pk_add_f32 v[54:55], v[54:55], s[0:1] op_sel:[0,1] op_sel_hi:[1,1]
    v_pk_add_f32 v[56:57], v[56:57], s[0:1] op_sel:[0,1] op_sel_hi:[1,1]
    v_rcp_f32 v54, v54
    v_rcp_f32 v55, v55
    v_rcp_f32 v56, v56
    v_rcp_f32 v57, v57
    v_lshlrev_b32 v240, 16, v80
    v_and_b32 v241, 0xffff0000, v80
    v_lshlrev_b32 v242, 16, v81
    v_and_b32 v243, 0xffff0000, v81
    v_pk_mul_f32 v[128:129], v[128:129], v[54:55]
    v_pk_mul_f32 v[130:131], v[130:131], v[56:57]
    v_lshlrev_b32 v54, 16, v30
    v_and_b32 v55, 0xffff0000, v30
    v_lshlrev_b32 v56, 16, v31
    v_and_b32 v57, 0xffff0000, v31
    v_pk_add_f32 v[132:133], v[132:133], v[54:55]
    v_pk_add_f32 v[134:135], v[134:135], v[56:57]
    v_pk_mul_f32 v[54:55], v[132:133], s[0:1] op_sel_hi:[1,0]
    v_pk_mul_f32 v[56:57], v[134:135], s[0:1] op_sel_hi:[1,0]
    v_exp_f32 v54, v54
    v_exp_f32 v55, v55
    v_exp_f32 v56, v56
    v_exp_f32 v57, v57
    v_pk_add_f32 v[54:55], v[54:55], s[0:1] op_sel:[0,1] op_sel_hi:[1,1]
    v_pk_add_f32 v[56:57], v[56:57], s[0:1] op_sel:[0,1] op_sel_hi:[1,1]
    v_rcp_f32 v54, v54
    v_rcp_f32 v55, v55
    v_rcp_f32 v56, v56
    v_rcp_f32 v57, v57
    v_lshlrev_b32 v244, 16, v82
    v_and_b32 v245, 0xffff0000, v82
    v_lshlrev_b32 v246, 16, v83
    v_and_b32 v247, 0xffff0000, v83
    v_pk_mul_f32 v[132:133], v[132:133], v[54:55]
    v_pk_mul_f32 v[134:135], v[134:135], v[56:57]
    v_lshlrev_b32 v54, 16, v32
    v_and_b32 v55, 0xffff0000, v32
    v_lshlrev_b32 v56, 16, v33
    v_and_b32 v57, 0xffff0000, v33
    v_pk_add_f32 v[136:137], v[136:137], v[54:55]
    v_pk_add_f32 v[138:139], v[138:139], v[56:57]
    v_pk_mul_f32 v[54:55], v[136:137], s[0:1] op_sel_hi:[1,0]
    v_pk_mul_f32 v[56:57], v[138:139], s[0:1] op_sel_hi:[1,0]
    v_exp_f32 v54, v54
    v_exp_f32 v55, v55
    v_exp_f32 v56, v56
    v_exp_f32 v57, v57
    v_pk_add_f32 v[54:55], v[54:55], s[0:1] op_sel:[0,1] op_sel_hi:[1,1]
    v_pk_add_f32 v[56:57], v[56:57], s[0:1] op_sel:[0,1] op_sel_hi:[1,1]
    v_rcp_f32 v54, v54
    v_rcp_f32 v55, v55
    v_rcp_f32 v56, v56
    v_rcp_f32 v57, v57
    v_lshlrev_b32 v248, 16, v84
    v_and_b32 v249, 0xffff0000, v84
    v_lshlrev_b32 v250, 16, v85
    v_and_b32 v251, 0xffff0000, v85
    v_pk_mul_f32 v[136:137], v[136:137], v[54:55]
    v_pk_mul_f32 v[138:139], v[138:139], v[56:57]
    v_lshlrev_b32 v54, 16, v34
    v_and_b32 v55, 0xffff0000, v34
    v_lshlrev_b32 v56, 16, v35
    v_and_b32 v57, 0xffff0000, v35
    v_pk_add_f32 v[140:141], v[140:141], v[54:55]
    v_pk_add_f32 v[142:143], v[142:143], v[56:57]
    v_pk_mul_f32 v[54:55], v[140:141], s[0:1] op_sel_hi:[1,0]
    v_pk_mul_f32 v[56:57], v[142:143], s[0:1] op_sel_hi:[1,0]
    v_exp_f32 v54, v54
    v_exp_f32 v55, v55
    v_exp_f32 v56, v56
    v_exp_f32 v57, v57
    v_pk_add_f32 v[54:55], v[54:55], s[0:1] op_sel:[0,1] op_sel_hi:[1,1]
    v_pk_add_f32 v[56:57], v[56:57], s[0:1] op_sel:[0,1] op_sel_hi:[1,1]
    v_rcp_f32 v54, v54
    v_rcp_f32 v55, v55
    v_rcp_f32 v56, v56
    v_rcp_f32 v57, v57
    v_lshlrev_b32 v252, 16, v86
    v_and_b32 v253, 0xffff0000, v86
    v_lshlrev_b32 v254, 16, v87
    v_and_b32 v255, 0xffff0000, v87
    v_pk_mul_f32 v[140:141], v[140:141], v[54:55]
    v_pk_mul_f32 v[142:143], v[142:143], v[56:57]
    s_waitcnt vmcnt(7)
    v_lshlrev_b32 v224, 16, v96
    v_and_b32 v225, 0xffff0000, v96
    v_lshlrev_b32 v226, 16, v97
    v_and_b32 v227, 0xffff0000, v97
    v_lshlrev_b32 v228, 16, v98
    v_and_b32 v229, 0xffff0000, v98
    v_lshlrev_b32 v230, 16, v99
    v_and_b32 v231, 0xffff0000, v99
    s_waitcnt vmcnt(6)
    v_lshlrev_b32 v232, 16, v100
    v_and_b32 v233, 0xffff0000, v100
    v_lshlrev_b32 v234, 16, v101
    v_and_b32 v235, 0xffff0000, v101
    v_lshlrev_b32 v236, 16, v102
    v_and_b32 v237, 0xffff0000, v102
    v_lshlrev_b32 v238, 16, v103
    v_and_b32 v239, 0xffff0000, v103
    s_waitcnt vmcnt(5)
    v_lshlrev_b32 v54, 16, v104
    v_and_b32 v55, 0xffff0000, v104
    v_pk_add_f32 v[224:225], v[224:225], v[54:55]
    v_lshlrev_b32 v56, 16, v105
    v_and_b32 v57, 0xffff0000, v105
    v_pk_add_f32 v[226:227], v[226:227], v[56:57]
    v_lshlrev_b32 v54, 16, v106
    v_and_b32 v55, 0xffff0000, v106
    v_pk_add_f32 v[228:229], v[228:229], v[54:55]
    v_lshlrev_b32 v56, 16, v107
    v_and_b32 v57, 0xffff0000, v107
    v_pk_add_f32 v[230:231], v[230:231], v[56:57]
    s_waitcnt vmcnt(4)
    v_lshlrev_b32 v54, 16, v108
    v_and_b32 v55, 0xffff0000, v108
    v_pk_add_f32 v[232:233], v[232:233], v[54:55]
    v_lshlrev_b32 v56, 16, v109
    v_and_b32 v57, 0xffff0000, v109
    v_pk_add_f32 v[234:235], v[234:235], v[56:57]
    v_lshlrev_b32 v54, 16, v110
    v_and_b32 v55, 0xffff0000, v110
    v_pk_add_f32 v[236:237], v[236:237], v[54:55]
    v_lshlrev_b32 v56, 16, v111
    v_and_b32 v57, 0xffff0000, v111
    v_pk_add_f32 v[238:239], v[238:239], v[56:57]
    s_waitcnt vmcnt(3)
    v_lshlrev_b32 v54, 16, v112
    v_and_b32 v55, 0xffff0000, v112
    v_pk_add_f32 v[224:225], v[224:225], v[54:55]
    v_lshlrev_b32 v56, 16, v113
    v_and_b32 v57, 0xffff0000, v113
    v_pk_add_f32 v[226:227], v[226:227], v[56:57]
    v_lshlrev_b32 v54, 16, v114
    v_and_b32 v55, 0xffff0000, v114
    v_pk_add_f32 v[228:229], v[228:229], v[54:55]
    v_lshlrev_b32 v56, 16, v115
    v_and_b32 v57, 0xffff0000, v115
    v_pk_add_f32 v[230:231], v[230:231], v[56:57]
    s_waitcnt vmcnt(2)
    v_lshlrev_b32 v54, 16, v116
    v_and_b32 v55, 0xffff0000, v116
    v_pk_add_f32 v[232:233], v[232:233], v[54:55]
    v_lshlrev_b32 v56, 16, v117
    v_and_b32 v57, 0xffff0000, v117
    v_pk_add_f32 v[234:235], v[234:235], v[56:57]
    v_lshlrev_b32 v54, 16, v118
    v_and_b32 v55, 0xffff0000, v118
    v_pk_add_f32 v[236:237], v[236:237], v[54:55]
    v_lshlrev_b32 v56, 16, v119
    v_and_b32 v57, 0xffff0000, v119
    v_pk_add_f32 v[238:239], v[238:239], v[56:57]
    s_waitcnt vmcnt(1)
    v_lshlrev_b32 v54, 16, v120
    v_and_b32 v55, 0xffff0000, v120
    v_pk_add_f32 v[224:225], v[224:225], v[54:55]
    v_pk_fma_f32 v[240:241], v[224:225], v[128:129], v[240:241]
    v_cvt_pk_bf16_f32 v192, v240, v241
    v_lshlrev_b32 v56, 16, v121
    v_and_b32 v57, 0xffff0000, v121
    v_pk_add_f32 v[226:227], v[226:227], v[56:57]
    v_pk_fma_f32 v[242:243], v[226:227], v[130:131], v[242:243]
    v_cvt_pk_bf16_f32 v193, v242, v243
    buffer_store_dwordx2 v[192:193], v59, s[68:71], s95 offen offset:0
    v_lshlrev_b32 v54, 16, v122
    v_and_b32 v55, 0xffff0000, v122
    v_pk_add_f32 v[228:229], v[228:229], v[54:55]
    v_pk_fma_f32 v[244:245], v[228:229], v[132:133], v[244:245]
    v_cvt_pk_bf16_f32 v194, v244, v245
    v_lshlrev_b32 v56, 16, v123
    v_and_b32 v57, 0xffff0000, v123
    v_pk_add_f32 v[230:231], v[230:231], v[56:57]
    v_pk_fma_f32 v[246:247], v[230:231], v[134:135], v[246:247]
    v_cvt_pk_bf16_f32 v195, v246, v247
    buffer_store_dwordx2 v[194:195], v59, s[68:71], s95 offen offset:32
    s_waitcnt vmcnt(2)
    v_lshlrev_b32 v54, 16, v124
    v_and_b32 v55, 0xffff0000, v124
    v_pk_add_f32 v[232:233], v[232:233], v[54:55]
    v_pk_fma_f32 v[248:249], v[232:233], v[136:137], v[248:249]
    v_cvt_pk_bf16_f32 v196, v248, v249
    v_lshlrev_b32 v56, 16, v125
    v_and_b32 v57, 0xffff0000, v125
    v_pk_add_f32 v[234:235], v[234:235], v[56:57]
    v_pk_fma_f32 v[250:251], v[234:235], v[138:139], v[250:251]
    v_cvt_pk_bf16_f32 v197, v250, v251
    buffer_store_dwordx2 v[196:197], v59, s[68:71], s91 offen offset:0
    v_lshlrev_b32 v54, 16, v126
    v_and_b32 v55, 0xffff0000, v126
    v_pk_add_f32 v[236:237], v[236:237], v[54:55]
    v_pk_fma_f32 v[252:253], v[236:237], v[140:141], v[252:253]
    v_cvt_pk_bf16_f32 v198, v252, v253
    v_lshlrev_b32 v56, 16, v127
    v_and_b32 v57, 0xffff0000, v127
    v_pk_add_f32 v[238:239], v[238:239], v[56:57]
    v_pk_fma_f32 v[254:255], v[238:239], v[142:143], v[254:255]
    v_cvt_pk_bf16_f32 v199, v254, v255
    buffer_store_dwordx2 v[198:199], v59, s[68:71], s91 offen offset:32
    s_waitcnt vmcnt(0)
L_end:
    s_endpgm
L_spin_1:
    s_mov_b32 s26, 0
L_spin_1_l:
    s_sleep 4
    buffer_load_dword v26, v55, s[72:75], 0 offen offset:0 sc1
    s_add_u32 s26, s26, 1
    s_cmp_gt_u32 s26, 0x4000
    s_waitcnt vmcnt(0)
    s_cbranch_scc1 L_back_2
    v_cmp_gt_u32 vcc, v56, v26
    s_cbranch_vccnz L_spin_1_l
    s_branch L_back_2
L_spin_3:
    s_mov_b32 s26, 0
L_spin_3_l:
    s_sleep 4
    buffer_load_dword v26, off, s[76:79], s23 offset:0 sc1
    s_add_u32 s26, s26, 1
    s_cmp_gt_u32 s26, 0x4000
    s_waitcnt vmcnt(0)
    s_cbranch_scc1 L_back_4
    v_cmp_gt_u32 vcc, 32, v26
    s_cbranch_vccnz L_spin_3_l
    s_branch L_back_4
L_spin_5:
    s_mov_b32 s26, 0
L_spin_5_l:
    s_sleep 4
    buffer_load_dword v26, v58, s[76:79], 0 offen offset:128 sc1
    s_add_u32 s26, s26, 1
    s_cmp_gt_u32 s26, 0x4000
    s_waitcnt vmcnt(0)
    s_cbranch_scc1 L_back_6
    v_cmp_gt_u32 vcc, 32, v26
    s_cbranch_vccnz L_spin_5_l
    s_branch L_back_6
L_spin_7:
    s_mov_b32 s26, 0
L_spin_7_l:
    s_sleep 4
    buffer_load_dword v26, off, s[76:79], s97 offset:256 sc1
    s_add_u32 s26, s26, 1
    s_cmp_gt_u32 s26, 0x4000
    s_waitcnt vmcnt(0)
    s_cbranch_scc1 L_back_8
    v_cmp_gt_u32 vcc, 16, v26
    s_cbranch_vccnz L_spin_7_l
    s_branch L_back_8
L_redo:
    s_waitcnt vmcnt(0) lgkmcnt(0)
    s_nop 15
    v_and_b32 v56, 15, v0
    v_lshrrev_b32 v59, 4, v0
    v_lshlrev_b32 v27, 3, v59
    v_lshl_add_u32 v56, v56, 8, v27
    s_lshl_b32 s0, s5, 6
    v_add_u32 v56, s0, v56
    s_lshl_b32 s0, s5, 12
    s_add_u32 s0, s0, 139264
    s_mov_b32 m0, s0
    v_bfe_u32 v27, v0, 2, 2
    v_lshl_add_u32 v27, v59, 2, v27
    v_lshlrev_b32 v57, 7, v27
    v_bfe_u32 v27, v27, 1, 2
    v_lshl_add_u32 v57, v27, 5, v57
    v_and_b32 v27, 3, v0
    v_lshl_add_u32 v57, v27, 3, v57
    v_add_u32 v57, s0, v57
    v_lshlrev_b32 v59, 1, v59
    v_and_b32 v27, 7, v0
    v_xor_b32 v59, v59, v27
    v_lshlrev_b32 v59, 4, v59
    v_lshrrev_b32 v27, 3, v0
    v_lshl_add_u32 v58, v27, 8, v59
    v_mov_b32 v17, 0xff800000
    v_mov_b32 v18, 0xff800000
    v_mov_b32 v19, 0xff800000
    v_mov_b32 v20, 0xff800000
    s_mov_b32 s1, 0
L_redo_max:
    s_add_u32 s0, s1, 0
    v_xor_b32 v59, 0, v56
    buffer_load_dwordx2 v[64:65], v59, s[36:39], s0 offen offset:0
    buffer_load_dwordx2 v[66:67], v59, s[36:39], s0 offen offset:32
    v_xor_b32 v59, 64, v56
    buffer_load_dwordx2 v[72:73], v59, s[36:39], s0 offen offset:0
    buffer_load_dwordx2 v[74:75], v59, s[36:39], s0 offen offset:32
    v_xor_b32 v59, 128, v56
    buffer_load_dwordx2 v[80:81], v59, s[36:39], s0 offen offset:0
    buffer_load_dwordx2 v[82:83], v59, s[36:39], s0 offen offset:32
    v_xor_b32 v59, 192, v56
    buffer_load_dwordx2 v[88:89], v59, s[36:39], s0 offen offset:0
    buffer_load_dwordx2 v[90:91], v59, s[36:39], s0 offen offset:32
    s_add_u32 s0, s1, 4096
    v_xor_b32 v59, 0, v56
    buffer_load_dwordx2 v[68:69], v59, s[36:39], s0 offen offset:0
    buffer_load_dwordx2 v[70:71], v59, s[36:39], s0 offen offset:32
    v_xor_b32 v59, 64, v56
    buffer_load_dwordx2 v[76:77], v59, s[36:39], s0 offen offset:0
    buffer_load_dwordx2 v[78:79], v59, s[36:39], s0 offen offset:32
    v_xor_b32 v59, 128, v56
    buffer_load_dwordx2 v[84:85], v59, s[36:39], s0 offen offset:0
    buffer_load_dwordx2 v[86:87], v59, s[36:39], s0 offen offset:32
    v_xor_b32 v59, 192, v56
    buffer_load_dwordx2 v[92:93], v59, s[36:39], s0 offen offset:0
    buffer_load_dwordx2 v[94:95], v59, s[36:39], s0 offen offset:32
    s_waitcnt vmcnt(0)
    v_mfma_f32_16x16x32_bf16 v[224:227], v[64:67], v[128:131], 0
    v_mfma_f32_16x16x32_bf16 v[224:227], v[72:75], v[132:135], v[224:227]
    v_mfma_f32_16x16x32_bf16 v[224:227], v[80:83], v[136:139], v[224:227]
    v_mfma_f32_16x16x32_bf16 v[224:227], v[88:91], v[140:143], v[224:227]
    v_mfma_f32_16x16x32_bf16 v[228:231], v[68:71], v[128:131], 0
    v_mfma_f32_16x16x32_bf16 v[228:231], v[76:79], v[132:135], v[228:231]
    v_mfma_f32_16x16x32_bf16 v[228:231], v[84:87], v[136:139], v[228:231]
    v_mfma_f32_16x16x32_bf16 v[228:231], v[92:95], v[140:143], v[228:231]
    v_mfma_f32_16x16x32_bf16 v[232:235], v[64:67], v[144:147], 0
    v_mfma_f32_16x16x32_bf16 v[232:235], v[72:75], v[148:151], v[232:235]
    v_mfma_f32_16x16x32_bf16 v[232:235], v[80:83], v[152:155], v[232:235]
    v_mfma_f32_16x16x32_bf16 v[232:235], v[88:91], v[156:159], v[232:235]
    v_mfma_f32_16x16x32_bf16 v[236:239], v[68:71], v[144:147], 0
    v_mfma_f32_16x16x32_bf16 v[236:239], v[76:79], v[148:151], v[236:239]
    v_mfma_f32_16x16x32_bf16 v[236:239], v[84:87], v[152:155], v[236:239]
    v_mfma_f32_16x16x32_bf16 v[236:239], v[92:95], v[156:159], v[236:239]
    v_mfma_f32_16x16x32_bf16 v[240:243], v[64:67], v[160:163], 0
    v_mfma_f32_16x16x32_bf16 v[240:243], v[72:75], v[164:167], v[240:243]
    v_mfma_f32_16x16x32_bf16 v[240:243], v[80:83], v[168:171], v[240:243]
    v_mfma_f32_16x16x32_bf16 v[240:243], v[88:91], v[172:175], v[240:243]
    v_mfma_f32_16x16x32_bf16 v[244:247], v[68:71], v[160:163], 0
    v_mfma_f32_16x16x32_bf16 v[244:247], v[76:79], v[164:167], v[244:247]
    v_mfma_f32_16x16x32_bf16 v[244:247], v[84:87], v[168:171], v[244:247]
    v_mfma_f32_16x16x32_bf16 v[244:247], v[92:95], v[172:175], v[244:247]
    v_mfma_f32_16x16x32_bf16 v[248:251], v[64:67], v[176:179], 0
    v_mfma_f32_16x16x32_bf16 v[248:251], v[72:75], v[180:183], v[248:251]
    v_mfma_f32_16x16x32_bf16 v[248:251], v[80:83], v[184:187], v[248:251]
    v_mfma_f32_16x16x32_bf16 v[248:251], v[88:91], v[188:191], v[248:251]
    v_mfma_f32_16x16x32_bf16 v[252:255], v[68:71], v[176:179], 0
    v_mfma_f32_16x16x32_bf16 v[252:255], v[76:79], v[180:183], v[252:255]
    v_mfma_f32_16x16x32_bf16 v[252:255], v[84:87], v[184:187], v[252:255]
    v_mfma_f32_16x16x32_bf16 v[252:255], v[92:95], v[188:191], v[252:255]
    s_nop 15
    v_max3_f32 v17, v224, v225, v17
    v_max3_f32 v17, v226, v227, v17
    v_max3_f32 v17, v228, v229, v17
    v_max3_f32 v17, v230, v231, v17
    v_max3_f32 v18, v232, v233, v18
    v_max3_f32 v18, v234, v235, v18
    v_max3_f32 v18, v236, v237, v18
    v_max3_f32 v18, v238, v239, v18
    v_max3_f32 v19, v240, v241, v19
    v_max3_f32 v19, v242, v243, v19
    v_max3_f32 v19, v244, v245, v19
    v_max3_f32 v19, v246, v247, v19
    v_max3_f32 v20, v248, v249, v20
    v_max3_f32 v20, v250, v251, v20
    v_max3_f32 v20, v252, v253, v20
    v_max3_f32 v20, v254, v255, v20
    s_add_u32 s1, s1, 0x2000
    s_cmp_lt_u32 s1, 0x20000
    s_cbranch_scc1 L_redo_max
    v_mov_b32 v59, v17
    s_nop 1
    v_permlane16_swap_b32 v17, v59
    s_nop 1
    v_max_f32 v17, v17, v59
    v_mov_b32 v59, v17
    s_nop 1
    v_permlane32_swap_b32 v17, v59
    s_nop 1
    v_max_f32 v17, v17, v59
    v_mov_b32 v21, 0
    v_mov_b32 v59, v18
    s_nop 1
    v_permlane16_swap_b32 v18, v59
    s_nop 1
    v_max_f32 v18, v18, v59
    v_mov_b32 v59, v18
    s_nop 1
    v_permlane32_swap_b32 v18, v59
    s_nop 1
    v_max_f32 v18, v18, v59
    v_mov_b32 v22, 0
    v_mov_b32 v59, v19
    s_nop 1
    v_permlane16_swap_b32 v19, v59
    s_nop 1
    v_max_f32 v19, v19, v59
    v_mov_b32 v59, v19
    s_nop 1
    v_permlane32_swap_b32 v19, v59
    s_nop 1
    v_max_f32 v19, v19, v59
    v_mov_b32 v23, 0
    v_mov_b32 v59, v20
    s_nop 1
    v_permlane16_swap_b32 v20, v59
    s_nop 1
    v_max_f32 v20, v20, v59
    v_mov_b32 v59, v20
    s_nop 1
    v_permlane32_swap_b32 v20, v59
    s_nop 1
    v_max_f32 v20, v20, v59
    v_mov_b32 v24, 0
    v_accvgpr_write_b32 a0, 0
    v_accvgpr_write_b32 a1, 0
    v_accvgpr_write_b32 a2, 0
    v_accvgpr_write_b32 a3, 0
    v_accvgpr_write_b32 a4, 0
    v_accvgpr_write_b32 a5, 0
    v_accvgpr_write_b32 a6, 0
    v_accvgpr_write_b32 a7, 0
    v_accvgpr_write_b32 a8, 0
    v_accvgpr_write_b32 a9, 0
    v_accvgpr_write_b32 a10, 0
    v_accvgpr_write_b32 a11, 0
    v_accvgpr_write_b32 a12, 0
    v_accvgpr_write_b32 a13, 0
    v_accvgpr_write_b32 a14, 0
    v_accvgpr_write_b32 a15, 0
    v_accvgpr_write_b32 a16, 0
    v_accvgpr_write_b32 a17, 0
    v_accvgpr_write_b32 a18, 0
    v_accvgpr_write_b32 a19, 0
    v_accvgpr_write_b32 a20, 0
    v_accvgpr_write_b32 a21, 0
    v_accvgpr_write_b32 a22, 0
    v_accvgpr_write_b32 a23, 0
    v_accvgpr_write_b32 a24, 0
    v_accvgpr_write_b32 a25, 0
    v_accvgpr_write_b32 a26, 0
    v_accvgpr_write_b32 a27, 0
    v_accvgpr_write_b32 a28, 0
    v_accvgpr_write_b32 a29, 0
    v_accvgpr_write_b32 a30, 0
    v_accvgpr_write_b32 a31, 0
    v_accvgpr_write_b32 a32, 0
    v_accvgpr_write_b32 a33, 0
    v_accvgpr_write_b32 a34, 0
    v_accvgpr_write_b32 a35, 0
    v_accvgpr_write_b32 a36, 0
    v_accvgpr_write_b32 a37, 0
    v_accvgpr_write_b32 a38, 0
    v_accvgpr_write_b32 a39, 0
    v_accvgpr_write_b32 a40, 0
    v_accvgpr_write_b32 a41, 0
    v_accvgpr_write_b32 a42, 0
    v_accvgpr_write_b32 a43, 0
    v_accvgpr_write_b32 a44, 0
    v_accvgpr_write_b32 a45, 0
    v_accvgpr_write_b32 a46, 0
    v_accvgpr_write_b32 a47, 0
    v_accvgpr_write_b32 a48, 0
    v_accvgpr_write_b32 a49, 0
    v_accvgpr_write_b32 a50, 0
    v_accvgpr_write_b32 a51, 0
    v_accvgpr_write_b32 a52, 0
    v_accvgpr_write_b32 a53, 0
    v_accvgpr_write_b32 a54, 0
    v_accvgpr_write_b32 a55, 0
    v_accvgpr_write_b32 a56, 0
    v_accvgpr_write_b32 a57, 0
    v_accvgpr_write_b32 a58, 0
    v_accvgpr_write_b32 a59, 0
    v_accvgpr_write_b32 a60, 0
    v_accvgpr_write_b32 a61, 0
    v_accvgpr_write_b32 a62, 0
    v_accvgpr_write_b32 a63, 0
    v_accvgpr_write_b32 a64, 0
    v_accvgpr_write_b32 a65, 0
    v_accvgpr_write_b32 a66, 0
    v_accvgpr_write_b32 a67, 0
    v_accvgpr_write_b32 a68, 0
    v_accvgpr_write_b32 a69, 0
    v_accvgpr_write_b32 a70, 0
    v_accvgpr_write_b32 a71, 0
    v_accvgpr_write_b32 a72, 0
    v_accvgpr_write_b32 a73, 0
    v_accvgpr_write_b32 a74, 0
    v_accvgpr_write_b32 a75, 0
    v_accvgpr_write_b32 a76, 0
    v_accvgpr_write_b32 a77, 0
    v_accvgpr_write_b32 a78, 0
    v_accvgpr_write_b32 a79, 0
    v_accvgpr_write_b32 a80, 0
    v_accvgpr_write_b32 a81, 0
    v_accvgpr_write_b32 a82, 0
    v_accvgpr_write_b32 a83, 0
    v_accvgpr_write_b32 a84, 0
    v_accvgpr_write_b32 a85, 0
    v_accvgpr_write_b32 a86, 0
    v_accvgpr_write_b32 a87, 0
    v_accvgpr_write_b32 a88, 0
    v_accvgpr_write_b32 a89, 0
    v_accvgpr_write_b32 a90, 0
    v_accvgpr_write_b32 a91, 0
    v_accvgpr_write_b32 a92, 0
    v_accvgpr_write_b32 a93, 0
    v_accvgpr_write_b32 a94, 0
    v_accvgpr_write_b32 a95, 0
    v_accvgpr_write_b32 a96, 0
    v_accvgpr_write_b32 a97, 0
    v_accvgpr_write_b32 a98, 0
    v_accvgpr_write_b32 a99, 0
    v_accvgpr_write_b32 a100, 0
    v_accvgpr_write_b32 a101, 0
    v_accvgpr_write_b32 a102, 0
    v_accvgpr_write_b32 a103, 0
    v_accvgpr_write_b32 a104, 0
    v_accvgpr_write_b32 a105, 0
    v_accvgpr_write_b32 a106, 0
    v_accvgpr_write_b32 a107, 0
    v_accvgpr_write_b32 a108, 0
    v_accvgpr_write_b32 a109, 0
    v_accvgpr_write_b32 a110, 0
    v_accvgpr_write_b32 a111, 0
    v_accvgpr_write_b32 a112, 0
    v_accvgpr_write_b32 a113, 0
    v_accvgpr_write_b32 a114, 0
    v_accvgpr_write_b32 a115, 0
    v_accvgpr_write_b32 a116, 0
    v_accvgpr_write_b32 a117, 0
    v_accvgpr_write_b32 a118, 0
    v_accvgpr_write_b32 a119, 0
    v_accvgpr_write_b32 a120, 0
    v_accvgpr_write_b32 a121, 0
    v_accvgpr_write_b32 a122, 0
    v_accvgpr_write_b32 a123, 0
    v_accvgpr_write_b32 a124, 0
    v_accvgpr_write_b32 a125, 0
    v_accvgpr_write_b32 a126, 0
    v_accvgpr_write_b32 a127, 0
    s_mov_b32 s1, 0
L_redo_pv:
    s_add_u32 s0, s1, 0
    v_xor_b32 v59, 0, v56
    buffer_load_dwordx2 v[64:65], v59, s[36:39], s0 offen offset:0
    buffer_load_dwordx2 v[66:67], v59, s[36:39], s0 offen offset:32
    v_xor_b32 v59, 64, v56
    buffer_load_dwordx2 v[72:73], v59, s[36:39], s0 offen offset:0
    buffer_load_dwordx2 v[74:75], v59, s[36:39], s0 offen offset:32
    v_xor_b32 v59, 128, v56
    buffer_load_dwordx2 v[80:81], v59, s[36:39], s0 offen offset:0
    buffer_load_dwordx2 v[82:83], v59, s[36:39], s0 offen offset:32
    v_xor_b32 v59, 192, v56
    buffer_load_dwordx2 v[88:89], v59, s[36:39], s0 offen offset:0
    buffer_load_dwordx2 v[90:91], v59, s[36:39], s0 offen offset:32
    s_add_u32 s0, s1, 4096
    v_xor_b32 v59, 0, v56
    buffer_load_dwordx2 v[68:69], v59, s[36:39], s0 offen offset:0
    buffer_load_dwordx2 v[70:71], v59, s[36:39], s0 offen offset:32
    v_xor_b32 v59, 64, v56
    buffer_load_dwordx2 v[76:77], v59, s[36:39], s0 offen offset:0
    buffer_load_dwordx2 v[78:79], v59, s[36:39], s0 offen offset:32
    v_xor_b32 v59, 128, v56
    buffer_load_dwordx2 v[84:85], v59, s[36:39], s0 offen offset:0
    buffer_load_dwordx2 v[86:87], v59, s[36:39], s0 offen offset:32
    v_xor_b32 v59, 192, v56
    buffer_load_dwordx2 v[92:93], v59, s[36:39], s0 offen offset:0
    buffer_load_dwordx2 v[94:95], v59, s[36:39], s0 offen offset:32
    s_waitcnt vmcnt(0)
    v_mfma_f32_16x16x32_bf16 v[224:227], v[64:67], v[128:131], 0
    v_mfma_f32_16x16x32_bf16 v[224:227], v[72:75], v[132:135], v[224:227]
    v_mfma_f32_16x16x32_bf16 v[224:227], v[80:83], v[136:139], v[224:227]
    v_mfma_f32_16x16x32_bf16 v[224:227], v[88:91], v[140:143], v[224:227]
    v_mfma_f32_16x16x32_bf16 v[228:231], v[68:71], v[128:131], 0
    v_mfma_f32_16x16x32_bf16 v[228:231], v[76:79], v[132:135], v[228:231]
    v_mfma_f32_16x16x32_bf16 v[228:231], v[84:87], v[136:139], v[228:231]
    v_mfma_f32_16x16x32_bf16 v[228:231], v[92:95], v[140:143], v[228:231]
    v_mfma_f32_16x16x32_bf16 v[232:235], v[64:67], v[144:147], 0
    v_mfma_f32_16x16x32_bf16 v[232:235], v[72:75], v[148:151], v[232:235]
    v_mfma_f32_16x16x32_bf16 v[232:235], v[80:83], v[152:155], v[232:235]
    v_mfma_f32_16x16x32_bf16 v[232:235], v[88:91], v[156:159], v[232:235]
    v_mfma_f32_16x16x32_bf16 v[236:239], v[68:71], v[144:147], 0
    v_mfma_f32_16x16x32_bf16 v[236:239], v[76:79], v[148:151], v[236:239]
    v_mfma_f32_16x16x32_bf16 v[236:239], v[84:87], v[152:155], v[236:239]
    v_mfma_f32_16x16x32_bf16 v[236:239], v[92:95], v[156:159], v[236:239]
    v_mfma_f32_16x16x32_bf16 v[240:243], v[64:67], v[160:163], 0
    v_mfma_f32_16x16x32_bf16 v[240:243], v[72:75], v[164:167], v[240:243]
    v_mfma_f32_16x16x32_bf16 v[240:243], v[80:83], v[168:171], v[240:243]
    v_mfma_f32_16x16x32_bf16 v[240:243], v[88:91], v[172:175], v[240:243]
    v_mfma_f32_16x16x32_bf16 v[244:247], v[68:71], v[160:163], 0
    v_mfma_f32_16x16x32_bf16 v[244:247], v[76:79], v[164:167], v[244:247]
    v_mfma_f32_16x16x32_bf16 v[244:247], v[84:87], v[168:171], v[244:247]
    v_mfma_f32_16x16x32_bf16 v[244:247], v[92:95], v[172:175], v[244:247]
    v_mfma_f32_16x16x32_bf16 v[248:251], v[64:67], v[176:179], 0
    v_mfma_f32_16x16x32_bf16 v[248:251], v[72:75], v[180:183], v[248:251]
    v_mfma_f32_16x16x32_bf16 v[248:251], v[80:83], v[184:187], v[248:251]
    v_mfma_f32_16x16x32_bf16 v[248:251], v[88:91], v[188:191], v[248:251]
    v_mfma_f32_16x16x32_bf16 v[252:255], v[68:71], v[176:179], 0
    v_mfma_f32_16x16x32_bf16 v[252:255], v[76:79], v[180:183], v[252:255]
    v_mfma_f32_16x16x32_bf16 v[252:255], v[84:87], v[184:187], v[252:255]
    v_mfma_f32_16x16x32_bf16 v[252:255], v[92:95], v[188:191], v[252:255]
    s_nop 15
    v_sub_f32 v224, v224, v17
    v_sub_f32 v225, v225, v17
    v_sub_f32 v226, v226, v17
    v_sub_f32 v227, v227, v17
    v_sub_f32 v228, v228, v17
    v_sub_f32 v229, v229, v17
    v_sub_f32 v230, v230, v17
    v_sub_f32 v231, v231, v17
    v_exp_f32 v224, v224
    v_exp_f32 v225, v225
    v_exp_f32 v226, v226
    v_exp_f32 v227, v227
    v_exp_f32 v228, v228
    v_exp_f32 v229, v229
    v_exp_f32 v230, v230
    v_exp_f32 v231, v231
    s_nop 0
    v_add_f32 v21, v21, v224
    v_add_f32 v21, v21, v225
    v_add_f32 v21, v21, v226
    v_add_f32 v21, v21, v227
    v_add_f32 v21, v21, v228
    v_add_f32 v21, v21, v229
    v_add_f32 v21, v21, v230
    v_add_f32 v21, v21, v231
    v_cvt_pk_bf16_f32 v112, v224, v225
    v_cvt_pk_bf16_f32 v113, v226, v227
    v_cvt_pk_bf16_f32 v114, v228, v229
    v_cvt_pk_bf16_f32 v115, v230, v231
    v_sub_f32 v232, v232, v18
    v_sub_f32 v233, v233, v18
    v_sub_f32 v234, v234, v18
    v_sub_f32 v235, v235, v18
    v_sub_f32 v236, v236, v18
    v_sub_f32 v237, v237, v18
    v_sub_f32 v238, v238, v18
    v_sub_f32 v239, v239, v18
    v_exp_f32 v232, v232
    v_exp_f32 v233, v233
    v_exp_f32 v234, v234
    v_exp_f32 v235, v235
    v_exp_f32 v236, v236
    v_exp_f32 v237, v237
    v_exp_f32 v238, v238
    v_exp_f32 v239, v239
    s_nop 0
    v_add_f32 v22, v22, v232
    v_add_f32 v22, v22, v233
    v_add_f32 v22, v22, v234
    v_add_f32 v22, v22, v235
    v_add_f32 v22, v22, v236
    v_add_f32 v22, v22, v237
    v_add_f32 v22, v22, v238
    v_add_f32 v22, v22, v239
    v_cvt_pk_bf16_f32 v116, v232, v233
    v_cvt_pk_bf16_f32 v117, v234, v235
    v_cvt_pk_bf16_f32 v118, v236, v237
    v_cvt_pk_bf16_f32 v119, v238, v239
    v_sub_f32 v240, v240, v19
    v_sub_f32 v241, v241, v19
    v_sub_f32 v242, v242, v19
    v_sub_f32 v243, v243, v19
    v_sub_f32 v244, v244, v19
    v_sub_f32 v245, v245, v19
    v_sub_f32 v246, v246, v19
    v_sub_f32 v247, v247, v19
    v_exp_f32 v240, v240
    v_exp_f32 v241, v241
    v_exp_f32 v242, v242
    v_exp_f32 v243, v243
    v_exp_f32 v244, v244
    v_exp_f32 v245, v245
    v_exp_f32 v246, v246
    v_exp_f32 v247, v247
    s_nop 0
    v_add_f32 v23, v23, v240
    v_add_f32 v23, v23, v241
    v_add_f32 v23, v23, v242
    v_add_f32 v23, v23, v243
    v_add_f32 v23, v23, v244
    v_add_f32 v23, v23, v245
    v_add_f32 v23, v23, v246
    v_add_f32 v23, v23, v247
    v_cvt_pk_bf16_f32 v120, v240, v241
    v_cvt_pk_bf16_f32 v121, v242, v243
    v_cvt_pk_bf16_f32 v122, v244, v245
    v_cvt_pk_bf16_f32 v123, v246, v247
    v_sub_f32 v248, v248, v20
    v_sub_f32 v249, v249, v20
    v_sub_f32 v250, v250, v20
    v_sub_f32 v251, v251, v20
    v_sub_f32 v252, v252, v20
    v_sub_f32 v253, v253, v20
    v_sub_f32 v254, v254, v20
    v_sub_f32 v255, v255, v20
    v_exp_f32 v248, v248
    v_exp_f32 v249, v249
    v_exp_f32 v250, v250
    v_exp_f32 v251, v251
    v_exp_f32 v252, v252
    v_exp_f32 v253, v253
    v_exp_f32 v254, v254
    v_exp_f32 v255, v255
    s_nop 0
    v_add_f32 v24, v24, v248
    v_add_f32 v24, v24, v249
    v_add_f32 v24, v24, v250
    v_add_f32 v24, v24, v251
    v_add_f32 v24, v24, v252
    v_add_f32 v24, v24, v253
    v_add_f32 v24, v24, v254
    v_add_f32 v24, v24, v255
    v_cvt_pk_bf16_f32 v124, v248, v249
    v_cvt_pk_bf16_f32 v125, v250, v251
    v_cvt_pk_bf16_f32 v126, v252, v253
    v_cvt_pk_bf16_f32 v127, v254, v255
    s_add_u32 s0, s1, 0
    buffer_load_dwordx4 v58, s[40:43], s0 offen offset:0 lds
    s_add_u32 s0, s1, 1024
    buffer_load_dwordx4 v58, s[40:43], s0 offen offset:1024 lds
    s_add_u32 s0, s1, 2048
    buffer_load_dwordx4 v58, s[40:43], s0 offen offset:2048 lds
    s_add_u32 s0, s1, 3072
    buffer_load_dwordx4 v58, s[40:43], s0 offen offset:3072 lds
    s_waitcnt vmcnt(0)
    v_xor_b32 v59, 0, v57
    ds_read_b64_tr_b16 v[96:97], v59
    ds_read_b64_tr_b16 v[98:99], v59 offset:2048
    v_xor_b32 v59, 32, v57
    ds_read_b64_tr_b16 v[100:101], v59
    ds_read_b64_tr_b16 v[102:103], v59 offset:2048
    v_xor_b32 v59, 64, v57
    ds_read_b64_tr_b16 v[104:105], v59
    ds_read_b64_tr_b16 v[106:107], v59 offset:2048
    v_xor_b32 v59, 96, v57
    ds_read_b64_tr_b16 v[108:109], v59
    ds_read_b64_tr_b16 v[110:111], v59 offset:2048
    s_waitcnt lgkmcnt(0)
    v_mfma_f32_16x16x32_bf16 a[0:3], v[96:99], v[112:115], a[0:3]
    v_mfma_f32_16x16x32_bf16 a[4:7], v[100:103], v[112:115], a[4:7]
    v_mfma_f32_16x16x32_bf16 a[8:11], v[104:107], v[112:115], a[8:11]
    v_mfma_f32_16x16x32_bf16 a[12:15], v[108:111], v[112:115], a[12:15]
    v_mfma_f32_16x16x32_bf16 a[32:35], v[96:99], v[116:119], a[32:35]
    v_mfma_f32_16x16x32_bf16 a[36:39], v[100:103], v[116:119], a[36:39]
    v_mfma_f32_16x16x32_bf16 a[40:43], v[104:107], v[116:119], a[40:43]
    v_mfma_f32_16x16x32_bf16 a[44:47], v[108:111], v[116:119], a[44:47]
    v_mfma_f32_16x16x32_bf16 a[64:67], v[96:99], v[120:123], a[64:67]
    v_mfma_f32_16x16x32_bf16 a[68:71], v[100:103], v[120:123], a[68:71]
    v_mfma_f32_16x16x32_bf16 a[72:75], v[104:107], v[120:123], a[72:75]
    v_mfma_f32_16x16x32_bf16 a[76:79], v[108:111], v[120:123], a[76:79]
    v_mfma_f32_16x16x32_bf16 a[96:99], v[96:99], v[124:127], a[96:99]
    v_mfma_f32_16x16x32_bf16 a[100:103], v[100:103], v[124:127], a[100:103]
    v_mfma_f32_16x16x32_bf16 a[104:107], v[104:107], v[124:127], a[104:107]
    v_mfma_f32_16x16x32_bf16 a[108:111], v[108:111], v[124:127], a[108:111]
    s_add_u32 s0, s1, 128
    buffer_load_dwordx4 v58, s[40:43], s0 offen offset:0 lds
    s_add_u32 s0, s1, 1152
    buffer_load_dwordx4 v58, s[40:43], s0 offen offset:1024 lds
    s_add_u32 s0, s1, 2176
    buffer_load_dwordx4 v58, s[40:43], s0 offen offset:2048 lds
    s_add_u32 s0, s1, 3200
    buffer_load_dwordx4 v58, s[40:43], s0 offen offset:3072 lds
    s_waitcnt vmcnt(0)
    v_xor_b32 v59, 0, v57
    ds_read_b64_tr_b16 v[96:97], v59
    ds_read_b64_tr_b16 v[98:99], v59 offset:2048
    v_xor_b32 v59, 32, v57
    ds_read_b64_tr_b16 v[100:101], v59
    ds_read_b64_tr_b16 v[102:103], v59 offset:2048
    v_xor_b32 v59, 64, v57
    ds_read_b64_tr_b16 v[104:105], v59
    ds_read_b64_tr_b16 v[106:107], v59 offset:2048
    v_xor_b32 v59, 96, v57
    ds_read_b64_tr_b16 v[108:109], v59
    ds_read_b64_tr_b16 v[110:111], v59 offset:2048
    s_waitcnt lgkmcnt(0)
    v_mfma_f32_16x16x32_bf16 a[16:19], v[96:99], v[112:115], a[16:19]
    v_mfma_f32_16x16x32_bf16 a[20:23], v[100:103], v[112:115], a[20:23]
    v_mfma_f32_16x16x32_bf16 a[24:27], v[104:107], v[112:115], a[24:27]
    v_mfma_f32_16x16x32_bf16 a[28:31], v[108:111], v[112:115], a[28:31]
    v_mfma_f32_16x16x32_bf16 a[48:51], v[96:99], v[116:119], a[48:51]
    v_mfma_f32_16x16x32_bf16 a[52:55], v[100:103], v[116:119], a[52:55]
    v_mfma_f32_16x16x32_bf16 a[56:59], v[104:107], v[116:119], a[56:59]
    v_mfma_f32_16x16x32_bf16 a[60:63], v[108:111], v[116:119], a[60:63]
    v_mfma_f32_16x16x32_bf16 a[80:83], v[96:99], v[120:123], a[80:83]
    v_mfma_f32_16x16x32_bf16 a[84:87], v[100:103], v[120:123], a[84:87]
    v_mfma_f32_16x16x32_bf16 a[88:91], v[104:107], v[120:123], a[88:91]
    v_mfma_f32_16x16x32_bf16 a[92:95], v[108:111], v[120:123], a[92:95]
    v_mfma_f32_16x16x32_bf16 a[112:115], v[96:99], v[124:127], a[112:115]
    v_mfma_f32_16x16x32_bf16 a[116:119], v[100:103], v[124:127], a[116:119]
    v_mfma_f32_16x16x32_bf16 a[120:123], v[104:107], v[124:127], a[120:123]
    v_mfma_f32_16x16x32_bf16 a[124:127], v[108:111], v[124:127], a[124:127]
    s_add_u32 s1, s1, 0x2000
    s_cmp_lt_u32 s1, 0x20000
    s_cbranch_scc1 L_redo_pv
    v_mov_b32 v59, v21
    s_nop 1
    v_permlane16_swap_b32 v21, v59
    s_nop 1
    v_add_f32 v21, v21, v59
    v_mov_b32 v59, v21
    s_nop 1
    v_permlane32_swap_b32 v21, v59
    s_nop 1
    v_add_f32 v21, v21, v59
    v_rcp_f32 v21, v21
    v_mov_b32 v59, v22
    s_nop 1
    v_permlane16_swap_b32 v22, v59
    s_nop 1
    v_add_f32 v22, v22, v59
    v_mov_b32 v59, v22
    s_nop 1
    v_permlane32_swap_b32 v22, v59
    s_nop 1
    v_add_f32 v22, v22, v59
    v_rcp_f32 v22, v22
    v_mov_b32 v59, v23
    s_nop 1
    v_permlane16_swap_b32 v23, v59
    s_nop 1
    v_add_f32 v23, v23, v59
    v_mov_b32 v59, v23
    s_nop 1
    v_permlane32_swap_b32 v23, v59
    s_nop 1
    v_add_f32 v23, v23, v59
    v_rcp_f32 v23, v23
    v_mov_b32 v59, v24
    s_nop 1
    v_permlane16_swap_b32 v24, v59
    s_nop 1
    v_add_f32 v24, v24, v59
    v_mov_b32 v59, v24
    s_nop 1
    v_permlane32_swap_b32 v24, v59
    s_nop 1
    v_add_f32 v24, v24, v59
    v_rcp_f32 v24, v24
    s_nop 15
    s_branch L_redo_back
L_spin_9:
    s_mov_b32 s26, 0
L_spin_9_l:
    s_sleep 4
    buffer_load_dword v26, off, s[76:79], s92 offset:768 sc1
    s_add_u32 s26, s26, 1
    s_cmp_gt_u32 s26, 0x4000
    s_waitcnt vmcnt(0)
    s_cbranch_scc1 L_back_10
    v_cmp_gt_u32 vcc, 8, v26
    s_cbranch_vccnz L_spin_9_l
    s_branch L_back_10
L_spin_11:
    s_mov_b32 s26, 0
L_spin_11_l:
    s_sleep 4
    buffer_load_dword v26, off, s[76:79], s97 offset:512 sc1
    s_add_u32 s26, s26, 1
    s_cmp_gt_u32 s26, 0x4000
    s_waitcnt vmcnt(0)
    s_cbranch_scc1 L_back_12
    v_cmp_gt_u32 vcc, 16, v26
    s_cbranch_vccnz L_spin_11_l
    s_branch L_back_12
L_spin_13:
    s_mov_b32 s26, 0
L_spin_13_l:
    s_sleep 4
    buffer_load_dword v26, off, s[76:79], s90 offset:1280 sc1
    s_add_u32 s26, s26, 1
    s_cmp_gt_u32 s26, 0x4000
    s_waitcnt vmcnt(0)
    s_cbranch_scc1 L_back_14
    v_cmp_gt_u32 vcc, 4, v26
    s_cbranch_vccnz L_spin_13_l
    s_branch L_back_14

.section .rodata,"a"
.p2align 6
.amdhsa_kernel recurrent_scan__sliding_block_cached__mixer_s_mlp__prompt_kernel
  .amdhsa_next_free_vgpr 512
  .amdhsa_next_free_sgpr 102
  .amdhsa_accum_offset 256
  .amdhsa_group_segment_fixed_size 0
  .amdhsa_kernarg_size 104
  .amdhsa_user_sgpr_count 2
  .amdhsa_user_sgpr_kernarg_segment_ptr 1
  .amdhsa_system_sgpr_workgroup_id_x 1
  .amdhsa_float_denorm_mode_32 3
.end_amdhsa_kernel
```
